```python
import torch

def _softmax(x, axis=-1):
    return torch.softmax(x, dim=axis)
def _gelu(x):
    return torch.nn.functional.gelu(x, approximate="tanh")
def _silu(x):
    return torch.nn.functional.silu(x)
def _sigmoid(x):
    return torch.sigmoid(x)
def _layernorm(x, axis=-1, eps=1e-5):
    m = x.mean(dim=axis, keepdim=True)
    v = x.var(dim=axis, keepdim=True, unbiased=False)
    return (x - m) / torch.sqrt(v + eps)
def _scatter_add(tgt, idx, src, axis=0):
    return tgt.clone().index_add_(axis, idx, src)
def _segment_sum(src, seg, n):
    out = torch.zeros((n,) + src.shape[1:], dtype=src.dtype)
    return out.index_add_(0, seg, src)
def _pad(x, pw):
    flat = tuple(v for pair in reversed(pw) for v in pair)
    return torch.nn.functional.pad(x, flat)

kernel_name = 'standalone__mha_block_cached__near_ridge'

def setup_inputs():

    _w = (lambda a: (lambda t: t.to(torch.bfloat16) if t.is_floating_point() else t)(torch.as_tensor(a)))
    B, Sq, D = 32, 208, 512
    H, Sk, Dh = 32, 512, 128
    return {
        "x": _w((lambda *s: torch.randn(*s, dtype=torch.bfloat16) * 0.8)(B, Sq, D)),
        "k_cache": _w((lambda *s: torch.randn(*s, dtype=torch.bfloat16) * 0.8)(B, H, Sk, Dh)),
        "v_cache": _w((lambda *s: torch.randn(*s, dtype=torch.bfloat16) * 0.05)(B, H, Sk, Dh)),
        "wq": _w((lambda *s: torch.randn(*s, dtype=torch.bfloat16) * 0.8)(D, H * Dh) * (D ** -0.5)),
        "wo": _w((lambda *s: torch.randn(*s, dtype=torch.bfloat16) * 0.05)(H * Dh, D) * ((H * Dh) ** -0.5)),
    }

def reference(x, k_cache, v_cache, wq, wo):
    B, Sq, D = x.shape
    H, Dh = 32, 128
    q = (lambda x, *d: x.permute(*d))((x @ wq).reshape(B, Sq, H, Dh), 0, 2, 1, 3)
    scores = torch.einsum("bhqd,bhkd->bhqk", q, k_cache) * (Dh ** -0.5)
    p = _softmax(scores, axis=-1)
    o = torch.einsum("bhqk,bhkd->bhqd", p, v_cache)
    return (lambda x, *d: x.permute(*d))(o, 0, 2, 1, 3).reshape(B, Sq, H * Dh) @ wo
```

```asm
; @launch kernel=mha_main_kernel grid=(256,1,1) block=(256,1,1) lds=163840
; @launch kernel=mha_reduce_kernel grid=(832,1,1) block=(256,1,1) lds=8192
.amdgcn_target "amdgcn-amd-amdhsa--gfx950"

.macro Ma d,a,b
v_mfma_f32_16x16x32_bf16 v[\d:\d+3],a[\a:\a+3],a[\b:\b+3],v[\d:\d+3]
.endm
.macro Mv d,a,b
v_mfma_f32_16x16x32_bf16 v[\d:\d+3],a[\a:\a+3],v[\b:\b+3],v[\d:\d+3]
.endm
.macro Za d,a,b
v_mfma_f32_16x16x32_bf16 v[\d:\d+3],a[\a:\a+3],a[\b:\b+3],0
.endm
.macro Zv d,a,b
v_mfma_f32_16x16x32_bf16 v[\d:\d+3],a[\a:\a+3],v[\b:\b+3],0
.endm
.macro Ca d,a,b,c
v_mfma_f32_16x16x32_bf16 v[\d:\d+3],a[\a:\a+3],a[\b:\b+3],v[\c:\c+3]
.endm
.macro Cv d,a,b,c
v_mfma_f32_16x16x32_bf16 v[\d:\d+3],a[\a:\a+3],v[\b:\b+3],v[\c:\c+3]
.endm
.macro TR d,r,o
ds_read_b64_tr_b16 a[\d:\d+1],v\r offset:\o
.endm
.macro RD d,r,o
ds_read_b128 a[\d:\d+3],v\r offset:\o
.endm
.macro EX d
v_exp_f32 v\d,v\d
.endm
.macro CV d,a,b
v_cvt_pk_bf16_f32 v\d,v\a,v\b
.endm
.macro DM p,s,o
global_load_lds_dwordx4 v\p,s[\s:\s+1] offset:\o nt
.endm
.macro DW p,s,o
global_load_lds_dwordx4 v\p,s[\s:\s+1] offset:\o
.endm
.macro AW d,s
v_accvgpr_write_b32 a\d,v\s
.endm
.macro AM d,s
v_accvgpr_mov_b32 a\d,a\s
.endm
.macro MU d,s
v_mul_f32 v\d,\s,v\d
.endm
.macro LG n
s_waitcnt lgkmcnt(\n)
.endm

.text
.globl mha_main_kernel
.p2align 8
.type mha_main_kernel,@function
mha_main_kernel:
s_cmp_ge_u32 s2,256
s_cbranch_scc0 GO
s_endpgm
GO:
s_load_dwordx4 s[4:7],s[0:1],0
s_load_dwordx4 s[8:11],s[0:1],16
s_load_dwordx2 s[12:13],s[0:1],32
s_load_dwordx2 s[14:15],s[0:1],56
v_lshrrev_b32 v1,6,v0
s_nop 0
v_readfirstlane_b32 s28,v1
s_getpc_b64 s[30:31]
PCW:
s_sub_u32 s30,s30,PCW-mha_main_kernel
s_subb_u32 s31,s31,0
s_lshr_b32 s29,s2,3
s_lshl_b32 s29,s29,8
v_add_u32 v2,s29,v0
v_lshlrev_b32 v2,7,v2
v_min_u32 v2,CODE_END-mha_main_kernel-4,v2
global_load_dword a253,v2,s[30:31]
s_waitcnt lgkmcnt(0)
s_cmp_eq_u32 s28,1
s_cbranch_scc0 NX1
s_getpc_b64 s[30:31]
PC1:
s_add_u32 s30,s30,W1-PC1
s_addc_u32 s31,s31,0
s_setpc_b64 s[30:31]
NX1:
s_cmp_eq_u32 s28,2
s_cbranch_scc0 NX2
s_getpc_b64 s[30:31]
PC2:
s_add_u32 s30,s30,W2-PC2
s_addc_u32 s31,s31,0
s_setpc_b64 s[30:31]
NX2:
s_cmp_eq_u32 s28,3
s_cbranch_scc0 NX3
s_getpc_b64 s[30:31]
PC3:
s_add_u32 s30,s30,W3-PC3
s_addc_u32 s31,s31,0
s_setpc_b64 s[30:31]
NX3:
.p2align 6
W0:
s_and_b32 s28,s2,7
s_lshr_b32 s29,s2,3
s_lshr_b32 s30,s29,3
s_lshl_b32 s28,s28,2
s_add_u32 s28,s28,s30
s_and_b32 s29,s29,7
s_mul_i32 s30,s28,212992
s_add_u32 s4,s4,s30
s_addc_u32 s5,s5,0
s_lshl_b32 s30,s28,22
s_lshl_b32 s31,s29,19
s_add_u32 s30,s30,s31
s_add_u32 s30,s30,0
s_add_u32 s6,s6,s30
s_addc_u32 s7,s7,0
s_add_u32 s8,s8,s30
s_addc_u32 s9,s9,0
s_lshl_b32 s30,s29,10
s_add_u32 s30,s30,0
s_add_u32 s10,s10,s30
s_addc_u32 s11,s11,0
s_add_u32 s30,s31,0
s_add_u32 s12,s12,s30
s_addc_u32 s13,s13,0
s_lshl_b32 s30,s28,3
s_add_u32 s30,s30,s29
s_mul_i32 s30,s30,212992
s_add_u32 s14,s14,s30
s_addc_u32 s15,s15,0
s_sub_u32 s14,s14,135168
s_subb_u32 s15,s15,0
s_mov_b32 s26,0x3e0293ee
s_mov_b32 s27,0x4f800000
s_mov_b32 s20,0
v_and_b32 v255,63,v0
v_lshlrev_b32 v249,4,v255
v_add_u32 v249,135168,v249
v_bfe_u32 v0,v255,2,3
v_mul_u32_u24 v248,1056,v0
v_lshrrev_b32 v0,5,v255
v_lshlrev_b32 v0,8,v0
v_and_b32 v1,3,v255
v_lshlrev_b32 v1,3,v1
v_add3_u32 v248,v248,v0,v1
v_lshrrev_b32 v0,4,v255
v_lshlrev_b32 v0,17,v0
v_and_b32 v1,15,v255
v_lshl_add_u32 v250,v1,4,v0
v_add_u32 v251,7936,v250
v_add_u32 v252,15872,v250
v_add_u32 v253,23808,v250
s_mov_b32 s31,0x3f803f80
v_accvgpr_write_b32 a240,s31
v_accvgpr_write_b32 a241,s31
v_accvgpr_write_b32 a242,s31
v_accvgpr_write_b32 a243,s31
v_lshrrev_b32 v4,3,v255
v_lshrrev_b32 v5,1,v4
v_and_b32 v6,7,v255
v_xor_b32 v7,v5,v6
v_lshlrev_b32 v7,4,v7
v_lshl_add_u32 v108,v4,10,v7
v_xor_b32 v109,64,v108
v_add_u32 v109,8192,v109
v_and_b32 v4,15,v255
v_lshrrev_b32 v5,4,v255
v_lshrrev_b32 v6,1,v4
v_xor_b32 v7,v5,v6
v_lshlrev_b32 v7,4,v7
v_lshl_add_u32 v104,v4,7,v7
v_xor_b32 v105,64,v104
v_add_u32 v106,67584,v104
v_add_u32 v107,67584,v105
v_lshrrev_b32 v6,2,v4
v_sub_u32 v6,4,v6
v_and_b32 v6,3,v6
v_xor_b32 v7,v5,v6
v_lshlrev_b32 v7,4,v7
v_lshl_add_u32 v254,v4,6,v7
v_add_u32 v254,135168,v254
v_lshrrev_b32 v4,2,v255
v_sub_u32 v6,4,v5
v_and_b32 v6,3,v6
v_and_b32 v7,3,v255
v_xor_b32 v7,v6,v7
v_lshlrev_b32 v7,4,v7
v_lshl_add_u32 v110,v4,10,v7
s_add_u32 s40,s4,0
s_addc_u32 s41,s5,0
s_add_u32 s42,s4,16384
s_addc_u32 s43,s5,0
s_add_u32 s44,s4,32768
s_addc_u32 s45,s5,0
s_add_u32 s46,s4,196608
s_addc_u32 s47,s5,0
s_add_u32 s16,s10,0
s_addc_u32 s17,s11,0
s_mov_b32 m0,0
s_nop 0
DW 250,16,0
s_mov_b32 m0,800
s_nop 0
DW 251,16,256
s_mov_b32 m0,1600
s_nop 0
DW 252,16,512
s_mov_b32 m0,2400
s_nop 0
DW 253,16,768
s_mov_b32 m0,16896
s_nop 0
DW 108,40,0
s_mov_b32 m0,17920
s_nop 0
DW 109,40,0
s_mov_b32 m0,18944
s_nop 0
DW 108,42,0
s_mov_b32 m0,19968
s_nop 0
DW 109,42,0
s_add_u32 s40,s40,128
s_addc_u32 s41,s41,0
s_add_u32 s42,s42,128
s_addc_u32 s43,s43,0
s_mov_b32 m0,33792
s_nop 0
DW 108,44,0
s_mov_b32 m0,34816
s_nop 0
DW 109,44,0
s_add_u32 s44,s44,128
s_addc_u32 s45,s45,0
s_mov_b32 m0,135168
s_nop 0
DW 110,46,0
s_mov_b32 m0,136128
s_nop 0
DW 110,46,64
s_mov_b32 m0,137088
s_nop 0
DW 110,46,128
s_mov_b32 m0,138048
s_nop 0
DW 110,46,192
s_add_u32 s16,s10,524288
s_addc_u32 s17,s11,0
s_mov_b32 m0,50688
s_nop 0
DW 250,16,0
s_mov_b32 m0,51488
s_nop 0
DW 251,16,256
s_mov_b32 m0,52288
s_nop 0
DW 252,16,512
s_mov_b32 m0,53088
s_nop 0
DW 253,16,768
s_mov_b32 m0,67584
s_nop 0
DW 108,40,0
s_mov_b32 m0,68608
s_nop 0
DW 109,40,0
s_mov_b32 m0,69632
s_nop 0
DW 108,42,0
s_mov_b32 m0,70656
s_nop 0
DW 109,42,0
s_add_u32 s40,s40,128
s_addc_u32 s41,s41,0
s_add_u32 s42,s42,128
s_addc_u32 s43,s43,0
s_mov_b32 m0,84480
s_nop 0
DW 108,44,0
s_mov_b32 m0,85504
s_nop 0
DW 109,44,0
s_add_u32 s44,s44,128
s_addc_u32 s45,s45,0
s_add_u32 s16,s10,1048576
s_addc_u32 s17,s11,0
s_mov_b32 m0,101376
s_nop 0
DW 250,16,0
s_mov_b32 m0,102176
s_nop 0
DW 251,16,256
s_mov_b32 m0,102976
s_nop 0
DW 252,16,512
s_mov_b32 m0,103776
s_nop 0
DW 253,16,768
s_mov_b32 m0,118272
s_nop 0
DW 108,40,0
s_mov_b32 m0,119296
s_nop 0
DW 109,40,0
s_mov_b32 m0,120320
s_nop 0
DW 108,42,0
s_mov_b32 m0,121344
s_nop 0
DW 109,42,0
s_add_u32 s40,s40,128
s_addc_u32 s41,s41,0
s_add_u32 s42,s42,128
s_addc_u32 s43,s43,0
s_waitcnt vmcnt(18) lgkmcnt(0)
s_barrier
TR 192,248,0
TR 194,248,8448
TR 196,248,512
TR 198,248,8960
TR 200,248,32
TR 202,248,8480
TR 204,248,544
TR 206,248,8992
RD 0,104,16896
RD 12,105,16896
RD 4,104,18944
RD 16,105,18944
RD 8,104,33792
RD 20,105,33792
RD 224,254,0
LG 14
RD 228,254,1024
LG 0
Za 0,192,0
TR 208,248,64
v_subrev_u32 v255,135168,v249
s_mov_b32 m0,0
s_add_u32 s16,s10,1572864
s_addc_u32 s17,s11,0
Ma 0,196,12
TR 210,248,8512
v_lshrrev_b32 v255,6,v255
s_lshl_b32 s30,s20,17
s_add_u32 s38,s6,s30
s_addc_u32 s39,s7,0
Za 4,192,4
TR 212,248,576
v_lshlrev_b32 v255,11,v255
s_add_u32 s38,s38,0
s_addc_u32 s39,s39,0
s_lshl_b32 s30,s20,17
Ma 4,196,16
TR 214,248,9024
s_add_u32 s18,s10,3670272
s_addc_u32 s19,s11,0
Za 8,192,8
TR 216,248,96
Ma 8,196,20
TR 218,248,8544
Za 96,192,224
TR 220,248,608
Ma 96,196,228
TR 222,248,9056
Za 12,200,0
TR 192,248,128
Ma 12,204,12
TR 194,248,8576
Za 16,200,4
TR 196,248,640
Ma 16,204,16
TR 198,248,9088
Za 20,200,8
Ma 20,204,20
Za 100,200,224
TR 200,248,160
Ma 100,204,228
TR 202,248,8608
LG 12
Za 24,208,0
TR 204,248,672
LG 11
Ma 24,212,12
TR 206,248,9120
Za 28,208,4
Ma 28,212,16
Za 32,208,8
TR 208,248,192
Ma 32,212,20
TR 210,248,8640
LG 12
Za 36,216,0
TR 212,248,704
LG 11
Ma 36,220,12
TR 214,248,9152
Za 40,216,4
Ma 40,220,16
Za 44,216,8
TR 216,248,224
Ma 44,220,20
TR 218,248,8672
LG 12
Za 48,192,0
TR 220,248,736
LG 11
Ma 48,196,12
TR 222,248,9184
Za 52,192,4
Ma 52,196,16
Za 56,192,8
Ma 56,196,20
LG 10
Za 60,200,0
LG 8
Ma 60,204,12
Za 64,200,4
Ma 64,204,16
Za 68,200,8
Ma 68,204,20
s_waitcnt vmcnt(8) lgkmcnt(0)
s_barrier
Za 72,208,0
TR 192,248,50688
Ma 72,212,12
TR 194,248,59136
Za 76,208,4
TR 196,248,51200
Ma 76,212,16
TR 198,248,59648
Za 80,208,8
TR 200,248,50720
Ma 80,212,20
TR 202,248,59168
Za 84,216,0
TR 204,248,51232
TR 206,248,59680
Ma 84,220,12
RD 24,106,0
RD 36,107,0
Za 88,216,4
DW 108,44,0
s_mov_b32 m0,1024
Ma 88,220,16
RD 28,106,2048
RD 40,107,2048
Za 92,216,8
RD 32,106,16896
Ma 92,220,20
RD 44,107,16896
LG 5
Ma 0,192,24
DW 109,44,0
s_mov_b32 m0,16896
s_add_u32 s44,s44,128
s_addc_u32 s45,s45,0
LG 4
Ma 0,196,36
RD 232,254,2048
RD 236,254,3072
LG 5
Ma 4,192,28
DW 250,16,0
s_mov_b32 m0,17696
LG 4
Ma 4,196,40
DW 251,16,256
s_mov_b32 m0,18496
LG 3
Ma 8,192,32
TR 208,248,50752
LG 3
Ma 8,196,44
TR 210,248,59200
LG 3
Ma 96,192,232
DW 252,16,512
s_mov_b32 m0,19296
LG 2
Ma 96,196,236
TR 212,248,51264
Ma 12,200,24
TR 214,248,59712
Ma 12,204,36
DW 253,16,768
s_mov_b32 m0,33792
s_add_u32 s16,s10,2097152
s_addc_u32 s17,s11,0
Ma 16,200,28
TR 216,248,50784
Ma 16,204,40
TR 218,248,59232
Ma 20,200,32
TR 220,248,51296
Ma 20,204,44
TR 222,248,59744
Ma 100,200,232
DW 108,40,0
s_mov_b32 m0,34816
Ma 100,204,236
TR 192,248,50816
LG 7
Ma 24,208,24
TR 194,248,59264
LG 6
Ma 24,212,36
DW 109,40,0
s_mov_b32 m0,35840
s_add_u32 s40,s40,128
s_addc_u32 s41,s41,0
Ma 28,208,28
TR 196,248,51328
Ma 28,212,40
TR 198,248,59776
Ma 32,208,32
TR 200,248,50848
Ma 32,212,44
DW 108,42,0
s_mov_b32 m0,36864
LG 7
Ma 36,216,24
TR 202,248,59296
LG 6
Ma 36,220,36
TR 204,248,51360
Ma 40,216,28
TR 206,248,59808
Ma 40,220,40
DW 109,42,0
s_mov_b32 m0,50688
s_add_u32 s42,s42,128
s_addc_u32 s43,s43,0
Ma 44,216,32
TR 208,248,50880
Ma 44,220,44
TR 210,248,59328
LG 8
Ma 48,192,24
TR 212,248,51392
LG 7
Ma 48,196,36
TR 214,248,59840
Ma 52,192,28
TR 216,248,50912
Ma 52,196,40
TR 218,248,59360
Ma 56,192,32
TR 220,248,51424
Ma 56,196,44
TR 222,248,59872
v_add_u32 v248,67584,v248
LG 10
Ma 60,200,24
LG 8
Ma 60,204,36
Ma 64,200,28
Ma 64,204,40
Ma 68,200,32
Ma 68,204,44
s_waitcnt vmcnt(8) lgkmcnt(0)
s_barrier
Ma 72,208,24
TR 192,248,33792
Ma 72,212,36
TR 194,248,42240
Ma 76,208,28
TR 196,248,34304
Ma 76,212,40
TR 198,248,42752
Ma 80,208,32
TR 200,248,33824
Ma 80,212,44
TR 202,248,42272
Ma 84,216,24
TR 204,248,34336
TR 206,248,42784
Ma 84,220,36
RD 48,106,50688
RD 60,107,50688
Ma 88,216,28
DW 108,44,0
s_mov_b32 m0,51712
Ma 88,220,40
RD 52,106,52736
RD 64,107,52736
Ma 92,216,32
RD 56,104,0
Ma 92,220,44
RD 68,105,0
LG 5
Ma 0,192,48
DW 109,44,0
s_mov_b32 m0,67584
s_add_u32 s44,s44,128
s_addc_u32 s45,s45,0
LG 4
Ma 0,196,60
RD 224,254,4096
RD 228,254,5120
LG 5
Ma 4,192,52
DW 250,16,0
s_mov_b32 m0,68384
LG 4
Ma 4,196,64
DW 251,16,256
s_mov_b32 m0,69184
LG 3
Ma 8,192,56
TR 208,248,33856
LG 3
Ma 8,196,68
TR 210,248,42304
LG 3
Ma 96,192,224
DW 252,16,512
s_mov_b32 m0,69984
LG 2
Ma 96,196,228
TR 212,248,34368
Ma 12,200,48
TR 214,248,42816
Ma 12,204,60
DW 253,16,768
s_mov_b32 m0,84480
s_add_u32 s16,s10,2621440
s_addc_u32 s17,s11,0
Ma 16,200,52
TR 216,248,33888
Ma 16,204,64
TR 218,248,42336
Ma 20,200,56
TR 220,248,34400
Ma 20,204,68
TR 222,248,42848
Ma 100,200,224
DW 108,40,0
s_mov_b32 m0,85504
Ma 100,204,228
TR 192,248,33920
LG 7
Ma 24,208,48
TR 194,248,42368
LG 6
Ma 24,212,60
DW 109,40,0
s_mov_b32 m0,86528
s_add_u32 s40,s40,128
s_addc_u32 s41,s41,0
Ma 28,208,52
TR 196,248,34432
Ma 28,212,64
TR 198,248,42880
Ma 32,208,56
TR 200,248,33952
Ma 32,212,68
DW 108,42,0
s_mov_b32 m0,87552
LG 7
Ma 36,216,48
TR 202,248,42400
LG 6
Ma 36,220,60
TR 204,248,34464
Ma 40,216,52
TR 206,248,42912
Ma 40,220,64
DW 109,42,0
s_mov_b32 m0,101376
s_add_u32 s42,s42,128
s_addc_u32 s43,s43,0
Ma 44,216,56
TR 208,248,33984
Ma 44,220,68
TR 210,248,42432
LG 8
Ma 48,192,48
TR 212,248,34496
LG 7
Ma 48,196,60
TR 214,248,42944
Ma 52,192,52
TR 216,248,34016
Ma 52,196,64
TR 218,248,42464
Ma 56,192,56
TR 220,248,34528
Ma 56,196,68
TR 222,248,42976
v_add_u32 v248,4294899712,v248
LG 10
Ma 60,200,48
LG 8
Ma 60,204,60
Ma 64,200,52
Ma 64,204,64
Ma 68,200,56
Ma 68,204,68
s_waitcnt vmcnt(8) lgkmcnt(0)
s_barrier
Ma 72,208,48
TR 192,248,16896
Ma 72,212,60
TR 194,248,25344
Ma 76,208,52
TR 196,248,17408
Ma 76,212,64
TR 198,248,25856
Ma 80,208,56
TR 200,248,16928
Ma 80,212,68
TR 202,248,25376
Ma 84,216,48
TR 204,248,17440
TR 206,248,25888
Ma 84,220,60
RD 72,104,33792
RD 84,105,33792
Ma 88,216,52
DW 108,44,0
s_mov_b32 m0,102400
Ma 88,220,64
RD 76,104,35840
RD 88,105,35840
Ma 92,216,56
RD 80,104,50688
Ma 92,220,68
RD 92,105,50688
LG 5
Ma 0,192,72
DW 109,44,0
s_mov_b32 m0,118272
s_add_u32 s44,s44,128
s_addc_u32 s45,s45,0
LG 4
Ma 0,196,84
RD 232,254,6144
RD 236,254,7168
LG 5
Ma 4,192,76
DW 250,16,0
s_mov_b32 m0,119072
LG 4
Ma 4,196,88
DW 251,16,256
s_mov_b32 m0,119872
LG 3
Ma 8,192,80
TR 208,248,16960
LG 3
Ma 8,196,92
TR 210,248,25408
LG 3
Ma 96,192,232
DW 252,16,512
s_mov_b32 m0,120672
LG 2
Ma 96,196,236
TR 212,248,17472
Ma 12,200,72
TR 214,248,25920
Ma 12,204,84
DW 253,16,768
s_mov_b32 m0,0
s_add_u32 s16,s10,3145728
s_addc_u32 s17,s11,0
Ma 16,200,76
TR 216,248,16992
Ma 16,204,88
TR 218,248,25440
Ma 20,200,80
TR 220,248,17504
Ma 20,204,92
TR 222,248,25952
Ma 100,200,232
DW 108,40,0
s_mov_b32 m0,1024
Ma 100,204,236
TR 192,248,17024
LG 7
Ma 24,208,72
TR 194,248,25472
LG 6
Ma 24,212,84
DW 109,40,0
s_mov_b32 m0,2048
s_add_u32 s40,s40,128
s_addc_u32 s41,s41,0
Ma 28,208,76
TR 196,248,17536
Ma 28,212,88
TR 198,248,25984
Ma 32,208,80
TR 200,248,17056
Ma 32,212,92
DW 108,42,0
s_mov_b32 m0,3072
LG 7
Ma 36,216,72
TR 202,248,25504
LG 6
Ma 36,220,84
TR 204,248,17568
Ma 40,216,76
TR 206,248,26016
Ma 40,220,88
DW 109,42,0
s_mov_b32 m0,16896
s_add_u32 s42,s42,128
s_addc_u32 s43,s43,0
Ma 44,216,80
TR 208,248,17088
Ma 44,220,92
TR 210,248,25536
LG 8
Ma 48,192,72
TR 212,248,17600
LG 7
Ma 48,196,84
TR 214,248,26048
Ma 52,192,76
TR 216,248,17120
Ma 52,196,88
TR 218,248,25568
Ma 56,192,80
TR 220,248,17632
Ma 56,196,92
TR 222,248,26080
v_add_u32 v248,67584,v248
LG 10
Ma 60,200,72
LG 8
Ma 60,204,84
Ma 64,200,76
Ma 64,204,88
Ma 68,200,80
Ma 68,204,92
s_waitcnt vmcnt(8) lgkmcnt(0)
s_barrier
Ma 72,208,72
TR 192,248,0
Ma 72,212,84
TR 194,248,8448
Ma 76,208,76
TR 196,248,512
Ma 76,212,88
TR 198,248,8960
Ma 80,208,80
TR 200,248,32
Ma 80,212,92
TR 202,248,8480
Ma 84,216,72
TR 204,248,544
TR 206,248,8992
Ma 84,220,84
RD 96,106,16896
RD 108,107,16896
Ma 88,216,76
DW 108,44,0
s_mov_b32 m0,17920
Ma 88,220,88
RD 100,106,18944
RD 112,107,18944
Ma 92,216,80
RD 104,106,33792
Ma 92,220,92
RD 116,107,33792
LG 5
Ma 0,192,96
DW 109,44,0
s_mov_b32 m0,33792
s_add_u32 s44,s44,128
s_addc_u32 s45,s45,0
LG 4
Ma 0,196,108
RD 224,254,8192
RD 228,254,9216
LG 5
Ma 4,192,100
DW 250,16,0
s_mov_b32 m0,34592
LG 4
Ma 4,196,112
DW 251,16,256
s_mov_b32 m0,35392
LG 3
Ma 8,192,104
TR 208,248,64
LG 3
Ma 8,196,116
TR 210,248,8512
LG 3
Ma 96,192,224
DW 252,16,512
s_mov_b32 m0,36192
LG 2
Ma 96,196,228
TR 212,248,576
Ma 12,200,96
TR 214,248,9024
Ma 12,204,108
DW 253,16,768
s_mov_b32 m0,50688
s_add_u32 s16,s10,3670016
s_addc_u32 s17,s11,0
Ma 16,200,100
TR 216,248,96
Ma 16,204,112
TR 218,248,8544
Ma 20,200,104
TR 220,248,608
Ma 20,204,116
TR 222,248,9056
Ma 100,200,224
DW 108,40,0
s_mov_b32 m0,51712
Ma 100,204,228
TR 192,248,128
LG 7
Ma 24,208,96
TR 194,248,8576
LG 6
Ma 24,212,108
DW 109,40,0
s_mov_b32 m0,52736
s_add_u32 s40,s40,128
s_addc_u32 s41,s41,0
Ma 28,208,100
TR 196,248,640
Ma 28,212,112
TR 198,248,9088
Ma 32,208,104
TR 200,248,160
Ma 32,212,116
DW 108,42,0
s_mov_b32 m0,53760
LG 7
Ma 36,216,96
TR 202,248,8608
LG 6
Ma 36,220,108
TR 204,248,672
Ma 40,216,100
TR 206,248,9120
Ma 40,220,112
DW 109,42,0
s_mov_b32 m0,67584
s_add_u32 s42,s42,128
s_addc_u32 s43,s43,0
Ma 44,216,104
TR 208,248,192
Ma 44,220,116
TR 210,248,8640
LG 8
Ma 48,192,96
TR 212,248,704
LG 7
Ma 48,196,108
TR 214,248,9152
Ma 52,192,100
TR 216,248,224
Ma 52,196,112
TR 218,248,8672
Ma 56,192,104
TR 220,248,736
Ma 56,196,116
TR 222,248,9184
LG 10
Ma 60,200,96
LG 8
Ma 60,204,108
Ma 64,200,100
Ma 64,204,112
Ma 68,200,104
Ma 68,204,116
s_waitcnt vmcnt(8) lgkmcnt(0)
s_barrier
Ma 72,208,96
TR 192,248,50688
Ma 72,212,108
TR 194,248,59136
Ma 76,208,100
TR 196,248,51200
Ma 76,212,112
TR 198,248,59648
Ma 80,208,104
TR 200,248,50720
Ma 80,212,116
TR 202,248,59168
Ma 84,216,96
TR 204,248,51232
TR 206,248,59680
Ma 84,220,108
RD 120,104,0
RD 132,105,0
Ma 88,216,100
DW 108,44,0
s_mov_b32 m0,68608
Ma 88,220,112
RD 124,104,2048
RD 136,105,2048
Ma 92,216,104
RD 128,104,16896
Ma 92,220,116
RD 140,105,16896
LG 5
Ma 0,192,120
DW 109,44,0
s_mov_b32 m0,84480
s_add_u32 s44,s44,128
s_addc_u32 s45,s45,0
LG 4
Ma 0,196,132
RD 232,254,10240
RD 236,254,11264
LG 5
Ma 4,192,124
DW 250,16,0
s_mov_b32 m0,85280
LG 4
Ma 4,196,136
DW 251,16,256
s_mov_b32 m0,86080
LG 3
Ma 8,192,128
TR 208,248,50752
LG 3
Ma 8,196,140
TR 210,248,59200
LG 3
Ma 96,192,232
DW 252,16,512
s_mov_b32 m0,86880
LG 2
Ma 96,196,236
TR 212,248,51264
Ma 12,200,120
TR 214,248,59712
Ma 12,204,132
DW 253,16,768
s_mov_b32 m0,101376
s_add_u32 s16,s10,256
s_addc_u32 s17,s11,0
Ma 16,200,124
TR 216,248,50784
Ma 16,204,136
TR 218,248,59232
Ma 20,200,128
TR 220,248,51296
Ma 20,204,140
TR 222,248,59744
Ma 100,200,232
DW 108,40,0
s_mov_b32 m0,102400
Ma 100,204,236
TR 192,248,50816
LG 7
Ma 24,208,120
TR 194,248,59264
LG 6
Ma 24,212,132
DW 109,40,0
s_mov_b32 m0,103424
s_add_u32 s40,s40,128
s_addc_u32 s41,s41,0
Ma 28,208,124
TR 196,248,51328
Ma 28,212,136
TR 198,248,59776
Ma 32,208,128
TR 200,248,50848
Ma 32,212,140
DW 108,42,0
s_mov_b32 m0,104448
LG 7
Ma 36,216,120
TR 202,248,59296
LG 6
Ma 36,220,132
TR 204,248,51360
Ma 40,216,124
TR 206,248,59808
Ma 40,220,136
DW 109,42,0
s_mov_b32 m0,118272
s_add_u32 s42,s42,128
s_addc_u32 s43,s43,0
Ma 44,216,128
TR 208,248,50880
Ma 44,220,140
TR 210,248,59328
LG 8
Ma 48,192,120
TR 212,248,51392
LG 7
Ma 48,196,132
TR 214,248,59840
Ma 52,192,124
TR 216,248,50912
Ma 52,196,136
TR 218,248,59360
Ma 56,192,128
TR 220,248,51424
Ma 56,196,140
TR 222,248,59872
v_add_u32 v248,4294899712,v248
LG 10
Ma 60,200,120
LG 8
Ma 60,204,132
Ma 64,200,124
Ma 64,204,136
Ma 68,200,128
Ma 68,204,140
s_waitcnt vmcnt(8) lgkmcnt(0)
s_barrier
Ma 72,208,120
TR 192,248,33792
Ma 72,212,132
TR 194,248,42240
Ma 76,208,124
TR 196,248,34304
Ma 76,212,136
TR 198,248,42752
Ma 80,208,128
TR 200,248,33824
Ma 80,212,140
TR 202,248,42272
Ma 84,216,120
TR 204,248,34336
TR 206,248,42784
Ma 84,220,132
RD 144,104,50688
RD 156,105,50688
Ma 88,216,124
DW 108,44,0
s_mov_b32 m0,119296
Ma 88,220,136
RD 148,104,52736
RD 160,105,52736
Ma 92,216,128
RD 152,106,0
Ma 92,220,140
RD 164,107,0
LG 5
Ma 0,192,144
DW 109,44,0
s_mov_b32 m0,0
s_add_u32 s44,s44,128
s_addc_u32 s45,s45,0
LG 4
Ma 0,196,156
RD 224,254,12288
RD 228,254,13312
LG 5
Ma 4,192,148
DW 250,16,0
s_mov_b32 m0,800
LG 4
Ma 4,196,160
DW 251,16,256
s_mov_b32 m0,1600
LG 3
Ma 8,192,152
TR 208,248,33856
LG 3
Ma 8,196,164
TR 210,248,42304
LG 3
Ma 96,192,224
DW 252,16,512
s_mov_b32 m0,2400
LG 2
Ma 96,196,228
TR 212,248,34368
Ma 12,200,144
TR 214,248,42816
Ma 12,204,156
DW 253,16,768
s_add_u32 s16,s10,524544
s_addc_u32 s17,s11,0
s_mov_b32 m0,16896
Ma 16,200,148
TR 216,248,33888
Ma 16,204,160
TR 218,248,42336
Ma 20,200,152
TR 220,248,34400
Ma 20,204,164
TR 222,248,42848
Ma 100,200,224
DW 250,16,0
s_mov_b32 m0,17696
Ma 100,204,228
TR 192,248,33920
LG 7
Ma 24,208,144
TR 194,248,42368
LG 6
Ma 24,212,156
DW 251,16,256
s_mov_b32 m0,18496
Ma 28,208,148
TR 196,248,34432
Ma 28,212,160
TR 198,248,42880
Ma 32,208,152
TR 200,248,33952
Ma 32,212,164
DW 252,16,512
s_mov_b32 m0,19296
LG 7
Ma 36,216,144
TR 202,248,42400
LG 6
Ma 36,220,156
TR 204,248,34464
Ma 40,216,148
TR 206,248,42912
Ma 40,220,160
DW 253,16,768
s_add_u32 s16,s10,1048832
s_addc_u32 s17,s11,0
s_mov_b32 m0,33792
Ma 44,216,152
global_load_dword a253,v255,s[38:39]
s_add_u32 s38,s8,s30
s_addc_u32 s39,s9,0
s_add_u32 s38,s38,0
s_addc_u32 s39,s39,0
Ma 44,220,164
TR 208,248,33984
v_subrev_u32 v255,135168,v249
LG 7
Ma 48,192,144
TR 210,248,42432
v_lshrrev_b32 v255,6,v255
LG 6
Ma 48,196,156
TR 212,248,34496
v_lshlrev_b32 v255,11,v255
Ma 52,192,148
TR 214,248,42944
Ma 52,196,160
TR 216,248,34016
Ma 56,192,152
TR 218,248,42464
Ma 56,196,164
TR 220,248,34528
LG 9
Ma 60,200,144
TR 222,248,42976
v_add_u32 v248,67584,v248
LG 8
Ma 60,204,156
Ma 64,200,148
Ma 64,204,160
Ma 68,200,152
Ma 68,204,164
s_waitcnt vmcnt(9) lgkmcnt(0)
s_barrier
Ma 72,208,144
TR 192,248,16896
Ma 72,212,156
TR 194,248,25344
Ma 76,208,148
TR 196,248,17408
Ma 76,212,160
TR 198,248,25856
Ma 80,208,152
TR 200,248,16928
Ma 80,212,164
TR 202,248,25376
Ma 84,216,144
TR 204,248,17440
TR 206,248,25888
Ma 84,220,156
RD 168,106,33792
RD 180,107,33792
Ma 88,216,148
DW 250,16,0
s_mov_b32 m0,34592
Ma 88,220,160
RD 172,106,35840
RD 184,107,35840
Ma 92,216,152
RD 176,106,50688
Ma 92,220,164
RD 188,107,50688
LG 5
Ma 0,192,168
DW 251,16,256
s_mov_b32 m0,35392
LG 4
Ma 0,196,180
RD 232,254,14336
RD 236,254,15360
LG 5
Ma 4,192,172
DW 252,16,512
s_mov_b32 m0,36192
LG 4
Ma 4,196,184
DW 253,16,768
s_add_u32 s16,s10,1573120
s_addc_u32 s17,s11,0
s_mov_b32 m0,50688
LG 3
Ma 8,192,176
TR 208,248,16960
MU 0,s26
LG 3
Ma 8,196,188
TR 210,248,25408
MU 1,s26
LG 3
Ma 96,192,232
DW 250,16,0
s_mov_b32 m0,51488
LG 2
Ma 96,196,236
TR 212,248,17472
MU 2,s26
Ma 12,200,168
TR 214,248,25920
MU 3,s26
Ma 12,204,180
DW 251,16,256
s_mov_b32 m0,52288
Ma 16,200,172
TR 216,248,16992
CV 0,0,1
Ma 16,204,184
TR 218,248,25440
CV 1,2,3
Ma 20,200,176
TR 220,248,17504
MU 12,s26
Ma 20,204,188
TR 222,248,25952
MU 13,s26
Ma 100,200,232
DW 252,16,512
s_mov_b32 m0,53088
Ma 100,204,236
TR 192,248,17024
MU 14,s26
LG 7
Ma 24,208,168
TR 194,248,25472
MU 15,s26
LG 6
Ma 24,212,180
DW 253,16,768
s_add_u32 s16,s10,2097408
s_addc_u32 s17,s11,0
s_mov_b32 m0,67584
Ma 28,208,172
TR 196,248,17536
CV 2,12,13
Ma 28,212,184
TR 198,248,25984
CV 3,14,15
Ma 32,208,176
TR 200,248,17056
v_permlane32_swap_b32 v0,v2
Ma 32,212,188
DW 250,16,0
s_mov_b32 m0,68384
LG 7
Ma 36,216,168
TR 202,248,25504
v_permlane32_swap_b32 v1,v3
LG 6
Ma 36,220,180
TR 204,248,17568
v_permlane16_swap_b32 v0,v2
Ma 40,216,172
TR 206,248,26016
v_permlane16_swap_b32 v1,v3
Ma 40,220,184
DW 251,16,256
s_mov_b32 m0,69184
Ma 44,216,176
TR 208,248,17088
MU 4,s26
Ma 44,220,188
TR 210,248,25536
MU 5,s26
LG 8
Ma 48,192,168
TR 212,248,17600
MU 6,s26
LG 7
Ma 48,196,180
DW 252,16,512
s_mov_b32 m0,69984
Ma 52,192,172
TR 214,248,26048
MU 7,s26
Ma 52,196,184
TR 216,248,17120
MU 16,s26
Ma 56,192,176
TR 218,248,25568
MU 17,s26
Ma 56,196,188
DW 253,16,768
s_add_u32 s16,s10,2621696
s_addc_u32 s17,s11,0
s_mov_b32 m0,84480
LG 8
Ma 60,200,168
global_load_dword a253,v255,s[38:39]
LG 6
Ma 60,204,180
TR 220,248,17632
TR 222,248,26080
Ma 64,200,172
v_add_u32 v248,4294899712,v248
MU 18,s26
Ma 64,204,184
MU 19,s26
CV 4,4,5
Ma 68,200,176
CV 5,6,7
CV 6,16,17
Ma 68,204,188
CV 7,18,19
v_permlane32_swap_b32 v4,v6
s_waitcnt vmcnt(14) lgkmcnt(0)
s_barrier
Ma 72,208,168
TR 192,248,0
v_permlane32_swap_b32 v5,v7
Ma 72,212,180
TR 194,248,8448
v_permlane16_swap_b32 v4,v6
Ma 76,208,172
TR 196,248,512
v_permlane16_swap_b32 v5,v7
Ma 76,212,184
TR 198,248,8960
MU 8,s26
Ma 80,208,176
TR 200,248,16896
MU 9,s26
Ma 80,212,188
TR 202,248,25344
MU 10,s26
Ma 84,216,168
TR 204,248,17408
TR 206,248,25856
Ma 84,220,180
RD 224,254,0
RD 228,254,1024
Ma 88,216,172
RD 232,254,2048
RD 236,254,3072
Ma 88,220,184
DW 250,16,0
s_mov_b32 m0,85280
Ma 92,216,176
DW 251,16,256
s_mov_b32 m0,86080
Ma 92,220,188
DW 252,16,512
s_mov_b32 m0,86880
s_nop 0
DW 253,16,768
s_add_u32 s16,s10,3145984
s_addc_u32 s17,s11,0
MU 11,s26
MU 20,s26
MU 21,s26
MU 22,s26
MU 23,s26
CV 8,8,9
CV 9,10,11
CV 10,20,21
CV 11,22,23
s_nop 0
v_permlane32_swap_b32 v8,v10
v_permlane32_swap_b32 v9,v11
s_nop 0
v_permlane16_swap_b32 v8,v10
v_permlane16_swap_b32 v9,v11
MU 24,s26
MU 25,s26
MU 26,s26
MU 27,s26
MU 36,s26
MU 37,s26
MU 38,s26
MU 39,s26
CV 24,24,25
CV 25,26,27
CV 26,36,37
CV 27,38,39
s_nop 0
v_permlane32_swap_b32 v24,v26
v_permlane32_swap_b32 v25,v27
s_nop 0
v_permlane16_swap_b32 v24,v26
v_permlane16_swap_b32 v25,v27
MU 28,s26
MU 29,s26
MU 30,s26
MU 31,s26
MU 40,s26
MU 41,s26
MU 42,s26
MU 43,s26
CV 28,28,29
CV 29,30,31
CV 30,40,41
CV 31,42,43
s_nop 0
v_permlane32_swap_b32 v28,v30
v_permlane32_swap_b32 v29,v31
s_nop 0
v_permlane16_swap_b32 v28,v30
v_permlane16_swap_b32 v29,v31
MU 32,s26
MU 33,s26
MU 34,s26
MU 35,s26
MU 44,s26
MU 45,s26
MU 46,s26
MU 47,s26
CV 32,32,33
CV 33,34,35
CV 34,44,45
CV 35,46,47
s_nop 0
v_permlane32_swap_b32 v32,v34
v_permlane32_swap_b32 v33,v35
s_nop 0
v_permlane16_swap_b32 v32,v34
v_permlane16_swap_b32 v33,v35
v_pk_mul_f32 v[48:49],v[48:49],s[26:27] op_sel_hi:[1,0]
v_pk_mul_f32 v[50:51],v[50:51],s[26:27] op_sel_hi:[1,0]
v_pk_mul_f32 v[60:61],v[60:61],s[26:27] op_sel_hi:[1,0]
v_pk_mul_f32 v[62:63],v[62:63],s[26:27] op_sel_hi:[1,0]
CV 48,48,49
CV 49,50,51
CV 50,60,61
CV 51,62,63
s_nop 0
v_permlane32_swap_b32 v48,v50
v_permlane32_swap_b32 v49,v51
s_nop 0
v_permlane16_swap_b32 v48,v50
v_permlane16_swap_b32 v49,v51
v_pk_mul_f32 v[52:53],v[52:53],s[26:27] op_sel_hi:[1,0]
v_pk_mul_f32 v[54:55],v[54:55],s[26:27] op_sel_hi:[1,0]
v_pk_mul_f32 v[64:65],v[64:65],s[26:27] op_sel_hi:[1,0]
v_pk_mul_f32 v[66:67],v[66:67],s[26:27] op_sel_hi:[1,0]
CV 52,52,53
CV 53,54,55
CV 54,64,65
CV 55,66,67
s_nop 0
v_permlane32_swap_b32 v52,v54
v_permlane32_swap_b32 v53,v55
s_nop 0
v_permlane16_swap_b32 v52,v54
v_permlane16_swap_b32 v53,v55
v_pk_mul_f32 v[56:57],v[56:57],s[26:27] op_sel_hi:[1,0]
v_pk_mul_f32 v[58:59],v[58:59],s[26:27] op_sel_hi:[1,0]
v_pk_mul_f32 v[68:69],v[68:69],s[26:27] op_sel_hi:[1,0]
v_pk_mul_f32 v[70:71],v[70:71],s[26:27] op_sel_hi:[1,0]
CV 56,56,57
CV 57,58,59
CV 58,68,69
CV 59,70,71
s_nop 0
v_permlane32_swap_b32 v56,v58
v_permlane32_swap_b32 v57,v59
s_nop 0
v_permlane16_swap_b32 v56,v58
v_permlane16_swap_b32 v57,v59
v_pk_mul_f32 v[72:73],v[72:73],s[26:27] op_sel_hi:[1,0]
v_pk_mul_f32 v[74:75],v[74:75],s[26:27] op_sel_hi:[1,0]
v_pk_mul_f32 v[84:85],v[84:85],s[26:27] op_sel_hi:[1,0]
v_pk_mul_f32 v[86:87],v[86:87],s[26:27] op_sel_hi:[1,0]
CV 72,72,73
CV 73,74,75
CV 74,84,85
CV 75,86,87
s_nop 0
v_permlane32_swap_b32 v72,v74
v_permlane32_swap_b32 v73,v75
s_nop 0
v_permlane16_swap_b32 v72,v74
v_permlane16_swap_b32 v73,v75
v_pk_mul_f32 v[76:77],v[76:77],s[26:27] op_sel_hi:[1,0]
v_pk_mul_f32 v[78:79],v[78:79],s[26:27] op_sel_hi:[1,0]
v_pk_mul_f32 v[88:89],v[88:89],s[26:27] op_sel_hi:[1,0]
v_pk_mul_f32 v[90:91],v[90:91],s[26:27] op_sel_hi:[1,0]
CV 76,76,77
CV 77,78,79
CV 78,88,89
CV 79,90,91
s_nop 0
v_permlane32_swap_b32 v76,v78
v_permlane32_swap_b32 v77,v79
s_nop 0
v_permlane16_swap_b32 v76,v78
v_permlane16_swap_b32 v77,v79
v_pk_mul_f32 v[80:81],v[80:81],s[26:27] op_sel_hi:[1,0]
v_pk_mul_f32 v[82:83],v[82:83],s[26:27] op_sel_hi:[1,0]
v_pk_mul_f32 v[92:93],v[92:93],s[26:27] op_sel_hi:[1,0]
v_pk_mul_f32 v[94:95],v[94:95],s[26:27] op_sel_hi:[1,0]
CV 80,80,81
CV 81,82,83
CV 82,92,93
CV 83,94,95
s_nop 0
v_permlane32_swap_b32 v80,v82
v_permlane32_swap_b32 v81,v83
s_nop 0
v_permlane16_swap_b32 v80,v82
v_permlane16_swap_b32 v81,v83
MU 96,s26
MU 97,s26
MU 98,s26
MU 99,s26
MU 100,s26
MU 101,s26
MU 102,s26
MU 103,s26
CV 96,96,97
CV 97,98,99
CV 98,100,101
CV 99,102,103
s_nop 0
v_permlane32_swap_b32 v96,v98
v_permlane32_swap_b32 v97,v99
s_nop 0
v_permlane16_swap_b32 v96,v98
v_permlane16_swap_b32 v97,v99
ds_write_b128 v249,v[96:99] offset:16384
v_mov_b32 v104,v0
v_mov_b32 v105,v1
v_mov_b32 v106,v2
v_mov_b32 v107,v3
v_mov_b32 v108,v4
v_mov_b32 v109,v5
v_mov_b32 v110,v6
v_mov_b32 v111,v7
v_mov_b32 v112,v8
v_mov_b32 v113,v9
v_mov_b32 v114,v10
v_mov_b32 v115,v11
v_mov_b32 v116,v24
v_mov_b32 v117,v25
v_mov_b32 v118,v26
v_mov_b32 v119,v27
v_mov_b32 v120,v28
v_mov_b32 v121,v29
v_mov_b32 v122,v30
v_mov_b32 v123,v31
v_mov_b32 v124,v32
v_mov_b32 v125,v33
v_mov_b32 v126,v34
v_mov_b32 v127,v35
v_mov_b32 v128,v48
v_mov_b32 v129,v49
v_mov_b32 v130,v50
v_mov_b32 v131,v51
v_mov_b32 v132,v52
v_mov_b32 v133,v53
v_mov_b32 v134,v54
v_mov_b32 v135,v55
v_mov_b32 v136,v56
v_mov_b32 v137,v57
v_mov_b32 v138,v58
v_mov_b32 v139,v59
v_mov_b32 v140,v72
v_mov_b32 v141,v73
v_mov_b32 v142,v74
v_mov_b32 v143,v75
v_mov_b32 v144,v76
v_mov_b32 v145,v77
v_mov_b32 v146,v78
v_mov_b32 v147,v79
v_mov_b32 v148,v80
v_mov_b32 v149,v81
v_mov_b32 v150,v82
v_mov_b32 v151,v83
s_add_u32 s10,s10,256
s_addc_u32 s11,s11,0
s_add_u32 s20,s20,1
LA_w0:
LG 0
Za 0,192,0
s_mov_b32 m0,101376
TR 208,248,32
v_subrev_u32 v255,135168,v249
s_lshl_b32 s30,s20,17
Ma 0,196,12
DW 250,16,0
s_mov_b32 m0,102176
s_add_u32 s38,s6,s30
s_addc_u32 s39,s7,0
s_add_u32 s38,s38,0
s_addc_u32 s39,s39,0
Ma 0,200,24
TR 210,248,8480
v_lshrrev_b32 v255,6,v255
s_lshl_b32 s30,s20,17
Ma 0,204,36
TR 212,248,544
v_lshlrev_b32 v255,11,v255
Za 4,192,4
TR 214,248,8992
Ma 4,196,16
TR 216,248,16928
Ma 4,200,28
TR 218,248,25376
Ma 4,204,40
TR 220,248,17440
Za 8,192,8
TR 222,248,25888
Ma 8,196,20
Ma 8,200,32
Ma 8,204,44
DW 251,16,256
s_mov_b32 m0,102976
Za 96,192,224
TR 192,248,64
Ma 96,196,228
TR 194,248,8512
Ma 96,200,232
TR 196,248,576
Ma 96,204,236
TR 198,248,9024
LG 10
Za 12,208,0
TR 200,248,16960
LG 9
Ma 12,212,12
TR 202,248,25408
LG 8
Ma 12,216,24
TR 204,248,17472
LG 7
Ma 12,220,36
TR 206,248,25920
Za 16,208,4
Ma 16,212,16
DW 252,16,512
s_mov_b32 m0,103776
Ma 16,216,28
Ma 16,220,40
Za 20,208,8
Ma 20,212,20
Ma 20,216,32
Ma 20,220,44
Za 100,208,224
TR 208,248,96
Ma 100,212,228
TR 210,248,8544
Ma 100,216,232
TR 212,248,608
Ma 100,220,236
DW 253,16,768
s_mov_b32 m0,118272
s_add_u32 s16,s10,256
s_addc_u32 s17,s11,0
LG 9
Za 24,192,0
TR 214,248,9056
LG 8
Ma 24,196,12
TR 216,248,16992
LG 7
Ma 24,200,24
TR 218,248,25440
LG 6
Ma 24,204,36
TR 220,248,17504
Za 28,192,4
TR 222,248,25952
Ma 28,196,16
Ma 28,200,28
Ma 28,204,40
Za 32,192,8
TR 192,248,128
Ma 32,196,20
DW 250,18,0
s_mov_b32 m0,119072
Ma 32,200,32
TR 194,248,8576
Ma 32,204,44
TR 196,248,640
LG 9
Za 36,208,0
TR 198,248,9088
LG 8
Ma 36,212,12
TR 200,248,17024
LG 7
Ma 36,216,24
TR 202,248,25472
LG 6
Ma 36,220,36
TR 204,248,17536
Za 40,208,4
TR 206,248,25984
Ma 40,212,16
Ma 40,216,28
Ma 40,220,40
DW 251,18,256
s_mov_b32 m0,119872
Za 44,208,8
TR 208,248,160
Ma 44,212,20
TR 210,248,8608
Ma 44,216,32
TR 212,248,672
Ma 44,220,44
TR 214,248,9120
LG 10
Za 48,192,0
TR 216,248,17056
LG 9
Ma 48,196,12
TR 218,248,25504
LG 8
Ma 48,200,24
TR 220,248,17568
LG 7
Ma 48,204,36
TR 222,248,26016
Za 52,192,4
Ma 52,196,16
DW 252,18,512
s_mov_b32 m0,120672
Ma 52,200,28
Ma 52,204,40
Za 56,192,8
TR 192,248,192
Ma 56,196,20
TR 194,248,8640
Ma 56,200,32
TR 196,248,704
Ma 56,204,44
TR 198,248,9152
LG 10
Za 60,208,0
TR 200,248,17088
LG 9
Ma 60,212,12
TR 202,248,25536
LG 8
Ma 60,216,24
TR 204,248,17600
LG 7
Ma 60,220,36
DW 253,18,768
s_mov_b32 m0,0
s_add_u32 s18,s10,524544
s_addc_u32 s19,s11,0
Za 64,208,4
TR 206,248,26048
Ma 64,212,16
Ma 64,216,28
Ma 64,220,40
Za 68,208,8
TR 208,248,224
Ma 68,212,20
TR 210,248,8672
Ma 68,216,32
TR 212,248,736
Ma 68,220,44
TR 214,248,9184
LG 10
Za 72,192,0
TR 216,248,17120
LG 9
Ma 72,196,12
TR 218,248,25568
LG 8
Ma 72,200,24
TR 220,248,17632
LG 7
Ma 72,204,36
TR 222,248,26080
Za 76,192,4
Ma 76,196,16
Ma 76,200,28
Ma 76,204,40
Za 80,192,8
Ma 80,196,20
Ma 80,200,32
Ma 80,204,44
LG 6
Za 84,208,0
LG 4
Ma 84,212,12
LG 2
Ma 84,216,24
LG 0
Ma 84,220,36
s_waitcnt vmcnt(17) lgkmcnt(0)
s_barrier
Za 88,208,4
TR 192,248,33792
Ma 88,212,16
TR 194,248,42240
Ma 88,216,28
TR 196,248,34304
Ma 88,220,40
TR 198,248,42752
Za 92,208,8
TR 200,248,50688
TR 202,248,59136
Ma 92,212,20
TR 204,248,51200
TR 206,248,59648
Ma 92,216,32
DW 250,16,0
s_mov_b32 m0,800
Ma 92,220,44
RD 224,254,4096
LG 7
Ma 0,192,48
RD 228,254,5120
LG 6
Ma 0,196,60
RD 232,254,6144
LG 5
Ma 0,200,72
RD 236,254,7168
LG 4
Ma 0,204,84
TR 208,248,33824
Ma 4,192,52
TR 210,248,42272
Ma 4,196,64
DW 251,16,256
s_mov_b32 m0,1600
Ma 4,200,76
TR 212,248,34336
Ma 4,204,88
TR 214,248,42784
Ma 8,192,56
TR 216,248,50720
Ma 8,196,68
TR 218,248,59168
Ma 8,200,80
TR 220,248,51232
Ma 8,204,92
TR 222,248,59680
LG 11
Ma 96,192,224
TR 192,248,33856
LG 11
Ma 96,196,228
TR 194,248,42304
LG 11
Ma 96,200,232
TR 196,248,34368
LG 11
Ma 96,204,236
TR 198,248,42816
LG 10
Ma 12,208,48
DW 252,16,512
s_mov_b32 m0,2400
LG 8
Ma 12,212,60
TR 200,248,50752
LG 7
Ma 12,216,72
TR 202,248,59200
LG 6
Ma 12,220,84
TR 204,248,51264
Ma 16,208,52
TR 206,248,59712
Ma 16,212,64
Ma 16,216,76
Ma 16,220,88
Ma 20,208,56
Ma 20,212,68
Ma 20,216,80
Ma 20,220,92
DW 253,16,768
s_mov_b32 m0,16896
s_add_u32 s16,s10,1048832
s_addc_u32 s17,s11,0
Ma 100,208,224
TR 208,248,33888
Ma 100,212,228
TR 210,248,42336
Ma 100,216,232
TR 212,248,34400
Ma 100,220,236
TR 214,248,42848
LG 10
Ma 24,192,48
TR 216,248,50784
LG 9
Ma 24,196,60
TR 218,248,59232
LG 8
Ma 24,200,72
TR 220,248,51296
LG 7
Ma 24,204,84
TR 222,248,59744
Ma 28,192,52
Ma 28,196,64
Ma 28,200,76
DW 250,18,0
s_mov_b32 m0,17696
Ma 28,204,88
Ma 32,192,56
TR 192,248,33920
Ma 32,196,68
TR 194,248,42368
Ma 32,200,80
TR 196,248,34432
Ma 32,204,92
TR 198,248,42880
LG 10
Ma 36,208,48
TR 200,248,50816
LG 9
Ma 36,212,60
TR 202,248,59264
LG 8
Ma 36,216,72
TR 204,248,51328
LG 7
Ma 36,220,84
TR 206,248,59776
Ma 40,208,52
Ma 40,212,64
DW 251,18,256
s_mov_b32 m0,18496
Ma 40,216,76
Ma 40,220,88
Ma 44,208,56
TR 208,248,33952
Ma 44,212,68
TR 210,248,42400
Ma 44,216,80
TR 212,248,34464
Ma 44,220,92
TR 214,248,42912
LG 10
Ma 48,192,48
TR 216,248,50848
LG 9
Ma 48,196,60
TR 218,248,59296
LG 8
Ma 48,200,72
TR 220,248,51360
LG 7
Ma 48,204,84
TR 222,248,59808
Ma 52,192,52
DW 252,18,512
s_mov_b32 m0,19296
Ma 52,196,64
Ma 52,200,76
Ma 52,204,88
Ma 56,192,56
TR 192,248,33984
Ma 56,196,68
TR 194,248,42432
Ma 56,200,80
TR 196,248,34496
Ma 56,204,92
TR 198,248,42944
LG 10
Ma 60,208,48
TR 200,248,50880
LG 9
Ma 60,212,60
TR 202,248,59328
LG 8
Ma 60,216,72
TR 204,248,51392
LG 7
Ma 60,220,84
DW 253,18,768
s_mov_b32 m0,33792
s_add_u32 s18,s10,1573120
s_addc_u32 s19,s11,0
Ma 64,208,52
global_load_dword a253,v255,s[38:39]
s_add_u32 s38,s8,s30
s_addc_u32 s39,s9,0
s_add_u32 s38,s38,0
s_addc_u32 s39,s39,0
Ma 64,212,64
TR 206,248,59840
v_subrev_u32 v255,135168,v249
Ma 64,216,76
v_lshrrev_b32 v255,6,v255
v_lshlrev_b32 v255,11,v255
Ma 64,220,88
Ma 68,208,56
TR 208,248,34016
Ma 68,212,68
TR 210,248,42464
Ma 68,216,80
TR 212,248,34528
Ma 68,220,92
TR 214,248,42976
LG 10
Ma 72,192,48
TR 216,248,50912
LG 9
Ma 72,196,60
TR 218,248,59360
LG 8
Ma 72,200,72
TR 220,248,51424
LG 7
Ma 72,204,84
TR 222,248,59872
v_add_u32 v248,67584,v248
Ma 76,192,52
Ma 76,196,64
Ma 76,200,76
Ma 76,204,88
Ma 80,192,56
Ma 80,196,68
Ma 80,200,80
Ma 80,204,92
LG 6
Ma 84,208,48
LG 4
Ma 84,212,60
LG 2
Ma 84,216,72
LG 0
Ma 84,220,84
s_waitcnt vmcnt(17) lgkmcnt(0)
s_barrier
Ma 88,208,52
TR 192,248,0
Ma 88,212,64
TR 194,248,8448
Ma 88,216,76
TR 196,248,512
Ma 88,220,88
TR 198,248,8960
Ma 92,208,56
TR 200,248,16896
TR 202,248,25344
Ma 92,212,68
TR 204,248,17408
TR 206,248,25856
Ma 92,216,80
DW 250,16,0
s_mov_b32 m0,34592
Ma 92,220,92
RD 224,254,8192
LG 7
Ma 0,192,96
RD 228,254,9216
LG 6
Ma 0,196,108
RD 232,254,10240
LG 5
Ma 0,200,120
RD 236,254,11264
LG 4
Ma 0,204,132
TR 208,248,32
Ma 4,192,100
TR 210,248,8480
Ma 4,196,112
DW 251,16,256
s_mov_b32 m0,35392
Ma 4,200,124
TR 212,248,544
Ma 4,204,136
TR 214,248,8992
Ma 8,192,104
TR 216,248,16928
Ma 8,196,116
TR 218,248,25376
Ma 8,200,128
TR 220,248,17440
Ma 8,204,140
TR 222,248,25888
LG 11
Ma 96,192,224
TR 192,248,64
LG 11
Ma 96,196,228
TR 194,248,8512
LG 11
Ma 96,200,232
TR 196,248,576
LG 11
Ma 96,204,236
TR 198,248,9024
LG 10
Ma 12,208,96
DW 252,16,512
s_mov_b32 m0,36192
LG 8
Ma 12,212,108
TR 200,248,16960
LG 7
Ma 12,216,120
TR 202,248,25408
LG 6
Ma 12,220,132
TR 204,248,17472
Ma 16,208,100
TR 206,248,25920
Ma 16,212,112
Ma 16,216,124
Ma 16,220,136
Ma 20,208,104
Ma 20,212,116
Ma 20,216,128
Ma 20,220,140
DW 253,16,768
s_mov_b32 m0,50688
s_add_u32 s16,s10,2097408
s_addc_u32 s17,s11,0
Ma 100,208,224
TR 208,248,96
Ma 100,212,228
TR 210,248,8544
Ma 100,216,232
TR 212,248,608
Ma 100,220,236
TR 214,248,9056
LG 10
Ma 24,192,96
TR 216,248,16992
LG 9
Ma 24,196,108
TR 218,248,25440
LG 8
Ma 24,200,120
TR 220,248,17504
LG 7
Ma 24,204,132
TR 222,248,25952
Ma 28,192,100
Ma 28,196,112
Ma 28,200,124
DW 250,18,0
s_mov_b32 m0,51488
Ma 28,204,136
Ma 32,192,104
TR 192,248,128
Ma 32,196,116
TR 194,248,8576
Ma 32,200,128
TR 196,248,640
Ma 32,204,140
TR 198,248,9088
LG 10
Ma 36,208,96
TR 200,248,17024
LG 9
Ma 36,212,108
TR 202,248,25472
LG 8
Ma 36,216,120
TR 204,248,17536
LG 7
Ma 36,220,132
TR 206,248,25984
Ma 40,208,100
Ma 40,212,112
DW 251,18,256
s_mov_b32 m0,52288
Ma 40,216,124
Ma 40,220,136
Ma 44,208,104
TR 208,248,160
Ma 44,212,116
TR 210,248,8608
Ma 44,216,128
TR 212,248,672
Ma 44,220,140
TR 214,248,9120
LG 10
Ma 48,192,96
TR 216,248,17056
LG 9
Ma 48,196,108
TR 218,248,25504
LG 8
Ma 48,200,120
TR 220,248,17568
LG 7
Ma 48,204,132
TR 222,248,26016
Ma 52,192,100
DW 252,18,512
s_mov_b32 m0,53088
Ma 52,196,112
Ma 52,200,124
Ma 52,204,136
Ma 56,192,104
TR 192,248,192
Ma 56,196,116
TR 194,248,8640
Ma 56,200,128
TR 196,248,704
Ma 56,204,140
TR 198,248,9152
LG 10
Ma 60,208,96
TR 200,248,17088
LG 9
Ma 60,212,108
TR 202,248,25536
LG 8
Ma 60,216,120
TR 204,248,17600
LG 7
Ma 60,220,132
DW 253,18,768
s_mov_b32 m0,67584
s_add_u32 s18,s10,2621696
s_addc_u32 s19,s11,0
Ma 64,208,100
global_load_dword a253,v255,s[38:39]
Ma 64,212,112
TR 206,248,26048
Ma 64,216,124
Ma 64,220,136
Ma 68,208,104
TR 208,248,224
Ma 68,212,116
TR 210,248,8672
Ma 68,216,128
TR 212,248,736
Ma 68,220,140
TR 214,248,9184
LG 10
Ma 72,192,96
TR 216,248,17120
LG 9
Ma 72,196,108
TR 218,248,25568
LG 8
Ma 72,200,120
TR 220,248,17632
LG 7
Ma 72,204,132
TR 222,248,26080
Ma 76,192,100
Ma 76,196,112
Ma 76,200,124
Ma 76,204,136
Ma 80,192,104
Ma 80,196,116
Ma 80,200,128
Ma 80,204,140
LG 6
Ma 84,208,96
LG 4
Ma 84,212,108
LG 2
Ma 84,216,120
LG 0
Ma 84,220,132
s_waitcnt vmcnt(18) lgkmcnt(0)
s_barrier
Ma 88,208,100
TR 192,248,33792
Ma 88,212,112
TR 194,248,42240
Ma 88,216,124
TR 196,248,34304
Ma 88,220,136
TR 198,248,42752
Ma 92,208,104
TR 200,248,50688
TR 202,248,59136
Ma 92,212,116
TR 204,248,51200
TR 206,248,59648
Ma 92,216,128
DW 250,16,0
s_mov_b32 m0,68384
Ma 92,220,140
RD 224,254,12288
LG 7
Ma 0,192,144
RD 228,254,13312
LG 6
Ma 0,196,156
RD 232,254,14336
LG 5
Ma 0,200,168
RD 236,254,15360
LG 4
Ma 0,204,180
TR 208,248,33824
Ma 4,192,148
TR 210,248,42272
Ma 4,196,160
DW 251,16,256
s_mov_b32 m0,69184
Ma 4,200,172
TR 212,248,34336
s_nop 0
MU 0,s26
Ma 4,204,184
TR 214,248,42784
MU 1,s26
Ma 8,192,152
TR 216,248,50720
MU 2,s26
Ma 8,196,164
TR 218,248,59168
MU 3,s26
Ma 8,200,176
TR 220,248,51232
CV 0,0,1
Ma 8,204,188
TR 222,248,59680
CV 1,2,3
LG 11
Ma 96,192,224
TR 192,248,33856
MU 4,s26
LG 11
Ma 96,196,228
TR 194,248,42304
MU 5,s26
LG 11
Ma 96,200,232
TR 196,248,34368
MU 6,s26
LG 11
Ma 96,204,236
TR 198,248,42816
MU 7,s26
LG 10
Ma 12,208,144
DW 252,16,512
s_mov_b32 m0,69984
LG 8
Ma 12,212,156
TR 200,248,50752
CV 4,4,5
LG 7
Ma 12,216,168
TR 202,248,59200
CV 5,6,7
LG 6
Ma 12,220,180
TR 204,248,51264
MU 8,s26
Ma 16,208,148
TR 206,248,59712
MU 9,s26
Ma 16,212,160
MU 10,s26
MU 11,s26
Ma 16,216,172
MU 12,s26
MU 13,s26
Ma 16,220,184
MU 14,s26
MU 15,s26
Ma 20,208,152
CV 2,12,13
CV 3,14,15
Ma 20,212,164
v_permlane32_swap_b32 v0,v2
v_permlane32_swap_b32 v1,v3
Ma 20,216,176
v_permlane16_swap_b32 v0,v2
v_permlane16_swap_b32 v1,v3
Ma 20,220,188
DW 253,16,768
s_mov_b32 m0,84480
s_add_u32 s16,s10,3145984
s_addc_u32 s17,s11,0
Ma 100,208,224
TR 208,248,33888
MU 16,s26
Ma 100,212,228
TR 210,248,42336
MU 17,s26
Ma 100,216,232
TR 212,248,34400
MU 18,s26
Ma 100,220,236
TR 214,248,42848
MU 19,s26
LG 10
Ma 24,192,144
TR 216,248,50784
CV 6,16,17
LG 9
Ma 24,196,156
TR 218,248,59232
CV 7,18,19
LG 8
Ma 24,200,168
TR 220,248,51296
v_permlane32_swap_b32 v4,v6
LG 7
Ma 24,204,180
TR 222,248,59744
v_permlane32_swap_b32 v5,v7
Ma 28,192,148
v_permlane16_swap_b32 v4,v6
v_permlane16_swap_b32 v5,v7
Ma 28,196,160
MU 20,s26
MU 21,s26
Ma 28,200,172
DW 250,18,0
s_mov_b32 m0,85280
Ma 28,204,184
MU 22,s26
MU 23,s26
Ma 32,192,152
TR 192,248,33920
CV 8,8,9
Ma 32,196,164
TR 194,248,42368
CV 9,10,11
Ma 32,200,176
TR 196,248,34432
CV 10,20,21
Ma 32,204,188
TR 198,248,42880
CV 11,22,23
LG 10
Ma 36,208,144
TR 200,248,50816
v_permlane32_swap_b32 v8,v10
LG 9
Ma 36,212,156
TR 202,248,59264
v_permlane32_swap_b32 v9,v11
LG 8
Ma 36,216,168
TR 204,248,51328
v_permlane16_swap_b32 v8,v10
LG 7
Ma 36,220,180
TR 206,248,59776
v_permlane16_swap_b32 v9,v11
Ma 40,208,148
MU 24,s26
MU 25,s26
Ma 40,212,160
DW 251,18,256
s_mov_b32 m0,86080
Ma 40,216,172
MU 26,s26
MU 27,s26
Ma 40,220,184
MU 36,s26
MU 37,s26
Ma 44,208,152
TR 208,248,33952
MU 38,s26
Ma 44,212,164
TR 210,248,42400
MU 39,s26
Ma 44,216,176
TR 212,248,34464
CV 24,24,25
Ma 44,220,188
TR 214,248,42912
CV 25,26,27
LG 10
Ma 48,192,144
TR 216,248,50848
CV 26,36,37
LG 9
Ma 48,196,156
TR 218,248,59296
CV 27,38,39
LG 8
Ma 48,200,168
TR 220,248,51360
v_permlane32_swap_b32 v24,v26
LG 7
Ma 48,204,180
TR 222,248,59808
v_permlane32_swap_b32 v25,v27
Ma 52,192,148
DW 252,18,512
s_mov_b32 m0,86880
Ma 52,196,160
v_permlane16_swap_b32 v24,v26
v_permlane16_swap_b32 v25,v27
Ma 52,200,172
MU 28,s26
MU 29,s26
Ma 52,204,184
MU 30,s26
MU 31,s26
Ma 56,192,152
TR 192,248,33984
MU 40,s26
Ma 56,196,164
TR 194,248,42432
MU 41,s26
Ma 56,200,176
TR 196,248,34496
MU 42,s26
Ma 56,204,188
TR 198,248,42944
MU 43,s26
LG 10
Ma 60,208,144
TR 200,248,50880
CV 28,28,29
LG 9
Ma 60,212,156
TR 202,248,59328
CV 29,30,31
LG 8
Ma 60,216,168
TR 204,248,51392
CV 30,40,41
LG 7
Ma 60,220,180
DW 253,18,768
s_add_u32 s18,s10,3670272
s_addc_u32 s19,s11,0
Ma 64,208,148
TR 206,248,59840
CV 31,42,43
Ma 64,212,160
v_permlane32_swap_b32 v28,v30
v_permlane32_swap_b32 v29,v31
Ma 64,216,172
v_permlane16_swap_b32 v28,v30
v_permlane16_swap_b32 v29,v31
Ma 64,220,184
MU 32,s26
MU 33,s26
Ma 68,208,152
TR 208,248,34016
MU 34,s26
Ma 68,212,164
TR 210,248,42464
MU 35,s26
Ma 68,216,176
TR 212,248,34528
MU 44,s26
Ma 68,220,188
TR 214,248,42976
MU 45,s26
LG 10
Ma 72,192,144
TR 216,248,50912
MU 46,s26
LG 9
Ma 72,196,156
TR 218,248,59360
MU 47,s26
LG 8
Ma 72,200,168
TR 220,248,51424
CV 32,32,33
LG 7
Ma 72,204,180
TR 222,248,59872
v_add_u32 v248,4294899712,v248
Ma 76,192,148
CV 33,34,35
CV 34,44,45
Ma 76,196,160
CV 35,46,47
v_permlane32_swap_b32 v32,v34
Ma 76,200,172
v_permlane32_swap_b32 v33,v35
v_permlane16_swap_b32 v32,v34
Ma 76,204,184
v_permlane16_swap_b32 v33,v35
MU 96,s26
Ma 80,192,152
MU 97,s26
MU 98,s26
Ma 80,196,164
MU 99,s26
MU 100,s26
Ma 80,200,176
MU 101,s26
MU 102,s26
Ma 80,204,188
MU 103,s26
CV 96,96,97
LG 6
Ma 84,208,144
CV 97,98,99
CV 98,100,101
LG 4
Ma 84,212,156
CV 99,102,103
v_permlane32_swap_b32 v96,v98
LG 2
Ma 84,216,168
v_permlane32_swap_b32 v97,v99
v_permlane16_swap_b32 v96,v98
LG 0
Ma 84,220,180
v_permlane16_swap_b32 v97,v99
s_waitcnt vmcnt(18) lgkmcnt(0)
s_barrier
Ma 88,208,148
TR 192,248,0
Ma 88,212,160
TR 194,248,8448
Ma 88,216,172
TR 196,248,512
TR 198,248,8960
Ma 88,220,184
TR 200,248,16896
TR 202,248,25344
Ma 92,208,152
TR 204,248,17408
TR 206,248,25856
Ma 92,212,164
RD 224,254,0
RD 228,254,1024
Ma 92,216,176
RD 232,254,2048
RD 236,254,3072
Ma 92,220,188
v_pk_mul_f32 v[48:49],v[48:49],s[26:27] op_sel_hi:[1,0]
v_pk_mul_f32 v[50:51],v[50:51],s[26:27] op_sel_hi:[1,0]
v_pk_mul_f32 v[60:61],v[60:61],s[26:27] op_sel_hi:[1,0]
v_pk_mul_f32 v[62:63],v[62:63],s[26:27] op_sel_hi:[1,0]
CV 48,48,49
CV 49,50,51
CV 50,60,61
CV 51,62,63
s_nop 0
v_permlane32_swap_b32 v48,v50
v_permlane32_swap_b32 v49,v51
s_nop 0
v_permlane16_swap_b32 v48,v50
v_permlane16_swap_b32 v49,v51
v_pk_mul_f32 v[52:53],v[52:53],s[26:27] op_sel_hi:[1,0]
v_pk_mul_f32 v[54:55],v[54:55],s[26:27] op_sel_hi:[1,0]
v_pk_mul_f32 v[64:65],v[64:65],s[26:27] op_sel_hi:[1,0]
v_pk_mul_f32 v[66:67],v[66:67],s[26:27] op_sel_hi:[1,0]
CV 52,52,53
CV 53,54,55
CV 54,64,65
CV 55,66,67
s_nop 0
v_permlane32_swap_b32 v52,v54
v_permlane32_swap_b32 v53,v55
s_nop 0
v_permlane16_swap_b32 v52,v54
v_permlane16_swap_b32 v53,v55
v_pk_mul_f32 v[56:57],v[56:57],s[26:27] op_sel_hi:[1,0]
v_pk_mul_f32 v[58:59],v[58:59],s[26:27] op_sel_hi:[1,0]
v_pk_mul_f32 v[68:69],v[68:69],s[26:27] op_sel_hi:[1,0]
v_pk_mul_f32 v[70:71],v[70:71],s[26:27] op_sel_hi:[1,0]
CV 56,56,57
CV 57,58,59
CV 58,68,69
CV 59,70,71
s_nop 0
v_permlane32_swap_b32 v56,v58
v_permlane32_swap_b32 v57,v59
s_nop 0
v_permlane16_swap_b32 v56,v58
v_permlane16_swap_b32 v57,v59
v_pk_mul_f32 v[72:73],v[72:73],s[26:27] op_sel_hi:[1,0]
v_pk_mul_f32 v[74:75],v[74:75],s[26:27] op_sel_hi:[1,0]
v_pk_mul_f32 v[84:85],v[84:85],s[26:27] op_sel_hi:[1,0]
v_pk_mul_f32 v[86:87],v[86:87],s[26:27] op_sel_hi:[1,0]
CV 72,72,73
CV 73,74,75
CV 74,84,85
CV 75,86,87
s_nop 0
v_permlane32_swap_b32 v72,v74
v_permlane32_swap_b32 v73,v75
s_nop 0
v_permlane16_swap_b32 v72,v74
v_permlane16_swap_b32 v73,v75
v_pk_mul_f32 v[76:77],v[76:77],s[26:27] op_sel_hi:[1,0]
v_pk_mul_f32 v[78:79],v[78:79],s[26:27] op_sel_hi:[1,0]
v_pk_mul_f32 v[88:89],v[88:89],s[26:27] op_sel_hi:[1,0]
v_pk_mul_f32 v[90:91],v[90:91],s[26:27] op_sel_hi:[1,0]
CV 76,76,77
CV 77,78,79
CV 78,88,89
CV 79,90,91
s_nop 0
v_permlane32_swap_b32 v76,v78
v_permlane32_swap_b32 v77,v79
s_nop 0
v_permlane16_swap_b32 v76,v78
v_permlane16_swap_b32 v77,v79
v_pk_mul_f32 v[80:81],v[80:81],s[26:27] op_sel_hi:[1,0]
v_pk_mul_f32 v[82:83],v[82:83],s[26:27] op_sel_hi:[1,0]
v_pk_mul_f32 v[92:93],v[92:93],s[26:27] op_sel_hi:[1,0]
v_pk_mul_f32 v[94:95],v[94:95],s[26:27] op_sel_hi:[1,0]
CV 80,80,81
CV 81,82,83
CV 82,92,93
CV 83,94,95
s_nop 0
v_permlane32_swap_b32 v80,v82
v_permlane32_swap_b32 v81,v83
s_nop 0
v_permlane16_swap_b32 v80,v82
v_permlane16_swap_b32 v81,v83
s_cmp_eq_u32 s20,1
s_cbranch_scc0 EA2_w0
ds_write_b128 v249,v[96:99] offset:20480
v_mov_b32 v152,v0
v_mov_b32 v153,v1
v_mov_b32 v154,v2
v_mov_b32 v155,v3
v_mov_b32 v156,v4
v_mov_b32 v157,v5
v_mov_b32 v158,v6
v_mov_b32 v159,v7
v_mov_b32 v160,v8
v_mov_b32 v161,v9
v_mov_b32 v162,v10
v_mov_b32 v163,v11
v_mov_b32 v164,v24
v_mov_b32 v165,v25
v_mov_b32 v166,v26
v_mov_b32 v167,v27
v_mov_b32 v168,v28
v_mov_b32 v169,v29
v_mov_b32 v170,v30
v_mov_b32 v171,v31
v_mov_b32 v172,v32
v_mov_b32 v173,v33
v_mov_b32 v174,v34
v_mov_b32 v175,v35
v_mov_b32 v176,v48
v_mov_b32 v177,v49
v_mov_b32 v178,v50
v_mov_b32 v179,v51
v_mov_b32 v180,v52
v_mov_b32 v181,v53
v_mov_b32 v182,v54
v_mov_b32 v183,v55
v_mov_b32 v184,v56
v_mov_b32 v185,v57
v_mov_b32 v186,v58
v_mov_b32 v187,v59
v_mov_b32 v188,v72
v_mov_b32 v189,v73
v_mov_b32 v190,v74
v_mov_b32 v191,v75
v_mov_b32 v192,v76
v_mov_b32 v193,v77
v_mov_b32 v194,v78
v_mov_b32 v195,v79
v_mov_b32 v196,v80
v_mov_b32 v197,v81
v_mov_b32 v198,v82
v_mov_b32 v199,v83
s_add_u32 s10,s10,256
s_addc_u32 s11,s11,0
s_add_u32 s20,s20,1
s_branch LA_w0
EA2_w0:
ds_write_b128 v249,v[96:99] offset:24576
v_mov_b32 v200,v0
v_mov_b32 v201,v1
v_mov_b32 v202,v2
v_mov_b32 v203,v3
v_mov_b32 v204,v4
v_mov_b32 v205,v5
v_mov_b32 v206,v6
v_mov_b32 v207,v7
v_mov_b32 v208,v8
v_mov_b32 v209,v9
v_mov_b32 v210,v10
v_mov_b32 v211,v11
v_mov_b32 v212,v24
v_mov_b32 v213,v25
v_mov_b32 v214,v26
v_mov_b32 v215,v27
v_mov_b32 v216,v28
v_mov_b32 v217,v29
v_mov_b32 v218,v30
v_mov_b32 v219,v31
v_mov_b32 v220,v32
v_mov_b32 v221,v33
v_mov_b32 v222,v34
v_mov_b32 v223,v35
v_mov_b32 v224,v48
v_mov_b32 v225,v49
v_mov_b32 v226,v50
v_mov_b32 v227,v51
v_mov_b32 v228,v52
v_mov_b32 v229,v53
v_mov_b32 v230,v54
v_mov_b32 v231,v55
v_mov_b32 v232,v56
v_mov_b32 v233,v57
v_mov_b32 v234,v58
v_mov_b32 v235,v59
v_mov_b32 v236,v72
v_mov_b32 v237,v73
v_mov_b32 v238,v74
v_mov_b32 v239,v75
v_mov_b32 v240,v76
v_mov_b32 v241,v77
v_mov_b32 v242,v78
v_mov_b32 v243,v79
v_mov_b32 v244,v80
v_mov_b32 v245,v81
v_mov_b32 v246,v82
v_mov_b32 v247,v83
s_add_u32 s10,s10,256
s_addc_u32 s11,s11,0
s_add_u32 s20,s20,1
LG 0
Za 0,192,0
s_mov_b32 m0,101376
TR 208,248,32
v_subrev_u32 v255,135168,v249
Ma 0,196,12
DW 250,16,0
s_mov_b32 m0,102176
Ma 0,200,24
TR 210,248,8480
Ma 0,204,36
TR 212,248,544
Za 4,192,4
TR 214,248,8992
Ma 4,196,16
TR 216,248,16928
Ma 4,200,28
TR 218,248,25376
Ma 4,204,40
TR 220,248,17440
Za 8,192,8
TR 222,248,25888
Ma 8,196,20
Ma 8,200,32
Ma 8,204,44
DW 251,16,256
s_mov_b32 m0,102976
Za 96,192,224
TR 192,248,64
Ma 96,196,228
TR 194,248,8512
Ma 96,200,232
TR 196,248,576
Ma 96,204,236
TR 198,248,9024
LG 10
Za 12,208,0
TR 200,248,16960
LG 9
Ma 12,212,12
TR 202,248,25408
LG 8
Ma 12,216,24
TR 204,248,17472
LG 7
Ma 12,220,36
TR 206,248,25920
Za 16,208,4
Ma 16,212,16
DW 252,16,512
s_mov_b32 m0,103776
Ma 16,216,28
Ma 16,220,40
Za 20,208,8
Ma 20,212,20
Ma 20,216,32
Ma 20,220,44
Za 100,208,224
TR 208,248,96
Ma 100,212,228
TR 210,248,8544
Ma 100,216,232
TR 212,248,608
Ma 100,220,236
DW 253,16,768
s_mov_b32 m0,118272
s_add_u32 s16,s6,0
s_addc_u32 s17,s7,0
LG 9
Za 24,192,0
TR 214,248,9056
LG 8
Ma 24,196,12
TR 216,248,16992
LG 7
Ma 24,200,24
TR 218,248,25440
LG 6
Ma 24,204,36
TR 220,248,17504
Za 28,192,4
TR 222,248,25952
Ma 28,196,16
Ma 28,200,28
Ma 28,204,40
Za 32,192,8
TR 192,248,128
Ma 32,196,20
DW 250,18,0
s_mov_b32 m0,119072
Ma 32,200,32
TR 194,248,8576
v_and_b32 v250,0xf0,v255
Ma 32,204,44
TR 196,248,640
v_lshrrev_b32 v255,8,v255
LG 9
Za 36,208,0
TR 198,248,9088
v_lshl_add_u32 v250,v255,12,v250
LG 8
Ma 36,212,12
TR 200,248,17024
LG 7
Ma 36,216,24
TR 202,248,25472
LG 6
Ma 36,220,36
TR 204,248,17536
Za 40,208,4
TR 206,248,25984
Ma 40,212,16
Ma 40,216,28
Ma 40,220,40
DW 251,18,256
s_mov_b32 m0,119872
Za 44,208,8
TR 208,248,160
v_mov_b32 v251,v250
Ma 44,212,20
TR 210,248,8608
Ma 44,216,32
TR 212,248,672
Ma 44,220,44
TR 214,248,9120
LG 10
Za 48,192,0
TR 216,248,17056
LG 9
Ma 48,196,12
TR 218,248,25504
LG 8
Ma 48,200,24
TR 220,248,17568
LG 7
Ma 48,204,36
TR 222,248,26016
Za 52,192,4
Ma 52,196,16
DW 252,18,512
s_mov_b32 m0,120672
Ma 52,200,28
v_mov_b32 v252,v250
Ma 52,204,40
Za 56,192,8
TR 192,248,192
Ma 56,196,20
TR 194,248,8640
Ma 56,200,32
TR 196,248,704
Ma 56,204,44
TR 198,248,9152
LG 10
Za 60,208,0
TR 200,248,17088
LG 9
Ma 60,212,12
TR 202,248,25536
LG 8
Ma 60,216,24
TR 204,248,17600
LG 7
Ma 60,220,36
DW 253,18,768
s_mov_b32 m0,0
s_add_u32 s18,s6,16384
s_addc_u32 s19,s7,0
Za 64,208,4
TR 206,248,26048
v_mov_b32 v253,v250
Ma 64,212,16
Ma 64,216,28
Ma 64,220,40
Za 68,208,8
TR 208,248,224
Ma 68,212,20
TR 210,248,8672
Ma 68,216,32
TR 212,248,736
Ma 68,220,44
TR 214,248,9184
LG 10
Za 72,192,0
TR 216,248,17120
LG 9
Ma 72,196,12
TR 218,248,25568
LG 8
Ma 72,200,24
TR 220,248,17632
LG 7
Ma 72,204,36
TR 222,248,26080
Za 76,192,4
Ma 76,196,16
Ma 76,200,28
Ma 76,204,40
Za 80,192,8
Ma 80,196,20
Ma 80,200,32
Ma 80,204,44
LG 6
Za 84,208,0
AW 0,104
AW 1,105
LG 4
Ma 84,212,12
AW 2,106
AW 3,107
LG 2
Ma 84,216,24
AW 12,116
AW 13,117
LG 0
Ma 84,220,36
AW 14,118
AW 15,119
s_waitcnt vmcnt(17) lgkmcnt(0)
s_barrier
Za 88,208,4
TR 192,248,33792
AW 4,108
Ma 88,212,16
TR 194,248,42240
AW 5,109
Ma 88,216,28
TR 196,248,34304
AW 6,110
Ma 88,220,40
TR 198,248,42752
AW 7,111
Za 92,208,8
TR 200,248,50688
TR 202,248,59136
Ma 92,212,20
TR 204,248,51200
TR 206,248,59648
Ma 92,216,32
DM 250,16,0
s_mov_b32 m0,800
Ma 92,220,44
RD 224,254,4096
AW 8,112
LG 7
Ma 0,192,48
RD 228,254,5120
AW 9,113
LG 6
Ma 0,196,60
RD 232,254,6144
AW 10,114
LG 5
Ma 0,200,72
RD 236,254,7168
AW 11,115
LG 4
Ma 0,204,84
TR 208,248,33824
AW 16,120
Ma 4,192,52
TR 210,248,42272
AW 17,121
Ma 4,196,64
DM 251,16,256
s_mov_b32 m0,1600
Ma 4,200,76
TR 212,248,34336
AW 18,122
Ma 4,204,88
TR 214,248,42784
AW 19,123
Ma 8,192,56
TR 216,248,50720
AW 20,124
Ma 8,196,68
TR 218,248,59168
AW 21,125
Ma 8,200,80
TR 220,248,51232
AW 22,126
Ma 8,204,92
TR 222,248,59680
AW 23,127
LG 11
Ma 96,192,224
TR 192,248,33856
AW 24,128
LG 11
Ma 96,196,228
TR 194,248,42304
AW 25,129
LG 11
Ma 96,200,232
TR 196,248,34368
AW 26,130
LG 11
Ma 96,204,236
TR 198,248,42816
AW 27,131
LG 10
Ma 12,208,48
DM 252,16,512
s_mov_b32 m0,2400
LG 8
Ma 12,212,60
TR 200,248,50752
AW 28,132
LG 7
Ma 12,216,72
TR 202,248,59200
AW 29,133
LG 6
Ma 12,220,84
TR 204,248,51264
AW 30,134
Ma 16,208,52
TR 206,248,59712
AW 31,135
Ma 16,212,64
AW 32,136
AW 33,137
Ma 16,216,76
AW 34,138
AW 35,139
Ma 16,220,88
AW 36,140
AW 37,141
Ma 20,208,56
AW 38,142
AW 39,143
Ma 20,212,68
AW 40,144
AW 41,145
Ma 20,216,80
AW 42,146
AW 43,147
Ma 20,220,92
DM 253,16,768
s_mov_b32 m0,16896
s_add_u32 s16,s8,0
s_addc_u32 s17,s9,0
Ma 100,208,224
TR 208,248,33888
AW 44,148
Ma 100,212,228
TR 210,248,42336
AW 45,149
Ma 100,216,232
TR 212,248,34400
AW 46,150
Ma 100,220,236
TR 214,248,42848
AW 47,151
LG 10
Ma 24,192,48
TR 216,248,50784
LG 9
Ma 24,196,60
TR 218,248,59232
LG 8
Ma 24,200,72
TR 220,248,51296
LG 7
Ma 24,204,84
TR 222,248,59744
Ma 28,192,52
Ma 28,196,64
Ma 28,200,76
DM 250,18,0
s_mov_b32 m0,17696
Ma 28,204,88
Ma 32,192,56
TR 192,248,33920
Ma 32,196,68
TR 194,248,42368
Ma 32,200,80
TR 196,248,34432
Ma 32,204,92
TR 198,248,42880
LG 10
Ma 36,208,48
TR 200,248,50816
LG 9
Ma 36,212,60
TR 202,248,59264
LG 8
Ma 36,216,72
TR 204,248,51328
LG 7
Ma 36,220,84
TR 206,248,59776
Ma 40,208,52
Ma 40,212,64
DM 251,18,256
s_mov_b32 m0,18496
Ma 40,216,76
Ma 40,220,88
Ma 44,208,56
TR 208,248,33952
Ma 44,212,68
TR 210,248,42400
Ma 44,216,80
TR 212,248,34464
Ma 44,220,92
TR 214,248,42912
LG 10
Ma 48,192,48
TR 216,248,50848
LG 9
Ma 48,196,60
TR 218,248,59296
LG 8
Ma 48,200,72
TR 220,248,51360
LG 7
Ma 48,204,84
TR 222,248,59808
Ma 52,192,52
DM 252,18,512
s_mov_b32 m0,19296
Ma 52,196,64
Ma 52,200,76
Ma 52,204,88
Ma 56,192,56
TR 192,248,33984
Ma 56,196,68
TR 194,248,42432
Ma 56,200,80
TR 196,248,34496
Ma 56,204,92
TR 198,248,42944
LG 10
Ma 60,208,48
TR 200,248,50880
LG 9
Ma 60,212,60
TR 202,248,59328
LG 8
Ma 60,216,72
TR 204,248,51392
LG 7
Ma 60,220,84
DM 253,18,768
s_mov_b32 m0,33792
s_add_u32 s18,s6,32768
s_addc_u32 s19,s7,0
Ma 64,208,52
TR 206,248,59840
Ma 64,212,64
Ma 64,216,76
Ma 64,220,88
Ma 68,208,56
TR 208,248,34016
Ma 68,212,68
TR 210,248,42464
Ma 68,216,80
TR 212,248,34528
Ma 68,220,92
TR 214,248,42976
LG 10
Ma 72,192,48
TR 216,248,50912
LG 9
Ma 72,196,60
TR 218,248,59360
LG 8
Ma 72,200,72
TR 220,248,51424
LG 7
Ma 72,204,84
TR 222,248,59872
v_add_u32 v248,67584,v248
Ma 76,192,52
Ma 76,196,64
Ma 76,200,76
Ma 76,204,88
Ma 80,192,56
Ma 80,196,68
Ma 80,200,80
Ma 80,204,92
LG 6
Ma 84,208,48
AW 48,152
AW 49,153
LG 4
Ma 84,212,60
AW 50,154
AW 51,155
LG 2
Ma 84,216,72
AW 60,164
AW 61,165
LG 0
Ma 84,220,84
AW 62,166
AW 63,167
s_waitcnt vmcnt(16) lgkmcnt(0)
s_barrier
Ma 88,208,52
TR 192,248,0
AW 52,156
Ma 88,212,64
TR 194,248,8448
AW 53,157
Ma 88,216,76
TR 196,248,512
AW 54,158
Ma 88,220,88
TR 198,248,8960
AW 55,159
Ma 92,208,56
TR 200,248,16896
TR 202,248,25344
Ma 92,212,68
TR 204,248,17408
TR 206,248,25856
Ma 92,216,80
DM 250,16,0
s_mov_b32 m0,34592
Ma 92,220,92
RD 224,254,8192
AW 56,160
LG 7
Ma 0,192,96
RD 228,254,9216
AW 57,161
LG 6
Ma 0,196,108
RD 232,254,10240
AW 58,162
LG 5
Ma 0,200,120
RD 236,254,11264
AW 59,163
LG 4
Ma 0,204,132
TR 208,248,32
AW 64,168
Ma 4,192,100
TR 210,248,8480
AW 65,169
Ma 4,196,112
DM 251,16,256
s_mov_b32 m0,35392
Ma 4,200,124
TR 212,248,544
AW 66,170
Ma 4,204,136
TR 214,248,8992
AW 67,171
Ma 8,192,104
TR 216,248,16928
AW 68,172
Ma 8,196,116
TR 218,248,25376
AW 69,173
Ma 8,200,128
TR 220,248,17440
AW 70,174
Ma 8,204,140
TR 222,248,25888
AW 71,175
LG 11
Ma 96,192,224
TR 192,248,64
AW 72,176
LG 11
Ma 96,196,228
TR 194,248,8512
AW 73,177
LG 11
Ma 96,200,232
TR 196,248,576
AW 74,178
LG 11
Ma 96,204,236
TR 198,248,9024
AW 75,179
LG 10
Ma 12,208,96
DM 252,16,512
s_mov_b32 m0,36192
LG 8
Ma 12,212,108
TR 200,248,16960
AW 76,180
LG 7
Ma 12,216,120
TR 202,248,25408
AW 77,181
LG 6
Ma 12,220,132
TR 204,248,17472
AW 78,182
Ma 16,208,100
TR 206,248,25920
AW 79,183
Ma 16,212,112
AW 80,184
AW 81,185
Ma 16,216,124
AW 82,186
AW 83,187
Ma 16,220,136
AW 84,188
AW 85,189
Ma 20,208,104
AW 86,190
AW 87,191
Ma 20,212,116
AW 88,192
AW 89,193
Ma 20,216,128
AW 90,194
AW 91,195
Ma 20,220,140
DM 253,16,768
s_mov_b32 m0,50688
s_add_u32 s16,s8,16384
s_addc_u32 s17,s9,0
Ma 100,208,224
TR 208,248,96
AW 92,196
Ma 100,212,228
TR 210,248,8544
AW 93,197
Ma 100,216,232
TR 212,248,608
AW 94,198
Ma 100,220,236
TR 214,248,9056
AW 95,199
LG 10
Ma 24,192,96
TR 216,248,16992
LG 9
Ma 24,196,108
TR 218,248,25440
LG 8
Ma 24,200,120
TR 220,248,17504
LG 7
Ma 24,204,132
TR 222,248,25952
Ma 28,192,100
Ma 28,196,112
Ma 28,200,124
DM 250,18,0
s_mov_b32 m0,51488
Ma 28,204,136
Ma 32,192,104
TR 192,248,128
Ma 32,196,116
TR 194,248,8576
Ma 32,200,128
TR 196,248,640
Ma 32,204,140
TR 198,248,9088
LG 10
Ma 36,208,96
TR 200,248,17024
LG 9
Ma 36,212,108
TR 202,248,25472
LG 8
Ma 36,216,120
TR 204,248,17536
LG 7
Ma 36,220,132
TR 206,248,25984
Ma 40,208,100
Ma 40,212,112
DM 251,18,256
s_mov_b32 m0,52288
Ma 40,216,124
Ma 40,220,136
Ma 44,208,104
TR 208,248,160
Ma 44,212,116
TR 210,248,8608
Ma 44,216,128
TR 212,248,672
Ma 44,220,140
TR 214,248,9120
LG 10
Ma 48,192,96
TR 216,248,17056
LG 9
Ma 48,196,108
TR 218,248,25504
LG 8
Ma 48,200,120
TR 220,248,17568
LG 7
Ma 48,204,132
TR 222,248,26016
Ma 52,192,100
DM 252,18,512
s_mov_b32 m0,53088
Ma 52,196,112
Ma 52,200,124
Ma 52,204,136
Ma 56,192,104
TR 192,248,192
Ma 56,196,116
TR 194,248,8640
Ma 56,200,128
TR 196,248,704
Ma 56,204,140
TR 198,248,9152
LG 10
Ma 60,208,96
TR 200,248,17088
LG 9
Ma 60,212,108
TR 202,248,25536
LG 8
Ma 60,216,120
TR 204,248,17600
LG 7
Ma 60,220,132
DM 253,18,768
s_mov_b32 m0,67584
s_add_u32 s18,s6,49152
s_addc_u32 s19,s7,0
Ma 64,208,100
TR 206,248,26048
Ma 64,212,112
Ma 64,216,124
Ma 64,220,136
Ma 68,208,104
TR 208,248,224
Ma 68,212,116
TR 210,248,8672
Ma 68,216,128
TR 212,248,736
Ma 68,220,140
TR 214,248,9184
LG 10
Ma 72,192,96
TR 216,248,17120
LG 9
Ma 72,196,108
TR 218,248,25568
LG 8
Ma 72,200,120
TR 220,248,17632
LG 7
Ma 72,204,132
TR 222,248,26080
Ma 76,192,100
Ma 76,196,112
Ma 76,200,124
Ma 76,204,136
Ma 80,192,104
Ma 80,196,116
Ma 80,200,128
Ma 80,204,140
LG 6
Ma 84,208,96
AW 96,200
AW 97,201
LG 4
Ma 84,212,108
AW 98,202
AW 99,203
LG 2
Ma 84,216,120
AW 108,212
AW 109,213
LG 0
Ma 84,220,132
AW 110,214
AW 111,215
s_waitcnt vmcnt(16) lgkmcnt(0)
s_barrier
Ma 88,208,100
TR 192,248,33792
AW 100,204
Ma 88,212,112
TR 194,248,42240
AW 101,205
Ma 88,216,124
TR 196,248,34304
AW 102,206
Ma 88,220,136
TR 198,248,42752
AW 103,207
Ma 92,208,104
TR 200,248,50688
TR 202,248,59136
Ma 92,212,116
TR 204,248,51200
TR 206,248,59648
Ma 92,216,128
DM 250,16,0
s_mov_b32 m0,68384
Ma 92,220,140
RD 224,254,12288
AW 104,208
LG 7
Ma 0,192,144
RD 228,254,13312
AW 105,209
LG 6
Ma 0,196,156
RD 232,254,14336
AW 106,210
LG 5
Ma 0,200,168
RD 236,254,15360
AW 107,211
LG 4
Ma 0,204,180
TR 208,248,33824
AW 112,216
Ma 4,192,148
TR 210,248,42272
AW 113,217
Ma 4,196,160
DM 251,16,256
s_mov_b32 m0,69184
Ma 4,200,172
TR 212,248,34336
AW 114,218
Ma 4,204,184
TR 214,248,42784
AW 115,219
Ma 8,192,152
TR 216,248,50720
AW 116,220
Ma 8,196,164
TR 218,248,59168
AW 117,221
Ma 8,200,176
TR 220,248,51232
AW 118,222
Ma 8,204,188
TR 222,248,59680
AW 119,223
LG 11
Ma 96,192,224
TR 192,248,33856
AW 120,224
LG 11
Ma 96,196,228
TR 194,248,42304
AW 121,225
LG 11
Ma 96,200,232
TR 196,248,34368
AW 122,226
LG 11
Ma 96,204,236
TR 198,248,42816
AW 123,227
LG 10
Ma 12,208,144
DM 252,16,512
s_mov_b32 m0,69984
LG 8
Ma 12,212,156
TR 200,248,50752
AW 124,228
LG 7
Ma 12,216,168
TR 202,248,59200
AW 125,229
LG 6
Ma 12,220,180
TR 204,248,51264
AW 126,230
Ma 16,208,148
TR 206,248,59712
AW 127,231
Ma 16,212,160
AW 128,232
AW 129,233
Ma 16,216,172
AW 130,234
AW 131,235
Ma 16,220,184
AW 132,236
AW 133,237
Ma 20,208,152
AW 134,238
AW 135,239
Ma 20,212,164
AW 136,240
AW 137,241
Ma 20,216,176
AW 138,242
AW 139,243
Ma 20,220,188
DM 253,16,768
s_mov_b32 m0,84480
s_add_u32 s16,s8,32768
s_addc_u32 s17,s9,0
Ma 100,208,224
TR 208,248,33888
AW 140,244
Ma 100,212,228
TR 210,248,42336
AW 141,245
Ma 100,216,232
TR 212,248,34400
AW 142,246
Ma 100,220,236
TR 214,248,42848
AW 143,247
LG 10
Ma 24,192,144
TR 216,248,50784
MU 0,s26
LG 9
Ma 24,196,156
TR 218,248,59232
MU 1,s26
LG 8
Ma 24,200,168
TR 220,248,51296
MU 2,s26
LG 7
Ma 24,204,180
TR 222,248,59744
MU 3,s26
Ma 28,192,148
MU 12,s26
MU 13,s26
Ma 28,196,160
MU 14,s26
MU 15,s26
Ma 28,200,172
DM 250,18,0
s_mov_b32 m0,85280
Ma 28,204,184
CV 0,0,1
CV 1,2,3
Ma 32,192,152
TR 192,248,33920
CV 2,12,13
Ma 32,196,164
TR 194,248,42368
CV 3,14,15
Ma 32,200,176
TR 196,248,34432
v_permlane32_swap_b32 v0,v2
Ma 32,204,188
TR 198,248,42880
v_permlane32_swap_b32 v1,v3
LG 10
Ma 36,208,144
TR 200,248,50816
v_permlane16_swap_b32 v0,v2
LG 9
Ma 36,212,156
TR 202,248,59264
v_permlane16_swap_b32 v1,v3
LG 8
Ma 36,216,168
TR 204,248,51328
MU 4,s26
LG 7
Ma 36,220,180
TR 206,248,59776
MU 5,s26
Ma 40,208,148
MU 6,s26
MU 7,s26
Ma 40,212,160
DM 251,18,256
s_mov_b32 m0,86080
Ma 40,216,172
MU 16,s26
MU 17,s26
Ma 40,220,184
MU 18,s26
MU 19,s26
Ma 44,208,152
TR 208,248,33952
CV 4,4,5
Ma 44,212,164
TR 210,248,42400
CV 5,6,7
Ma 44,216,176
TR 212,248,34464
CV 6,16,17
Ma 44,220,188
TR 214,248,42912
CV 7,18,19
LG 10
Ma 48,192,144
TR 216,248,50848
v_permlane32_swap_b32 v4,v6
LG 9
Ma 48,196,156
TR 218,248,59296
v_permlane32_swap_b32 v5,v7
LG 8
Ma 48,200,168
TR 220,248,51360
v_permlane16_swap_b32 v4,v6
LG 7
Ma 48,204,180
TR 222,248,59808
v_permlane16_swap_b32 v5,v7
Ma 52,192,148
DM 252,18,512
s_mov_b32 m0,86880
Ma 52,196,160
MU 8,s26
MU 9,s26
Ma 52,200,172
MU 10,s26
MU 11,s26
Ma 52,204,184
MU 20,s26
MU 21,s26
Ma 56,192,152
TR 192,248,33984
MU 22,s26
Ma 56,196,164
TR 194,248,42432
MU 23,s26
Ma 56,200,176
TR 196,248,34496
CV 8,8,9
Ma 56,204,188
TR 198,248,42944
CV 9,10,11
LG 10
Ma 60,208,144
TR 200,248,50880
CV 10,20,21
LG 9
Ma 60,212,156
TR 202,248,59328
CV 11,22,23
LG 8
Ma 60,216,168
TR 204,248,51392
v_permlane32_swap_b32 v8,v10
LG 7
Ma 60,220,180
DM 253,18,768
Ma 64,208,148
TR 206,248,59840
v_permlane32_swap_b32 v9,v11
Ma 64,212,160
v_permlane16_swap_b32 v8,v10
v_permlane16_swap_b32 v9,v11
Ma 64,216,172
MU 24,s26
MU 25,s26
Ma 64,220,184
MU 26,s26
MU 27,s26
Ma 68,208,152
TR 208,248,34016
MU 36,s26
Ma 68,212,164
TR 210,248,42464
MU 37,s26
Ma 68,216,176
TR 212,248,34528
MU 38,s26
Ma 68,220,188
TR 214,248,42976
MU 39,s26
LG 10
Ma 72,192,144
TR 216,248,50912
CV 24,24,25
LG 9
Ma 72,196,156
TR 218,248,59360
CV 25,26,27
LG 8
Ma 72,200,168
TR 220,248,51424
CV 26,36,37
LG 7
Ma 72,204,180
TR 222,248,59872
v_add_u32 v248,4294899712,v248
Ma 76,192,148
CV 27,38,39
v_permlane32_swap_b32 v24,v26
Ma 76,196,160
v_permlane32_swap_b32 v25,v27
v_permlane16_swap_b32 v24,v26
Ma 76,200,172
v_permlane16_swap_b32 v25,v27
MU 28,s26
Ma 76,204,184
MU 29,s26
MU 30,s26
Ma 80,192,152
MU 31,s26
MU 40,s26
Ma 80,196,164
MU 41,s26
MU 42,s26
Ma 80,200,176
MU 43,s26
CV 28,28,29
Ma 80,204,188
CV 29,30,31
CV 30,40,41
LG 6
Ma 84,208,144
CV 31,42,43
v_permlane32_swap_b32 v28,v30
LG 4
Ma 84,212,156
v_permlane32_swap_b32 v29,v31
v_permlane16_swap_b32 v28,v30
LG 2
Ma 84,216,168
v_permlane16_swap_b32 v29,v31
MU 32,s26
LG 0
Ma 84,220,180
MU 33,s26
MU 34,s26
s_waitcnt vmcnt(24) lgkmcnt(0)
s_barrier
Ma 88,208,148
TR 192,248,0
MU 35,s26
Ma 88,212,160
TR 194,248,8448
MU 44,s26
Ma 88,216,172
TR 196,248,512
TR 198,248,8960
Ma 88,220,184
TR 200,248,16896
TR 202,248,25344
Ma 92,208,152
TR 204,248,17408
TR 206,248,25856
Ma 92,212,164
RD 224,254,0
RD 228,254,1024
Ma 92,216,176
RD 232,254,2048
RD 236,254,3072
Ma 92,220,188
MU 45,s26
MU 46,s26
MU 47,s26
CV 32,32,33
CV 33,34,35
CV 34,44,45
CV 35,46,47
s_nop 0
v_permlane32_swap_b32 v32,v34
v_permlane32_swap_b32 v33,v35
s_nop 0
v_permlane16_swap_b32 v32,v34
v_permlane16_swap_b32 v33,v35
v_pk_mul_f32 v[48:49],v[48:49],s[26:27] op_sel_hi:[1,0]
v_pk_mul_f32 v[50:51],v[50:51],s[26:27] op_sel_hi:[1,0]
v_pk_mul_f32 v[60:61],v[60:61],s[26:27] op_sel_hi:[1,0]
v_pk_mul_f32 v[62:63],v[62:63],s[26:27] op_sel_hi:[1,0]
CV 48,48,49
CV 49,50,51
CV 50,60,61
CV 51,62,63
s_nop 0
v_permlane32_swap_b32 v48,v50
v_permlane32_swap_b32 v49,v51
s_nop 0
v_permlane16_swap_b32 v48,v50
v_permlane16_swap_b32 v49,v51
v_pk_mul_f32 v[52:53],v[52:53],s[26:27] op_sel_hi:[1,0]
v_pk_mul_f32 v[54:55],v[54:55],s[26:27] op_sel_hi:[1,0]
v_pk_mul_f32 v[64:65],v[64:65],s[26:27] op_sel_hi:[1,0]
v_pk_mul_f32 v[66:67],v[66:67],s[26:27] op_sel_hi:[1,0]
CV 52,52,53
CV 53,54,55
CV 54,64,65
CV 55,66,67
s_nop 0
v_permlane32_swap_b32 v52,v54
v_permlane32_swap_b32 v53,v55
s_nop 0
v_permlane16_swap_b32 v52,v54
v_permlane16_swap_b32 v53,v55
v_pk_mul_f32 v[56:57],v[56:57],s[26:27] op_sel_hi:[1,0]
v_pk_mul_f32 v[58:59],v[58:59],s[26:27] op_sel_hi:[1,0]
v_pk_mul_f32 v[68:69],v[68:69],s[26:27] op_sel_hi:[1,0]
v_pk_mul_f32 v[70:71],v[70:71],s[26:27] op_sel_hi:[1,0]
CV 56,56,57
CV 57,58,59
CV 58,68,69
CV 59,70,71
s_nop 0
v_permlane32_swap_b32 v56,v58
v_permlane32_swap_b32 v57,v59
s_nop 0
v_permlane16_swap_b32 v56,v58
v_permlane16_swap_b32 v57,v59
v_pk_mul_f32 v[72:73],v[72:73],s[26:27] op_sel_hi:[1,0]
v_pk_mul_f32 v[74:75],v[74:75],s[26:27] op_sel_hi:[1,0]
v_pk_mul_f32 v[84:85],v[84:85],s[26:27] op_sel_hi:[1,0]
v_pk_mul_f32 v[86:87],v[86:87],s[26:27] op_sel_hi:[1,0]
CV 72,72,73
CV 73,74,75
CV 74,84,85
CV 75,86,87
s_nop 0
v_permlane32_swap_b32 v72,v74
v_permlane32_swap_b32 v73,v75
s_nop 0
v_permlane16_swap_b32 v72,v74
v_permlane16_swap_b32 v73,v75
v_pk_mul_f32 v[76:77],v[76:77],s[26:27] op_sel_hi:[1,0]
v_pk_mul_f32 v[78:79],v[78:79],s[26:27] op_sel_hi:[1,0]
v_pk_mul_f32 v[88:89],v[88:89],s[26:27] op_sel_hi:[1,0]
v_pk_mul_f32 v[90:91],v[90:91],s[26:27] op_sel_hi:[1,0]
CV 76,76,77
CV 77,78,79
CV 78,88,89
CV 79,90,91
s_nop 0
v_permlane32_swap_b32 v76,v78
v_permlane32_swap_b32 v77,v79
s_nop 0
v_permlane16_swap_b32 v76,v78
v_permlane16_swap_b32 v77,v79
v_pk_mul_f32 v[80:81],v[80:81],s[26:27] op_sel_hi:[1,0]
v_pk_mul_f32 v[82:83],v[82:83],s[26:27] op_sel_hi:[1,0]
v_pk_mul_f32 v[92:93],v[92:93],s[26:27] op_sel_hi:[1,0]
v_pk_mul_f32 v[94:95],v[94:95],s[26:27] op_sel_hi:[1,0]
CV 80,80,81
CV 81,82,83
CV 82,92,93
CV 83,94,95
s_nop 0
v_permlane32_swap_b32 v80,v82
v_permlane32_swap_b32 v81,v83
s_nop 0
v_permlane16_swap_b32 v80,v82
v_permlane16_swap_b32 v81,v83
MU 96,s26
MU 97,s26
MU 98,s26
MU 99,s26
MU 100,s26
MU 101,s26
MU 102,s26
MU 103,s26
CV 96,96,97
CV 97,98,99
CV 98,100,101
CV 99,102,103
s_nop 0
v_permlane32_swap_b32 v96,v98
v_permlane32_swap_b32 v97,v99
s_nop 0
v_permlane16_swap_b32 v96,v98
v_permlane16_swap_b32 v97,v99
ds_write_b128 v249,v[96:99] offset:0
AW 144,0
AW 145,1
AW 146,2
AW 147,3
AW 148,4
AW 149,5
AW 150,6
AW 151,7
AW 152,8
AW 153,9
AW 154,10
AW 155,11
AW 156,24
AW 157,25
AW 158,26
AW 159,27
AW 160,28
AW 161,29
AW 162,30
AW 163,31
AW 164,32
AW 165,33
AW 166,34
AW 167,35
AW 168,48
AW 169,49
AW 170,50
AW 171,51
AW 172,52
AW 173,53
AW 174,54
AW 175,55
AW 176,56
AW 177,57
AW 178,58
AW 179,59
AW 180,72
AW 181,73
AW 182,74
AW 183,75
AW 184,76
AW 185,77
AW 186,78
AW 187,79
AW 188,80
AW 189,81
AW 190,82
AW 191,83
v_subrev_u32 v224,135168,v249
v_lshrrev_b32 v224,4,v224
v_and_b32 v225,15,v224
v_mul_u32_u24 v220,1056,v225
v_lshrrev_b32 v226,4,v224
v_lshl_add_u32 v220,v226,4,v220
v_lshrrev_b32 v225,2,v224
v_mul_u32_u24 v221,1056,v225
v_and_b32 v226,3,v224
v_lshl_add_u32 v221,v226,3,v221
v_lshrrev_b32 v225,4,v224
v_lshlrev_b32 v225,12,v225
v_and_b32 v226,15,v224
v_lshl_add_u32 v250,v226,4,v225
v_add_u32 v251,0,v250
v_add_u32 v252,0,v250
v_add_u32 v253,0,v250
v_mov_b32 v216,v250
v_mov_b32 v217,v250
v_mov_b32 v218,v250
v_mov_b32 v219,v250
s_mov_b32 s22,0
s_mov_b32 s23,16896
s_mov_b32 s24,33792
s_mov_b32 s25,118272
s_mov_b32 s21,0
s_mov_b32 s34,0
s_add_u32 s18,s8,32768
s_addc_u32 s19,s9,0
s_mov_b32 m0,101376
s_nop 0
DW 250,18,0
s_mov_b32 m0,102176
s_nop 0
DW 251,18,256
s_mov_b32 m0,102976
s_nop 0
DW 252,18,512
s_mov_b32 m0,103776
s_nop 0
DW 253,18,768
s_add_u32 s16,s6,65536
s_addc_u32 s17,s7,0
s_add_u32 s18,s8,49152
s_addc_u32 s19,s9,0
s_waitcnt vmcnt(24) lgkmcnt(0)
s_barrier
v_mov_b32 v254,v220
RD 208,254,0
RD 212,254,64
RD 216,254,128
RD 220,254,192
RD 192,254,256
RD 196,254,320
RD 200,254,384
RD 204,254,448
RD 224,249,16384
RD 228,249,17408
RD 232,249,18432
RD 236,249,19456
LB_w0:
LG 0
Za 136,208,0
v_add_u32 v248,s24,v221
s_mov_b32 s48,s22
s_mov_b32 s49,s25
Ma 136,212,12
Ma 136,216,24
Ma 136,220,36
Za 140,208,4
Ma 140,212,16
Ma 140,216,28
s_nop 4
v_max3_f32 v200,v136,v137,v138
v_max_f32 v200,v200,v139
Ma 140,220,40
v_mov_b32 v201,v200
s_nop 1
v_permlane16_swap_b32 v200,v201
Za 144,208,8
v_max_f32 v200,v200,v201
v_mov_b32 v201,v200
Ma 144,212,20
s_nop 0
v_permlane32_swap_b32 v200,v201
v_max_f32 v200,v200,v201
Ma 144,216,32
v_mul_f32 v200,-1.0,v200
v_mov_b32 v201,v200
Ma 144,220,44
v_mov_b32 v202,v200
v_mov_b32 v203,v200
Za 148,208,224
v_max3_f32 v204,v140,v141,v142
v_max_f32 v204,v204,v143
Ma 148,212,228
v_mov_b32 v205,v204
s_nop 1
v_permlane16_swap_b32 v204,v205
Ma 148,216,232
v_max_f32 v204,v204,v205
v_mov_b32 v205,v204
Ma 148,220,236
s_nop 0
v_permlane32_swap_b32 v204,v205
v_max_f32 v204,v204,v205
Ca 120,192,0,200
v_mul_f32 v204,-1.0,v204
v_mov_b32 v205,v204
Ma 120,196,12
v_mov_b32 v206,v204
v_mov_b32 v207,v204
Ma 120,200,24
v_max3_f32 v212,v148,v149,v150
v_max_f32 v212,v212,v151
Ma 120,204,36
v_mov_b32 v213,v212
s_nop 1
v_permlane16_swap_b32 v212,v213
Ca 124,192,4,204
v_max_f32 v212,v212,v213
v_mov_b32 v213,v212
Ma 124,196,16
s_nop 0
v_permlane32_swap_b32 v212,v213
v_max_f32 v212,v212,v213
Ma 124,200,28
v_mul_f32 v212,-1.0,v212
v_add_f32 v148,v148,v212
Ma 124,204,40
v_add_f32 v149,v149,v212
v_add_f32 v150,v150,v212
v_max3_f32 v208,v144,v145,v146
v_max_f32 v208,v208,v147
v_mov_b32 v209,v208
s_nop 1
v_permlane16_swap_b32 v208,v209
v_max_f32 v208,v208,v209
v_mov_b32 v209,v208
s_nop 1
v_permlane32_swap_b32 v208,v209
v_max_f32 v208,v208,v209
v_mul_f32 v208,-1.0,v208
v_mov_b32 v209,v208
v_mov_b32 v210,v208
v_mov_b32 v211,v208
s_nop 1
Ca 128,192,8,208
v_add_f32 v151,v151,v212
v_add_f32 v136,v136,v200
Ma 128,196,20
EX 148
Ma 128,200,32
EX 149
Ma 128,204,44
EX 150
EX 136
v_add_f32 v137,v137,v200
EX 137
v_add_f32 v138,v138,v200
EX 138
v_add_f32 v139,v139,v200
EX 139
CV 152,136,137
CV 153,138,139
CV 148,148,149
EX 151
s_nop 0
CV 149,150,151
ds_write_b64 v249,v[148:149] offset:4096
RD 208,254,512
LG 0
Ca 136,208,0,200
RD 212,254,576
RD 216,254,640
LG 1
Ma 136,212,12
RD 220,254,704
v_add_f32 v140,v140,v204
LG 1
Ma 136,216,24
v_add_f32 v141,v141,v204
v_add_f32 v142,v142,v204
LG 0
Ma 136,220,36
v_add_f32 v143,v143,v204
RD 192,254,768
EX 140
EX 141
EX 142
EX 143
CV 160,140,141
CV 161,142,143
Ca 140,208,4,204
RD 196,254,832
RD 200,254,896
Ma 140,212,16
RD 204,254,960
v_add_f32 v144,v144,v208
Ma 140,216,28
v_add_f32 v145,v145,v208
v_add_f32 v146,v146,v208
Ma 140,220,40
v_add_f32 v147,v147,v208
v_add_u32 v254,s23,v220
EX 144
EX 145
EX 146
EX 147
CV 168,144,145
CV 169,146,147
Ca 144,208,8,208
EX 120
Ma 144,212,20
EX 121
Ma 144,216,32
EX 122
Ma 144,220,44
EX 123
CV 154,120,121
CV 155,122,123
LG 3
Ca 120,192,0,200
EX 124
LG 2
Ma 120,196,12
EX 125
LG 1
Ma 120,200,24
EX 126
LG 0
Ma 120,204,36
EX 127
CV 162,124,125
CV 163,126,127
Ca 124,192,4,204
EX 128
Ma 124,196,16
EX 129
Ma 124,200,28
EX 130
Ma 124,204,40
EX 131
CV 170,128,129
CV 171,130,131
Ca 128,192,8,208
v_mov_b32 v213,v212
v_mov_b32 v214,v212
Ma 128,196,20
v_mov_b32 v215,v212
Ma 128,200,32
EX 136
Ma 128,204,44
EX 137
s_waitcnt vmcnt(16) lgkmcnt(0)
s_barrier
s_cmp_ge_u32 s21,28
s_cbranch_scc1 ProK_w0
ProK_r_w0:
EX 138
EX 139
CV 156,136,137
CV 157,138,139
EX 140
EX 141
EX 142
EX 143
CV 164,140,141
CV 165,142,143
EX 144
EX 145
EX 146
EX 147
CV 172,144,145
CV 173,146,147
EX 120
EX 121
EX 122
EX 123
CV 158,120,121
CV 159,122,123
EX 124
EX 125
EX 126
EX 127
CV 166,124,125
CV 167,126,127
EX 128
EX 129
EX 130
EX 131
CV 174,128,129
CV 175,130,131
s_sub_u32 s22,50688,s22
s_sub_u32 s25,185856,s25
s_add_u32 s21,s21,1
RD 192,254,0
RD 196,254,64
RD 200,254,128
RD 204,254,192
LG 0
Ca 120,192,0,200
s_add_u32 m0,s48,0
s_mov_b32 s48,s23
Ma 120,196,12
DM 250,16,0
s_add_u32 m0,m0,800
Ma 120,200,24
RD 244,249,4096
RD 248,249,5120
Ma 120,204,36
TR 208,248,64
TR 210,248,320
Ca 124,192,4,204
TR 212,248,576
TR 214,248,832
Ma 124,196,16
Ma 124,200,28
s_nop 0
EX 120
Ma 124,204,40
EX 121
Ca 128,192,8,208
TR 216,248,96
CV 176,120,121
Ma 128,196,20
TR 218,248,352
TR 220,248,608
Ma 128,200,32
TR 222,248,864
Ma 128,204,44
DM 251,16,256
s_add_u32 m0,m0,800
Ca 132,192,224,212
EX 122
Ma 132,196,228
EX 123
Ma 132,200,232
RD 192,254,256
CV 177,122,123
Ma 132,204,236
RD 196,254,320
LG 8
Zv 24,208,152
RD 200,254,384
LG 7
Mv 24,212,156
RD 204,254,448
Zv 28,208,160
EX 132
Mv 28,212,164
EX 133
Zv 32,208,168
EX 134
Mv 32,212,172
DM 252,16,512
s_add_u32 m0,m0,800
LG 6
Zv 36,216,152
EX 135
LG 4
Mv 36,220,156
CV 132,132,133
CV 133,134,135
Zv 40,216,160
ds_write_b64 v249,v[132:133] offset:6144
Mv 40,220,164
EX 124
Zv 44,216,168
TR 208,248,128
TR 210,248,384
Mv 44,220,172
TR 212,248,640
TR 214,248,896
LG 8
Ca 136,192,0,200
EX 125
LG 7
Ma 136,196,12
EX 126
LG 6
Ma 136,200,24
EX 127
LG 5
Ma 136,204,36
DM 253,16,768
s_add_u32 m0,s49,0
s_add_u32 s16,s16,16384
s_addc_u32 s17,s17,0
Ca 140,192,4,204
TR 216,248,160
CV 184,124,125
s_mov_b32 s49,s24
Ma 140,196,16
TR 218,248,416
CV 185,126,127
Ma 140,200,28
TR 220,248,672
TR 222,248,928
Ma 140,204,40
EX 128
Ca 144,192,8,208
EX 129
Ma 144,196,20
EX 130
Ma 144,200,32
RD 192,254,512
CV 192,128,129
Ma 144,204,44
RD 196,254,576
LG 8
Zv 48,208,152
RD 200,254,640
LG 7
Mv 48,212,156
DM 216,18,0
s_add_u32 m0,m0,800
Zv 52,208,160
RD 204,254,704
Mv 52,212,164
EX 131
Zv 56,208,168
CV 193,130,131
Mv 56,212,172
EX 136
LG 6
Zv 60,216,152
EX 137
LG 4
Mv 60,220,156
EX 138
Zv 64,216,160
EX 139
Mv 64,220,164
CV 178,136,137
CV 179,138,139
Zv 68,216,168
TR 208,248,192
TR 210,248,448
Mv 68,220,172
DM 217,18,256
s_add_u32 m0,m0,800
LG 5
Ca 120,192,0,200
TR 212,248,704
TR 214,248,960
LG 6
Ma 120,196,12
EX 140
LG 5
Ma 120,200,24
EX 141
LG 4
Ma 120,204,36
EX 142
Ca 124,192,4,204
TR 216,248,224
CV 186,140,141
Ma 124,196,16
TR 218,248,480
TR 220,248,736
Ma 124,200,28
TR 222,248,992
Ma 124,204,40
EX 143
Ca 128,192,8,208
CV 187,142,143
Ma 128,196,20
DM 218,18,512
s_add_u32 m0,m0,800
Ma 128,200,32
RD 192,254,768
Ma 128,204,44
RD 196,254,832
LG 8
Zv 72,208,152
RD 200,254,896
LG 7
Mv 72,212,156
RD 204,254,960
v_add_u32 v254,s22,v220
Zv 76,208,160
EX 144
Mv 76,212,164
EX 145
Zv 80,208,168
EX 146
Mv 80,212,172
EX 147
LG 6
Zv 84,216,152
CV 194,144,145
CV 195,146,147
LG 4
Mv 84,220,156
DM 219,18,768
s_add_u32 s18,s18,16384
s_addc_u32 s19,s19,0
Zv 88,216,160
EX 120
Mv 88,220,164
EX 121
Zv 92,216,168
TR 208,248,0
CV 180,120,121
Mv 92,220,172
TR 210,248,256
TR 212,248,512
LG 6
Ca 136,192,0,200
TR 214,248,768
LG 6
Ma 136,196,12
EX 122
LG 5
Ma 136,200,24
EX 123
LG 4
Ma 136,204,36
CV 181,122,123
Ca 140,192,4,204
EX 124
Ma 140,196,16
EX 125
Ma 140,200,28
TR 216,248,32
CV 188,124,125
Ma 140,204,40
TR 218,248,288
TR 220,248,544
Ca 144,192,8,208
TR 222,248,800
v_add_u32 v248,s25,v221
Ma 144,196,20
EX 126
Ma 144,200,32
EX 127
Ma 144,204,44
CV 189,126,127
LG 6
Zv 0,208,152
EX 128
LG 4
Mv 0,212,156
EX 129
Zv 4,208,160
EX 130
Mv 4,212,164
EX 131
Zv 8,208,168
CV 196,128,129
CV 197,130,131
Mv 8,212,172
EX 136
Za 96,208,244
EX 137
Ma 96,212,248
EX 138
LG 2
Zv 12,216,152
EX 139
LG 0
Mv 12,220,156
CV 182,136,137
CV 183,138,139
s_waitcnt vmcnt(16) lgkmcnt(0)
s_barrier
s_cmp_ge_u32 s21,28
s_cbranch_scc1 It0K_w0
It0K_r_w0:
Zv 16,216,160
RD 192,254,0
RD 196,254,64
s_sub_u32 s23,101376,s23
s_sub_u32 s24,135168,s24
Mv 16,220,164
RD 200,254,128
RD 204,254,192
s_add_u32 s21,s21,1
Zv 20,216,168
EX 140
Mv 20,220,172
EX 141
Za 100,216,244
EX 142
Ma 100,220,248
EX 143
Zv 104,240,152
CV 190,140,141
CV 191,142,143
Mv 104,240,156
EX 144
Zv 108,240,160
EX 145
Mv 108,240,164
EX 146
Zv 112,240,168
EX 147
Mv 112,240,172
CV 198,144,145
CV 199,146,147
Za 116,240,244
Ma 116,240,248
s_mov_b32 s20,3
LI_w0:
LG 0
Ca 120,192,0,200
s_add_u32 m0,s48,0
s_mov_b32 s48,s22
Ma 120,196,12
DM 250,16,0
s_add_u32 m0,m0,800
Ma 120,200,24
RD 244,249,6144
RD 248,249,7168
Ma 120,204,36
TR 208,248,64
TR 210,248,320
Ca 124,192,4,204
TR 212,248,576
TR 214,248,832
Ma 124,196,16
Ma 124,200,28
s_nop 0
EX 120
Ma 124,204,40
EX 121
Ca 128,192,8,208
TR 216,248,96
CV 152,120,121
Ma 128,196,20
TR 218,248,352
TR 220,248,608
Ma 128,200,32
TR 222,248,864
Ma 128,204,44
DM 251,16,256
s_add_u32 m0,m0,800
Ca 132,192,224,212
EX 122
Ma 132,196,228
EX 123
Ma 132,200,232
RD 192,254,256
CV 153,122,123
Ma 132,204,236
RD 196,254,320
LG 8
Mv 24,208,176
RD 200,254,384
LG 7
Mv 24,212,180
RD 204,254,448
Mv 28,208,184
EX 132
Mv 28,212,188
EX 133
Mv 32,208,192
EX 134
Mv 32,212,196
DM 252,16,512
s_add_u32 m0,m0,800
LG 6
Mv 36,216,176
EX 135
LG 4
Mv 36,220,180
CV 132,132,133
CV 133,134,135
Mv 40,216,184
ds_write_b64 v249,v[132:133] offset:4096
Mv 40,220,188
EX 124
Mv 44,216,192
TR 208,248,128
TR 210,248,384
Mv 44,220,196
TR 212,248,640
TR 214,248,896
LG 8
Ca 136,192,0,200
EX 125
LG 7
Ma 136,196,12
EX 126
LG 6
Ma 136,200,24
EX 127
LG 5
Ma 136,204,36
DM 253,16,768
s_add_u32 m0,s49,0
s_add_u32 s16,s16,16384
s_addc_u32 s17,s17,0
Ca 140,192,4,204
TR 216,248,160
CV 160,124,125
s_mov_b32 s49,s25
Ma 140,196,16
TR 218,248,416
CV 161,126,127
Ma 140,200,28
TR 220,248,672
TR 222,248,928
Ma 140,204,40
EX 128
Ca 144,192,8,208
EX 129
Ma 144,196,20
EX 130
Ma 144,200,32
RD 192,254,512
CV 168,128,129
Ma 144,204,44
RD 196,254,576
LG 8
Mv 48,208,176
RD 200,254,640
LG 7
Mv 48,212,180
DM 216,18,0
s_add_u32 m0,m0,800
Mv 52,208,184
RD 204,254,704
Mv 52,212,188
EX 131
Mv 56,208,192
CV 169,130,131
Mv 56,212,196
EX 136
LG 6
Mv 60,216,176
EX 137
LG 4
Mv 60,220,180
EX 138
Mv 64,216,184
EX 139
Mv 64,220,188
CV 154,136,137
CV 155,138,139
Mv 68,216,192
TR 208,248,192
TR 210,248,448
Mv 68,220,196
DM 217,18,256
s_add_u32 m0,m0,800
LG 5
Ca 120,192,0,200
TR 212,248,704
TR 214,248,960
LG 6
Ma 120,196,12
EX 140
LG 5
Ma 120,200,24
EX 141
LG 4
Ma 120,204,36
EX 142
Ca 124,192,4,204
TR 216,248,224
CV 162,140,141
Ma 124,196,16
TR 218,248,480
TR 220,248,736
Ma 124,200,28
TR 222,248,992
Ma 124,204,40
EX 143
Ca 128,192,8,208
CV 163,142,143
Ma 128,196,20
DM 218,18,512
s_add_u32 m0,m0,800
Ma 128,200,32
RD 192,254,768
Ma 128,204,44
RD 196,254,832
LG 8
Mv 72,208,176
RD 200,254,896
LG 7
Mv 72,212,180
RD 204,254,960
v_add_u32 v254,s23,v220
Mv 76,208,184
EX 144
Mv 76,212,188
EX 145
Mv 80,208,192
EX 146
Mv 80,212,196
EX 147
LG 6
Mv 84,216,176
CV 170,144,145
CV 171,146,147
LG 4
Mv 84,220,180
DM 219,18,768
s_add_u32 s18,s18,16384
s_addc_u32 s19,s19,0
Mv 88,216,184
EX 120
Mv 88,220,188
EX 121
Mv 92,216,192
TR 208,248,0
CV 156,120,121
Mv 92,220,196
TR 210,248,256
TR 212,248,512
LG 6
Ca 136,192,0,200
TR 214,248,768
LG 6
Ma 136,196,12
EX 122
LG 5
Ma 136,200,24
EX 123
LG 4
Ma 136,204,36
CV 157,122,123
Ca 140,192,4,204
EX 124
Ma 140,196,16
EX 125
Ma 140,200,28
TR 216,248,32
CV 164,124,125
Ma 140,204,40
TR 218,248,288
TR 220,248,544
Ca 144,192,8,208
TR 222,248,800
v_add_u32 v248,s24,v221
Ma 144,196,20
EX 126
Ma 144,200,32
EX 127
Ma 144,204,44
CV 165,126,127
LG 6
Mv 0,208,176
EX 128
LG 4
Mv 0,212,180
EX 129
Mv 4,208,184
EX 130
Mv 4,212,188
EX 131
Mv 8,208,192
CV 172,128,129
CV 173,130,131
Mv 8,212,196
EX 136
Ma 96,208,244
EX 137
Ma 96,212,248
EX 138
LG 2
Mv 12,216,176
EX 139
LG 0
Mv 12,220,180
CV 158,136,137
CV 159,138,139
s_waitcnt vmcnt(16) lgkmcnt(0)
s_barrier
s_cmp_ge_u32 s21,28
s_cbranch_scc1 ItOK_w0
ItOK_r_w0:
Mv 16,216,184
RD 192,254,0
RD 196,254,64
s_sub_u32 s22,50688,s22
s_sub_u32 s25,185856,s25
Mv 16,220,188
RD 200,254,128
RD 204,254,192
s_add_u32 s21,s21,1
Mv 20,216,192
EX 140
Mv 20,220,196
EX 141
Ma 100,216,244
EX 142
Ma 100,220,248
EX 143
Mv 104,240,176
CV 166,140,141
CV 167,142,143
Mv 104,240,180
EX 144
Mv 108,240,184
EX 145
Mv 108,240,188
EX 146
Mv 112,240,192
EX 147
Mv 112,240,196
CV 174,144,145
CV 175,146,147
Ma 116,240,244
Ma 116,240,248
LG 0
Ca 120,192,0,200
s_add_u32 m0,s48,0
s_mov_b32 s48,s23
Ma 120,196,12
DM 250,16,0
s_add_u32 m0,m0,800
Ma 120,200,24
RD 244,249,4096
RD 248,249,5120
Ma 120,204,36
TR 208,248,64
TR 210,248,320
Ca 124,192,4,204
TR 212,248,576
TR 214,248,832
Ma 124,196,16
Ma 124,200,28
s_nop 0
EX 120
Ma 124,204,40
EX 121
Ca 128,192,8,208
TR 216,248,96
CV 176,120,121
Ma 128,196,20
TR 218,248,352
TR 220,248,608
Ma 128,200,32
TR 222,248,864
Ma 128,204,44
DM 251,16,256
s_add_u32 m0,m0,800
Ca 132,192,224,212
EX 122
Ma 132,196,228
EX 123
Ma 132,200,232
RD 192,254,256
CV 177,122,123
Ma 132,204,236
RD 196,254,320
LG 8
Mv 24,208,152
RD 200,254,384
LG 7
Mv 24,212,156
RD 204,254,448
Mv 28,208,160
EX 132
Mv 28,212,164
EX 133
Mv 32,208,168
EX 134
Mv 32,212,172
DM 252,16,512
s_add_u32 m0,m0,800
LG 6
Mv 36,216,152
EX 135
LG 4
Mv 36,220,156
CV 132,132,133
CV 133,134,135
Mv 40,216,160
ds_write_b64 v249,v[132:133] offset:6144
Mv 40,220,164
EX 124
Mv 44,216,168
TR 208,248,128
TR 210,248,384
Mv 44,220,172
TR 212,248,640
TR 214,248,896
LG 8
Ca 136,192,0,200
EX 125
LG 7
Ma 136,196,12
EX 126
LG 6
Ma 136,200,24
EX 127
LG 5
Ma 136,204,36
DM 253,16,768
s_add_u32 m0,s49,0
s_add_u32 s16,s16,16384
s_addc_u32 s17,s17,0
Ca 140,192,4,204
TR 216,248,160
CV 184,124,125
s_mov_b32 s49,s24
Ma 140,196,16
TR 218,248,416
CV 185,126,127
Ma 140,200,28
TR 220,248,672
TR 222,248,928
Ma 140,204,40
EX 128
Ca 144,192,8,208
EX 129
Ma 144,196,20
EX 130
Ma 144,200,32
RD 192,254,512
CV 192,128,129
Ma 144,204,44
RD 196,254,576
LG 8
Mv 48,208,152
RD 200,254,640
LG 7
Mv 48,212,156
DM 216,18,0
s_add_u32 m0,m0,800
Mv 52,208,160
RD 204,254,704
Mv 52,212,164
EX 131
Mv 56,208,168
CV 193,130,131
Mv 56,212,172
EX 136
LG 6
Mv 60,216,152
EX 137
LG 4
Mv 60,220,156
EX 138
Mv 64,216,160
EX 139
Mv 64,220,164
CV 178,136,137
CV 179,138,139
Mv 68,216,168
TR 208,248,192
TR 210,248,448
Mv 68,220,172
DM 217,18,256
s_add_u32 m0,m0,800
LG 5
Ca 120,192,0,200
TR 212,248,704
TR 214,248,960
LG 6
Ma 120,196,12
EX 140
LG 5
Ma 120,200,24
EX 141
LG 4
Ma 120,204,36
EX 142
Ca 124,192,4,204
TR 216,248,224
CV 186,140,141
Ma 124,196,16
TR 218,248,480
TR 220,248,736
Ma 124,200,28
TR 222,248,992
Ma 124,204,40
EX 143
Ca 128,192,8,208
CV 187,142,143
Ma 128,196,20
DM 218,18,512
s_add_u32 m0,m0,800
Ma 128,200,32
RD 192,254,768
Ma 128,204,44
RD 196,254,832
LG 8
Mv 72,208,152
RD 200,254,896
LG 7
Mv 72,212,156
RD 204,254,960
v_add_u32 v254,s22,v220
Mv 76,208,160
EX 144
Mv 76,212,164
EX 145
Mv 80,208,168
EX 146
Mv 80,212,172
EX 147
LG 6
Mv 84,216,152
CV 194,144,145
CV 195,146,147
LG 4
Mv 84,220,156
DM 219,18,768
s_add_u32 s18,s18,16384
s_addc_u32 s19,s19,0
Mv 88,216,160
EX 120
Mv 88,220,164
EX 121
Mv 92,216,168
TR 208,248,0
CV 180,120,121
Mv 92,220,172
TR 210,248,256
TR 212,248,512
LG 6
Ca 136,192,0,200
TR 214,248,768
LG 6
Ma 136,196,12
EX 122
LG 5
Ma 136,200,24
EX 123
LG 4
Ma 136,204,36
CV 181,122,123
Ca 140,192,4,204
EX 124
Ma 140,196,16
EX 125
Ma 140,200,28
TR 216,248,32
CV 188,124,125
Ma 140,204,40
TR 218,248,288
TR 220,248,544
Ca 144,192,8,208
TR 222,248,800
v_add_u32 v248,s25,v221
Ma 144,196,20
EX 126
Ma 144,200,32
EX 127
Ma 144,204,44
CV 189,126,127
LG 6
Mv 0,208,152
EX 128
LG 4
Mv 0,212,156
EX 129
Mv 4,208,160
EX 130
Mv 4,212,164
EX 131
Mv 8,208,168
CV 196,128,129
CV 197,130,131
Mv 8,212,172
EX 136
Ma 96,208,244
EX 137
Ma 96,212,248
EX 138
LG 2
Mv 12,216,152
EX 139
LG 0
Mv 12,220,156
CV 182,136,137
CV 183,138,139
s_waitcnt vmcnt(16) lgkmcnt(0)
s_barrier
s_cmp_ge_u32 s21,28
s_cbranch_scc1 ItEK_w0
ItEK_r_w0:
Mv 16,216,160
RD 192,254,0
RD 196,254,64
s_sub_u32 s23,101376,s23
s_sub_u32 s24,135168,s24
Mv 16,220,164
RD 200,254,128
RD 204,254,192
s_add_u32 s21,s21,1
Mv 20,216,168
EX 140
Mv 20,220,172
EX 141
Ma 100,216,244
EX 142
Ma 100,220,248
EX 143
Mv 104,240,152
CV 190,140,141
CV 191,142,143
Mv 104,240,156
EX 144
Mv 108,240,160
EX 145
Mv 108,240,164
EX 146
Mv 112,240,168
EX 147
Mv 112,240,172
CV 198,144,145
CV 199,146,147
Ma 116,240,244
Ma 116,240,248
s_sub_u32 s20,s20,1
s_cmp_lg_u32 s20,0
s_cbranch_scc1 LI_w0
LG 0
Mv 104,240,176
RD 244,249,6144
Mv 104,240,180
RD 248,249,7168
Mv 108,240,184
TR 208,248,64
TR 210,248,320
Mv 108,240,188
TR 212,248,576
TR 214,248,832
Mv 112,240,192
TR 216,248,96
TR 218,248,352
Mv 112,240,196
TR 220,248,608
TR 222,248,864
LG 9
Ma 116,240,244
LG 8
Ma 116,240,248
s_nop 7
v_cmp_nge_f32 vcc,s27,v104
v_cmp_nle_f32_e64 s[72:73],v108,s27
s_nop 1
s_or_b64 vcc,vcc,s[72:73]
v_cmp_nle_f32_e64 s[72:73],v112,s27
s_nop 1
s_or_b64 vcc,vcc,s[72:73]
v_cmp_nle_f32_e64 s[72:73],v116,s27
s_nop 1
s_or_b64 vcc,vcc,s[72:73]
s_cbranch_vccnz SLOW_w0
LG 6
Mv 24,208,176
v_rcp_f32 v224,v104
s_add_u32 m0,s48,0
LG 4
Mv 24,212,180
v_rcp_f32 v226,v108
Mv 28,208,184
v_rcp_f32 v228,v112
Mv 28,212,188
v_rcp_f32 v230,v116
Mv 32,208,192
TR 192,248,128
TR 194,248,384
Mv 32,212,196
DM 250,16,0
s_add_u32 m0,m0,800
LG 4
Mv 36,216,176
TR 196,248,640
TR 198,248,896
LG 4
Mv 36,220,180
DM 251,16,256
s_add_u32 m0,m0,800
Mv 40,216,184
TR 200,248,160
MU 24,v224
Mv 40,220,188
TR 202,248,416
MU 25,v224
Mv 44,216,192
TR 204,248,672
TR 206,248,928
Mv 44,220,196
DM 252,16,512
s_add_u32 m0,m0,800
LG 6
Mv 48,192,176
TR 208,248,192
MU 26,v224
LG 5
Mv 48,196,180
TR 210,248,448
MU 27,v224
Mv 52,192,184
TR 212,248,704
MU 36,v224
Mv 52,196,188
TR 214,248,960
MU 37,v224
Mv 56,192,192
DM 253,16,768
s_add_u32 m0,s49,0
s_add_u32 s16,s16,16384
s_addc_u32 s17,s17,0
Mv 56,196,196
TR 216,248,224
MU 38,v224
LG 7
Mv 60,200,176
TR 218,248,480
MU 39,v224
LG 6
Mv 60,204,180
TR 220,248,736
CV 24,24,25
Mv 64,200,184
TR 222,248,992
CV 25,26,27
Mv 64,204,188
DM 216,18,0
s_add_u32 m0,m0,800
Mv 68,200,192
TR 192,248,0
CV 26,36,37
Mv 68,204,196
TR 194,248,256
CV 27,38,39
LG 8
Mv 72,208,176
TR 196,248,512
MU 28,v226
LG 7
Mv 72,212,180
TR 198,248,768
MU 29,v226
Mv 76,208,184
DM 217,18,256
s_add_u32 m0,m0,800
Mv 76,212,188
MU 30,v226
MU 31,v226
Mv 80,208,192
MU 40,v226
MU 41,v226
Mv 80,212,196
MU 42,v226
MU 43,v226
LG 6
Mv 84,216,176
TR 200,248,32
CV 28,28,29
LG 5
Mv 84,220,180
DM 218,18,512
s_add_u32 m0,m0,800
Mv 88,216,184
TR 202,248,288
CV 29,30,31
Mv 88,220,188
TR 204,248,544
CV 30,40,41
Mv 92,216,192
TR 206,248,800
CV 31,42,43
Mv 92,220,196
MU 32,v228
MU 33,v228
LG 6
Mv 0,192,176
DM 219,18,768
s_add_u32 s18,s18,16384
s_addc_u32 s19,s19,0
LG 4
Mv 0,196,180
MU 34,v228
MU 35,v228
Mv 4,192,184
MU 44,v228
MU 45,v228
Mv 4,196,188
MU 46,v228
MU 47,v228
Mv 8,192,192
CV 32,32,33
CV 33,34,35
Mv 8,196,196
CV 34,44,45
CV 35,46,47
Ma 96,192,244
MU 48,v224
MU 49,v224
Ma 96,196,248
MU 50,v224
MU 51,v224
LG 2
Mv 12,200,176
MU 60,v224
MU 61,v224
LG 0
Mv 12,204,180
MU 62,v224
MU 63,v224
Mv 16,200,184
CV 48,48,49
CV 49,50,51
Mv 16,204,188
CV 50,60,61
CV 51,62,63
Mv 20,200,192
MU 52,v226
MU 53,v226
Mv 20,204,196
MU 54,v226
MU 55,v226
Ma 100,200,244
MU 64,v226
MU 65,v226
Ma 100,204,248
MU 66,v226
MU 67,v226
CV 52,52,53
CV 53,54,55
CV 54,64,65
CV 55,66,67
MU 56,v228
MU 57,v228
MU 58,v228
MU 59,v228
MU 68,v228
MU 69,v228
MU 70,v228
MU 71,v228
CV 56,56,57
CV 57,58,59
CV 58,68,69
CV 59,70,71
v_pk_mul_f32 v[72:73],v[72:73],v[224:225] op_sel_hi:[1,0]
v_pk_mul_f32 v[74:75],v[74:75],v[224:225] op_sel_hi:[1,0]
v_pk_mul_f32 v[84:85],v[84:85],v[224:225] op_sel_hi:[1,0]
v_pk_mul_f32 v[86:87],v[86:87],v[224:225] op_sel_hi:[1,0]
CV 72,72,73
CV 73,74,75
CV 74,84,85
CV 75,86,87
v_pk_mul_f32 v[76:77],v[76:77],v[226:227] op_sel_hi:[1,0]
v_pk_mul_f32 v[78:79],v[78:79],v[226:227] op_sel_hi:[1,0]
v_pk_mul_f32 v[88:89],v[88:89],v[226:227] op_sel_hi:[1,0]
v_pk_mul_f32 v[90:91],v[90:91],v[226:227] op_sel_hi:[1,0]
CV 76,76,77
CV 77,78,79
CV 78,88,89
CV 79,90,91
v_pk_mul_f32 v[80:81],v[80:81],v[228:229] op_sel_hi:[1,0]
v_pk_mul_f32 v[82:83],v[82:83],v[228:229] op_sel_hi:[1,0]
v_pk_mul_f32 v[92:93],v[92:93],v[228:229] op_sel_hi:[1,0]
v_pk_mul_f32 v[94:95],v[94:95],v[228:229] op_sel_hi:[1,0]
CV 80,80,81
CV 81,82,83
CV 82,92,93
CV 83,94,95
v_pk_mul_f32 v[0:1],v[0:1],v[224:225] op_sel_hi:[1,0]
v_pk_mul_f32 v[2:3],v[2:3],v[224:225] op_sel_hi:[1,0]
v_pk_mul_f32 v[12:13],v[12:13],v[224:225] op_sel_hi:[1,0]
v_pk_mul_f32 v[14:15],v[14:15],v[224:225] op_sel_hi:[1,0]
CV 0,0,1
CV 1,2,3
CV 2,12,13
CV 3,14,15
v_pk_mul_f32 v[4:5],v[4:5],v[226:227] op_sel_hi:[1,0]
v_pk_mul_f32 v[6:7],v[6:7],v[226:227] op_sel_hi:[1,0]
v_pk_mul_f32 v[16:17],v[16:17],v[226:227] op_sel_hi:[1,0]
v_pk_mul_f32 v[18:19],v[18:19],v[226:227] op_sel_hi:[1,0]
CV 4,4,5
CV 5,6,7
CV 6,16,17
CV 7,18,19
v_pk_mul_f32 v[8:9],v[8:9],v[228:229] op_sel_hi:[1,0]
v_pk_mul_f32 v[10:11],v[10:11],v[228:229] op_sel_hi:[1,0]
v_pk_mul_f32 v[20:21],v[20:21],v[228:229] op_sel_hi:[1,0]
v_pk_mul_f32 v[22:23],v[22:23],v[228:229] op_sel_hi:[1,0]
CV 8,8,9
CV 9,10,11
CV 10,20,21
CV 11,22,23
v_pk_mul_f32 v[96:97],v[96:97],v[230:231] op_sel_hi:[1,0]
v_pk_mul_f32 v[98:99],v[98:99],v[230:231] op_sel_hi:[1,0]
v_pk_mul_f32 v[100:101],v[100:101],v[230:231] op_sel_hi:[1,0]
v_pk_mul_f32 v[102:103],v[102:103],v[230:231] op_sel_hi:[1,0]
CV 96,96,97
CV 97,98,99
CV 98,100,101
CV 99,102,103
SLOW_r_w0:
s_cmp_eq_u32 s34,0
s_cbranch_scc0 EB1_w0
v_mov_b32 v254,v220
RD 208,254,0
RD 212,254,64
RD 216,254,128
RD 220,254,192
RD 192,254,256
RD 196,254,320
RD 200,254,384
RD 204,254,448
RD 224,249,20480
RD 228,249,21504
RD 232,249,22528
RD 236,249,23552
ds_write_b128 v249,v[96:99] offset:16384
AM 0,48
AM 1,49
AM 2,50
AM 3,51
AM 4,52
AM 5,53
AM 6,54
AM 7,55
AM 8,56
AM 9,57
AM 10,58
AM 11,59
AM 12,60
AM 13,61
AM 14,62
AM 15,63
AM 16,64
AM 17,65
AM 18,66
AM 19,67
AM 20,68
AM 21,69
AM 22,70
AM 23,71
AM 24,72
AM 25,73
AM 26,74
AM 27,75
AM 28,76
AM 29,77
AM 30,78
AM 31,79
AM 32,80
AM 33,81
AM 34,82
AM 35,83
AM 36,84
AM 37,85
AM 38,86
AM 39,87
AM 40,88
AM 41,89
AM 42,90
AM 43,91
AM 44,92
AM 45,93
AM 46,94
AM 47,95
AW 48,0
AW 49,1
AW 50,2
AW 51,3
AW 52,4
AW 53,5
AW 54,6
AW 55,7
AW 56,8
AW 57,9
AW 58,10
AW 59,11
AW 60,24
AW 61,25
AW 62,26
AW 63,27
AW 64,28
AW 65,29
AW 66,30
AW 67,31
AW 68,32
AW 69,33
AW 70,34
AW 71,35
AW 72,48
AW 73,49
AW 74,50
AW 75,51
AW 76,52
AW 77,53
AW 78,54
AW 79,55
AW 80,56
AW 81,57
AW 82,58
AW 83,59
AW 84,72
AW 85,73
AW 86,74
AW 87,75
AW 88,76
AW 89,77
AW 90,78
AW 91,79
AW 92,80
AW 93,81
AW 94,82
AW 95,83
s_add_u32 s34,s34,1
s_branch LB_w0
EB1_w0:
s_cmp_eq_u32 s34,1
s_cbranch_scc0 EB2_w0
v_mov_b32 v254,v220
LG 12
RD 208,254,0
LG 12
RD 212,254,64
LG 12
RD 216,254,128
LG 12
RD 220,254,192
LG 12
RD 192,254,256
LG 12
RD 196,254,320
LG 12
RD 200,254,384
LG 12
RD 204,254,448
LG 12
RD 224,249,24576
LG 12
RD 228,249,25600
LG 12
RD 232,249,26624
LG 12
RD 236,249,27648
ds_write_b128 v249,v[96:99] offset:20480
AM 0,96
AM 1,97
AM 2,98
AM 3,99
AM 4,100
AM 5,101
AM 6,102
AM 7,103
AM 8,104
AM 9,105
AM 10,106
AM 11,107
AM 12,108
AM 13,109
AM 14,110
AM 15,111
AM 16,112
AM 17,113
AM 18,114
AM 19,115
AM 20,116
AM 21,117
AM 22,118
AM 23,119
AM 24,120
AM 25,121
AM 26,122
AM 27,123
AM 28,124
AM 29,125
AM 30,126
AM 31,127
AM 32,128
AM 33,129
AM 34,130
AM 35,131
AM 36,132
AM 37,133
AM 38,134
AM 39,135
AM 40,136
AM 41,137
AM 42,138
AM 43,139
AM 44,140
AM 45,141
AM 46,142
AM 47,143
AW 96,0
AW 97,1
AW 98,2
AW 99,3
AW 100,4
AW 101,5
AW 102,6
AW 103,7
AW 104,8
AW 105,9
AW 106,10
AW 107,11
AW 108,24
AW 109,25
AW 110,26
AW 111,27
AW 112,28
AW 113,29
AW 114,30
AW 115,31
AW 116,32
AW 117,33
AW 118,34
AW 119,35
AW 120,48
AW 121,49
AW 122,50
AW 123,51
AW 124,52
AW 125,53
AW 126,54
AW 127,55
AW 128,56
AW 129,57
AW 130,58
AW 131,59
AW 132,72
AW 133,73
AW 134,74
AW 135,75
AW 136,76
AW 137,77
AW 138,78
AW 139,79
AW 140,80
AW 141,81
AW 142,82
AW 143,83
s_add_u32 s34,s34,1
s_branch LB_w0
EB2_w0:
s_cmp_eq_u32 s34,2
s_cbranch_scc0 EB3_w0
v_mov_b32 v254,v220
LG 12
RD 208,254,0
LG 12
RD 212,254,64
LG 12
RD 216,254,128
LG 12
RD 220,254,192
LG 12
RD 192,254,256
LG 12
RD 196,254,320
LG 12
RD 200,254,384
LG 12
RD 204,254,448
LG 12
RD 224,249,0
LG 12
RD 228,249,1024
LG 12
RD 232,249,2048
LG 12
RD 236,249,3072
ds_write_b128 v249,v[96:99] offset:24576
AM 0,144
AM 1,145
AM 2,146
AM 3,147
AM 4,148
AM 5,149
AM 6,150
AM 7,151
AM 8,152
AM 9,153
AM 10,154
AM 11,155
AM 12,156
AM 13,157
AM 14,158
AM 15,159
AM 16,160
AM 17,161
AM 18,162
AM 19,163
AM 20,164
AM 21,165
AM 22,166
AM 23,167
AM 24,168
AM 25,169
AM 26,170
AM 27,171
AM 28,172
AM 29,173
AM 30,174
AM 31,175
AM 32,176
AM 33,177
AM 34,178
AM 35,179
AM 36,180
AM 37,181
AM 38,182
AM 39,183
AM 40,184
AM 41,185
AM 42,186
AM 43,187
AM 44,188
AM 45,189
AM 46,190
AM 47,191
AW 144,0
AW 145,1
AW 146,2
AW 147,3
AW 148,4
AW 149,5
AW 150,6
AW 151,7
AW 152,8
AW 153,9
AW 154,10
AW 155,11
AW 156,24
AW 157,25
AW 158,26
AW 159,27
AW 160,28
AW 161,29
AW 162,30
AW 163,31
AW 164,32
AW 165,33
AW 166,34
AW 167,35
AW 168,48
AW 169,49
AW 170,50
AW 171,51
AW 172,52
AW 173,53
AW 174,54
AW 175,55
AW 176,56
AW 177,57
AW 178,58
AW 179,59
AW 180,72
AW 181,73
AW 182,74
AW 183,75
AW 184,76
AW 185,77
AW 186,78
AW 187,79
AW 188,80
AW 189,81
AW 190,82
AW 191,83
s_add_u32 s34,s34,1
s_branch LB_w0
EB3_w0:
ds_write_b128 v249,v[96:99] offset:0
AW 0,0
AW 1,1
AW 2,2
AW 3,3
AW 4,4
AW 5,5
AW 6,6
AW 7,7
AW 8,8
AW 9,9
AW 10,10
AW 11,11
AW 12,24
AW 13,25
AW 14,26
AW 15,27
AW 16,28
AW 17,29
AW 18,30
AW 19,31
AW 20,32
AW 21,33
AW 22,34
AW 23,35
AW 24,48
AW 25,49
AW 26,50
AW 27,51
AW 28,52
AW 29,53
AW 30,54
AW 31,55
AW 32,56
AW 33,57
AW 34,58
AW 35,59
AW 36,72
AW 37,73
AW 38,74
AW 39,75
AW 40,76
AW 41,77
AW 42,78
AW 43,79
AW 44,80
AW 45,81
AW 46,82
AW 47,83
v_mov_b32 v248,v221
s_mov_b32 s20,0
s_waitcnt vmcnt(20) lgkmcnt(0)
s_barrier
TR 192,248,0
TR 194,248,256
TR 196,248,512
TR 198,248,768
TR 200,248,16896
TR 202,248,17152
TR 204,248,17408
TR 206,248,17664
RD 224,249,16384
RD 228,249,17408
RD 232,249,18432
RD 236,249,19456
s_add_u32 s16,s12,393216
s_addc_u32 s17,s13,0
s_add_u32 s18,s12,458752
s_addc_u32 s19,s13,0
s_mov_b64 s[36:37],0
LC_w0:
LG 0
Za 0,192,48
s_mov_b32 m0,101376
TR 208,248,32
s_add_u32 s32,s14,0
s_addc_u32 s33,s15,0
Ma 0,196,60
DW 250,16,0
s_mov_b32 m0,102176
Ma 0,200,72
TR 210,248,288
Ma 0,204,84
TR 212,248,544
Za 4,192,52
TR 214,248,800
Ma 4,196,64
TR 216,248,16928
Ma 4,200,76
TR 218,248,17184
Ma 4,204,88
TR 220,248,17440
Za 8,192,56
TR 222,248,17696
Ma 8,196,68
DW 251,16,256
s_mov_b32 m0,102976
Ma 8,200,80
Ma 8,204,92
Za 96,192,224
TR 192,248,64
Ma 96,196,228
TR 194,248,320
Ma 96,200,232
TR 196,248,576
Ma 96,204,236
s_mov_b64 exec,s[36:37]
global_store_dwordx4 v249,v[104:107],s[32:33] offset:0 sc1
s_mov_b64 exec,-1
LG 9
Za 12,208,48
TR 198,248,832
LG 8
Ma 12,212,60
TR 200,248,16960
LG 7
Ma 12,216,72
TR 202,248,17216
LG 6
Ma 12,220,84
TR 204,248,17472
Za 16,208,52
TR 206,248,17728
Ma 16,212,64
Ma 16,216,76
DW 252,16,512
s_mov_b32 m0,103776
Ma 16,220,88
Za 20,208,56
Ma 20,212,68
Ma 20,216,80
Ma 20,220,92
Za 100,208,224
TR 208,248,96
Ma 100,212,228
DW 253,16,768
s_mov_b32 m0,118272
Ma 100,216,232
TR 210,248,352
Ma 100,220,236
TR 212,248,608
LG 9
Za 24,192,48
TR 214,248,864
LG 8
Ma 24,196,60
TR 216,248,16992
LG 7
Ma 24,200,72
TR 218,248,17248
LG 6
Ma 24,204,84
TR 220,248,17504
Za 28,192,52
TR 222,248,17760
Ma 28,196,64
s_mov_b64 exec,s[36:37]
global_store_dwordx4 v249,v[108:111],s[32:33] offset:1024 sc1
s_mov_b64 exec,-1
Ma 28,200,76
Ma 28,204,88
Za 32,192,56
TR 192,248,128
Ma 32,196,68
TR 194,248,384
Ma 32,200,80
TR 196,248,640
Ma 32,204,92
DW 250,18,0
s_mov_b32 m0,119072
LG 9
Za 36,208,48
TR 198,248,896
LG 8
Ma 36,212,60
TR 200,248,17024
LG 7
Ma 36,216,72
TR 202,248,17280
LG 6
Ma 36,220,84
TR 204,248,17536
Za 40,208,52
TR 206,248,17792
Ma 40,212,64
Ma 40,216,76
DW 251,18,256
s_mov_b32 m0,119872
Ma 40,220,88
Za 44,208,56
TR 208,248,160
Ma 44,212,68
TR 210,248,416
Ma 44,216,80
TR 212,248,672
Ma 44,220,92
TR 214,248,928
LG 10
Za 48,192,48
TR 216,248,17056
LG 9
Ma 48,196,60
s_mov_b64 exec,s[36:37]
global_store_dwordx4 v249,v[112:115],s[32:33] offset:2048 sc1
s_mov_b64 exec,-1
LG 7
Ma 48,200,72
TR 218,248,17312
LG 6
Ma 48,204,84
TR 220,248,17568
Za 52,192,52
TR 222,248,17824
Ma 52,196,64
Ma 52,200,76
Ma 52,204,88
Za 56,192,56
DW 252,18,512
s_mov_b32 m0,120672
Ma 56,196,68
TR 192,248,192
Ma 56,200,80
TR 194,248,448
Ma 56,204,92
TR 196,248,704
LG 9
Za 60,208,48
TR 198,248,960
LG 8
Ma 60,212,60
TR 200,248,17088
LG 7
Ma 60,216,72
TR 202,248,17344
LG 6
Ma 60,220,84
DW 253,18,768
s_mov_b32 m0,0
Za 64,208,52
TR 204,248,17600
Ma 64,212,64
TR 206,248,17856
Ma 64,216,76
Ma 64,220,88
Za 68,208,56
TR 208,248,224
Ma 68,212,68
TR 210,248,480
Ma 68,216,80
TR 212,248,736
Ma 68,220,92
TR 214,248,992
LG 10
Za 72,192,48
TR 216,248,17120
LG 9
Ma 72,196,60
TR 218,248,17376
LG 8
Ma 72,200,72
TR 220,248,17632
LG 7
Ma 72,204,84
TR 222,248,17888
Za 76,192,52
Ma 76,196,64
Ma 76,200,76
Ma 76,204,88
Za 80,192,56
Ma 80,196,68
Ma 80,200,80
Ma 80,204,92
LG 6
Za 84,208,48
LG 4
Ma 84,212,60
LG 2
Ma 84,216,72
LG 0
Ma 84,220,84
s_waitcnt vmcnt(19) lgkmcnt(0)
s_barrier
s_cmp_eq_u32 s20,3
s_cbranch_scc1 Calt1_w0
s_add_u32 s16,s12,256
s_addc_u32 s17,s13,0
s_add_u32 s18,s12,65792
s_addc_u32 s19,s13,0
Calt1_r_w0:
Za 88,208,52
TR 192,248,33792
Ma 88,212,64
TR 194,248,34048
Ma 88,216,76
TR 196,248,34304
Ma 88,220,88
TR 198,248,34560
Za 92,208,56
TR 200,248,50688
TR 202,248,50944
Ma 92,212,68
TR 204,248,51200
TR 206,248,51456
Ma 92,216,80
DW 250,16,0
s_mov_b32 m0,800
Ma 92,220,92
RD 224,249,20480
LG 7
Ma 0,192,96
RD 228,249,21504
LG 6
Ma 0,196,108
DW 251,16,256
s_mov_b32 m0,1600
LG 4
Ma 0,200,120
RD 232,249,22528
LG 3
Ma 0,204,132
RD 236,249,23552
Ma 4,192,100
TR 208,248,33824
Ma 4,196,112
TR 210,248,34080
Ma 4,200,124
TR 212,248,34336
Ma 4,204,136
TR 214,248,34592
Ma 8,192,104
TR 216,248,50720
Ma 8,196,116
TR 218,248,50976
Ma 8,200,128
TR 220,248,51232
Ma 8,204,140
TR 222,248,51488
LG 11
Ma 96,192,224
s_mov_b64 exec,s[36:37]
global_store_dwordx4 v249,v[116:119],s[32:33] offset:3072 sc1
s_mov_b64 exec,-1
s_add_u32 s32,s14,4096
s_addc_u32 s33,s15,0
LG 10
Ma 96,196,228
TR 192,248,33856
LG 10
Ma 96,200,232
TR 194,248,34112
LG 10
Ma 96,204,236
DW 252,16,512
s_mov_b32 m0,2400
LG 8
Ma 12,208,96
TR 196,248,34368
LG 7
Ma 12,212,108
TR 198,248,34624
LG 6
Ma 12,216,120
TR 200,248,50752
LG 5
Ma 12,220,132
TR 202,248,51008
Ma 16,208,100
TR 204,248,51264
Ma 16,212,112
TR 206,248,51520
Ma 16,216,124
DW 253,16,768
s_mov_b32 m0,16896
Ma 16,220,136
Ma 20,208,104
Ma 20,212,116
Ma 20,216,128
Ma 20,220,140
Ma 100,208,224
TR 208,248,33888
Ma 100,212,228
s_mov_b64 exec,s[36:37]
global_store_dwordx4 v249,v[120:123],s[32:33] offset:0 sc1
s_mov_b64 exec,-1
Ma 100,216,232
TR 210,248,34144
Ma 100,220,236
TR 212,248,34400
LG 9
Ma 24,192,96
TR 214,248,34656
LG 8
Ma 24,196,108
TR 216,248,50784
LG 7
Ma 24,200,120
TR 218,248,51040
LG 6
Ma 24,204,132
TR 220,248,51296
Ma 28,192,100
TR 222,248,51552
Ma 28,196,112
DW 250,18,0
s_mov_b32 m0,17696
Ma 28,200,124
Ma 28,204,136
Ma 32,192,104
TR 192,248,33920
Ma 32,196,116
TR 194,248,34176
Ma 32,200,128
TR 196,248,34432
Ma 32,204,140
DW 251,18,256
s_mov_b32 m0,18496
LG 9
Ma 36,208,96
TR 198,248,34688
LG 8
Ma 36,212,108
TR 200,248,50816
LG 7
Ma 36,216,120
TR 202,248,51072
LG 6
Ma 36,220,132
TR 204,248,51328
Ma 40,208,100
TR 206,248,51584
Ma 40,212,112
Ma 40,216,124
s_mov_b64 exec,s[36:37]
global_store_dwordx4 v249,v[124:127],s[32:33] offset:1024 sc1
s_mov_b64 exec,-1
Ma 40,220,136
Ma 44,208,104
TR 208,248,33952
Ma 44,212,116
TR 210,248,34208
Ma 44,216,128
TR 212,248,34464
Ma 44,220,140
TR 214,248,34720
LG 10
Ma 48,192,96
TR 216,248,50848
LG 9
Ma 48,196,108
DW 252,18,512
s_mov_b32 m0,19296
LG 7
Ma 48,200,120
TR 218,248,51104
LG 6
Ma 48,204,132
TR 220,248,51360
Ma 52,192,100
TR 222,248,51616
Ma 52,196,112
Ma 52,200,124
Ma 52,204,136
Ma 56,192,104
DW 253,18,768
s_mov_b32 m0,33792
Ma 56,196,116
TR 192,248,33984
Ma 56,200,128
TR 194,248,34240
Ma 56,204,140
TR 196,248,34496
LG 9
Ma 60,208,96
TR 198,248,34752
LG 8
Ma 60,212,108
TR 200,248,50880
LG 7
Ma 60,216,120
TR 202,248,51136
LG 6
Ma 60,220,132
s_mov_b64 exec,s[36:37]
global_store_dwordx4 v249,v[128:131],s[32:33] offset:2048 sc1
s_mov_b64 exec,-1
Ma 64,208,100
TR 204,248,51392
Ma 64,212,112
TR 206,248,51648
Ma 64,216,124
Ma 64,220,136
Ma 68,208,104
TR 208,248,34016
Ma 68,212,116
TR 210,248,34272
Ma 68,216,128
TR 212,248,34528
Ma 68,220,140
TR 214,248,34784
LG 10
Ma 72,192,96
TR 216,248,50912
LG 9
Ma 72,196,108
TR 218,248,51168
LG 8
Ma 72,200,120
TR 220,248,51424
LG 7
Ma 72,204,132
TR 222,248,51680
v_add_u32 v248,67584,v248
Ma 76,192,100
Ma 76,196,112
Ma 76,200,124
Ma 76,204,136
Ma 80,192,104
Ma 80,196,116
Ma 80,200,128
Ma 80,204,140
LG 6
Ma 84,208,96
LG 4
Ma 84,212,108
LG 2
Ma 84,216,120
LG 0
Ma 84,220,132
s_waitcnt vmcnt(20) lgkmcnt(0)
s_barrier
s_cmp_eq_u32 s20,3
s_cbranch_scc1 Calt2_w0
s_add_u32 s16,s12,131328
s_addc_u32 s17,s13,0
s_add_u32 s18,s12,196864
s_addc_u32 s19,s13,0
Calt2_r_w0:
Ma 88,208,100
TR 192,248,0
Ma 88,212,112
TR 194,248,256
Ma 88,216,124
TR 196,248,512
Ma 88,220,136
TR 198,248,768
Ma 92,208,104
TR 200,248,16896
TR 202,248,17152
Ma 92,212,116
TR 204,248,17408
TR 206,248,17664
Ma 92,216,128
DW 250,16,0
s_mov_b32 m0,34592
Ma 92,220,140
RD 224,249,24576
LG 7
Ma 0,192,144
RD 228,249,25600
LG 6
Ma 0,196,156
DW 251,16,256
s_mov_b32 m0,35392
LG 4
Ma 0,200,168
RD 232,249,26624
LG 3
Ma 0,204,180
RD 236,249,27648
Ma 4,192,148
TR 208,248,32
Ma 4,196,160
TR 210,248,288
Ma 4,200,172
TR 212,248,544
Ma 4,204,184
TR 214,248,800
Ma 8,192,152
TR 216,248,16928
Ma 8,196,164
TR 218,248,17184
Ma 8,200,176
TR 220,248,17440
Ma 8,204,188
TR 222,248,17696
LG 11
Ma 96,192,224
s_mov_b64 exec,s[36:37]
global_store_dwordx4 v249,v[132:135],s[32:33] offset:3072 sc1
s_mov_b64 exec,-1
s_add_u32 s32,s14,8192
s_addc_u32 s33,s15,0
LG 10
Ma 96,196,228
TR 192,248,64
LG 10
Ma 96,200,232
TR 194,248,320
LG 10
Ma 96,204,236
DW 252,16,512
s_mov_b32 m0,36192
LG 8
Ma 12,208,144
TR 196,248,576
LG 7
Ma 12,212,156
TR 198,248,832
LG 6
Ma 12,216,168
TR 200,248,16960
LG 5
Ma 12,220,180
TR 202,248,17216
Ma 16,208,148
TR 204,248,17472
Ma 16,212,160
TR 206,248,17728
Ma 16,216,172
DW 253,16,768
s_mov_b32 m0,50688
Ma 16,220,184
Ma 20,208,152
Ma 20,212,164
Ma 20,216,176
Ma 20,220,188
Ma 100,208,224
TR 208,248,96
Ma 100,212,228
s_mov_b64 exec,s[36:37]
global_store_dwordx4 v249,v[136:139],s[32:33] offset:0 sc1
s_mov_b64 exec,-1
Ma 100,216,232
TR 210,248,352
Ma 100,220,236
TR 212,248,608
LG 9
Ma 24,192,144
TR 214,248,864
LG 8
Ma 24,196,156
TR 216,248,16992
LG 7
Ma 24,200,168
TR 218,248,17248
LG 6
Ma 24,204,180
TR 220,248,17504
Ma 28,192,148
TR 222,248,17760
Ma 28,196,160
DW 250,18,0
s_mov_b32 m0,51488
Ma 28,200,172
Ma 28,204,184
Ma 32,192,152
TR 192,248,128
Ma 32,196,164
TR 194,248,384
Ma 32,200,176
TR 196,248,640
Ma 32,204,188
DW 251,18,256
s_mov_b32 m0,52288
LG 9
Ma 36,208,144
TR 198,248,896
LG 8
Ma 36,212,156
TR 200,248,17024
LG 7
Ma 36,216,168
TR 202,248,17280
LG 6
Ma 36,220,180
TR 204,248,17536
Ma 40,208,148
TR 206,248,17792
Ma 40,212,160
Ma 40,216,172
s_mov_b64 exec,s[36:37]
global_store_dwordx4 v249,v[140:143],s[32:33] offset:1024 sc1
s_mov_b64 exec,-1
Ma 40,220,184
Ma 44,208,152
TR 208,248,160
Ma 44,212,164
TR 210,248,416
Ma 44,216,176
TR 212,248,672
Ma 44,220,188
TR 214,248,928
LG 10
Ma 48,192,144
TR 216,248,17056
LG 9
Ma 48,196,156
DW 252,18,512
s_mov_b32 m0,53088
LG 7
Ma 48,200,168
TR 218,248,17312
LG 6
Ma 48,204,180
TR 220,248,17568
Ma 52,192,148
TR 222,248,17824
Ma 52,196,160
Ma 52,200,172
Ma 52,204,184
Ma 56,192,152
DW 253,18,768
s_mov_b32 m0,67584
Ma 56,196,164
TR 192,248,192
Ma 56,200,176
TR 194,248,448
Ma 56,204,188
TR 196,248,704
LG 9
Ma 60,208,144
TR 198,248,960
LG 8
Ma 60,212,156
TR 200,248,17088
LG 7
Ma 60,216,168
TR 202,248,17344
LG 6
Ma 60,220,180
TR 204,248,17600
Ma 64,208,148
TR 206,248,17856
Ma 64,212,160
Ma 64,216,172
Ma 64,220,184
Ma 68,208,152
TR 208,248,224
Ma 68,212,164
TR 210,248,480
Ma 68,216,176
TR 212,248,736
Ma 68,220,188
TR 214,248,992
LG 10
Ma 72,192,144
TR 216,248,17120
LG 9
Ma 72,196,156
TR 218,248,17376
LG 8
Ma 72,200,168
TR 220,248,17632
LG 7
Ma 72,204,180
TR 222,248,17888
Ma 76,192,148
Ma 76,196,160
Ma 76,200,172
Ma 76,204,184
Ma 80,192,152
Ma 80,196,164
Ma 80,200,176
Ma 80,204,188
LG 6
Ma 84,208,144
LG 4
Ma 84,212,156
LG 2
Ma 84,216,168
LG 0
Ma 84,220,180
s_waitcnt vmcnt(16) lgkmcnt(0)
s_barrier
s_cmp_eq_u32 s20,3
s_cbranch_scc1 Calt3_w0
s_add_u32 s16,s12,262400
s_addc_u32 s17,s13,0
s_add_u32 s18,s12,327936
s_addc_u32 s19,s13,0
Calt3_r_w0:
Ma 88,208,148
TR 192,248,33792
Ma 88,212,160
TR 194,248,34048
Ma 88,216,172
TR 196,248,34304
Ma 88,220,184
TR 198,248,34560
Ma 92,208,152
TR 200,248,50688
TR 202,248,50944
Ma 92,212,164
TR 204,248,51200
TR 206,248,51456
Ma 92,216,176
DW 250,16,0
s_mov_b32 m0,68384
Ma 92,220,188
RD 224,249,0
LG 7
Ma 0,192,0
RD 228,249,1024
LG 6
Ma 0,196,12
DW 251,16,256
s_mov_b32 m0,69184
LG 4
Ma 0,200,24
RD 232,249,2048
LG 3
Ma 0,204,36
RD 236,249,3072
Ma 4,192,4
TR 208,248,33824
Ma 4,196,16
TR 210,248,34080
Ma 4,200,28
TR 212,248,34336
s_nop 0
CV 104,0,1
Ma 4,204,40
TR 214,248,34592
CV 105,2,3
Ma 8,192,8
TR 216,248,50720
Ma 8,196,20
TR 218,248,50976
Ma 8,200,32
TR 220,248,51232
CV 120,4,5
Ma 8,204,44
TR 222,248,51488
CV 121,6,7
LG 11
Ma 96,192,224
s_mov_b64 exec,s[36:37]
global_store_dwordx4 v249,v[144:147],s[32:33] offset:2048 sc1
s_mov_b64 exec,-1
LG 10
Ma 96,196,228
TR 192,248,33856
LG 10
Ma 96,200,232
TR 194,248,34112
CV 136,8,9
LG 10
Ma 96,204,236
DW 252,16,512
s_mov_b32 m0,69984
LG 8
Ma 12,208,0
TR 196,248,34368
CV 137,10,11
LG 7
Ma 12,212,12
TR 198,248,34624
LG 6
Ma 12,216,24
TR 200,248,50752
LG 5
Ma 12,220,36
TR 202,248,51008
Ma 16,208,4
TR 204,248,51264
Ma 16,212,16
TR 206,248,51520
Ma 16,216,28
DW 253,16,768
s_mov_b32 m0,84480
Ma 16,220,40
CV 106,12,13
CV 107,14,15
Ma 20,208,8
Ma 20,212,20
Ma 20,216,32
s_nop 2
CV 122,16,17
CV 123,18,19
Ma 20,220,44
Ma 100,208,224
TR 208,248,33888
Ma 100,212,228
s_mov_b64 exec,s[36:37]
global_store_dwordx4 v249,v[148:151],s[32:33] offset:3072 sc1
s_mov_b64 exec,-1
s_add_u32 s32,s14,49152
s_addc_u32 s33,s15,0
Ma 100,216,232
TR 210,248,34144
CV 138,20,21
Ma 100,220,236
TR 212,248,34400
CV 139,22,23
LG 9
Ma 24,192,0
TR 214,248,34656
LG 8
Ma 24,196,12
TR 216,248,50784
LG 7
Ma 24,200,24
TR 218,248,51040
LG 6
Ma 24,204,36
TR 220,248,51296
Ma 28,192,4
TR 222,248,51552
Ma 28,196,16
DW 250,18,0
s_mov_b32 m0,85280
Ma 28,200,28
s_nop 1
CV 108,24,25
CV 109,26,27
Ma 28,204,40
Ma 32,192,8
TR 192,248,33920
Ma 32,196,20
TR 194,248,34176
Ma 32,200,32
TR 196,248,34432
s_nop 1
CV 124,28,29
Ma 32,204,44
DW 251,18,256
s_mov_b32 m0,86080
LG 9
Ma 36,208,0
TR 198,248,34688
CV 125,30,31
LG 8
Ma 36,212,12
TR 200,248,50816
LG 7
Ma 36,216,24
TR 202,248,51072
CV 140,32,33
LG 6
Ma 36,220,36
TR 204,248,51328
CV 141,34,35
Ma 40,208,4
TR 206,248,51584
Ma 40,212,16
Ma 40,216,28
s_mov_b64 exec,s[36:37]
global_store_dwordx4 v249,v[152:155],s[32:33] offset:0 sc1
s_mov_b64 exec,-1
Ma 40,220,40
CV 110,36,37
CV 111,38,39
Ma 44,208,8
TR 208,248,33952
CV 152,96,97
Ma 44,212,20
TR 210,248,34208
CV 153,98,99
Ma 44,216,32
TR 212,248,34464
CV 126,40,41
Ma 44,220,44
TR 214,248,34720
CV 127,42,43
LG 10
Ma 48,192,0
TR 216,248,50848
CV 154,100,101
LG 9
Ma 48,196,12
DW 252,18,512
s_mov_b32 m0,86880
LG 7
Ma 48,200,24
TR 218,248,51104
CV 142,44,45
LG 6
Ma 48,204,36
TR 220,248,51360
CV 143,46,47
Ma 52,192,4
TR 222,248,51616
CV 155,102,103
Ma 52,196,16
Ma 52,200,28
s_nop 0
CV 112,48,49
CV 113,50,51
Ma 52,204,40
Ma 56,192,8
DW 253,18,768
Ma 56,196,20
TR 192,248,33984
Ma 56,200,32
TR 194,248,34240
s_nop 1
CV 128,52,53
Ma 56,204,44
TR 196,248,34496
CV 129,54,55
LG 9
Ma 60,208,0
TR 198,248,34752
LG 8
Ma 60,212,12
TR 200,248,50880
LG 7
Ma 60,216,24
TR 202,248,51136
CV 144,56,57
LG 6
Ma 60,220,36
TR 204,248,51392
CV 145,58,59
Ma 64,208,4
TR 206,248,51648
Ma 64,212,16
Ma 64,216,28
s_nop 1
CV 114,60,61
CV 115,62,63
Ma 64,220,40
Ma 68,208,8
TR 208,248,34016
Ma 68,212,20
TR 210,248,34272
Ma 68,216,32
TR 212,248,34528
s_nop 1
CV 130,64,65
Ma 68,220,44
TR 214,248,34784
CV 131,66,67
LG 10
Ma 72,192,0
TR 216,248,50912
LG 9
Ma 72,196,12
TR 218,248,51168
LG 8
Ma 72,200,24
TR 220,248,51424
CV 146,68,69
LG 7
Ma 72,204,36
TR 222,248,51680
v_add_u32 v248,4294899712,v248
Ma 76,192,4
CV 147,70,71
Ma 76,196,16
Ma 76,200,28
s_nop 1
CV 116,72,73
CV 117,74,75
Ma 76,204,40
Ma 80,192,8
Ma 80,196,20
Ma 80,200,32
s_nop 4
CV 132,76,77
CV 133,78,79
Ma 80,204,44
LG 6
Ma 84,208,0
LG 4
Ma 84,212,12
LG 2
Ma 84,216,24
s_nop 1
CV 148,80,81
CV 149,82,83
LG 0
Ma 84,220,36
s_waitcnt vmcnt(16) lgkmcnt(0)
s_barrier
s_cmp_eq_u32 s20,3
s_cbranch_scc1 Calt4_w0
s_add_u32 s16,s12,393472
s_addc_u32 s17,s13,0
s_add_u32 s18,s12,459008
s_addc_u32 s19,s13,0
Calt4_r_w0:
Ma 88,208,4
TR 192,248,0
Ma 88,212,16
TR 194,248,256
Ma 88,216,28
TR 196,248,512
TR 198,248,768
Ma 88,220,40
TR 200,248,16896
TR 202,248,17152
Ma 92,208,8
TR 204,248,17408
TR 206,248,17664
Ma 92,212,20
RD 224,249,16384
RD 228,249,17408
Ma 92,216,32
RD 232,249,18432
RD 236,249,19456
Ma 92,220,44
CV 118,84,85
CV 119,86,87
CV 134,88,89
CV 135,90,91
s_nop 3
CV 150,92,93
CV 151,94,95
s_add_u32 s12,s12,256
s_addc_u32 s13,s13,0
s_cmp_eq_u32 s20,0
s_cselect_b32 s28,0,53248
s_add_u32 s14,s14,s28
s_addc_u32 s15,s15,0
s_mov_b64 s[36:37],-1
s_add_u32 s20,s20,1
s_cmp_lg_u32 s20,4
s_cbranch_scc1 LC_w0
s_add_u32 s32,s14,0
s_addc_u32 s33,s15,0
global_store_dwordx4 v249,v[104:107],s[32:33] offset:0 sc1
global_store_dwordx4 v249,v[108:111],s[32:33] offset:1024 sc1
global_store_dwordx4 v249,v[112:115],s[32:33] offset:2048 sc1
global_store_dwordx4 v249,v[116:119],s[32:33] offset:3072 sc1
s_add_u32 s32,s14,4096
s_addc_u32 s33,s15,0
global_store_dwordx4 v249,v[120:123],s[32:33] offset:0 sc1
global_store_dwordx4 v249,v[124:127],s[32:33] offset:1024 sc1
global_store_dwordx4 v249,v[128:131],s[32:33] offset:2048 sc1
global_store_dwordx4 v249,v[132:135],s[32:33] offset:3072 sc1
s_add_u32 s32,s14,8192
s_addc_u32 s33,s15,0
global_store_dwordx4 v249,v[136:139],s[32:33] offset:0 sc1
global_store_dwordx4 v249,v[140:143],s[32:33] offset:1024 sc1
global_store_dwordx4 v249,v[144:147],s[32:33] offset:2048 sc1
global_store_dwordx4 v249,v[148:151],s[32:33] offset:3072 sc1
s_add_u32 s32,s14,49152
s_addc_u32 s33,s15,0
global_store_dwordx4 v249,v[152:155],s[32:33] offset:0 sc1
s_waitcnt vmcnt(0) lgkmcnt(0)
s_waitcnt vmcnt(0) lgkmcnt(0)
s_endpgm
ProK_w0:
s_nop 1
v_subrev_u32 v255,135168,v249
v_and_b32 v250,0xf0,v255
v_lshrrev_b32 v255,8,v255
v_lshl_add_u32 v250,v255,14,v250
v_add_u32 v251,768,v250
v_add_u32 v252,1536,v250
v_add_u32 v253,2304,v250
s_mul_hi_u32 s28,s22,254201
s_lshl_b32 s28,s28,16
s_add_u32 s16,s12,s28
s_addc_u32 s17,s13,0
s_cmp_ge_u32 s21,29
s_cbranch_scc0 ProK_r_w0
v_subrev_u32 v255,135168,v249
v_and_b32 v216,0xf0,v255
v_lshrrev_b32 v255,8,v255
v_lshl_add_u32 v216,v255,14,v216
v_add_u32 v217,768,v216
v_add_u32 v218,1536,v216
v_add_u32 v219,2304,v216
s_mul_hi_u32 s28,s25,254201
s_lshl_b32 s28,s28,16
s_add_u32 s18,s12,s28
s_addc_u32 s19,s13,0
s_nop 1
s_branch ProK_r_w0
It0K_w0:
s_nop 1
v_subrev_u32 v255,135168,v249
v_and_b32 v250,0xf0,v255
v_lshrrev_b32 v255,8,v255
v_lshl_add_u32 v250,v255,14,v250
v_add_u32 v251,768,v250
v_add_u32 v252,1536,v250
v_add_u32 v253,2304,v250
s_mul_hi_u32 s28,s23,254201
s_lshl_b32 s28,s28,16
s_add_u32 s16,s12,s28
s_addc_u32 s17,s13,0
s_cmp_ge_u32 s21,29
s_cbranch_scc0 It0K_r_w0
v_subrev_u32 v255,135168,v249
v_and_b32 v216,0xf0,v255
v_lshrrev_b32 v255,8,v255
v_lshl_add_u32 v216,v255,14,v216
v_add_u32 v217,768,v216
v_add_u32 v218,1536,v216
v_add_u32 v219,2304,v216
s_mul_hi_u32 s28,s24,254201
s_lshl_b32 s28,s28,16
s_add_u32 s18,s12,s28
s_addc_u32 s19,s13,0
s_nop 1
s_branch It0K_r_w0
ItOK_w0:
s_nop 1
v_subrev_u32 v255,135168,v249
v_and_b32 v250,0xf0,v255
v_lshrrev_b32 v255,8,v255
v_lshl_add_u32 v250,v255,14,v250
v_add_u32 v251,768,v250
v_add_u32 v252,1536,v250
v_add_u32 v253,2304,v250
s_mul_hi_u32 s28,s22,254201
s_lshl_b32 s28,s28,16
s_add_u32 s16,s12,s28
s_addc_u32 s17,s13,0
s_cmp_ge_u32 s21,29
s_cbranch_scc0 ItOK_r_w0
v_subrev_u32 v255,135168,v249
v_and_b32 v216,0xf0,v255
v_lshrrev_b32 v255,8,v255
v_lshl_add_u32 v216,v255,14,v216
v_add_u32 v217,768,v216
v_add_u32 v218,1536,v216
v_add_u32 v219,2304,v216
s_mul_hi_u32 s28,s25,254201
s_lshl_b32 s28,s28,16
s_add_u32 s18,s12,s28
s_addc_u32 s19,s13,0
s_nop 1
s_branch ItOK_r_w0
ItEK_w0:
s_nop 1
v_subrev_u32 v255,135168,v249
v_and_b32 v250,0xf0,v255
v_lshrrev_b32 v255,8,v255
v_lshl_add_u32 v250,v255,14,v250
v_add_u32 v251,768,v250
v_add_u32 v252,1536,v250
v_add_u32 v253,2304,v250
s_mul_hi_u32 s28,s23,254201
s_lshl_b32 s28,s28,16
s_add_u32 s16,s12,s28
s_addc_u32 s17,s13,0
s_cmp_ge_u32 s21,29
s_cbranch_scc0 ItEK_r_w0
v_subrev_u32 v255,135168,v249
v_and_b32 v216,0xf0,v255
v_lshrrev_b32 v255,8,v255
v_lshl_add_u32 v216,v255,14,v216
v_add_u32 v217,768,v216
v_add_u32 v218,1536,v216
v_add_u32 v219,2304,v216
s_mul_hi_u32 s28,s24,254201
s_lshl_b32 s28,s28,16
s_add_u32 s18,s12,s28
s_addc_u32 s19,s13,0
s_nop 1
s_branch ItEK_r_w0
SLOW_w0:
s_nop 1
LG 0
s_add_u32 m0,s48,0
s_nop 0
DM 250,16,0
s_add_u32 m0,m0,800
s_nop 0
DM 251,16,256
s_add_u32 m0,m0,800
s_nop 0
DM 252,16,512
s_add_u32 m0,m0,800
s_nop 0
DM 253,16,768
s_add_u32 s16,s16,16384
s_addc_u32 s17,s17,0
s_add_u32 m0,s49,0
s_nop 0
DM 216,18,0
s_add_u32 m0,m0,800
s_nop 0
DM 217,18,256
s_add_u32 m0,m0,800
s_nop 0
DM 218,18,512
s_add_u32 m0,m0,800
s_nop 0
DM 219,18,768
s_add_u32 s18,s18,16384
s_addc_u32 s19,s19,0
v_subrev_u32 v230,135168,v249
v_lshrrev_b32 v230,4,v230
v_and_b32 v231,15,v230
v_lshrrev_b32 v230,4,v230
v_lshlrev_b32 v228,8,v231
v_lshl_add_u32 v228,v230,4,v228
v_lshlrev_b32 v229,10,v230
v_lshl_add_u32 v229,v231,1,v229
s_lshl_b32 s80,s34,17
s_add_u32 s72,s6,s80
s_addc_u32 s73,s7,0
s_sub_u32 s72,s72,0
s_subb_u32 s73,s73,0
v_mov_b32 v232,0xff800000
v_mov_b32 v233,0xff800000
v_mov_b32 v234,0xff800000
v_mov_b32 v235,0xff800000
s_mov_b32 s80,0
SL1_w0:
global_load_dwordx4 v[152:155],v228,s[72:73] offset:0
global_load_dwordx4 v[156:159],v228,s[72:73] offset:64
global_load_dwordx4 v[160:163],v228,s[72:73] offset:128
global_load_dwordx4 v[164:167],v228,s[72:73] offset:192
s_waitcnt vmcnt(0)
v_mfma_f32_16x16x32_bf16 v[120:123],v[152:155],a[0:3],0
v_mfma_f32_16x16x32_bf16 v[120:123],v[156:159],a[12:15],v[120:123]
v_mfma_f32_16x16x32_bf16 v[120:123],v[160:163],a[24:27],v[120:123]
v_mfma_f32_16x16x32_bf16 v[120:123],v[164:167],a[36:39],v[120:123]
v_mfma_f32_16x16x32_bf16 v[124:127],v[152:155],a[4:7],0
v_mfma_f32_16x16x32_bf16 v[124:127],v[156:159],a[16:19],v[124:127]
v_mfma_f32_16x16x32_bf16 v[124:127],v[160:163],a[28:31],v[124:127]
v_mfma_f32_16x16x32_bf16 v[124:127],v[164:167],a[40:43],v[124:127]
v_mfma_f32_16x16x32_bf16 v[128:131],v[152:155],a[8:11],0
v_mfma_f32_16x16x32_bf16 v[128:131],v[156:159],a[20:23],v[128:131]
v_mfma_f32_16x16x32_bf16 v[128:131],v[160:163],a[32:35],v[128:131]
v_mfma_f32_16x16x32_bf16 v[128:131],v[164:167],a[44:47],v[128:131]
v_mfma_f32_16x16x32_bf16 v[132:135],v[152:155],a[224:227],0
v_mfma_f32_16x16x32_bf16 v[132:135],v[156:159],a[228:231],v[132:135]
v_mfma_f32_16x16x32_bf16 v[132:135],v[160:163],a[232:235],v[132:135]
v_mfma_f32_16x16x32_bf16 v[132:135],v[164:167],a[236:239],v[132:135]
v_max3_f32 v232,v232,v120,v121
v_max3_f32 v232,v232,v122,v123
v_max3_f32 v233,v233,v124,v125
v_max3_f32 v233,v233,v126,v127
v_max3_f32 v234,v234,v128,v129
v_max3_f32 v234,v234,v130,v131
s_nop 1
v_max3_f32 v235,v235,v132,v133
v_max3_f32 v235,v235,v134,v135
s_add_u32 s72,s72,4096
s_addc_u32 s73,s73,0
s_add_u32 s80,s80,1
s_cmp_lg_u32 s80,32
s_cbranch_scc1 SL1_w0
v_mov_b32 v200,v232
v_mov_b32 v201,v200
s_nop 1
v_permlane16_swap_b32 v200,v201
v_max_f32 v200,v200,v201
v_mov_b32 v201,v200
s_nop 1
v_permlane32_swap_b32 v200,v201
v_max_f32 v200,v200,v201
v_mul_f32 v200,-1.0,v200
v_mov_b32 v201,v200
v_mov_b32 v202,v200
v_mov_b32 v203,v200
v_mov_b32 v204,v233
v_mov_b32 v205,v204
s_nop 1
v_permlane16_swap_b32 v204,v205
v_max_f32 v204,v204,v205
v_mov_b32 v205,v204
s_nop 1
v_permlane32_swap_b32 v204,v205
v_max_f32 v204,v204,v205
v_mul_f32 v204,-1.0,v204
v_mov_b32 v205,v204
v_mov_b32 v206,v204
v_mov_b32 v207,v204
v_mov_b32 v208,v234
v_mov_b32 v209,v208
s_nop 1
v_permlane16_swap_b32 v208,v209
v_max_f32 v208,v208,v209
v_mov_b32 v209,v208
s_nop 1
v_permlane32_swap_b32 v208,v209
v_max_f32 v208,v208,v209
v_mul_f32 v208,-1.0,v208
v_mov_b32 v209,v208
v_mov_b32 v210,v208
v_mov_b32 v211,v208
v_mov_b32 v212,v235
v_mov_b32 v213,v212
s_nop 1
v_permlane16_swap_b32 v212,v213
v_max_f32 v212,v212,v213
v_mov_b32 v213,v212
s_nop 1
v_permlane32_swap_b32 v212,v213
v_max_f32 v212,v212,v213
v_mul_f32 v212,-1.0,v212
v_mov_b32 v213,v212
v_mov_b32 v214,v212
v_mov_b32 v215,v212
s_lshl_b32 s80,s34,17
s_add_u32 s72,s6,s80
s_addc_u32 s73,s7,0
s_sub_u32 s72,s72,0
s_subb_u32 s73,s73,0
s_lshl_b32 s80,s34,17
s_add_u32 s76,s8,s80
s_addc_u32 s77,s9,0
s_sub_u32 s76,s76,0
s_subb_u32 s77,s77,0
v_mov_b32 v0,0
v_mov_b32 v1,0
v_mov_b32 v2,0
v_mov_b32 v3,0
v_mov_b32 v4,0
v_mov_b32 v5,0
v_mov_b32 v6,0
v_mov_b32 v7,0
v_mov_b32 v8,0
v_mov_b32 v9,0
v_mov_b32 v10,0
v_mov_b32 v11,0
v_mov_b32 v12,0
v_mov_b32 v13,0
v_mov_b32 v14,0
v_mov_b32 v15,0
v_mov_b32 v16,0
v_mov_b32 v17,0
v_mov_b32 v18,0
v_mov_b32 v19,0
v_mov_b32 v20,0
v_mov_b32 v21,0
v_mov_b32 v22,0
v_mov_b32 v23,0
v_mov_b32 v24,0
v_mov_b32 v25,0
v_mov_b32 v26,0
v_mov_b32 v27,0
v_mov_b32 v28,0
v_mov_b32 v29,0
v_mov_b32 v30,0
v_mov_b32 v31,0
v_mov_b32 v32,0
v_mov_b32 v33,0
v_mov_b32 v34,0
v_mov_b32 v35,0
v_mov_b32 v36,0
v_mov_b32 v37,0
v_mov_b32 v38,0
v_mov_b32 v39,0
v_mov_b32 v40,0
v_mov_b32 v41,0
v_mov_b32 v42,0
v_mov_b32 v43,0
v_mov_b32 v44,0
v_mov_b32 v45,0
v_mov_b32 v46,0
v_mov_b32 v47,0
v_mov_b32 v48,0
v_mov_b32 v49,0
v_mov_b32 v50,0
v_mov_b32 v51,0
v_mov_b32 v52,0
v_mov_b32 v53,0
v_mov_b32 v54,0
v_mov_b32 v55,0
v_mov_b32 v56,0
v_mov_b32 v57,0
v_mov_b32 v58,0
v_mov_b32 v59,0
v_mov_b32 v60,0
v_mov_b32 v61,0
v_mov_b32 v62,0
v_mov_b32 v63,0
v_mov_b32 v64,0
v_mov_b32 v65,0
v_mov_b32 v66,0
v_mov_b32 v67,0
v_mov_b32 v68,0
v_mov_b32 v69,0
v_mov_b32 v70,0
v_mov_b32 v71,0
v_mov_b32 v72,0
v_mov_b32 v73,0
v_mov_b32 v74,0
v_mov_b32 v75,0
v_mov_b32 v76,0
v_mov_b32 v77,0
v_mov_b32 v78,0
v_mov_b32 v79,0
v_mov_b32 v80,0
v_mov_b32 v81,0
v_mov_b32 v82,0
v_mov_b32 v83,0
v_mov_b32 v84,0
v_mov_b32 v85,0
v_mov_b32 v86,0
v_mov_b32 v87,0
v_mov_b32 v88,0
v_mov_b32 v89,0
v_mov_b32 v90,0
v_mov_b32 v91,0
v_mov_b32 v92,0
v_mov_b32 v93,0
v_mov_b32 v94,0
v_mov_b32 v95,0
v_mov_b32 v96,0
v_mov_b32 v97,0
v_mov_b32 v98,0
v_mov_b32 v99,0
v_mov_b32 v100,0
v_mov_b32 v101,0
v_mov_b32 v102,0
v_mov_b32 v103,0
v_mov_b32 v104,0
v_mov_b32 v105,0
v_mov_b32 v106,0
v_mov_b32 v107,0
v_mov_b32 v108,0
v_mov_b32 v109,0
v_mov_b32 v110,0
v_mov_b32 v111,0
v_mov_b32 v112,0
v_mov_b32 v113,0
v_mov_b32 v114,0
v_mov_b32 v115,0
v_mov_b32 v116,0
v_mov_b32 v117,0
v_mov_b32 v118,0
v_mov_b32 v119,0
s_mov_b32 s80,0
SL2_w0:
s_add_u32 s74,s72,4096
s_addc_u32 s75,s73,0
s_add_u32 s78,s76,4096
s_addc_u32 s79,s77,0
global_load_dwordx4 v[152:155],v228,s[72:73] offset:0
global_load_dwordx4 v[156:159],v228,s[72:73] offset:64
global_load_dwordx4 v[160:163],v228,s[72:73] offset:128
global_load_dwordx4 v[164:167],v228,s[72:73] offset:192
global_load_dwordx4 v[168:171],v228,s[74:75] offset:0
global_load_dwordx4 v[172:175],v228,s[74:75] offset:64
global_load_dwordx4 v[176:179],v228,s[74:75] offset:128
global_load_dwordx4 v[180:183],v228,s[74:75] offset:192
s_waitcnt vmcnt(0)
v_mfma_f32_16x16x32_bf16 v[120:123],v[152:155],a[0:3],v[200:203]
v_mfma_f32_16x16x32_bf16 v[120:123],v[156:159],a[12:15],v[120:123]
v_mfma_f32_16x16x32_bf16 v[120:123],v[160:163],a[24:27],v[120:123]
v_mfma_f32_16x16x32_bf16 v[120:123],v[164:167],a[36:39],v[120:123]
v_mfma_f32_16x16x32_bf16 v[124:127],v[152:155],a[4:7],v[204:207]
v_mfma_f32_16x16x32_bf16 v[124:127],v[156:159],a[16:19],v[124:127]
v_mfma_f32_16x16x32_bf16 v[124:127],v[160:163],a[28:31],v[124:127]
v_mfma_f32_16x16x32_bf16 v[124:127],v[164:167],a[40:43],v[124:127]
v_mfma_f32_16x16x32_bf16 v[128:131],v[152:155],a[8:11],v[208:211]
v_mfma_f32_16x16x32_bf16 v[128:131],v[156:159],a[20:23],v[128:131]
v_mfma_f32_16x16x32_bf16 v[128:131],v[160:163],a[32:35],v[128:131]
v_mfma_f32_16x16x32_bf16 v[128:131],v[164:167],a[44:47],v[128:131]
v_mfma_f32_16x16x32_bf16 v[132:135],v[152:155],a[224:227],v[212:215]
v_mfma_f32_16x16x32_bf16 v[132:135],v[156:159],a[228:231],v[132:135]
v_mfma_f32_16x16x32_bf16 v[132:135],v[160:163],a[232:235],v[132:135]
v_mfma_f32_16x16x32_bf16 v[132:135],v[164:167],a[236:239],v[132:135]
v_mfma_f32_16x16x32_bf16 v[136:139],v[168:171],a[0:3],v[200:203]
v_mfma_f32_16x16x32_bf16 v[136:139],v[172:175],a[12:15],v[136:139]
v_mfma_f32_16x16x32_bf16 v[136:139],v[176:179],a[24:27],v[136:139]
v_mfma_f32_16x16x32_bf16 v[136:139],v[180:183],a[36:39],v[136:139]
v_mfma_f32_16x16x32_bf16 v[140:143],v[168:171],a[4:7],v[204:207]
v_mfma_f32_16x16x32_bf16 v[140:143],v[172:175],a[16:19],v[140:143]
v_mfma_f32_16x16x32_bf16 v[140:143],v[176:179],a[28:31],v[140:143]
v_mfma_f32_16x16x32_bf16 v[140:143],v[180:183],a[40:43],v[140:143]
v_mfma_f32_16x16x32_bf16 v[144:147],v[168:171],a[8:11],v[208:211]
v_mfma_f32_16x16x32_bf16 v[144:147],v[172:175],a[20:23],v[144:147]
v_mfma_f32_16x16x32_bf16 v[144:147],v[176:179],a[32:35],v[144:147]
v_mfma_f32_16x16x32_bf16 v[144:147],v[180:183],a[44:47],v[144:147]
v_mfma_f32_16x16x32_bf16 v[148:151],v[168:171],a[224:227],v[212:215]
v_mfma_f32_16x16x32_bf16 v[148:151],v[172:175],a[228:231],v[148:151]
v_mfma_f32_16x16x32_bf16 v[148:151],v[176:179],a[232:235],v[148:151]
v_mfma_f32_16x16x32_bf16 v[148:151],v[180:183],a[236:239],v[148:151]
EX 120
EX 121
EX 122
EX 123
EX 124
EX 125
EX 126
EX 127
EX 128
EX 129
EX 130
EX 131
EX 132
EX 133
EX 134
EX 135
EX 136
EX 137
EX 138
EX 139
EX 140
EX 141
EX 142
EX 143
EX 144
EX 145
EX 146
EX 147
EX 148
EX 149
EX 150
EX 151
CV 184,120,121
CV 185,122,123
CV 188,124,125
CV 189,126,127
CV 192,128,129
CV 193,130,131
CV 196,132,133
CV 197,134,135
CV 186,136,137
CV 187,138,139
CV 190,140,141
CV 191,142,143
CV 194,144,145
CV 195,146,147
CV 198,148,149
CV 199,150,151
global_load_ushort v236,v229,s[76:77] offset:0
global_load_ushort v237,v229,s[76:77] offset:256
global_load_ushort v238,v229,s[76:77] offset:512
global_load_ushort v239,v229,s[76:77] offset:768
global_load_ushort v240,v229,s[78:79] offset:0
global_load_ushort v241,v229,s[78:79] offset:256
global_load_ushort v242,v229,s[78:79] offset:512
global_load_ushort v243,v229,s[78:79] offset:768
s_waitcnt vmcnt(0)
v_lshl_or_b32 v224,v237,16,v236
v_lshl_or_b32 v225,v239,16,v238
v_lshl_or_b32 v226,v241,16,v240
v_lshl_or_b32 v227,v243,16,v242
s_nop 1
v_mfma_f32_16x16x32_bf16 v[0:3],v[224:227],v[184:187],v[0:3]
v_mfma_f32_16x16x32_bf16 v[4:7],v[224:227],v[188:191],v[4:7]
v_mfma_f32_16x16x32_bf16 v[8:11],v[224:227],v[192:195],v[8:11]
v_mfma_f32_16x16x32_bf16 v[96:99],v[224:227],v[196:199],v[96:99]
s_nop 1
global_load_ushort v236,v229,s[76:77] offset:32
global_load_ushort v237,v229,s[76:77] offset:288
global_load_ushort v238,v229,s[76:77] offset:544
global_load_ushort v239,v229,s[76:77] offset:800
global_load_ushort v240,v229,s[78:79] offset:32
global_load_ushort v241,v229,s[78:79] offset:288
global_load_ushort v242,v229,s[78:79] offset:544
global_load_ushort v243,v229,s[78:79] offset:800
s_waitcnt vmcnt(0)
v_lshl_or_b32 v224,v237,16,v236
v_lshl_or_b32 v225,v239,16,v238
v_lshl_or_b32 v226,v241,16,v240
v_lshl_or_b32 v227,v243,16,v242
s_nop 1
v_mfma_f32_16x16x32_bf16 v[12:15],v[224:227],v[184:187],v[12:15]
v_mfma_f32_16x16x32_bf16 v[16:19],v[224:227],v[188:191],v[16:19]
v_mfma_f32_16x16x32_bf16 v[20:23],v[224:227],v[192:195],v[20:23]
v_mfma_f32_16x16x32_bf16 v[100:103],v[224:227],v[196:199],v[100:103]
s_nop 1
global_load_ushort v236,v229,s[76:77] offset:64
global_load_ushort v237,v229,s[76:77] offset:320
global_load_ushort v238,v229,s[76:77] offset:576
global_load_ushort v239,v229,s[76:77] offset:832
global_load_ushort v240,v229,s[78:79] offset:64
global_load_ushort v241,v229,s[78:79] offset:320
global_load_ushort v242,v229,s[78:79] offset:576
global_load_ushort v243,v229,s[78:79] offset:832
s_waitcnt vmcnt(0)
v_lshl_or_b32 v224,v237,16,v236
v_lshl_or_b32 v225,v239,16,v238
v_lshl_or_b32 v226,v241,16,v240
v_lshl_or_b32 v227,v243,16,v242
s_nop 1
v_mfma_f32_16x16x32_bf16 v[24:27],v[224:227],v[184:187],v[24:27]
v_mfma_f32_16x16x32_bf16 v[28:31],v[224:227],v[188:191],v[28:31]
v_mfma_f32_16x16x32_bf16 v[32:35],v[224:227],v[192:195],v[32:35]
s_nop 1
global_load_ushort v236,v229,s[76:77] offset:96
global_load_ushort v237,v229,s[76:77] offset:352
global_load_ushort v238,v229,s[76:77] offset:608
global_load_ushort v239,v229,s[76:77] offset:864
global_load_ushort v240,v229,s[78:79] offset:96
global_load_ushort v241,v229,s[78:79] offset:352
global_load_ushort v242,v229,s[78:79] offset:608
global_load_ushort v243,v229,s[78:79] offset:864
s_waitcnt vmcnt(0)
v_lshl_or_b32 v224,v237,16,v236
v_lshl_or_b32 v225,v239,16,v238
v_lshl_or_b32 v226,v241,16,v240
v_lshl_or_b32 v227,v243,16,v242
s_nop 1
v_mfma_f32_16x16x32_bf16 v[36:39],v[224:227],v[184:187],v[36:39]
v_mfma_f32_16x16x32_bf16 v[40:43],v[224:227],v[188:191],v[40:43]
v_mfma_f32_16x16x32_bf16 v[44:47],v[224:227],v[192:195],v[44:47]
s_nop 1
global_load_ushort v236,v229,s[76:77] offset:128
global_load_ushort v237,v229,s[76:77] offset:384
global_load_ushort v238,v229,s[76:77] offset:640
global_load_ushort v239,v229,s[76:77] offset:896
global_load_ushort v240,v229,s[78:79] offset:128
global_load_ushort v241,v229,s[78:79] offset:384
global_load_ushort v242,v229,s[78:79] offset:640
global_load_ushort v243,v229,s[78:79] offset:896
s_waitcnt vmcnt(0)
v_lshl_or_b32 v224,v237,16,v236
v_lshl_or_b32 v225,v239,16,v238
v_lshl_or_b32 v226,v241,16,v240
v_lshl_or_b32 v227,v243,16,v242
s_nop 1
v_mfma_f32_16x16x32_bf16 v[48:51],v[224:227],v[184:187],v[48:51]
v_mfma_f32_16x16x32_bf16 v[52:55],v[224:227],v[188:191],v[52:55]
v_mfma_f32_16x16x32_bf16 v[56:59],v[224:227],v[192:195],v[56:59]
s_nop 1
global_load_ushort v236,v229,s[76:77] offset:160
global_load_ushort v237,v229,s[76:77] offset:416
global_load_ushort v238,v229,s[76:77] offset:672
global_load_ushort v239,v229,s[76:77] offset:928
global_load_ushort v240,v229,s[78:79] offset:160
global_load_ushort v241,v229,s[78:79] offset:416
global_load_ushort v242,v229,s[78:79] offset:672
global_load_ushort v243,v229,s[78:79] offset:928
s_waitcnt vmcnt(0)
v_lshl_or_b32 v224,v237,16,v236
v_lshl_or_b32 v225,v239,16,v238
v_lshl_or_b32 v226,v241,16,v240
v_lshl_or_b32 v227,v243,16,v242
s_nop 1
v_mfma_f32_16x16x32_bf16 v[60:63],v[224:227],v[184:187],v[60:63]
v_mfma_f32_16x16x32_bf16 v[64:67],v[224:227],v[188:191],v[64:67]
v_mfma_f32_16x16x32_bf16 v[68:71],v[224:227],v[192:195],v[68:71]
s_nop 1
global_load_ushort v236,v229,s[76:77] offset:192
global_load_ushort v237,v229,s[76:77] offset:448
global_load_ushort v238,v229,s[76:77] offset:704
global_load_ushort v239,v229,s[76:77] offset:960
global_load_ushort v240,v229,s[78:79] offset:192
global_load_ushort v241,v229,s[78:79] offset:448
global_load_ushort v242,v229,s[78:79] offset:704
global_load_ushort v243,v229,s[78:79] offset:960
s_waitcnt vmcnt(0)
v_lshl_or_b32 v224,v237,16,v236
v_lshl_or_b32 v225,v239,16,v238
v_lshl_or_b32 v226,v241,16,v240
v_lshl_or_b32 v227,v243,16,v242
s_nop 1
v_mfma_f32_16x16x32_bf16 v[72:75],v[224:227],v[184:187],v[72:75]
v_mfma_f32_16x16x32_bf16 v[76:79],v[224:227],v[188:191],v[76:79]
v_mfma_f32_16x16x32_bf16 v[80:83],v[224:227],v[192:195],v[80:83]
s_nop 1
global_load_ushort v236,v229,s[76:77] offset:224
global_load_ushort v237,v229,s[76:77] offset:480
global_load_ushort v238,v229,s[76:77] offset:736
global_load_ushort v239,v229,s[76:77] offset:992
global_load_ushort v240,v229,s[78:79] offset:224
global_load_ushort v241,v229,s[78:79] offset:480
global_load_ushort v242,v229,s[78:79] offset:736
global_load_ushort v243,v229,s[78:79] offset:992
s_waitcnt vmcnt(0)
v_lshl_or_b32 v224,v237,16,v236
v_lshl_or_b32 v225,v239,16,v238
v_lshl_or_b32 v226,v241,16,v240
v_lshl_or_b32 v227,v243,16,v242
s_nop 1
v_mfma_f32_16x16x32_bf16 v[84:87],v[224:227],v[184:187],v[84:87]
v_mfma_f32_16x16x32_bf16 v[88:91],v[224:227],v[188:191],v[88:91]
v_mfma_f32_16x16x32_bf16 v[92:95],v[224:227],v[192:195],v[92:95]
s_nop 1
v_mfma_f32_16x16x32_bf16 v[104:107],a[240:243],v[184:187],v[104:107]
v_mfma_f32_16x16x32_bf16 v[108:111],a[240:243],v[188:191],v[108:111]
v_mfma_f32_16x16x32_bf16 v[112:115],a[240:243],v[192:195],v[112:115]
v_mfma_f32_16x16x32_bf16 v[116:119],a[240:243],v[196:199],v[116:119]
s_add_u32 s72,s72,8192
s_addc_u32 s73,s73,0
s_add_u32 s76,s76,8192
s_addc_u32 s77,s77,0
s_add_u32 s80,s80,1
s_cmp_lg_u32 s80,16
s_cbranch_scc1 SL2_w0
s_nop 7
s_nop 7
v_rcp_f32 v224,v104
v_rcp_f32 v226,v108
v_rcp_f32 v228,v112
v_rcp_f32 v230,v116
v_pk_mul_f32 v[0:1],v[0:1],v[224:225] op_sel_hi:[1,0]
v_pk_mul_f32 v[2:3],v[2:3],v[224:225] op_sel_hi:[1,0]
v_pk_mul_f32 v[12:13],v[12:13],v[224:225] op_sel_hi:[1,0]
v_pk_mul_f32 v[14:15],v[14:15],v[224:225] op_sel_hi:[1,0]
CV 0,0,1
CV 1,2,3
CV 2,12,13
CV 3,14,15
v_pk_mul_f32 v[4:5],v[4:5],v[226:227] op_sel_hi:[1,0]
v_pk_mul_f32 v[6:7],v[6:7],v[226:227] op_sel_hi:[1,0]
v_pk_mul_f32 v[16:17],v[16:17],v[226:227] op_sel_hi:[1,0]
v_pk_mul_f32 v[18:19],v[18:19],v[226:227] op_sel_hi:[1,0]
CV 4,4,5
CV 5,6,7
CV 6,16,17
CV 7,18,19
v_pk_mul_f32 v[8:9],v[8:9],v[228:229] op_sel_hi:[1,0]
v_pk_mul_f32 v[10:11],v[10:11],v[228:229] op_sel_hi:[1,0]
v_pk_mul_f32 v[20:21],v[20:21],v[228:229] op_sel_hi:[1,0]
v_pk_mul_f32 v[22:23],v[22:23],v[228:229] op_sel_hi:[1,0]
CV 8,8,9
CV 9,10,11
CV 10,20,21
CV 11,22,23
v_pk_mul_f32 v[24:25],v[24:25],v[224:225] op_sel_hi:[1,0]
v_pk_mul_f32 v[26:27],v[26:27],v[224:225] op_sel_hi:[1,0]
v_pk_mul_f32 v[36:37],v[36:37],v[224:225] op_sel_hi:[1,0]
v_pk_mul_f32 v[38:39],v[38:39],v[224:225] op_sel_hi:[1,0]
CV 24,24,25
CV 25,26,27
CV 26,36,37
CV 27,38,39
v_pk_mul_f32 v[28:29],v[28:29],v[226:227] op_sel_hi:[1,0]
v_pk_mul_f32 v[30:31],v[30:31],v[226:227] op_sel_hi:[1,0]
v_pk_mul_f32 v[40:41],v[40:41],v[226:227] op_sel_hi:[1,0]
v_pk_mul_f32 v[42:43],v[42:43],v[226:227] op_sel_hi:[1,0]
CV 28,28,29
CV 29,30,31
CV 30,40,41
CV 31,42,43
v_pk_mul_f32 v[32:33],v[32:33],v[228:229] op_sel_hi:[1,0]
v_pk_mul_f32 v[34:35],v[34:35],v[228:229] op_sel_hi:[1,0]
v_pk_mul_f32 v[44:45],v[44:45],v[228:229] op_sel_hi:[1,0]
v_pk_mul_f32 v[46:47],v[46:47],v[228:229] op_sel_hi:[1,0]
CV 32,32,33
CV 33,34,35
CV 34,44,45
CV 35,46,47
v_pk_mul_f32 v[48:49],v[48:49],v[224:225] op_sel_hi:[1,0]
v_pk_mul_f32 v[50:51],v[50:51],v[224:225] op_sel_hi:[1,0]
v_pk_mul_f32 v[60:61],v[60:61],v[224:225] op_sel_hi:[1,0]
v_pk_mul_f32 v[62:63],v[62:63],v[224:225] op_sel_hi:[1,0]
CV 48,48,49
CV 49,50,51
CV 50,60,61
CV 51,62,63
v_pk_mul_f32 v[52:53],v[52:53],v[226:227] op_sel_hi:[1,0]
v_pk_mul_f32 v[54:55],v[54:55],v[226:227] op_sel_hi:[1,0]
v_pk_mul_f32 v[64:65],v[64:65],v[226:227] op_sel_hi:[1,0]
v_pk_mul_f32 v[66:67],v[66:67],v[226:227] op_sel_hi:[1,0]
CV 52,52,53
CV 53,54,55
CV 54,64,65
CV 55,66,67
v_pk_mul_f32 v[56:57],v[56:57],v[228:229] op_sel_hi:[1,0]
v_pk_mul_f32 v[58:59],v[58:59],v[228:229] op_sel_hi:[1,0]
v_pk_mul_f32 v[68:69],v[68:69],v[228:229] op_sel_hi:[1,0]
v_pk_mul_f32 v[70:71],v[70:71],v[228:229] op_sel_hi:[1,0]
CV 56,56,57
CV 57,58,59
CV 58,68,69
CV 59,70,71
v_pk_mul_f32 v[72:73],v[72:73],v[224:225] op_sel_hi:[1,0]
v_pk_mul_f32 v[74:75],v[74:75],v[224:225] op_sel_hi:[1,0]
v_pk_mul_f32 v[84:85],v[84:85],v[224:225] op_sel_hi:[1,0]
v_pk_mul_f32 v[86:87],v[86:87],v[224:225] op_sel_hi:[1,0]
CV 72,72,73
CV 73,74,75
CV 74,84,85
CV 75,86,87
v_pk_mul_f32 v[76:77],v[76:77],v[226:227] op_sel_hi:[1,0]
v_pk_mul_f32 v[78:79],v[78:79],v[226:227] op_sel_hi:[1,0]
v_pk_mul_f32 v[88:89],v[88:89],v[226:227] op_sel_hi:[1,0]
v_pk_mul_f32 v[90:91],v[90:91],v[226:227] op_sel_hi:[1,0]
CV 76,76,77
CV 77,78,79
CV 78,88,89
CV 79,90,91
v_pk_mul_f32 v[80:81],v[80:81],v[228:229] op_sel_hi:[1,0]
v_pk_mul_f32 v[82:83],v[82:83],v[228:229] op_sel_hi:[1,0]
v_pk_mul_f32 v[92:93],v[92:93],v[228:229] op_sel_hi:[1,0]
v_pk_mul_f32 v[94:95],v[94:95],v[228:229] op_sel_hi:[1,0]
CV 80,80,81
CV 81,82,83
CV 82,92,93
CV 83,94,95
v_pk_mul_f32 v[96:97],v[96:97],v[230:231] op_sel_hi:[1,0]
v_pk_mul_f32 v[98:99],v[98:99],v[230:231] op_sel_hi:[1,0]
v_pk_mul_f32 v[100:101],v[100:101],v[230:231] op_sel_hi:[1,0]
v_pk_mul_f32 v[102:103],v[102:103],v[230:231] op_sel_hi:[1,0]
CV 96,96,97
CV 97,98,99
CV 98,100,101
CV 99,102,103
s_nop 1
s_branch SLOW_r_w0
Calt1_w0:
s_nop 1
v_mov_b32 v250,0
v_mov_b32 v251,0
v_mov_b32 v252,0
v_mov_b32 v253,0
s_add_u32 s16,s12,0
s_addc_u32 s17,s13,0
s_add_u32 s18,s12,0
s_addc_u32 s19,s13,0
s_nop 1
s_branch Calt1_r_w0
Calt2_w0:
s_nop 1
s_add_u32 s16,s12,0
s_addc_u32 s17,s13,0
s_add_u32 s18,s12,0
s_addc_u32 s19,s13,0
s_nop 1
s_branch Calt2_r_w0
Calt3_w0:
s_nop 1
s_add_u32 s16,s12,0
s_addc_u32 s17,s13,0
s_add_u32 s18,s12,0
s_addc_u32 s19,s13,0
s_nop 1
s_branch Calt3_r_w0
Calt4_w0:
s_nop 1
s_add_u32 s16,s12,0
s_addc_u32 s17,s13,0
s_add_u32 s18,s12,0
s_addc_u32 s19,s13,0
s_nop 1
s_branch Calt4_r_w0
.p2align 6
W1:
s_and_b32 s28,s2,7
s_lshr_b32 s29,s2,3
s_lshr_b32 s30,s29,3
s_lshl_b32 s28,s28,2
s_add_u32 s28,s28,s30
s_and_b32 s29,s29,7
s_mul_i32 s30,s28,212992
s_add_u32 s4,s4,s30
s_addc_u32 s5,s5,0
s_lshl_b32 s30,s28,22
s_lshl_b32 s31,s29,19
s_add_u32 s30,s30,s31
s_add_u32 s30,s30,1024
s_add_u32 s6,s6,s30
s_addc_u32 s7,s7,0
s_add_u32 s8,s8,s30
s_addc_u32 s9,s9,0
s_lshl_b32 s30,s29,10
s_add_u32 s30,s30,65536
s_add_u32 s10,s10,s30
s_addc_u32 s11,s11,0
s_add_u32 s30,s31,4096
s_add_u32 s12,s12,s30
s_addc_u32 s13,s13,0
s_lshl_b32 s30,s28,3
s_add_u32 s30,s30,s29
s_mul_i32 s30,s30,212992
s_add_u32 s14,s14,s30
s_addc_u32 s15,s15,0
s_sub_u32 s14,s14,135168
s_subb_u32 s15,s15,0
s_mov_b32 s26,0x3e0293ee
s_mov_b32 s27,0x4f800000
s_mov_b32 s20,0
v_and_b32 v255,63,v0
v_lshlrev_b32 v249,4,v255
v_add_u32 v249,135168,v249
v_bfe_u32 v0,v255,2,3
v_mul_u32_u24 v248,1056,v0
v_lshrrev_b32 v0,5,v255
v_lshlrev_b32 v0,8,v0
v_and_b32 v1,3,v255
v_lshlrev_b32 v1,3,v1
v_add3_u32 v248,v248,v0,v1
v_lshrrev_b32 v0,4,v255
v_lshlrev_b32 v0,17,v0
v_and_b32 v1,15,v255
v_lshl_add_u32 v250,v1,4,v0
v_add_u32 v251,7936,v250
v_add_u32 v252,15872,v250
v_add_u32 v253,23808,v250
s_mov_b32 s31,0x3f803f80
v_accvgpr_write_b32 a240,s31
v_accvgpr_write_b32 a241,s31
v_accvgpr_write_b32 a242,s31
v_accvgpr_write_b32 a243,s31
v_lshrrev_b32 v4,3,v255
v_lshrrev_b32 v5,1,v4
v_and_b32 v6,7,v255
v_xor_b32 v7,v5,v6
v_lshlrev_b32 v7,4,v7
v_lshl_add_u32 v108,v4,10,v7
v_xor_b32 v109,64,v108
v_add_u32 v109,8192,v109
v_and_b32 v4,15,v255
v_lshrrev_b32 v5,4,v255
v_lshrrev_b32 v6,1,v4
v_xor_b32 v7,v5,v6
v_lshlrev_b32 v7,4,v7
v_lshl_add_u32 v104,v4,7,v7
v_xor_b32 v105,64,v104
v_add_u32 v106,67584,v104
v_add_u32 v107,67584,v105
v_lshrrev_b32 v6,2,v4
v_sub_u32 v6,4,v6
v_and_b32 v6,3,v6
v_xor_b32 v7,v5,v6
v_lshlrev_b32 v7,4,v7
v_lshl_add_u32 v254,v4,6,v7
v_add_u32 v254,135168,v254
v_lshrrev_b32 v4,2,v255
v_sub_u32 v6,4,v5
v_and_b32 v6,3,v6
v_and_b32 v7,3,v255
v_xor_b32 v7,v6,v7
v_lshlrev_b32 v7,4,v7
v_lshl_add_u32 v110,v4,10,v7
s_add_u32 s40,s4,49152
s_addc_u32 s41,s5,0
s_add_u32 s42,s4,65536
s_addc_u32 s43,s5,0
s_add_u32 s44,s4,81920
s_addc_u32 s45,s5,0
s_add_u32 s46,s4,196864
s_addc_u32 s47,s5,0
s_add_u32 s16,s10,0
s_addc_u32 s17,s11,0
s_mov_b32 m0,4224
s_nop 0
DW 250,16,0
s_mov_b32 m0,5024
s_nop 0
DW 251,16,256
s_mov_b32 m0,5824
s_nop 0
DW 252,16,512
s_mov_b32 m0,6624
s_nop 0
DW 253,16,768
s_mov_b32 m0,20992
s_nop 0
DW 108,40,0
s_mov_b32 m0,22016
s_nop 0
DW 109,40,0
s_mov_b32 m0,23040
s_nop 0
DW 108,42,0
s_mov_b32 m0,24064
s_nop 0
DW 109,42,0
s_add_u32 s40,s40,128
s_addc_u32 s41,s41,0
s_add_u32 s42,s42,128
s_addc_u32 s43,s43,0
s_mov_b32 m0,35840
s_nop 0
DW 108,44,0
s_mov_b32 m0,36864
s_nop 0
DW 109,44,0
s_add_u32 s44,s44,128
s_addc_u32 s45,s45,0
s_mov_b32 m0,139264
s_nop 0
DW 110,46,0
s_mov_b32 m0,140224
s_nop 0
DW 110,46,64
s_mov_b32 m0,141184
s_nop 0
DW 110,46,128
s_mov_b32 m0,142144
s_nop 0
DW 110,46,192
s_add_u32 s16,s10,524288
s_addc_u32 s17,s11,0
s_mov_b32 m0,54912
s_nop 0
DW 250,16,0
s_mov_b32 m0,55712
s_nop 0
DW 251,16,256
s_mov_b32 m0,56512
s_nop 0
DW 252,16,512
s_mov_b32 m0,57312
s_nop 0
DW 253,16,768
s_mov_b32 m0,71680
s_nop 0
DW 108,40,0
s_mov_b32 m0,72704
s_nop 0
DW 109,40,0
s_mov_b32 m0,73728
s_nop 0
DW 108,42,0
s_mov_b32 m0,74752
s_nop 0
DW 109,42,0
s_add_u32 s40,s40,128
s_addc_u32 s41,s41,0
s_add_u32 s42,s42,128
s_addc_u32 s43,s43,0
s_mov_b32 m0,86528
s_nop 0
DW 108,44,0
s_mov_b32 m0,87552
s_nop 0
DW 109,44,0
s_add_u32 s44,s44,128
s_addc_u32 s45,s45,0
s_add_u32 s16,s10,1048576
s_addc_u32 s17,s11,0
s_mov_b32 m0,105600
s_nop 0
DW 250,16,0
s_mov_b32 m0,106400
s_nop 0
DW 251,16,256
s_mov_b32 m0,107200
s_nop 0
DW 252,16,512
s_mov_b32 m0,108000
s_nop 0
DW 253,16,768
s_mov_b32 m0,122368
s_nop 0
DW 108,40,0
s_mov_b32 m0,123392
s_nop 0
DW 109,40,0
s_mov_b32 m0,124416
s_nop 0
DW 108,42,0
s_mov_b32 m0,125440
s_nop 0
DW 109,42,0
s_add_u32 s40,s40,128
s_addc_u32 s41,s41,0
s_add_u32 s42,s42,128
s_addc_u32 s43,s43,0
s_waitcnt vmcnt(18) lgkmcnt(0)
s_barrier
TR 192,248,0
TR 194,248,8448
TR 196,248,512
TR 198,248,8960
TR 200,248,32
TR 202,248,8480
TR 204,248,544
TR 206,248,8992
RD 0,104,20992
RD 12,105,20992
RD 4,104,23040
RD 16,105,23040
RD 8,104,35840
RD 20,105,35840
RD 224,254,0
LG 14
RD 228,254,1024
LG 0
Za 0,192,0
TR 208,248,64
v_subrev_u32 v255,135168,v249
s_mov_b32 m0,2048
s_add_u32 s16,s10,1572864
s_addc_u32 s17,s11,0
Ma 0,196,12
TR 210,248,8512
v_lshrrev_b32 v255,6,v255
s_lshl_b32 s30,s20,17
s_add_u32 s38,s6,s30
s_addc_u32 s39,s7,0
Za 4,192,4
TR 212,248,576
v_lshlrev_b32 v255,11,v255
s_add_u32 s38,s38,31744
s_addc_u32 s39,s39,0
s_lshl_b32 s30,s20,17
Ma 4,196,16
TR 214,248,9024
s_add_u32 s18,s10,3670272
s_addc_u32 s19,s11,0
Za 8,192,8
TR 216,248,96
Ma 8,196,20
TR 218,248,8544
Za 12,200,0
TR 220,248,608
Ma 12,204,12
TR 222,248,9056
Za 16,200,4
TR 192,248,128
Ma 16,204,16
TR 194,248,8576
Za 20,200,8
TR 196,248,640
Ma 20,204,20
TR 198,248,9088
LG 10
Za 24,208,0
LG 8
Ma 24,212,12
Za 28,208,4
TR 200,248,160
Ma 28,212,16
TR 202,248,8608
Za 32,208,8
TR 204,248,672
Ma 32,212,20
TR 206,248,9120
Za 96,208,224
Ma 96,212,228
LG 10
Za 36,216,0
TR 208,248,192
LG 9
Ma 36,220,12
TR 210,248,8640
Za 40,216,4
TR 212,248,704
Ma 40,220,16
TR 214,248,9152
Za 44,216,8
Ma 44,220,20
Za 100,216,224
TR 216,248,224
Ma 100,220,228
TR 218,248,8672
LG 12
Za 48,192,0
TR 220,248,736
LG 11
Ma 48,196,12
TR 222,248,9184
Za 52,192,4
Ma 52,196,16
Za 56,192,8
Ma 56,196,20
LG 10
Za 60,200,0
LG 8
Ma 60,204,12
Za 64,200,4
Ma 64,204,16
Za 68,200,8
Ma 68,204,20
s_waitcnt vmcnt(8) lgkmcnt(0)
s_barrier
Za 72,208,0
TR 192,248,50688
Ma 72,212,12
TR 194,248,59136
Za 76,208,4
TR 196,248,51200
Ma 76,212,16
TR 198,248,59648
Za 80,208,8
TR 200,248,50720
Ma 80,212,20
TR 202,248,59168
Za 84,216,0
TR 204,248,51232
TR 206,248,59680
Ma 84,220,12
RD 24,106,4096
RD 36,107,4096
Za 88,216,4
RD 28,106,6144
Ma 88,220,16
DW 108,44,0
s_mov_b32 m0,3072
Za 92,216,8
RD 40,107,6144
RD 32,106,18944
Ma 92,220,20
RD 44,107,18944
LG 5
Ma 0,192,24
DW 109,44,0
s_mov_b32 m0,21120
s_add_u32 s44,s44,128
s_addc_u32 s45,s45,0
LG 4
Ma 0,196,36
DW 250,16,0
s_mov_b32 m0,21920
LG 3
Ma 4,192,28
RD 232,254,2048
LG 3
Ma 4,196,40
RD 236,254,3072
LG 3
Ma 8,192,32
TR 208,248,50752
LG 3
Ma 8,196,44
TR 210,248,59200
Ma 12,200,24
TR 212,248,51264
Ma 12,204,36
TR 214,248,59712
Ma 16,200,28
DW 251,16,256
s_mov_b32 m0,22720
Ma 16,204,40
DW 252,16,512
s_mov_b32 m0,23520
Ma 20,200,32
TR 216,248,50784
Ma 20,204,44
TR 218,248,59232
LG 4
Ma 24,208,24
TR 220,248,51296
LG 3
Ma 24,212,36
TR 222,248,59744
Ma 28,208,28
DW 253,16,768
s_mov_b32 m0,37888
s_add_u32 s16,s10,2097152
s_addc_u32 s17,s11,0
Ma 28,212,40
DW 108,40,0
s_mov_b32 m0,38912
Ma 32,208,32
TR 192,248,50816
Ma 32,212,44
TR 194,248,59264
Ma 96,208,232
TR 196,248,51328
Ma 96,212,236
TR 198,248,59776
LG 6
Ma 36,216,24
DW 109,40,0
s_mov_b32 m0,39936
s_add_u32 s40,s40,128
s_addc_u32 s41,s41,0
LG 4
Ma 36,220,36
TR 200,248,50848
Ma 40,216,28
DW 108,42,0
s_mov_b32 m0,40960
Ma 40,220,40
TR 202,248,59296
Ma 44,216,32
TR 204,248,51360
Ma 44,220,44
TR 206,248,59808
Ma 100,216,232
DW 109,42,0
s_mov_b32 m0,52736
s_add_u32 s42,s42,128
s_addc_u32 s43,s43,0
Ma 100,220,236
TR 208,248,50880
LG 7
Ma 48,192,24
TR 210,248,59328
LG 6
Ma 48,196,36
TR 212,248,51392
Ma 52,192,28
TR 214,248,59840
Ma 52,196,40
TR 216,248,50912
Ma 56,192,32
TR 218,248,59360
Ma 56,196,44
TR 220,248,51424
LG 9
Ma 60,200,24
TR 222,248,59872
v_add_u32 v248,67584,v248
LG 8
Ma 60,204,36
Ma 64,200,28
Ma 64,204,40
Ma 68,200,32
Ma 68,204,44
s_waitcnt vmcnt(8) lgkmcnt(0)
s_barrier
Ma 72,208,24
TR 192,248,33792
Ma 72,212,36
TR 194,248,42240
Ma 76,208,28
TR 196,248,34304
Ma 76,212,40
TR 198,248,42752
Ma 80,208,32
TR 200,248,33824
Ma 80,212,44
TR 202,248,42272
Ma 84,216,24
TR 204,248,34336
TR 206,248,42784
Ma 84,220,36
RD 48,106,54784
RD 60,107,54784
Ma 88,216,28
RD 52,106,56832
Ma 88,220,40
DW 108,44,0
s_mov_b32 m0,53760
Ma 92,216,32
RD 64,107,56832
RD 56,104,2048
Ma 92,220,44
RD 68,105,2048
LG 5
Ma 0,192,48
DW 109,44,0
s_mov_b32 m0,71808
s_add_u32 s44,s44,128
s_addc_u32 s45,s45,0
LG 4
Ma 0,196,60
DW 250,16,0
s_mov_b32 m0,72608
LG 3
Ma 4,192,52
RD 224,254,4096
LG 3
Ma 4,196,64
RD 228,254,5120
LG 3
Ma 8,192,56
TR 208,248,33856
LG 3
Ma 8,196,68
TR 210,248,42304
Ma 12,200,48
TR 212,248,34368
Ma 12,204,60
TR 214,248,42816
Ma 16,200,52
DW 251,16,256
s_mov_b32 m0,73408
Ma 16,204,64
DW 252,16,512
s_mov_b32 m0,74208
Ma 20,200,56
TR 216,248,33888
Ma 20,204,68
TR 218,248,42336
LG 4
Ma 24,208,48
TR 220,248,34400
LG 3
Ma 24,212,60
TR 222,248,42848
Ma 28,208,52
DW 253,16,768
s_mov_b32 m0,88576
s_add_u32 s16,s10,2621440
s_addc_u32 s17,s11,0
Ma 28,212,64
DW 108,40,0
s_mov_b32 m0,89600
Ma 32,208,56
TR 192,248,33920
Ma 32,212,68
TR 194,248,42368
Ma 96,208,224
TR 196,248,34432
Ma 96,212,228
TR 198,248,42880
LG 6
Ma 36,216,48
DW 109,40,0
s_mov_b32 m0,90624
s_add_u32 s40,s40,128
s_addc_u32 s41,s41,0
LG 4
Ma 36,220,60
TR 200,248,33952
Ma 40,216,52
DW 108,42,0
s_mov_b32 m0,91648
Ma 40,220,64
TR 202,248,42400
Ma 44,216,56
TR 204,248,34464
Ma 44,220,68
TR 206,248,42912
Ma 100,216,224
DW 109,42,0
s_mov_b32 m0,103424
s_add_u32 s42,s42,128
s_addc_u32 s43,s43,0
Ma 100,220,228
TR 208,248,33984
LG 7
Ma 48,192,48
TR 210,248,42432
LG 6
Ma 48,196,60
TR 212,248,34496
Ma 52,192,52
TR 214,248,42944
Ma 52,196,64
TR 216,248,34016
Ma 56,192,56
TR 218,248,42464
Ma 56,196,68
TR 220,248,34528
LG 9
Ma 60,200,48
TR 222,248,42976
v_add_u32 v248,4294899712,v248
LG 8
Ma 60,204,60
Ma 64,200,52
Ma 64,204,64
Ma 68,200,56
Ma 68,204,68
s_waitcnt vmcnt(8) lgkmcnt(0)
s_barrier
Ma 72,208,48
TR 192,248,16896
Ma 72,212,60
TR 194,248,25344
Ma 76,208,52
TR 196,248,17408
Ma 76,212,64
TR 198,248,25856
Ma 80,208,56
TR 200,248,16928
Ma 80,212,68
TR 202,248,25376
Ma 84,216,48
TR 204,248,17440
TR 206,248,25888
Ma 84,220,60
RD 72,104,37888
RD 84,105,37888
Ma 88,216,52
RD 76,104,39936
Ma 88,220,64
DW 108,44,0
s_mov_b32 m0,104448
Ma 92,216,56
RD 88,105,39936
RD 80,104,52736
Ma 92,220,68
RD 92,105,52736
LG 5
Ma 0,192,72
DW 109,44,0
s_mov_b32 m0,122496
s_add_u32 s44,s44,128
s_addc_u32 s45,s45,0
LG 4
Ma 0,196,84
DW 250,16,0
s_mov_b32 m0,123296
LG 3
Ma 4,192,76
RD 232,254,6144
LG 3
Ma 4,196,88
RD 236,254,7168
LG 3
Ma 8,192,80
TR 208,248,16960
LG 3
Ma 8,196,92
TR 210,248,25408
Ma 12,200,72
TR 212,248,17472
Ma 12,204,84
TR 214,248,25920
Ma 16,200,76
DW 251,16,256
s_mov_b32 m0,124096
Ma 16,204,88
DW 252,16,512
s_mov_b32 m0,124896
Ma 20,200,80
TR 216,248,16992
Ma 20,204,92
TR 218,248,25440
LG 4
Ma 24,208,72
TR 220,248,17504
LG 3
Ma 24,212,84
TR 222,248,25952
Ma 28,208,76
DW 253,16,768
s_mov_b32 m0,4096
s_add_u32 s16,s10,3145728
s_addc_u32 s17,s11,0
Ma 28,212,88
DW 108,40,0
s_mov_b32 m0,5120
Ma 32,208,80
TR 192,248,17024
Ma 32,212,92
TR 194,248,25472
Ma 96,208,232
TR 196,248,17536
Ma 96,212,236
TR 198,248,25984
LG 6
Ma 36,216,72
DW 109,40,0
s_mov_b32 m0,6144
s_add_u32 s40,s40,128
s_addc_u32 s41,s41,0
LG 4
Ma 36,220,84
TR 200,248,17056
Ma 40,216,76
DW 108,42,0
s_mov_b32 m0,7168
Ma 40,220,88
TR 202,248,25504
Ma 44,216,80
TR 204,248,17568
Ma 44,220,92
TR 206,248,26016
Ma 100,216,232
DW 109,42,0
s_mov_b32 m0,18944
s_add_u32 s42,s42,128
s_addc_u32 s43,s43,0
Ma 100,220,236
TR 208,248,17088
LG 7
Ma 48,192,72
TR 210,248,25536
LG 6
Ma 48,196,84
TR 212,248,17600
Ma 52,192,76
TR 214,248,26048
Ma 52,196,88
TR 216,248,17120
Ma 56,192,80
TR 218,248,25568
Ma 56,196,92
TR 220,248,17632
LG 9
Ma 60,200,72
TR 222,248,26080
v_add_u32 v248,67584,v248
LG 8
Ma 60,204,84
Ma 64,200,76
Ma 64,204,88
Ma 68,200,80
Ma 68,204,92
s_waitcnt vmcnt(8) lgkmcnt(0)
s_barrier
Ma 72,208,72
TR 192,248,0
Ma 72,212,84
TR 194,248,8448
Ma 76,208,76
TR 196,248,512
Ma 76,212,88
TR 198,248,8960
Ma 80,208,80
TR 200,248,32
Ma 80,212,92
TR 202,248,8480
Ma 84,216,72
TR 204,248,544
TR 206,248,8992
Ma 84,220,84
RD 96,106,20992
RD 108,107,20992
Ma 88,216,76
RD 100,106,23040
Ma 88,220,88
DW 108,44,0
s_mov_b32 m0,19968
Ma 92,216,80
RD 112,107,23040
RD 104,106,35840
Ma 92,220,92
RD 116,107,35840
LG 5
Ma 0,192,96
DW 109,44,0
s_mov_b32 m0,38016
s_add_u32 s44,s44,128
s_addc_u32 s45,s45,0
LG 4
Ma 0,196,108
DW 250,16,0
s_mov_b32 m0,38816
LG 3
Ma 4,192,100
RD 224,254,8192
LG 3
Ma 4,196,112
RD 228,254,9216
LG 3
Ma 8,192,104
TR 208,248,64
LG 3
Ma 8,196,116
TR 210,248,8512
Ma 12,200,96
TR 212,248,576
Ma 12,204,108
TR 214,248,9024
Ma 16,200,100
DW 251,16,256
s_mov_b32 m0,39616
Ma 16,204,112
DW 252,16,512
s_mov_b32 m0,40416
Ma 20,200,104
TR 216,248,96
Ma 20,204,116
TR 218,248,8544
LG 4
Ma 24,208,96
TR 220,248,608
LG 3
Ma 24,212,108
TR 222,248,9056
Ma 28,208,100
DW 253,16,768
s_mov_b32 m0,54784
s_add_u32 s16,s10,3670016
s_addc_u32 s17,s11,0
Ma 28,212,112
DW 108,40,0
s_mov_b32 m0,55808
Ma 32,208,104
TR 192,248,128
Ma 32,212,116
TR 194,248,8576
Ma 96,208,224
TR 196,248,640
Ma 96,212,228
TR 198,248,9088
LG 6
Ma 36,216,96
DW 109,40,0
s_mov_b32 m0,56832
s_add_u32 s40,s40,128
s_addc_u32 s41,s41,0
LG 4
Ma 36,220,108
TR 200,248,160
Ma 40,216,100
DW 108,42,0
s_mov_b32 m0,57856
Ma 40,220,112
TR 202,248,8608
Ma 44,216,104
TR 204,248,672
Ma 44,220,116
TR 206,248,9120
Ma 100,216,224
DW 109,42,0
s_mov_b32 m0,69632
s_add_u32 s42,s42,128
s_addc_u32 s43,s43,0
Ma 100,220,228
TR 208,248,192
LG 7
Ma 48,192,96
TR 210,248,8640
LG 6
Ma 48,196,108
TR 212,248,704
Ma 52,192,100
TR 214,248,9152
Ma 52,196,112
TR 216,248,224
Ma 56,192,104
TR 218,248,8672
Ma 56,196,116
TR 220,248,736
LG 9
Ma 60,200,96
TR 222,248,9184
LG 8
Ma 60,204,108
Ma 64,200,100
Ma 64,204,112
Ma 68,200,104
Ma 68,204,116
s_waitcnt vmcnt(8) lgkmcnt(0)
s_barrier
Ma 72,208,96
TR 192,248,50688
Ma 72,212,108
TR 194,248,59136
Ma 76,208,100
TR 196,248,51200
Ma 76,212,112
TR 198,248,59648
Ma 80,208,104
TR 200,248,50720
Ma 80,212,116
TR 202,248,59168
Ma 84,216,96
TR 204,248,51232
TR 206,248,59680
Ma 84,220,108
RD 120,104,4096
RD 132,105,4096
Ma 88,216,100
RD 124,104,6144
Ma 88,220,112
DW 108,44,0
s_mov_b32 m0,70656
Ma 92,216,104
RD 136,105,6144
RD 128,104,18944
Ma 92,220,116
RD 140,105,18944
LG 5
Ma 0,192,120
DW 109,44,0
s_mov_b32 m0,88704
s_add_u32 s44,s44,128
s_addc_u32 s45,s45,0
LG 4
Ma 0,196,132
DW 250,16,0
s_mov_b32 m0,89504
LG 3
Ma 4,192,124
RD 232,254,10240
LG 3
Ma 4,196,136
RD 236,254,11264
LG 3
Ma 8,192,128
TR 208,248,50752
LG 3
Ma 8,196,140
TR 210,248,59200
Ma 12,200,120
TR 212,248,51264
Ma 12,204,132
TR 214,248,59712
Ma 16,200,124
DW 251,16,256
s_mov_b32 m0,90304
Ma 16,204,136
DW 252,16,512
s_mov_b32 m0,91104
Ma 20,200,128
TR 216,248,50784
Ma 20,204,140
TR 218,248,59232
LG 4
Ma 24,208,120
TR 220,248,51296
LG 3
Ma 24,212,132
TR 222,248,59744
Ma 28,208,124
DW 253,16,768
s_mov_b32 m0,105472
s_add_u32 s16,s10,256
s_addc_u32 s17,s11,0
Ma 28,212,136
DW 108,40,0
s_mov_b32 m0,106496
Ma 32,208,128
TR 192,248,50816
Ma 32,212,140
TR 194,248,59264
Ma 96,208,232
TR 196,248,51328
Ma 96,212,236
TR 198,248,59776
LG 6
Ma 36,216,120
DW 109,40,0
s_mov_b32 m0,107520
s_add_u32 s40,s40,128
s_addc_u32 s41,s41,0
LG 4
Ma 36,220,132
TR 200,248,50848
Ma 40,216,124
DW 108,42,0
s_mov_b32 m0,108544
Ma 40,220,136
TR 202,248,59296
Ma 44,216,128
TR 204,248,51360
Ma 44,220,140
TR 206,248,59808
Ma 100,216,232
DW 109,42,0
s_mov_b32 m0,120320
s_add_u32 s42,s42,128
s_addc_u32 s43,s43,0
Ma 100,220,236
TR 208,248,50880
LG 7
Ma 48,192,120
TR 210,248,59328
LG 6
Ma 48,196,132
TR 212,248,51392
Ma 52,192,124
TR 214,248,59840
Ma 52,196,136
TR 216,248,50912
Ma 56,192,128
TR 218,248,59360
Ma 56,196,140
TR 220,248,51424
LG 9
Ma 60,200,120
TR 222,248,59872
v_add_u32 v248,4294899712,v248
LG 8
Ma 60,204,132
Ma 64,200,124
Ma 64,204,136
Ma 68,200,128
Ma 68,204,140
s_waitcnt vmcnt(8) lgkmcnt(0)
s_barrier
Ma 72,208,120
TR 192,248,33792
Ma 72,212,132
TR 194,248,42240
Ma 76,208,124
TR 196,248,34304
Ma 76,212,136
TR 198,248,42752
Ma 80,208,128
TR 200,248,33824
Ma 80,212,140
TR 202,248,42272
Ma 84,216,120
TR 204,248,34336
TR 206,248,42784
Ma 84,220,132
RD 144,104,54784
RD 156,105,54784
Ma 88,216,124
RD 148,104,56832
Ma 88,220,136
DW 108,44,0
s_mov_b32 m0,121344
Ma 92,216,128
RD 160,105,56832
RD 152,106,2048
Ma 92,220,140
RD 164,107,2048
LG 5
Ma 0,192,144
DW 109,44,0
s_mov_b32 m0,4224
s_add_u32 s44,s44,128
s_addc_u32 s45,s45,0
LG 4
Ma 0,196,156
DW 250,16,0
s_mov_b32 m0,5024
LG 3
Ma 4,192,148
RD 224,254,12288
LG 3
Ma 4,196,160
RD 228,254,13312
LG 3
Ma 8,192,152
TR 208,248,33856
LG 3
Ma 8,196,164
TR 210,248,42304
Ma 12,200,144
TR 212,248,34368
Ma 12,204,156
TR 214,248,42816
Ma 16,200,148
DW 251,16,256
s_mov_b32 m0,5824
Ma 16,204,160
DW 252,16,512
s_mov_b32 m0,6624
Ma 20,200,152
TR 216,248,33888
Ma 20,204,164
TR 218,248,42336
LG 4
Ma 24,208,144
TR 220,248,34400
LG 3
Ma 24,212,156
TR 222,248,42848
Ma 28,208,148
DW 253,16,768
s_add_u32 s16,s10,524544
s_addc_u32 s17,s11,0
s_mov_b32 m0,21120
Ma 28,212,160
DW 250,16,0
s_mov_b32 m0,21920
Ma 32,208,152
TR 192,248,33920
Ma 32,212,164
TR 194,248,42368
Ma 96,208,224
DW 251,16,256
s_mov_b32 m0,22720
Ma 96,212,228
TR 196,248,34432
LG 5
Ma 36,216,144
TR 198,248,42880
LG 4
Ma 36,220,156
TR 200,248,33952
Ma 40,216,148
DW 252,16,512
s_mov_b32 m0,23520
Ma 40,220,160
TR 202,248,42400
Ma 44,216,152
TR 204,248,34464
Ma 44,220,164
TR 206,248,42912
Ma 100,216,224
DW 253,16,768
s_add_u32 s16,s10,1048832
s_addc_u32 s17,s11,0
s_mov_b32 m0,38016
Ma 100,220,228
global_load_dword a253,v255,s[38:39]
s_add_u32 s38,s8,s30
s_addc_u32 s39,s9,0
s_add_u32 s38,s38,31744
s_addc_u32 s39,s39,0
LG 6
Ma 48,192,144
TR 208,248,33984
v_subrev_u32 v255,135168,v249
LG 5
Ma 48,196,156
TR 210,248,42432
v_lshrrev_b32 v255,6,v255
Ma 52,192,148
TR 212,248,34496
v_lshlrev_b32 v255,11,v255
Ma 52,196,160
TR 214,248,42944
Ma 56,192,152
TR 216,248,34016
Ma 56,196,164
TR 218,248,42464
LG 8
Ma 60,200,144
TR 220,248,34528
TR 222,248,42976
LG 8
Ma 60,204,156
v_add_u32 v248,67584,v248
Ma 64,200,148
Ma 64,204,160
Ma 68,200,152
Ma 68,204,164
s_waitcnt vmcnt(9) lgkmcnt(0)
s_barrier
Ma 72,208,144
TR 192,248,16896
Ma 72,212,156
TR 194,248,25344
Ma 76,208,148
TR 196,248,17408
Ma 76,212,160
TR 198,248,25856
Ma 80,208,152
TR 200,248,16928
Ma 80,212,164
TR 202,248,25376
Ma 84,216,144
TR 204,248,17440
TR 206,248,25888
Ma 84,220,156
RD 168,106,37888
RD 180,107,37888
Ma 88,216,148
RD 172,106,39936
Ma 88,220,160
DW 250,16,0
s_mov_b32 m0,38816
Ma 92,216,152
RD 184,107,39936
RD 176,106,52736
Ma 92,220,164
RD 188,107,52736
LG 5
Ma 0,192,168
DW 251,16,256
s_mov_b32 m0,39616
LG 4
Ma 0,196,180
DW 252,16,512
s_mov_b32 m0,40416
LG 3
Ma 4,192,172
RD 232,254,14336
LG 3
Ma 4,196,184
RD 236,254,15360
LG 3
Ma 8,192,176
TR 208,248,16960
MU 0,s26
LG 3
Ma 8,196,188
TR 210,248,25408
MU 1,s26
Ma 12,200,168
TR 212,248,17472
MU 2,s26
Ma 12,204,180
TR 214,248,25920
MU 3,s26
Ma 16,200,172
DW 253,16,768
s_add_u32 s16,s10,1573120
s_addc_u32 s17,s11,0
s_mov_b32 m0,54912
Ma 16,204,184
DW 250,16,0
s_mov_b32 m0,55712
Ma 20,200,176
TR 216,248,16992
MU 12,s26
Ma 20,204,188
TR 218,248,25440
MU 13,s26
LG 4
Ma 24,208,168
TR 220,248,17504
MU 14,s26
LG 3
Ma 24,212,180
TR 222,248,25952
MU 15,s26
Ma 28,208,172
DW 251,16,256
s_mov_b32 m0,56512
Ma 28,212,184
DW 252,16,512
s_mov_b32 m0,57312
Ma 32,208,176
TR 192,248,17024
CV 0,0,1
Ma 32,212,188
TR 194,248,25472
CV 1,2,3
Ma 96,208,232
DW 253,16,768
s_add_u32 s16,s10,2097408
s_addc_u32 s17,s11,0
s_mov_b32 m0,71808
Ma 96,212,236
TR 196,248,17536
CV 2,12,13
LG 5
Ma 36,216,168
TR 198,248,25984
CV 3,14,15
LG 4
Ma 36,220,180
TR 200,248,17056
v_permlane32_swap_b32 v0,v2
Ma 40,216,172
DW 250,16,0
s_mov_b32 m0,72608
Ma 40,220,184
TR 202,248,25504
v_permlane32_swap_b32 v1,v3
Ma 44,216,176
TR 204,248,17568
v_permlane16_swap_b32 v0,v2
Ma 44,220,188
TR 206,248,26016
v_permlane16_swap_b32 v1,v3
Ma 100,216,232
DW 251,16,256
s_mov_b32 m0,73408
Ma 100,220,236
TR 208,248,17088
MU 4,s26
LG 7
Ma 48,192,168
TR 210,248,25536
MU 5,s26
LG 6
Ma 48,196,180
TR 212,248,17600
MU 6,s26
Ma 52,192,172
DW 252,16,512
s_mov_b32 m0,74208
Ma 52,196,184
TR 214,248,26048
MU 7,s26
Ma 56,192,176
TR 216,248,17120
MU 16,s26
Ma 56,196,188
TR 218,248,25568
MU 17,s26
LG 8
Ma 60,200,168
DW 253,16,768
s_add_u32 s16,s10,2621696
s_addc_u32 s17,s11,0
s_mov_b32 m0,88704
LG 6
Ma 60,204,180
global_load_dword a253,v255,s[38:39]
Ma 64,200,172
TR 220,248,17632
TR 222,248,26080
Ma 64,204,184
v_add_u32 v248,4294899712,v248
MU 18,s26
Ma 68,200,176
MU 19,s26
CV 4,4,5
Ma 68,204,188
CV 5,6,7
CV 6,16,17
s_waitcnt vmcnt(14) lgkmcnt(0)
s_barrier
Ma 72,208,168
TR 192,248,0
CV 7,18,19
Ma 72,212,180
TR 194,248,8448
v_permlane32_swap_b32 v4,v6
Ma 76,208,172
TR 196,248,512
v_permlane32_swap_b32 v5,v7
Ma 76,212,184
TR 198,248,8960
v_permlane16_swap_b32 v4,v6
Ma 80,208,176
TR 200,248,16896
v_permlane16_swap_b32 v5,v7
Ma 80,212,188
TR 202,248,25344
MU 8,s26
Ma 84,216,168
TR 204,248,17408
TR 206,248,25856
Ma 84,220,180
RD 224,254,0
RD 228,254,1024
Ma 88,216,172
RD 232,254,2048
RD 236,254,3072
Ma 88,220,184
DW 250,16,0
s_mov_b32 m0,89504
Ma 92,216,176
DW 251,16,256
s_mov_b32 m0,90304
Ma 92,220,188
DW 252,16,512
s_mov_b32 m0,91104
s_nop 0
DW 253,16,768
s_add_u32 s16,s10,3145984
s_addc_u32 s17,s11,0
MU 9,s26
MU 10,s26
MU 11,s26
MU 20,s26
MU 21,s26
MU 22,s26
MU 23,s26
CV 8,8,9
CV 9,10,11
CV 10,20,21
CV 11,22,23
s_nop 0
v_permlane32_swap_b32 v8,v10
v_permlane32_swap_b32 v9,v11
s_nop 0
v_permlane16_swap_b32 v8,v10
v_permlane16_swap_b32 v9,v11
MU 24,s26
MU 25,s26
MU 26,s26
MU 27,s26
MU 36,s26
MU 37,s26
MU 38,s26
MU 39,s26
CV 24,24,25
CV 25,26,27
CV 26,36,37
CV 27,38,39
s_nop 0
v_permlane32_swap_b32 v24,v26
v_permlane32_swap_b32 v25,v27
s_nop 0
v_permlane16_swap_b32 v24,v26
v_permlane16_swap_b32 v25,v27
MU 28,s26
MU 29,s26
MU 30,s26
MU 31,s26
MU 40,s26
MU 41,s26
MU 42,s26
MU 43,s26
CV 28,28,29
CV 29,30,31
CV 30,40,41
CV 31,42,43
s_nop 0
v_permlane32_swap_b32 v28,v30
v_permlane32_swap_b32 v29,v31
s_nop 0
v_permlane16_swap_b32 v28,v30
v_permlane16_swap_b32 v29,v31
MU 32,s26
MU 33,s26
MU 34,s26
MU 35,s26
MU 44,s26
MU 45,s26
MU 46,s26
MU 47,s26
CV 32,32,33
CV 33,34,35
CV 34,44,45
CV 35,46,47
s_nop 0
v_permlane32_swap_b32 v32,v34
v_permlane32_swap_b32 v33,v35
s_nop 0
v_permlane16_swap_b32 v32,v34
v_permlane16_swap_b32 v33,v35
v_pk_mul_f32 v[48:49],v[48:49],s[26:27] op_sel_hi:[1,0]
v_pk_mul_f32 v[50:51],v[50:51],s[26:27] op_sel_hi:[1,0]
v_pk_mul_f32 v[60:61],v[60:61],s[26:27] op_sel_hi:[1,0]
v_pk_mul_f32 v[62:63],v[62:63],s[26:27] op_sel_hi:[1,0]
CV 48,48,49
CV 49,50,51
CV 50,60,61
CV 51,62,63
s_nop 0
v_permlane32_swap_b32 v48,v50
v_permlane32_swap_b32 v49,v51
s_nop 0
v_permlane16_swap_b32 v48,v50
v_permlane16_swap_b32 v49,v51
v_pk_mul_f32 v[52:53],v[52:53],s[26:27] op_sel_hi:[1,0]
v_pk_mul_f32 v[54:55],v[54:55],s[26:27] op_sel_hi:[1,0]
v_pk_mul_f32 v[64:65],v[64:65],s[26:27] op_sel_hi:[1,0]
v_pk_mul_f32 v[66:67],v[66:67],s[26:27] op_sel_hi:[1,0]
CV 52,52,53
CV 53,54,55
CV 54,64,65
CV 55,66,67
s_nop 0
v_permlane32_swap_b32 v52,v54
v_permlane32_swap_b32 v53,v55
s_nop 0
v_permlane16_swap_b32 v52,v54
v_permlane16_swap_b32 v53,v55
v_pk_mul_f32 v[56:57],v[56:57],s[26:27] op_sel_hi:[1,0]
v_pk_mul_f32 v[58:59],v[58:59],s[26:27] op_sel_hi:[1,0]
v_pk_mul_f32 v[68:69],v[68:69],s[26:27] op_sel_hi:[1,0]
v_pk_mul_f32 v[70:71],v[70:71],s[26:27] op_sel_hi:[1,0]
CV 56,56,57
CV 57,58,59
CV 58,68,69
CV 59,70,71
s_nop 0
v_permlane32_swap_b32 v56,v58
v_permlane32_swap_b32 v57,v59
s_nop 0
v_permlane16_swap_b32 v56,v58
v_permlane16_swap_b32 v57,v59
v_pk_mul_f32 v[72:73],v[72:73],s[26:27] op_sel_hi:[1,0]
v_pk_mul_f32 v[74:75],v[74:75],s[26:27] op_sel_hi:[1,0]
v_pk_mul_f32 v[84:85],v[84:85],s[26:27] op_sel_hi:[1,0]
v_pk_mul_f32 v[86:87],v[86:87],s[26:27] op_sel_hi:[1,0]
CV 72,72,73
CV 73,74,75
CV 74,84,85
CV 75,86,87
s_nop 0
v_permlane32_swap_b32 v72,v74
v_permlane32_swap_b32 v73,v75
s_nop 0
v_permlane16_swap_b32 v72,v74
v_permlane16_swap_b32 v73,v75
v_pk_mul_f32 v[76:77],v[76:77],s[26:27] op_sel_hi:[1,0]
v_pk_mul_f32 v[78:79],v[78:79],s[26:27] op_sel_hi:[1,0]
v_pk_mul_f32 v[88:89],v[88:89],s[26:27] op_sel_hi:[1,0]
v_pk_mul_f32 v[90:91],v[90:91],s[26:27] op_sel_hi:[1,0]
CV 76,76,77
CV 77,78,79
CV 78,88,89
CV 79,90,91
s_nop 0
v_permlane32_swap_b32 v76,v78
v_permlane32_swap_b32 v77,v79
s_nop 0
v_permlane16_swap_b32 v76,v78
v_permlane16_swap_b32 v77,v79
v_pk_mul_f32 v[80:81],v[80:81],s[26:27] op_sel_hi:[1,0]
v_pk_mul_f32 v[82:83],v[82:83],s[26:27] op_sel_hi:[1,0]
v_pk_mul_f32 v[92:93],v[92:93],s[26:27] op_sel_hi:[1,0]
v_pk_mul_f32 v[94:95],v[94:95],s[26:27] op_sel_hi:[1,0]
CV 80,80,81
CV 81,82,83
CV 82,92,93
CV 83,94,95
s_nop 0
v_permlane32_swap_b32 v80,v82
v_permlane32_swap_b32 v81,v83
s_nop 0
v_permlane16_swap_b32 v80,v82
v_permlane16_swap_b32 v81,v83
MU 96,s26
MU 97,s26
MU 98,s26
MU 99,s26
MU 100,s26
MU 101,s26
MU 102,s26
MU 103,s26
CV 96,96,97
CV 97,98,99
CV 98,100,101
CV 99,102,103
s_nop 0
v_permlane32_swap_b32 v96,v98
v_permlane32_swap_b32 v97,v99
s_nop 0
v_permlane16_swap_b32 v96,v98
v_permlane16_swap_b32 v97,v99
ds_write_b128 v249,v[96:99] offset:17408
v_mov_b32 v104,v0
v_mov_b32 v105,v1
v_mov_b32 v106,v2
v_mov_b32 v107,v3
v_mov_b32 v108,v4
v_mov_b32 v109,v5
v_mov_b32 v110,v6
v_mov_b32 v111,v7
v_mov_b32 v112,v8
v_mov_b32 v113,v9
v_mov_b32 v114,v10
v_mov_b32 v115,v11
v_mov_b32 v116,v24
v_mov_b32 v117,v25
v_mov_b32 v118,v26
v_mov_b32 v119,v27
v_mov_b32 v120,v28
v_mov_b32 v121,v29
v_mov_b32 v122,v30
v_mov_b32 v123,v31
v_mov_b32 v124,v32
v_mov_b32 v125,v33
v_mov_b32 v126,v34
v_mov_b32 v127,v35
v_mov_b32 v128,v48
v_mov_b32 v129,v49
v_mov_b32 v130,v50
v_mov_b32 v131,v51
v_mov_b32 v132,v52
v_mov_b32 v133,v53
v_mov_b32 v134,v54
v_mov_b32 v135,v55
v_mov_b32 v136,v56
v_mov_b32 v137,v57
v_mov_b32 v138,v58
v_mov_b32 v139,v59
v_mov_b32 v140,v72
v_mov_b32 v141,v73
v_mov_b32 v142,v74
v_mov_b32 v143,v75
v_mov_b32 v144,v76
v_mov_b32 v145,v77
v_mov_b32 v146,v78
v_mov_b32 v147,v79
v_mov_b32 v148,v80
v_mov_b32 v149,v81
v_mov_b32 v150,v82
v_mov_b32 v151,v83
s_add_u32 s10,s10,256
s_addc_u32 s11,s11,0
s_add_u32 s20,s20,1
LA_w1:
LG 0
Za 0,192,0
TR 208,248,32
v_subrev_u32 v255,135168,v249
s_mov_b32 m0,105600
s_lshl_b32 s30,s20,17
Ma 0,196,12
TR 210,248,8480
v_lshrrev_b32 v255,6,v255
s_add_u32 s38,s6,s30
s_addc_u32 s39,s7,0
s_add_u32 s38,s38,31744
s_addc_u32 s39,s39,0
Ma 0,200,24
TR 212,248,544
v_lshlrev_b32 v255,11,v255
s_lshl_b32 s30,s20,17
Ma 0,204,36
TR 214,248,8992
Za 4,192,4
TR 216,248,16928
Ma 4,196,16
TR 218,248,25376
Ma 4,200,28
DW 250,16,0
s_mov_b32 m0,106400
Ma 4,204,40
TR 220,248,17440
Za 8,192,8
TR 222,248,25888
Ma 8,196,20
TR 192,248,64
Ma 8,200,32
TR 194,248,8512
Ma 8,204,44
TR 196,248,576
LG 9
Za 12,208,0
TR 198,248,9024
LG 8
Ma 12,212,12
DW 251,16,256
s_mov_b32 m0,107200
LG 6
Ma 12,216,24
TR 200,248,16960
LG 5
Ma 12,220,36
TR 202,248,25408
Za 16,208,4
TR 204,248,17472
Ma 16,212,16
TR 206,248,25920
Ma 16,216,28
Ma 16,220,40
Za 20,208,8
TR 208,248,96
Ma 20,212,20
TR 210,248,8544
Ma 20,216,32
TR 212,248,608
Ma 20,220,44
DW 252,16,512
s_mov_b32 m0,108000
LG 9
Za 24,192,0
TR 214,248,9056
LG 8
Ma 24,196,12
TR 216,248,16992
LG 7
Ma 24,200,24
TR 218,248,25440
LG 6
Ma 24,204,36
TR 220,248,17504
Za 28,192,4
TR 222,248,25952
Ma 28,196,16
Ma 28,200,28
Ma 28,204,40
Za 32,192,8
Ma 32,196,20
DW 253,16,768
s_mov_b32 m0,122496
s_add_u32 s16,s10,256
s_addc_u32 s17,s11,0
Ma 32,200,32
Ma 32,204,44
Za 96,192,224
TR 192,248,128
Ma 96,196,228
TR 194,248,8576
Ma 96,200,232
TR 196,248,640
Ma 96,204,236
TR 198,248,9088
LG 10
Za 36,208,0
TR 200,248,17024
LG 9
Ma 36,212,12
TR 202,248,25472
LG 8
Ma 36,216,24
TR 204,248,17536
LG 7
Ma 36,220,36
DW 250,18,0
s_mov_b32 m0,123296
Za 40,208,4
TR 206,248,25984
Ma 40,212,16
Ma 40,216,28
Ma 40,220,40
Za 44,208,8
Ma 44,212,20
Ma 44,216,32
Ma 44,220,44
Za 100,208,224
TR 208,248,160
Ma 100,212,228
DW 251,18,256
s_mov_b32 m0,124096
Ma 100,216,232
TR 210,248,8608
Ma 100,220,236
TR 212,248,672
LG 9
Za 48,192,0
TR 214,248,9120
LG 8
Ma 48,196,12
TR 216,248,17056
LG 7
Ma 48,200,24
TR 218,248,25504
LG 6
Ma 48,204,36
TR 220,248,17568
Za 52,192,4
TR 222,248,26016
Ma 52,196,16
Ma 52,200,28
Ma 52,204,40
DW 252,18,512
s_mov_b32 m0,124896
Za 56,192,8
TR 192,248,192
Ma 56,196,20
TR 194,248,8640
Ma 56,200,32
TR 196,248,704
Ma 56,204,44
TR 198,248,9152
LG 10
Za 60,208,0
TR 200,248,17088
LG 9
Ma 60,212,12
TR 202,248,25536
LG 8
Ma 60,216,24
TR 204,248,17600
LG 7
Ma 60,220,36
TR 206,248,26048
Za 64,208,4
Ma 64,212,16
DW 253,18,768
s_mov_b32 m0,4224
s_add_u32 s18,s10,524544
s_addc_u32 s19,s11,0
Ma 64,216,28
Ma 64,220,40
Za 68,208,8
TR 208,248,224
Ma 68,212,20
TR 210,248,8672
Ma 68,216,32
TR 212,248,736
Ma 68,220,44
TR 214,248,9184
LG 10
Za 72,192,0
TR 216,248,17120
LG 9
Ma 72,196,12
TR 218,248,25568
LG 8
Ma 72,200,24
TR 220,248,17632
LG 7
Ma 72,204,36
TR 222,248,26080
Za 76,192,4
Ma 76,196,16
Ma 76,200,28
Ma 76,204,40
Za 80,192,8
Ma 80,196,20
Ma 80,200,32
Ma 80,204,44
LG 6
Za 84,208,0
LG 4
Ma 84,212,12
LG 2
Ma 84,216,24
LG 0
Ma 84,220,36
s_waitcnt vmcnt(17) lgkmcnt(0)
s_barrier
Za 88,208,4
TR 192,248,33792
Ma 88,212,16
TR 194,248,42240
Ma 88,216,28
TR 196,248,34304
Ma 88,220,40
TR 198,248,42752
Za 92,208,8
TR 200,248,50688
TR 202,248,59136
Ma 92,212,20
TR 204,248,51200
TR 206,248,59648
Ma 92,216,32
DW 250,16,0
s_mov_b32 m0,5024
Ma 92,220,44
RD 224,254,4096
LG 7
Ma 0,192,48
RD 228,254,5120
LG 6
Ma 0,196,60
RD 232,254,6144
LG 5
Ma 0,200,72
RD 236,254,7168
LG 4
Ma 0,204,84
TR 208,248,33824
Ma 4,192,52
TR 210,248,42272
Ma 4,196,64
TR 212,248,34336
Ma 4,200,76
TR 214,248,42784
Ma 4,204,88
TR 216,248,50720
Ma 8,192,56
TR 218,248,59168
Ma 8,196,68
TR 220,248,51232
TR 222,248,59680
Ma 8,200,80
DW 251,16,256
s_mov_b32 m0,5824
Ma 8,204,92
TR 192,248,33856
LG 7
Ma 12,208,48
TR 194,248,42304
LG 6
Ma 12,212,60
TR 196,248,34368
LG 5
Ma 12,216,72
TR 198,248,42816
LG 4
Ma 12,220,84
TR 200,248,50752
Ma 16,208,52
TR 202,248,59200
Ma 16,212,64
TR 204,248,51264
Ma 16,216,76
TR 206,248,59712
Ma 16,220,88
DW 252,16,512
s_mov_b32 m0,6624
Ma 20,208,56
TR 208,248,33888
Ma 20,212,68
TR 210,248,42336
Ma 20,216,80
TR 212,248,34400
Ma 20,220,92
TR 214,248,42848
LG 10
Ma 24,192,48
TR 216,248,50784
LG 9
Ma 24,196,60
TR 218,248,59232
LG 8
Ma 24,200,72
TR 220,248,51296
LG 7
Ma 24,204,84
TR 222,248,59744
Ma 28,192,52
Ma 28,196,64
DW 253,16,768
s_mov_b32 m0,21120
s_add_u32 s16,s10,1048832
s_addc_u32 s17,s11,0
Ma 28,200,76
Ma 28,204,88
Ma 32,192,56
Ma 32,196,68
Ma 32,200,80
Ma 32,204,92
Ma 96,192,224
TR 192,248,33920
Ma 96,196,228
TR 194,248,42368
Ma 96,200,232
TR 196,248,34432
Ma 96,204,236
TR 198,248,42880
LG 10
Ma 36,208,48
DW 250,18,0
s_mov_b32 m0,21920
LG 8
Ma 36,212,60
TR 200,248,50816
LG 7
Ma 36,216,72
TR 202,248,59264
LG 6
Ma 36,220,84
TR 204,248,51328
Ma 40,208,52
TR 206,248,59776
Ma 40,212,64
Ma 40,216,76
Ma 40,220,88
Ma 44,208,56
Ma 44,212,68
Ma 44,216,80
Ma 44,220,92
DW 251,18,256
s_mov_b32 m0,22720
Ma 100,208,224
TR 208,248,33952
Ma 100,212,228
TR 210,248,42400
Ma 100,216,232
TR 212,248,34464
Ma 100,220,236
TR 214,248,42912
LG 10
Ma 48,192,48
TR 216,248,50848
LG 9
Ma 48,196,60
TR 218,248,59296
LG 8
Ma 48,200,72
TR 220,248,51360
LG 7
Ma 48,204,84
TR 222,248,59808
Ma 52,192,52
Ma 52,196,64
Ma 52,200,76
DW 252,18,512
s_mov_b32 m0,23520
Ma 52,204,88
Ma 56,192,56
TR 192,248,33984
Ma 56,196,68
TR 194,248,42432
Ma 56,200,80
TR 196,248,34496
Ma 56,204,92
TR 198,248,42944
LG 10
Ma 60,208,48
TR 200,248,50880
LG 9
Ma 60,212,60
TR 202,248,59328
LG 8
Ma 60,216,72
TR 204,248,51392
LG 7
Ma 60,220,84
TR 206,248,59840
Ma 64,208,52
Ma 64,212,64
DW 253,18,768
s_mov_b32 m0,38016
s_add_u32 s18,s10,1573120
s_addc_u32 s19,s11,0
Ma 64,216,76
global_load_dword a253,v255,s[38:39]
s_add_u32 s38,s8,s30
s_addc_u32 s39,s9,0
s_add_u32 s38,s38,31744
s_addc_u32 s39,s39,0
Ma 64,220,88
v_subrev_u32 v255,135168,v249
v_lshrrev_b32 v255,6,v255
Ma 68,208,56
TR 208,248,34016
v_lshlrev_b32 v255,11,v255
Ma 68,212,68
TR 210,248,42464
Ma 68,216,80
TR 212,248,34528
Ma 68,220,92
TR 214,248,42976
LG 10
Ma 72,192,48
TR 216,248,50912
LG 9
Ma 72,196,60
TR 218,248,59360
LG 8
Ma 72,200,72
TR 220,248,51424
LG 7
Ma 72,204,84
TR 222,248,59872
v_add_u32 v248,67584,v248
Ma 76,192,52
Ma 76,196,64
Ma 76,200,76
Ma 76,204,88
Ma 80,192,56
Ma 80,196,68
Ma 80,200,80
Ma 80,204,92
LG 6
Ma 84,208,48
LG 4
Ma 84,212,60
LG 2
Ma 84,216,72
LG 0
Ma 84,220,84
s_waitcnt vmcnt(17) lgkmcnt(0)
s_barrier
Ma 88,208,52
TR 192,248,0
Ma 88,212,64
TR 194,248,8448
Ma 88,216,76
TR 196,248,512
Ma 88,220,88
TR 198,248,8960
Ma 92,208,56
TR 200,248,16896
TR 202,248,25344
Ma 92,212,68
TR 204,248,17408
TR 206,248,25856
Ma 92,216,80
DW 250,16,0
s_mov_b32 m0,38816
Ma 92,220,92
RD 224,254,8192
LG 7
Ma 0,192,96
RD 228,254,9216
LG 6
Ma 0,196,108
RD 232,254,10240
LG 5
Ma 0,200,120
RD 236,254,11264
LG 4
Ma 0,204,132
TR 208,248,32
Ma 4,192,100
TR 210,248,8480
Ma 4,196,112
TR 212,248,544
Ma 4,200,124
TR 214,248,8992
Ma 4,204,136
TR 216,248,16928
Ma 8,192,104
TR 218,248,25376
Ma 8,196,116
TR 220,248,17440
TR 222,248,25888
Ma 8,200,128
DW 251,16,256
s_mov_b32 m0,39616
Ma 8,204,140
TR 192,248,64
LG 7
Ma 12,208,96
TR 194,248,8512
LG 6
Ma 12,212,108
TR 196,248,576
LG 5
Ma 12,216,120
TR 198,248,9024
LG 4
Ma 12,220,132
TR 200,248,16960
Ma 16,208,100
TR 202,248,25408
Ma 16,212,112
TR 204,248,17472
Ma 16,216,124
TR 206,248,25920
Ma 16,220,136
DW 252,16,512
s_mov_b32 m0,40416
Ma 20,208,104
TR 208,248,96
Ma 20,212,116
TR 210,248,8544
Ma 20,216,128
TR 212,248,608
Ma 20,220,140
TR 214,248,9056
LG 10
Ma 24,192,96
TR 216,248,16992
LG 9
Ma 24,196,108
TR 218,248,25440
LG 8
Ma 24,200,120
TR 220,248,17504
LG 7
Ma 24,204,132
TR 222,248,25952
Ma 28,192,100
Ma 28,196,112
DW 253,16,768
s_mov_b32 m0,54912
s_add_u32 s16,s10,2097408
s_addc_u32 s17,s11,0
Ma 28,200,124
Ma 28,204,136
Ma 32,192,104
Ma 32,196,116
Ma 32,200,128
Ma 32,204,140
Ma 96,192,224
TR 192,248,128
Ma 96,196,228
TR 194,248,8576
Ma 96,200,232
TR 196,248,640
Ma 96,204,236
TR 198,248,9088
LG 10
Ma 36,208,96
DW 250,18,0
s_mov_b32 m0,55712
LG 8
Ma 36,212,108
TR 200,248,17024
LG 7
Ma 36,216,120
TR 202,248,25472
LG 6
Ma 36,220,132
TR 204,248,17536
Ma 40,208,100
TR 206,248,25984
Ma 40,212,112
Ma 40,216,124
Ma 40,220,136
Ma 44,208,104
Ma 44,212,116
Ma 44,216,128
Ma 44,220,140
DW 251,18,256
s_mov_b32 m0,56512
Ma 100,208,224
TR 208,248,160
Ma 100,212,228
TR 210,248,8608
Ma 100,216,232
TR 212,248,672
Ma 100,220,236
TR 214,248,9120
LG 10
Ma 48,192,96
TR 216,248,17056
LG 9
Ma 48,196,108
TR 218,248,25504
LG 8
Ma 48,200,120
TR 220,248,17568
LG 7
Ma 48,204,132
TR 222,248,26016
Ma 52,192,100
Ma 52,196,112
Ma 52,200,124
DW 252,18,512
s_mov_b32 m0,57312
Ma 52,204,136
Ma 56,192,104
TR 192,248,192
Ma 56,196,116
TR 194,248,8640
Ma 56,200,128
TR 196,248,704
Ma 56,204,140
TR 198,248,9152
LG 10
Ma 60,208,96
TR 200,248,17088
LG 9
Ma 60,212,108
TR 202,248,25536
LG 8
Ma 60,216,120
TR 204,248,17600
LG 7
Ma 60,220,132
TR 206,248,26048
Ma 64,208,100
Ma 64,212,112
DW 253,18,768
s_mov_b32 m0,71808
s_add_u32 s18,s10,2621696
s_addc_u32 s19,s11,0
Ma 64,216,124
global_load_dword a253,v255,s[38:39]
Ma 64,220,136
Ma 68,208,104
TR 208,248,224
Ma 68,212,116
TR 210,248,8672
Ma 68,216,128
TR 212,248,736
Ma 68,220,140
TR 214,248,9184
LG 10
Ma 72,192,96
TR 216,248,17120
LG 9
Ma 72,196,108
TR 218,248,25568
LG 8
Ma 72,200,120
TR 220,248,17632
LG 7
Ma 72,204,132
TR 222,248,26080
Ma 76,192,100
Ma 76,196,112
Ma 76,200,124
Ma 76,204,136
Ma 80,192,104
Ma 80,196,116
Ma 80,200,128
Ma 80,204,140
LG 6
Ma 84,208,96
LG 4
Ma 84,212,108
LG 2
Ma 84,216,120
LG 0
Ma 84,220,132
s_waitcnt vmcnt(18) lgkmcnt(0)
s_barrier
Ma 88,208,100
TR 192,248,33792
Ma 88,212,112
TR 194,248,42240
Ma 88,216,124
TR 196,248,34304
Ma 88,220,136
TR 198,248,42752
Ma 92,208,104
TR 200,248,50688
TR 202,248,59136
Ma 92,212,116
TR 204,248,51200
TR 206,248,59648
Ma 92,216,128
DW 250,16,0
s_mov_b32 m0,72608
Ma 92,220,140
RD 224,254,12288
LG 7
Ma 0,192,144
RD 228,254,13312
LG 6
Ma 0,196,156
RD 232,254,14336
LG 5
Ma 0,200,168
RD 236,254,15360
LG 4
Ma 0,204,180
TR 208,248,33824
Ma 4,192,148
TR 210,248,42272
Ma 4,196,160
TR 212,248,34336
Ma 4,200,172
TR 214,248,42784
s_nop 0
MU 0,s26
Ma 4,204,184
TR 216,248,50720
MU 1,s26
Ma 8,192,152
TR 218,248,59168
MU 2,s26
Ma 8,196,164
TR 220,248,51232
TR 222,248,59680
Ma 8,200,176
DW 251,16,256
s_mov_b32 m0,73408
Ma 8,204,188
TR 192,248,33856
MU 3,s26
LG 7
Ma 12,208,144
TR 194,248,42304
CV 0,0,1
LG 6
Ma 12,212,156
TR 196,248,34368
CV 1,2,3
LG 5
Ma 12,216,168
TR 198,248,42816
MU 4,s26
LG 4
Ma 12,220,180
TR 200,248,50752
MU 5,s26
Ma 16,208,148
TR 202,248,59200
MU 6,s26
Ma 16,212,160
TR 204,248,51264
MU 7,s26
Ma 16,216,172
TR 206,248,59712
MU 12,s26
Ma 16,220,184
DW 252,16,512
s_mov_b32 m0,74208
Ma 20,208,152
TR 208,248,33888
MU 13,s26
Ma 20,212,164
TR 210,248,42336
MU 14,s26
Ma 20,216,176
TR 212,248,34400
MU 15,s26
Ma 20,220,188
TR 214,248,42848
CV 2,12,13
LG 10
Ma 24,192,144
TR 216,248,50784
CV 3,14,15
LG 9
Ma 24,196,156
TR 218,248,59232
v_permlane32_swap_b32 v0,v2
LG 8
Ma 24,200,168
TR 220,248,51296
v_permlane32_swap_b32 v1,v3
LG 7
Ma 24,204,180
TR 222,248,59744
v_permlane16_swap_b32 v0,v2
Ma 28,192,148
v_permlane16_swap_b32 v1,v3
MU 16,s26
Ma 28,196,160
DW 253,16,768
s_mov_b32 m0,88704
s_add_u32 s16,s10,3145984
s_addc_u32 s17,s11,0
Ma 28,200,172
MU 17,s26
MU 18,s26
Ma 28,204,184
MU 19,s26
CV 4,4,5
Ma 32,192,152
CV 5,6,7
CV 6,16,17
Ma 32,196,164
CV 7,18,19
v_permlane32_swap_b32 v4,v6
Ma 32,200,176
v_permlane32_swap_b32 v5,v7
v_permlane16_swap_b32 v4,v6
Ma 32,204,188
v_permlane16_swap_b32 v5,v7
MU 8,s26
Ma 96,192,224
TR 192,248,33920
MU 9,s26
Ma 96,196,228
TR 194,248,42368
MU 10,s26
Ma 96,200,232
TR 196,248,34432
MU 11,s26
Ma 96,204,236
TR 198,248,42880
MU 20,s26
LG 10
Ma 36,208,144
DW 250,18,0
s_mov_b32 m0,89504
LG 8
Ma 36,212,156
TR 200,248,50816
MU 21,s26
LG 7
Ma 36,216,168
TR 202,248,59264
MU 22,s26
LG 6
Ma 36,220,180
TR 204,248,51328
MU 23,s26
Ma 40,208,148
TR 206,248,59776
CV 8,8,9
Ma 40,212,160
CV 9,10,11
CV 10,20,21
Ma 40,216,172
CV 11,22,23
v_permlane32_swap_b32 v8,v10
Ma 40,220,184
v_permlane32_swap_b32 v9,v11
v_permlane16_swap_b32 v8,v10
Ma 44,208,152
v_permlane16_swap_b32 v9,v11
MU 24,s26
Ma 44,212,164
MU 25,s26
MU 26,s26
Ma 44,216,176
MU 27,s26
MU 36,s26
Ma 44,220,188
DW 251,18,256
s_mov_b32 m0,90304
Ma 100,208,224
TR 208,248,33952
MU 37,s26
Ma 100,212,228
TR 210,248,42400
MU 38,s26
Ma 100,216,232
TR 212,248,34464
MU 39,s26
Ma 100,220,236
TR 214,248,42912
CV 24,24,25
LG 10
Ma 48,192,144
TR 216,248,50848
CV 25,26,27
LG 9
Ma 48,196,156
TR 218,248,59296
CV 26,36,37
LG 8
Ma 48,200,168
TR 220,248,51360
CV 27,38,39
LG 7
Ma 48,204,180
TR 222,248,59808
v_permlane32_swap_b32 v24,v26
Ma 52,192,148
v_permlane32_swap_b32 v25,v27
v_permlane16_swap_b32 v24,v26
Ma 52,196,160
v_permlane16_swap_b32 v25,v27
MU 28,s26
Ma 52,200,172
DW 252,18,512
s_mov_b32 m0,91104
Ma 52,204,184
MU 29,s26
MU 30,s26
Ma 56,192,152
TR 192,248,33984
MU 31,s26
Ma 56,196,164
TR 194,248,42432
MU 40,s26
Ma 56,200,176
TR 196,248,34496
MU 41,s26
Ma 56,204,188
TR 198,248,42944
MU 42,s26
LG 10
Ma 60,208,144
TR 200,248,50880
MU 43,s26
LG 9
Ma 60,212,156
TR 202,248,59328
CV 28,28,29
LG 8
Ma 60,216,168
TR 204,248,51392
CV 29,30,31
LG 7
Ma 60,220,180
TR 206,248,59840
CV 30,40,41
Ma 64,208,148
CV 31,42,43
v_permlane32_swap_b32 v28,v30
Ma 64,212,160
DW 253,18,768
s_add_u32 s18,s10,3670272
s_addc_u32 s19,s11,0
Ma 64,216,172
v_permlane32_swap_b32 v29,v31
v_permlane16_swap_b32 v28,v30
Ma 64,220,184
v_permlane16_swap_b32 v29,v31
MU 32,s26
Ma 68,208,152
TR 208,248,34016
MU 33,s26
Ma 68,212,164
TR 210,248,42464
MU 34,s26
Ma 68,216,176
TR 212,248,34528
MU 35,s26
Ma 68,220,188
TR 214,248,42976
MU 44,s26
LG 10
Ma 72,192,144
TR 216,248,50912
MU 45,s26
LG 9
Ma 72,196,156
TR 218,248,59360
MU 46,s26
LG 8
Ma 72,200,168
TR 220,248,51424
MU 47,s26
LG 7
Ma 72,204,180
TR 222,248,59872
v_add_u32 v248,4294899712,v248
Ma 76,192,148
CV 32,32,33
CV 33,34,35
Ma 76,196,160
CV 34,44,45
CV 35,46,47
Ma 76,200,172
v_permlane32_swap_b32 v32,v34
v_permlane32_swap_b32 v33,v35
Ma 76,204,184
v_permlane16_swap_b32 v32,v34
v_permlane16_swap_b32 v33,v35
Ma 80,192,152
MU 96,s26
MU 97,s26
Ma 80,196,164
MU 98,s26
MU 99,s26
Ma 80,200,176
MU 100,s26
MU 101,s26
Ma 80,204,188
MU 102,s26
MU 103,s26
LG 6
Ma 84,208,144
CV 96,96,97
CV 97,98,99
LG 4
Ma 84,212,156
CV 98,100,101
CV 99,102,103
LG 2
Ma 84,216,168
v_permlane32_swap_b32 v96,v98
v_permlane32_swap_b32 v97,v99
LG 0
Ma 84,220,180
v_permlane16_swap_b32 v96,v98
v_permlane16_swap_b32 v97,v99
s_waitcnt vmcnt(18) lgkmcnt(0)
s_barrier
Ma 88,208,148
TR 192,248,0
Ma 88,212,160
TR 194,248,8448
Ma 88,216,172
TR 196,248,512
TR 198,248,8960
Ma 88,220,184
TR 200,248,16896
TR 202,248,25344
Ma 92,208,152
TR 204,248,17408
TR 206,248,25856
Ma 92,212,164
RD 224,254,0
RD 228,254,1024
Ma 92,216,176
RD 232,254,2048
RD 236,254,3072
Ma 92,220,188
v_pk_mul_f32 v[48:49],v[48:49],s[26:27] op_sel_hi:[1,0]
v_pk_mul_f32 v[50:51],v[50:51],s[26:27] op_sel_hi:[1,0]
v_pk_mul_f32 v[60:61],v[60:61],s[26:27] op_sel_hi:[1,0]
v_pk_mul_f32 v[62:63],v[62:63],s[26:27] op_sel_hi:[1,0]
CV 48,48,49
CV 49,50,51
CV 50,60,61
CV 51,62,63
s_nop 0
v_permlane32_swap_b32 v48,v50
v_permlane32_swap_b32 v49,v51
s_nop 0
v_permlane16_swap_b32 v48,v50
v_permlane16_swap_b32 v49,v51
v_pk_mul_f32 v[52:53],v[52:53],s[26:27] op_sel_hi:[1,0]
v_pk_mul_f32 v[54:55],v[54:55],s[26:27] op_sel_hi:[1,0]
v_pk_mul_f32 v[64:65],v[64:65],s[26:27] op_sel_hi:[1,0]
v_pk_mul_f32 v[66:67],v[66:67],s[26:27] op_sel_hi:[1,0]
CV 52,52,53
CV 53,54,55
CV 54,64,65
CV 55,66,67
s_nop 0
v_permlane32_swap_b32 v52,v54
v_permlane32_swap_b32 v53,v55
s_nop 0
v_permlane16_swap_b32 v52,v54
v_permlane16_swap_b32 v53,v55
v_pk_mul_f32 v[56:57],v[56:57],s[26:27] op_sel_hi:[1,0]
v_pk_mul_f32 v[58:59],v[58:59],s[26:27] op_sel_hi:[1,0]
v_pk_mul_f32 v[68:69],v[68:69],s[26:27] op_sel_hi:[1,0]
v_pk_mul_f32 v[70:71],v[70:71],s[26:27] op_sel_hi:[1,0]
CV 56,56,57
CV 57,58,59
CV 58,68,69
CV 59,70,71
s_nop 0
v_permlane32_swap_b32 v56,v58
v_permlane32_swap_b32 v57,v59
s_nop 0
v_permlane16_swap_b32 v56,v58
v_permlane16_swap_b32 v57,v59
v_pk_mul_f32 v[72:73],v[72:73],s[26:27] op_sel_hi:[1,0]
v_pk_mul_f32 v[74:75],v[74:75],s[26:27] op_sel_hi:[1,0]
v_pk_mul_f32 v[84:85],v[84:85],s[26:27] op_sel_hi:[1,0]
v_pk_mul_f32 v[86:87],v[86:87],s[26:27] op_sel_hi:[1,0]
CV 72,72,73
CV 73,74,75
CV 74,84,85
CV 75,86,87
s_nop 0
v_permlane32_swap_b32 v72,v74
v_permlane32_swap_b32 v73,v75
s_nop 0
v_permlane16_swap_b32 v72,v74
v_permlane16_swap_b32 v73,v75
v_pk_mul_f32 v[76:77],v[76:77],s[26:27] op_sel_hi:[1,0]
v_pk_mul_f32 v[78:79],v[78:79],s[26:27] op_sel_hi:[1,0]
v_pk_mul_f32 v[88:89],v[88:89],s[26:27] op_sel_hi:[1,0]
v_pk_mul_f32 v[90:91],v[90:91],s[26:27] op_sel_hi:[1,0]
CV 76,76,77
CV 77,78,79
CV 78,88,89
CV 79,90,91
s_nop 0
v_permlane32_swap_b32 v76,v78
v_permlane32_swap_b32 v77,v79
s_nop 0
v_permlane16_swap_b32 v76,v78
v_permlane16_swap_b32 v77,v79
v_pk_mul_f32 v[80:81],v[80:81],s[26:27] op_sel_hi:[1,0]
v_pk_mul_f32 v[82:83],v[82:83],s[26:27] op_sel_hi:[1,0]
v_pk_mul_f32 v[92:93],v[92:93],s[26:27] op_sel_hi:[1,0]
v_pk_mul_f32 v[94:95],v[94:95],s[26:27] op_sel_hi:[1,0]
CV 80,80,81
CV 81,82,83
CV 82,92,93
CV 83,94,95
s_nop 0
v_permlane32_swap_b32 v80,v82
v_permlane32_swap_b32 v81,v83
s_nop 0
v_permlane16_swap_b32 v80,v82
v_permlane16_swap_b32 v81,v83
s_cmp_eq_u32 s20,1
s_cbranch_scc0 EA2_w1
ds_write_b128 v249,v[96:99] offset:21504
v_mov_b32 v152,v0
v_mov_b32 v153,v1
v_mov_b32 v154,v2
v_mov_b32 v155,v3
v_mov_b32 v156,v4
v_mov_b32 v157,v5
v_mov_b32 v158,v6
v_mov_b32 v159,v7
v_mov_b32 v160,v8
v_mov_b32 v161,v9
v_mov_b32 v162,v10
v_mov_b32 v163,v11
v_mov_b32 v164,v24
v_mov_b32 v165,v25
v_mov_b32 v166,v26
v_mov_b32 v167,v27
v_mov_b32 v168,v28
v_mov_b32 v169,v29
v_mov_b32 v170,v30
v_mov_b32 v171,v31
v_mov_b32 v172,v32
v_mov_b32 v173,v33
v_mov_b32 v174,v34
v_mov_b32 v175,v35
v_mov_b32 v176,v48
v_mov_b32 v177,v49
v_mov_b32 v178,v50
v_mov_b32 v179,v51
v_mov_b32 v180,v52
v_mov_b32 v181,v53
v_mov_b32 v182,v54
v_mov_b32 v183,v55
v_mov_b32 v184,v56
v_mov_b32 v185,v57
v_mov_b32 v186,v58
v_mov_b32 v187,v59
v_mov_b32 v188,v72
v_mov_b32 v189,v73
v_mov_b32 v190,v74
v_mov_b32 v191,v75
v_mov_b32 v192,v76
v_mov_b32 v193,v77
v_mov_b32 v194,v78
v_mov_b32 v195,v79
v_mov_b32 v196,v80
v_mov_b32 v197,v81
v_mov_b32 v198,v82
v_mov_b32 v199,v83
s_add_u32 s10,s10,256
s_addc_u32 s11,s11,0
s_add_u32 s20,s20,1
s_branch LA_w1
EA2_w1:
ds_write_b128 v249,v[96:99] offset:25600
v_mov_b32 v200,v0
v_mov_b32 v201,v1
v_mov_b32 v202,v2
v_mov_b32 v203,v3
v_mov_b32 v204,v4
v_mov_b32 v205,v5
v_mov_b32 v206,v6
v_mov_b32 v207,v7
v_mov_b32 v208,v8
v_mov_b32 v209,v9
v_mov_b32 v210,v10
v_mov_b32 v211,v11
v_mov_b32 v212,v24
v_mov_b32 v213,v25
v_mov_b32 v214,v26
v_mov_b32 v215,v27
v_mov_b32 v216,v28
v_mov_b32 v217,v29
v_mov_b32 v218,v30
v_mov_b32 v219,v31
v_mov_b32 v220,v32
v_mov_b32 v221,v33
v_mov_b32 v222,v34
v_mov_b32 v223,v35
v_mov_b32 v224,v48
v_mov_b32 v225,v49
v_mov_b32 v226,v50
v_mov_b32 v227,v51
v_mov_b32 v228,v52
v_mov_b32 v229,v53
v_mov_b32 v230,v54
v_mov_b32 v231,v55
v_mov_b32 v232,v56
v_mov_b32 v233,v57
v_mov_b32 v234,v58
v_mov_b32 v235,v59
v_mov_b32 v236,v72
v_mov_b32 v237,v73
v_mov_b32 v238,v74
v_mov_b32 v239,v75
v_mov_b32 v240,v76
v_mov_b32 v241,v77
v_mov_b32 v242,v78
v_mov_b32 v243,v79
v_mov_b32 v244,v80
v_mov_b32 v245,v81
v_mov_b32 v246,v82
v_mov_b32 v247,v83
s_add_u32 s10,s10,256
s_addc_u32 s11,s11,0
s_add_u32 s20,s20,1
LG 0
Za 0,192,0
TR 208,248,32
v_subrev_u32 v255,135168,v249
s_mov_b32 m0,105600
Ma 0,196,12
TR 210,248,8480
Ma 0,200,24
TR 212,248,544
Ma 0,204,36
TR 214,248,8992
Za 4,192,4
TR 216,248,16928
Ma 4,196,16
TR 218,248,25376
Ma 4,200,28
DW 250,16,0
s_mov_b32 m0,106400
Ma 4,204,40
TR 220,248,17440
Za 8,192,8
TR 222,248,25888
Ma 8,196,20
TR 192,248,64
Ma 8,200,32
TR 194,248,8512
Ma 8,204,44
TR 196,248,576
LG 9
Za 12,208,0
TR 198,248,9024
LG 8
Ma 12,212,12
DW 251,16,256
s_mov_b32 m0,107200
LG 6
Ma 12,216,24
TR 200,248,16960
LG 5
Ma 12,220,36
TR 202,248,25408
Za 16,208,4
TR 204,248,17472
Ma 16,212,16
TR 206,248,25920
Ma 16,216,28
Ma 16,220,40
Za 20,208,8
TR 208,248,96
Ma 20,212,20
TR 210,248,8544
Ma 20,216,32
TR 212,248,608
Ma 20,220,44
DW 252,16,512
s_mov_b32 m0,108000
LG 9
Za 24,192,0
TR 214,248,9056
LG 8
Ma 24,196,12
TR 216,248,16992
LG 7
Ma 24,200,24
TR 218,248,25440
LG 6
Ma 24,204,36
TR 220,248,17504
Za 28,192,4
TR 222,248,25952
Ma 28,196,16
Ma 28,200,28
Ma 28,204,40
Za 32,192,8
Ma 32,196,20
DW 253,16,768
s_mov_b32 m0,122496
s_add_u32 s16,s6,0
s_addc_u32 s17,s7,0
Ma 32,200,32
Ma 32,204,44
Za 96,192,224
TR 192,248,128
Ma 96,196,228
TR 194,248,8576
Ma 96,200,232
TR 196,248,640
Ma 96,204,236
TR 198,248,9088
LG 10
Za 36,208,0
TR 200,248,17024
LG 9
Ma 36,212,12
TR 202,248,25472
LG 8
Ma 36,216,24
TR 204,248,17536
LG 7
Ma 36,220,36
DW 250,18,0
s_mov_b32 m0,123296
Za 40,208,4
TR 206,248,25984
v_and_b32 v250,0xf0,v255
Ma 40,212,16
v_lshrrev_b32 v255,8,v255
v_lshl_add_u32 v250,v255,12,v250
Ma 40,216,28
Ma 40,220,40
Za 44,208,8
Ma 44,212,20
Ma 44,216,32
Ma 44,220,44
Za 100,208,224
TR 208,248,160
Ma 100,212,228
DW 251,18,256
s_mov_b32 m0,124096
Ma 100,216,232
TR 210,248,8608
v_mov_b32 v251,v250
Ma 100,220,236
TR 212,248,672
LG 9
Za 48,192,0
TR 214,248,9120
LG 8
Ma 48,196,12
TR 216,248,17056
LG 7
Ma 48,200,24
TR 218,248,25504
LG 6
Ma 48,204,36
TR 220,248,17568
Za 52,192,4
TR 222,248,26016
Ma 52,196,16
Ma 52,200,28
Ma 52,204,40
DW 252,18,512
s_mov_b32 m0,124896
Za 56,192,8
TR 192,248,192
v_mov_b32 v252,v250
Ma 56,196,20
TR 194,248,8640
Ma 56,200,32
TR 196,248,704
Ma 56,204,44
TR 198,248,9152
LG 10
Za 60,208,0
TR 200,248,17088
LG 9
Ma 60,212,12
TR 202,248,25536
LG 8
Ma 60,216,24
TR 204,248,17600
LG 7
Ma 60,220,36
TR 206,248,26048
Za 64,208,4
Ma 64,212,16
DW 253,18,768
s_mov_b32 m0,4224
s_add_u32 s18,s6,16384
s_addc_u32 s19,s7,0
Ma 64,216,28
v_mov_b32 v253,v250
Ma 64,220,40
Za 68,208,8
TR 208,248,224
Ma 68,212,20
TR 210,248,8672
Ma 68,216,32
TR 212,248,736
Ma 68,220,44
TR 214,248,9184
LG 10
Za 72,192,0
TR 216,248,17120
LG 9
Ma 72,196,12
TR 218,248,25568
LG 8
Ma 72,200,24
TR 220,248,17632
LG 7
Ma 72,204,36
TR 222,248,26080
Za 76,192,4
Ma 76,196,16
Ma 76,200,28
Ma 76,204,40
Za 80,192,8
Ma 80,196,20
Ma 80,200,32
Ma 80,204,44
LG 6
Za 84,208,0
AW 0,104
AW 1,105
LG 4
Ma 84,212,12
AW 2,106
AW 3,107
LG 2
Ma 84,216,24
AW 12,116
AW 13,117
LG 0
Ma 84,220,36
AW 14,118
AW 15,119
s_waitcnt vmcnt(17) lgkmcnt(0)
s_barrier
Za 88,208,4
TR 192,248,33792
AW 4,108
Ma 88,212,16
TR 194,248,42240
AW 5,109
Ma 88,216,28
TR 196,248,34304
AW 6,110
Ma 88,220,40
TR 198,248,42752
AW 7,111
Za 92,208,8
TR 200,248,50688
TR 202,248,59136
Ma 92,212,20
TR 204,248,51200
TR 206,248,59648
Ma 92,216,32
DM 250,16,0
s_mov_b32 m0,5024
Ma 92,220,44
RD 224,254,4096
AW 8,112
LG 7
Ma 0,192,48
RD 228,254,5120
AW 9,113
LG 6
Ma 0,196,60
RD 232,254,6144
AW 10,114
LG 5
Ma 0,200,72
RD 236,254,7168
AW 11,115
LG 4
Ma 0,204,84
TR 208,248,33824
AW 16,120
Ma 4,192,52
TR 210,248,42272
AW 17,121
Ma 4,196,64
TR 212,248,34336
AW 18,122
Ma 4,200,76
TR 214,248,42784
AW 19,123
Ma 4,204,88
TR 216,248,50720
AW 20,124
Ma 8,192,56
TR 218,248,59168
AW 21,125
Ma 8,196,68
TR 220,248,51232
TR 222,248,59680
Ma 8,200,80
DM 251,16,256
s_mov_b32 m0,5824
Ma 8,204,92
TR 192,248,33856
AW 22,126
LG 7
Ma 12,208,48
TR 194,248,42304
AW 23,127
LG 6
Ma 12,212,60
TR 196,248,34368
AW 24,128
LG 5
Ma 12,216,72
TR 198,248,42816
AW 25,129
LG 4
Ma 12,220,84
TR 200,248,50752
AW 26,130
Ma 16,208,52
TR 202,248,59200
AW 27,131
Ma 16,212,64
TR 204,248,51264
AW 28,132
Ma 16,216,76
TR 206,248,59712
AW 29,133
Ma 16,220,88
DM 252,16,512
s_mov_b32 m0,6624
Ma 20,208,56
TR 208,248,33888
AW 30,134
Ma 20,212,68
TR 210,248,42336
AW 31,135
Ma 20,216,80
TR 212,248,34400
AW 32,136
Ma 20,220,92
TR 214,248,42848
AW 33,137
LG 10
Ma 24,192,48
TR 216,248,50784
AW 34,138
LG 9
Ma 24,196,60
TR 218,248,59232
AW 35,139
LG 8
Ma 24,200,72
TR 220,248,51296
AW 36,140
LG 7
Ma 24,204,84
TR 222,248,59744
AW 37,141
Ma 28,192,52
AW 38,142
AW 39,143
Ma 28,196,64
DM 253,16,768
s_mov_b32 m0,21120
s_add_u32 s16,s8,0
s_addc_u32 s17,s9,0
Ma 28,200,76
AW 40,144
AW 41,145
Ma 28,204,88
AW 42,146
AW 43,147
Ma 32,192,56
AW 44,148
AW 45,149
Ma 32,196,68
AW 46,150
AW 47,151
Ma 32,200,80
Ma 32,204,92
Ma 96,192,224
TR 192,248,33920
Ma 96,196,228
TR 194,248,42368
Ma 96,200,232
TR 196,248,34432
Ma 96,204,236
TR 198,248,42880
LG 10
Ma 36,208,48
DM 250,18,0
s_mov_b32 m0,21920
LG 8
Ma 36,212,60
TR 200,248,50816
LG 7
Ma 36,216,72
TR 202,248,59264
LG 6
Ma 36,220,84
TR 204,248,51328
Ma 40,208,52
TR 206,248,59776
Ma 40,212,64
Ma 40,216,76
Ma 40,220,88
Ma 44,208,56
Ma 44,212,68
Ma 44,216,80
Ma 44,220,92
DM 251,18,256
s_mov_b32 m0,22720
Ma 100,208,224
TR 208,248,33952
Ma 100,212,228
TR 210,248,42400
Ma 100,216,232
TR 212,248,34464
Ma 100,220,236
TR 214,248,42912
LG 10
Ma 48,192,48
TR 216,248,50848
LG 9
Ma 48,196,60
TR 218,248,59296
LG 8
Ma 48,200,72
TR 220,248,51360
LG 7
Ma 48,204,84
TR 222,248,59808
Ma 52,192,52
Ma 52,196,64
Ma 52,200,76
DM 252,18,512
s_mov_b32 m0,23520
Ma 52,204,88
Ma 56,192,56
TR 192,248,33984
Ma 56,196,68
TR 194,248,42432
Ma 56,200,80
TR 196,248,34496
Ma 56,204,92
TR 198,248,42944
LG 10
Ma 60,208,48
TR 200,248,50880
LG 9
Ma 60,212,60
TR 202,248,59328
LG 8
Ma 60,216,72
TR 204,248,51392
LG 7
Ma 60,220,84
TR 206,248,59840
Ma 64,208,52
Ma 64,212,64
DM 253,18,768
s_mov_b32 m0,38016
s_add_u32 s18,s6,32768
s_addc_u32 s19,s7,0
Ma 64,216,76
Ma 64,220,88
Ma 68,208,56
TR 208,248,34016
Ma 68,212,68
TR 210,248,42464
Ma 68,216,80
TR 212,248,34528
Ma 68,220,92
TR 214,248,42976
LG 10
Ma 72,192,48
TR 216,248,50912
LG 9
Ma 72,196,60
TR 218,248,59360
LG 8
Ma 72,200,72
TR 220,248,51424
LG 7
Ma 72,204,84
TR 222,248,59872
v_add_u32 v248,67584,v248
Ma 76,192,52
Ma 76,196,64
Ma 76,200,76
Ma 76,204,88
Ma 80,192,56
Ma 80,196,68
Ma 80,200,80
Ma 80,204,92
LG 6
Ma 84,208,48
AW 48,152
AW 49,153
LG 4
Ma 84,212,60
AW 50,154
AW 51,155
LG 2
Ma 84,216,72
AW 60,164
AW 61,165
LG 0
Ma 84,220,84
AW 62,166
AW 63,167
s_waitcnt vmcnt(16) lgkmcnt(0)
s_barrier
Ma 88,208,52
TR 192,248,0
AW 52,156
Ma 88,212,64
TR 194,248,8448
AW 53,157
Ma 88,216,76
TR 196,248,512
AW 54,158
Ma 88,220,88
TR 198,248,8960
AW 55,159
Ma 92,208,56
TR 200,248,16896
TR 202,248,25344
Ma 92,212,68
TR 204,248,17408
TR 206,248,25856
Ma 92,216,80
DM 250,16,0
s_mov_b32 m0,38816
Ma 92,220,92
RD 224,254,8192
AW 56,160
LG 7
Ma 0,192,96
RD 228,254,9216
AW 57,161
LG 6
Ma 0,196,108
RD 232,254,10240
AW 58,162
LG 5
Ma 0,200,120
RD 236,254,11264
AW 59,163
LG 4
Ma 0,204,132
TR 208,248,32
AW 64,168
Ma 4,192,100
TR 210,248,8480
AW 65,169
Ma 4,196,112
TR 212,248,544
AW 66,170
Ma 4,200,124
TR 214,248,8992
AW 67,171
Ma 4,204,136
TR 216,248,16928
AW 68,172
Ma 8,192,104
TR 218,248,25376
AW 69,173
Ma 8,196,116
TR 220,248,17440
TR 222,248,25888
Ma 8,200,128
DM 251,16,256
s_mov_b32 m0,39616
Ma 8,204,140
TR 192,248,64
AW 70,174
LG 7
Ma 12,208,96
TR 194,248,8512
AW 71,175
LG 6
Ma 12,212,108
TR 196,248,576
AW 72,176
LG 5
Ma 12,216,120
TR 198,248,9024
AW 73,177
LG 4
Ma 12,220,132
TR 200,248,16960
AW 74,178
Ma 16,208,100
TR 202,248,25408
AW 75,179
Ma 16,212,112
TR 204,248,17472
AW 76,180
Ma 16,216,124
TR 206,248,25920
AW 77,181
Ma 16,220,136
DM 252,16,512
s_mov_b32 m0,40416
Ma 20,208,104
TR 208,248,96
AW 78,182
Ma 20,212,116
TR 210,248,8544
AW 79,183
Ma 20,216,128
TR 212,248,608
AW 80,184
Ma 20,220,140
TR 214,248,9056
AW 81,185
LG 10
Ma 24,192,96
TR 216,248,16992
AW 82,186
LG 9
Ma 24,196,108
TR 218,248,25440
AW 83,187
LG 8
Ma 24,200,120
TR 220,248,17504
AW 84,188
LG 7
Ma 24,204,132
TR 222,248,25952
AW 85,189
Ma 28,192,100
AW 86,190
AW 87,191
Ma 28,196,112
DM 253,16,768
s_mov_b32 m0,54912
s_add_u32 s16,s8,16384
s_addc_u32 s17,s9,0
Ma 28,200,124
AW 88,192
AW 89,193
Ma 28,204,136
AW 90,194
AW 91,195
Ma 32,192,104
AW 92,196
AW 93,197
Ma 32,196,116
AW 94,198
AW 95,199
Ma 32,200,128
Ma 32,204,140
Ma 96,192,224
TR 192,248,128
Ma 96,196,228
TR 194,248,8576
Ma 96,200,232
TR 196,248,640
Ma 96,204,236
TR 198,248,9088
LG 10
Ma 36,208,96
DM 250,18,0
s_mov_b32 m0,55712
LG 8
Ma 36,212,108
TR 200,248,17024
LG 7
Ma 36,216,120
TR 202,248,25472
LG 6
Ma 36,220,132
TR 204,248,17536
Ma 40,208,100
TR 206,248,25984
Ma 40,212,112
Ma 40,216,124
Ma 40,220,136
Ma 44,208,104
Ma 44,212,116
Ma 44,216,128
Ma 44,220,140
DM 251,18,256
s_mov_b32 m0,56512
Ma 100,208,224
TR 208,248,160
Ma 100,212,228
TR 210,248,8608
Ma 100,216,232
TR 212,248,672
Ma 100,220,236
TR 214,248,9120
LG 10
Ma 48,192,96
TR 216,248,17056
LG 9
Ma 48,196,108
TR 218,248,25504
LG 8
Ma 48,200,120
TR 220,248,17568
LG 7
Ma 48,204,132
TR 222,248,26016
Ma 52,192,100
Ma 52,196,112
Ma 52,200,124
DM 252,18,512
s_mov_b32 m0,57312
Ma 52,204,136
Ma 56,192,104
TR 192,248,192
Ma 56,196,116
TR 194,248,8640
Ma 56,200,128
TR 196,248,704
Ma 56,204,140
TR 198,248,9152
LG 10
Ma 60,208,96
TR 200,248,17088
LG 9
Ma 60,212,108
TR 202,248,25536
LG 8
Ma 60,216,120
TR 204,248,17600
LG 7
Ma 60,220,132
TR 206,248,26048
Ma 64,208,100
Ma 64,212,112
DM 253,18,768
s_mov_b32 m0,71808
s_add_u32 s18,s6,49152
s_addc_u32 s19,s7,0
Ma 64,216,124
Ma 64,220,136
Ma 68,208,104
TR 208,248,224
Ma 68,212,116
TR 210,248,8672
Ma 68,216,128
TR 212,248,736
Ma 68,220,140
TR 214,248,9184
LG 10
Ma 72,192,96
TR 216,248,17120
LG 9
Ma 72,196,108
TR 218,248,25568
LG 8
Ma 72,200,120
TR 220,248,17632
LG 7
Ma 72,204,132
TR 222,248,26080
Ma 76,192,100
Ma 76,196,112
Ma 76,200,124
Ma 76,204,136
Ma 80,192,104
Ma 80,196,116
Ma 80,200,128
Ma 80,204,140
LG 6
Ma 84,208,96
AW 96,200
AW 97,201
LG 4
Ma 84,212,108
AW 98,202
AW 99,203
LG 2
Ma 84,216,120
AW 108,212
AW 109,213
LG 0
Ma 84,220,132
AW 110,214
AW 111,215
s_waitcnt vmcnt(16) lgkmcnt(0)
s_barrier
Ma 88,208,100
TR 192,248,33792
AW 100,204
Ma 88,212,112
TR 194,248,42240
AW 101,205
Ma 88,216,124
TR 196,248,34304
AW 102,206
Ma 88,220,136
TR 198,248,42752
AW 103,207
Ma 92,208,104
TR 200,248,50688
TR 202,248,59136
Ma 92,212,116
TR 204,248,51200
TR 206,248,59648
Ma 92,216,128
DM 250,16,0
s_mov_b32 m0,72608
Ma 92,220,140
RD 224,254,12288
AW 104,208
LG 7
Ma 0,192,144
RD 228,254,13312
AW 105,209
LG 6
Ma 0,196,156
RD 232,254,14336
AW 106,210
LG 5
Ma 0,200,168
RD 236,254,15360
AW 107,211
LG 4
Ma 0,204,180
TR 208,248,33824
AW 112,216
Ma 4,192,148
TR 210,248,42272
AW 113,217
Ma 4,196,160
TR 212,248,34336
AW 114,218
Ma 4,200,172
TR 214,248,42784
AW 115,219
Ma 4,204,184
TR 216,248,50720
AW 116,220
Ma 8,192,152
TR 218,248,59168
AW 117,221
Ma 8,196,164
TR 220,248,51232
TR 222,248,59680
Ma 8,200,176
DM 251,16,256
s_mov_b32 m0,73408
Ma 8,204,188
TR 192,248,33856
AW 118,222
LG 7
Ma 12,208,144
TR 194,248,42304
AW 119,223
LG 6
Ma 12,212,156
TR 196,248,34368
AW 120,224
LG 5
Ma 12,216,168
TR 198,248,42816
AW 121,225
LG 4
Ma 12,220,180
TR 200,248,50752
AW 122,226
Ma 16,208,148
TR 202,248,59200
AW 123,227
Ma 16,212,160
TR 204,248,51264
AW 124,228
Ma 16,216,172
TR 206,248,59712
AW 125,229
Ma 16,220,184
DM 252,16,512
s_mov_b32 m0,74208
Ma 20,208,152
TR 208,248,33888
AW 126,230
Ma 20,212,164
TR 210,248,42336
AW 127,231
Ma 20,216,176
TR 212,248,34400
AW 128,232
Ma 20,220,188
TR 214,248,42848
AW 129,233
LG 10
Ma 24,192,144
TR 216,248,50784
AW 130,234
LG 9
Ma 24,196,156
TR 218,248,59232
AW 131,235
LG 8
Ma 24,200,168
TR 220,248,51296
AW 132,236
LG 7
Ma 24,204,180
TR 222,248,59744
AW 133,237
Ma 28,192,148
AW 134,238
AW 135,239
Ma 28,196,160
DM 253,16,768
s_mov_b32 m0,88704
s_add_u32 s16,s8,32768
s_addc_u32 s17,s9,0
Ma 28,200,172
AW 136,240
AW 137,241
Ma 28,204,184
AW 138,242
AW 139,243
Ma 32,192,152
AW 140,244
AW 141,245
Ma 32,196,164
AW 142,246
AW 143,247
Ma 32,200,176
MU 0,s26
MU 1,s26
Ma 32,204,188
MU 2,s26
MU 3,s26
Ma 96,192,224
TR 192,248,33920
MU 12,s26
Ma 96,196,228
TR 194,248,42368
MU 13,s26
Ma 96,200,232
TR 196,248,34432
MU 14,s26
Ma 96,204,236
TR 198,248,42880
MU 15,s26
LG 10
Ma 36,208,144
DM 250,18,0
s_mov_b32 m0,89504
LG 8
Ma 36,212,156
TR 200,248,50816
CV 0,0,1
LG 7
Ma 36,216,168
TR 202,248,59264
CV 1,2,3
LG 6
Ma 36,220,180
TR 204,248,51328
CV 2,12,13
Ma 40,208,148
TR 206,248,59776
CV 3,14,15
Ma 40,212,160
v_permlane32_swap_b32 v0,v2
v_permlane32_swap_b32 v1,v3
Ma 40,216,172
v_permlane16_swap_b32 v0,v2
v_permlane16_swap_b32 v1,v3
Ma 40,220,184
MU 4,s26
MU 5,s26
Ma 44,208,152
MU 6,s26
MU 7,s26
Ma 44,212,164
MU 16,s26
MU 17,s26
Ma 44,216,176
MU 18,s26
MU 19,s26
Ma 44,220,188
DM 251,18,256
s_mov_b32 m0,90304
Ma 100,208,224
TR 208,248,33952
CV 4,4,5
Ma 100,212,228
TR 210,248,42400
CV 5,6,7
Ma 100,216,232
TR 212,248,34464
CV 6,16,17
Ma 100,220,236
TR 214,248,42912
CV 7,18,19
LG 10
Ma 48,192,144
TR 216,248,50848
v_permlane32_swap_b32 v4,v6
LG 9
Ma 48,196,156
TR 218,248,59296
v_permlane32_swap_b32 v5,v7
LG 8
Ma 48,200,168
TR 220,248,51360
v_permlane16_swap_b32 v4,v6
LG 7
Ma 48,204,180
TR 222,248,59808
v_permlane16_swap_b32 v5,v7
Ma 52,192,148
MU 8,s26
MU 9,s26
Ma 52,196,160
MU 10,s26
MU 11,s26
Ma 52,200,172
DM 252,18,512
s_mov_b32 m0,91104
Ma 52,204,184
MU 20,s26
MU 21,s26
Ma 56,192,152
TR 192,248,33984
MU 22,s26
Ma 56,196,164
TR 194,248,42432
MU 23,s26
Ma 56,200,176
TR 196,248,34496
CV 8,8,9
Ma 56,204,188
TR 198,248,42944
CV 9,10,11
LG 10
Ma 60,208,144
TR 200,248,50880
CV 10,20,21
LG 9
Ma 60,212,156
TR 202,248,59328
CV 11,22,23
LG 8
Ma 60,216,168
TR 204,248,51392
v_permlane32_swap_b32 v8,v10
LG 7
Ma 60,220,180
TR 206,248,59840
v_permlane32_swap_b32 v9,v11
Ma 64,208,148
v_permlane16_swap_b32 v8,v10
v_permlane16_swap_b32 v9,v11
Ma 64,212,160
DM 253,18,768
Ma 64,216,172
MU 24,s26
MU 25,s26
Ma 64,220,184
MU 26,s26
MU 27,s26
Ma 68,208,152
TR 208,248,34016
MU 36,s26
Ma 68,212,164
TR 210,248,42464
MU 37,s26
Ma 68,216,176
TR 212,248,34528
MU 38,s26
Ma 68,220,188
TR 214,248,42976
MU 39,s26
LG 10
Ma 72,192,144
TR 216,248,50912
CV 24,24,25
LG 9
Ma 72,196,156
TR 218,248,59360
CV 25,26,27
LG 8
Ma 72,200,168
TR 220,248,51424
CV 26,36,37
LG 7
Ma 72,204,180
TR 222,248,59872
v_add_u32 v248,4294899712,v248
Ma 76,192,148
CV 27,38,39
v_permlane32_swap_b32 v24,v26
Ma 76,196,160
v_permlane32_swap_b32 v25,v27
v_permlane16_swap_b32 v24,v26
Ma 76,200,172
v_permlane16_swap_b32 v25,v27
MU 28,s26
Ma 76,204,184
MU 29,s26
MU 30,s26
Ma 80,192,152
MU 31,s26
MU 40,s26
Ma 80,196,164
MU 41,s26
MU 42,s26
Ma 80,200,176
MU 43,s26
CV 28,28,29
Ma 80,204,188
CV 29,30,31
CV 30,40,41
LG 6
Ma 84,208,144
CV 31,42,43
v_permlane32_swap_b32 v28,v30
LG 4
Ma 84,212,156
v_permlane32_swap_b32 v29,v31
v_permlane16_swap_b32 v28,v30
LG 2
Ma 84,216,168
v_permlane16_swap_b32 v29,v31
MU 32,s26
LG 0
Ma 84,220,180
MU 33,s26
MU 34,s26
s_waitcnt vmcnt(24) lgkmcnt(0)
s_barrier
Ma 88,208,148
TR 192,248,0
MU 35,s26
Ma 88,212,160
TR 194,248,8448
MU 44,s26
Ma 88,216,172
TR 196,248,512
TR 198,248,8960
Ma 88,220,184
TR 200,248,16896
TR 202,248,25344
Ma 92,208,152
TR 204,248,17408
TR 206,248,25856
Ma 92,212,164
RD 224,254,0
RD 228,254,1024
Ma 92,216,176
RD 232,254,2048
RD 236,254,3072
Ma 92,220,188
MU 45,s26
MU 46,s26
MU 47,s26
CV 32,32,33
CV 33,34,35
CV 34,44,45
CV 35,46,47
s_nop 0
v_permlane32_swap_b32 v32,v34
v_permlane32_swap_b32 v33,v35
s_nop 0
v_permlane16_swap_b32 v32,v34
v_permlane16_swap_b32 v33,v35
v_pk_mul_f32 v[48:49],v[48:49],s[26:27] op_sel_hi:[1,0]
v_pk_mul_f32 v[50:51],v[50:51],s[26:27] op_sel_hi:[1,0]
v_pk_mul_f32 v[60:61],v[60:61],s[26:27] op_sel_hi:[1,0]
v_pk_mul_f32 v[62:63],v[62:63],s[26:27] op_sel_hi:[1,0]
CV 48,48,49
CV 49,50,51
CV 50,60,61
CV 51,62,63
s_nop 0
v_permlane32_swap_b32 v48,v50
v_permlane32_swap_b32 v49,v51
s_nop 0
v_permlane16_swap_b32 v48,v50
v_permlane16_swap_b32 v49,v51
v_pk_mul_f32 v[52:53],v[52:53],s[26:27] op_sel_hi:[1,0]
v_pk_mul_f32 v[54:55],v[54:55],s[26:27] op_sel_hi:[1,0]
v_pk_mul_f32 v[64:65],v[64:65],s[26:27] op_sel_hi:[1,0]
v_pk_mul_f32 v[66:67],v[66:67],s[26:27] op_sel_hi:[1,0]
CV 52,52,53
CV 53,54,55
CV 54,64,65
CV 55,66,67
s_nop 0
v_permlane32_swap_b32 v52,v54
v_permlane32_swap_b32 v53,v55
s_nop 0
v_permlane16_swap_b32 v52,v54
v_permlane16_swap_b32 v53,v55
v_pk_mul_f32 v[56:57],v[56:57],s[26:27] op_sel_hi:[1,0]
v_pk_mul_f32 v[58:59],v[58:59],s[26:27] op_sel_hi:[1,0]
v_pk_mul_f32 v[68:69],v[68:69],s[26:27] op_sel_hi:[1,0]
v_pk_mul_f32 v[70:71],v[70:71],s[26:27] op_sel_hi:[1,0]
CV 56,56,57
CV 57,58,59
CV 58,68,69
CV 59,70,71
s_nop 0
v_permlane32_swap_b32 v56,v58
v_permlane32_swap_b32 v57,v59
s_nop 0
v_permlane16_swap_b32 v56,v58
v_permlane16_swap_b32 v57,v59
v_pk_mul_f32 v[72:73],v[72:73],s[26:27] op_sel_hi:[1,0]
v_pk_mul_f32 v[74:75],v[74:75],s[26:27] op_sel_hi:[1,0]
v_pk_mul_f32 v[84:85],v[84:85],s[26:27] op_sel_hi:[1,0]
v_pk_mul_f32 v[86:87],v[86:87],s[26:27] op_sel_hi:[1,0]
CV 72,72,73
CV 73,74,75
CV 74,84,85
CV 75,86,87
s_nop 0
v_permlane32_swap_b32 v72,v74
v_permlane32_swap_b32 v73,v75
s_nop 0
v_permlane16_swap_b32 v72,v74
v_permlane16_swap_b32 v73,v75
v_pk_mul_f32 v[76:77],v[76:77],s[26:27] op_sel_hi:[1,0]
v_pk_mul_f32 v[78:79],v[78:79],s[26:27] op_sel_hi:[1,0]
v_pk_mul_f32 v[88:89],v[88:89],s[26:27] op_sel_hi:[1,0]
v_pk_mul_f32 v[90:91],v[90:91],s[26:27] op_sel_hi:[1,0]
CV 76,76,77
CV 77,78,79
CV 78,88,89
CV 79,90,91
s_nop 0
v_permlane32_swap_b32 v76,v78
v_permlane32_swap_b32 v77,v79
s_nop 0
v_permlane16_swap_b32 v76,v78
v_permlane16_swap_b32 v77,v79
v_pk_mul_f32 v[80:81],v[80:81],s[26:27] op_sel_hi:[1,0]
v_pk_mul_f32 v[82:83],v[82:83],s[26:27] op_sel_hi:[1,0]
v_pk_mul_f32 v[92:93],v[92:93],s[26:27] op_sel_hi:[1,0]
v_pk_mul_f32 v[94:95],v[94:95],s[26:27] op_sel_hi:[1,0]
CV 80,80,81
CV 81,82,83
CV 82,92,93
CV 83,94,95
s_nop 0
v_permlane32_swap_b32 v80,v82
v_permlane32_swap_b32 v81,v83
s_nop 0
v_permlane16_swap_b32 v80,v82
v_permlane16_swap_b32 v81,v83
MU 96,s26
MU 97,s26
MU 98,s26
MU 99,s26
MU 100,s26
MU 101,s26
MU 102,s26
MU 103,s26
CV 96,96,97
CV 97,98,99
CV 98,100,101
CV 99,102,103
s_nop 0
v_permlane32_swap_b32 v96,v98
v_permlane32_swap_b32 v97,v99
s_nop 0
v_permlane16_swap_b32 v96,v98
v_permlane16_swap_b32 v97,v99
ds_write_b128 v249,v[96:99] offset:1024
AW 144,0
AW 145,1
AW 146,2
AW 147,3
AW 148,4
AW 149,5
AW 150,6
AW 151,7
AW 152,8
AW 153,9
AW 154,10
AW 155,11
AW 156,24
AW 157,25
AW 158,26
AW 159,27
AW 160,28
AW 161,29
AW 162,30
AW 163,31
AW 164,32
AW 165,33
AW 166,34
AW 167,35
AW 168,48
AW 169,49
AW 170,50
AW 171,51
AW 172,52
AW 173,53
AW 174,54
AW 175,55
AW 176,56
AW 177,57
AW 178,58
AW 179,59
AW 180,72
AW 181,73
AW 182,74
AW 183,75
AW 184,76
AW 185,77
AW 186,78
AW 187,79
AW 188,80
AW 189,81
AW 190,82
AW 191,83
v_subrev_u32 v224,135168,v249
v_lshrrev_b32 v224,4,v224
v_and_b32 v225,15,v224
v_mul_u32_u24 v220,1056,v225
v_lshrrev_b32 v226,4,v224
v_lshl_add_u32 v220,v226,4,v220
v_lshrrev_b32 v225,2,v224
v_mul_u32_u24 v221,1056,v225
v_and_b32 v226,3,v224
v_lshl_add_u32 v221,v226,3,v221
v_lshrrev_b32 v225,4,v224
v_lshlrev_b32 v225,12,v225
v_and_b32 v226,15,v224
v_lshl_add_u32 v250,v226,4,v225
v_add_u32 v251,0,v250
v_add_u32 v252,0,v250
v_add_u32 v253,0,v250
v_mov_b32 v216,v250
v_mov_b32 v217,v250
v_mov_b32 v218,v250
v_mov_b32 v219,v250
s_mov_b32 s22,0
s_mov_b32 s23,16896
s_mov_b32 s24,33792
s_mov_b32 s25,118272
s_mov_b32 s21,0
s_mov_b32 s34,0
s_add_u32 s18,s8,32768
s_addc_u32 s19,s9,0
s_mov_b32 m0,105600
s_nop 0
DW 250,18,0
s_mov_b32 m0,106400
s_nop 0
DW 251,18,256
s_mov_b32 m0,107200
s_nop 0
DW 252,18,512
s_mov_b32 m0,108000
s_nop 0
DW 253,18,768
s_add_u32 s16,s6,65536
s_addc_u32 s17,s7,0
s_add_u32 s18,s8,49152
s_addc_u32 s19,s9,0
s_waitcnt vmcnt(24) lgkmcnt(0)
s_barrier
v_mov_b32 v254,v220
RD 208,254,0
RD 212,254,64
RD 216,254,128
RD 220,254,192
RD 192,254,256
RD 196,254,320
RD 200,254,384
RD 204,254,448
RD 224,249,16384
RD 228,249,17408
RD 232,249,18432
RD 236,249,19456
LB_w1:
LG 0
Za 136,208,0
v_add_u32 v248,s24,v221
s_mov_b32 s48,s22
s_mov_b32 s49,s25
Ma 136,212,12
Ma 136,216,24
Ma 136,220,36
Za 140,208,4
Ma 140,212,16
Ma 140,216,28
s_nop 4
v_max3_f32 v200,v136,v137,v138
v_max_f32 v200,v200,v139
Ma 140,220,40
v_mov_b32 v201,v200
s_nop 1
v_permlane16_swap_b32 v200,v201
Za 144,208,8
v_max_f32 v200,v200,v201
v_mov_b32 v201,v200
Ma 144,212,20
s_nop 0
v_permlane32_swap_b32 v200,v201
v_max_f32 v200,v200,v201
Ma 144,216,32
v_mul_f32 v200,-1.0,v200
v_mov_b32 v201,v200
Ma 144,220,44
v_mov_b32 v202,v200
v_mov_b32 v203,v200
Za 148,208,224
v_max3_f32 v204,v140,v141,v142
v_max_f32 v204,v204,v143
Ma 148,212,228
v_mov_b32 v205,v204
s_nop 1
v_permlane16_swap_b32 v204,v205
Ma 148,216,232
v_max_f32 v204,v204,v205
v_mov_b32 v205,v204
Ma 148,220,236
s_nop 0
v_permlane32_swap_b32 v204,v205
RD 208,254,512
Ca 120,192,0,200
v_max_f32 v204,v204,v205
RD 212,254,576
Ma 120,196,12
v_mul_f32 v204,-1.0,v204
v_mov_b32 v205,v204
Ma 120,200,24
v_mov_b32 v206,v204
v_mov_b32 v207,v204
Ma 120,204,36
v_max3_f32 v208,v144,v145,v146
v_max_f32 v208,v208,v147
Ca 124,192,4,204
v_mov_b32 v209,v208
s_nop 1
v_permlane16_swap_b32 v208,v209
Ma 124,196,16
v_max_f32 v208,v208,v209
v_mov_b32 v209,v208
Ma 124,200,28
s_nop 0
v_permlane32_swap_b32 v208,v209
v_max_f32 v208,v208,v209
Ma 124,204,40
v_mul_f32 v208,-1.0,v208
v_mov_b32 v209,v208
v_mov_b32 v210,v208
v_mov_b32 v211,v208
s_nop 1
Ca 128,192,8,208
RD 216,254,640
v_max3_f32 v212,v148,v149,v150
Ma 128,196,20
v_max_f32 v212,v212,v151
v_mov_b32 v213,v212
Ma 128,200,32
RD 220,254,704
v_permlane16_swap_b32 v212,v213
Ma 128,204,44
v_max_f32 v212,v212,v213
v_mov_b32 v213,v212
s_nop 1
v_permlane32_swap_b32 v212,v213
v_max_f32 v212,v212,v213
v_mul_f32 v212,-1.0,v212
v_mov_b32 v213,v212
v_mov_b32 v214,v212
v_mov_b32 v215,v212
s_nop 1
Ca 132,192,224,212
v_add_f32 v136,v136,v200
v_add_f32 v137,v137,v200
Ma 132,196,228
v_add_f32 v138,v138,v200
v_add_f32 v139,v139,v200
Ma 132,200,232
EX 136
Ma 132,204,236
EX 137
EX 138
EX 139
CV 152,136,137
CV 153,138,139
LG 3
Ca 136,208,0,200
v_add_f32 v140,v140,v204
v_add_f32 v141,v141,v204
LG 2
Ma 136,212,12
v_add_f32 v142,v142,v204
v_add_f32 v143,v143,v204
LG 1
Ma 136,216,24
EX 132
LG 0
Ma 136,220,36
EX 133
EX 140
EX 141
EX 142
EX 143
CV 160,140,141
CV 161,142,143
Ca 140,208,4,204
EX 134
Ma 140,212,16
EX 135
Ma 140,216,28
CV 132,132,133
CV 133,134,135
Ma 140,220,40
ds_write_b64 v249,v[132:133] offset:4104
RD 192,254,768
v_add_f32 v144,v144,v208
EX 144
v_add_f32 v145,v145,v208
EX 145
v_add_f32 v146,v146,v208
EX 146
v_add_f32 v147,v147,v208
EX 147
CV 168,144,145
CV 169,146,147
Ca 144,208,8,208
RD 196,254,832
RD 200,254,896
Ma 144,212,20
RD 204,254,960
v_add_u32 v254,s23,v220
Ma 144,216,32
EX 120
Ma 144,220,44
EX 121
EX 122
EX 123
CV 154,120,121
CV 155,122,123
LG 3
Ca 120,192,0,200
EX 124
LG 2
Ma 120,196,12
EX 125
LG 1
Ma 120,200,24
EX 126
LG 0
Ma 120,204,36
EX 127
CV 162,124,125
CV 163,126,127
Ca 124,192,4,204
EX 128
Ma 124,196,16
EX 129
Ma 124,200,28
EX 130
Ma 124,204,40
EX 131
CV 170,128,129
CV 171,130,131
Ca 128,192,8,208
EX 136
Ma 128,196,20
EX 137
Ma 128,200,32
EX 138
Ma 128,204,44
EX 139
s_waitcnt vmcnt(16) lgkmcnt(0)
s_barrier
s_cmp_ge_u32 s21,28
s_cbranch_scc1 ProK_w1
ProK_r_w1:
CV 156,136,137
CV 157,138,139
EX 140
EX 141
EX 142
EX 143
CV 164,140,141
CV 165,142,143
EX 144
EX 145
EX 146
EX 147
CV 172,144,145
CV 173,146,147
EX 120
EX 121
EX 122
EX 123
CV 158,120,121
CV 159,122,123
EX 124
EX 125
EX 126
EX 127
CV 166,124,125
CV 167,126,127
EX 128
EX 129
EX 130
EX 131
CV 174,128,129
CV 175,130,131
s_sub_u32 s22,50688,s22
s_sub_u32 s25,185856,s25
s_add_u32 s21,s21,1
RD 192,254,256
RD 196,254,320
RD 200,254,384
RD 204,254,448
LG 0
Ca 120,192,0,200
s_add_u32 m0,s48,4224
s_mov_b32 s48,s23
Ma 120,196,12
Ma 120,200,24
RD 244,249,4096
RD 248,249,5120
Ma 120,204,36
DM 250,16,0
s_add_u32 m0,m0,800
Ca 124,192,4,204
TR 208,248,128
TR 210,248,384
Ma 124,196,16
TR 212,248,640
TR 214,248,896
Ma 124,200,28
EX 120
Ma 124,204,40
EX 121
Ca 128,192,8,208
TR 216,248,160
CV 178,120,121
Ma 128,196,20
TR 218,248,416
TR 220,248,672
Ma 128,200,32
TR 222,248,928
Ma 128,204,44
EX 122
Ca 132,192,224,212
EX 123
Ma 132,196,228
DM 251,16,256
s_add_u32 m0,m0,800
Ma 132,200,232
RD 192,254,512
CV 179,122,123
Ma 132,204,236
RD 196,254,576
LG 8
Zv 48,208,152
RD 200,254,640
LG 7
Mv 48,212,156
RD 204,254,704
Zv 52,208,160
EX 132
Mv 52,212,164
EX 133
Zv 56,208,168
EX 134
Mv 56,212,172
EX 135
LG 6
Zv 60,216,152
CV 132,132,133
CV 133,134,135
LG 4
Mv 60,220,156
DM 252,16,512
s_add_u32 m0,m0,800
Zv 64,216,160
ds_write_b64 v249,v[132:133] offset:6152
Mv 64,220,164
EX 124
Zv 68,216,168
TR 208,248,192
TR 210,248,448
Mv 68,220,172
TR 212,248,704
TR 214,248,960
LG 8
Ca 136,192,0,200
EX 125
LG 7
Ma 136,196,12
EX 126
LG 6
Ma 136,200,24
EX 127
LG 5
Ma 136,204,36
CV 186,124,125
CV 187,126,127
Ca 140,192,4,204
TR 216,248,224
TR 218,248,480
Ma 140,196,16
DM 253,16,768
s_add_u32 m0,s49,4224
s_add_u32 s16,s16,16384
s_addc_u32 s17,s17,0
Ma 140,200,28
TR 220,248,736
TR 222,248,992
s_mov_b32 s49,s24
Ma 140,204,40
EX 128
Ca 144,192,8,208
EX 129
Ma 144,196,20
EX 130
Ma 144,200,32
RD 192,254,768
CV 194,128,129
Ma 144,204,44
RD 196,254,832
LG 8
Zv 72,208,152
RD 200,254,896
LG 7
Mv 72,212,156
RD 204,254,960
Zv 76,208,160
EX 131
Mv 76,212,164
DM 216,18,0
s_add_u32 m0,m0,800
Zv 80,208,168
CV 195,130,131
Mv 80,212,172
EX 136
LG 6
Zv 84,216,152
EX 137
LG 4
Mv 84,220,156
EX 138
Zv 88,216,160
EX 139
Mv 88,220,164
CV 180,136,137
CV 181,138,139
Zv 92,216,168
TR 208,248,0
TR 210,248,256
Mv 92,220,172
TR 212,248,512
TR 214,248,768
LG 7
Ca 120,192,0,200
EX 140
LG 6
Ma 120,196,12
DM 217,18,256
s_add_u32 m0,m0,800
LG 5
Ma 120,200,24
EX 141
LG 4
Ma 120,204,36
EX 142
Ca 124,192,4,204
TR 216,248,32
CV 188,140,141
Ma 124,196,16
TR 218,248,288
TR 220,248,544
Ma 124,200,28
TR 222,248,800
Ma 124,204,40
EX 143
Ca 128,192,8,208
CV 189,142,143
Ma 128,196,20
EX 144
Ma 128,200,32
RD 192,254,0
Ma 128,204,44
DM 218,18,512
s_add_u32 m0,m0,800
LG 7
Zv 0,208,152
RD 196,254,64
RD 200,254,128
LG 7
Mv 0,212,156
RD 204,254,192
v_add_u32 v254,s22,v220
Zv 4,208,160
EX 145
Mv 4,212,164
EX 146
Zv 8,208,168
EX 147
Mv 8,212,172
CV 196,144,145
CV 197,146,147
LG 6
Zv 12,216,152
EX 120
LG 4
Mv 12,220,156
EX 121
Zv 16,216,160
EX 122
Mv 16,220,164
DM 219,18,768
s_add_u32 s18,s18,16384
s_addc_u32 s19,s19,0
Zv 20,216,168
TR 208,248,64
CV 182,120,121
Mv 20,220,172
TR 210,248,320
TR 212,248,576
LG 6
Ca 136,192,0,200
TR 214,248,832
LG 6
Ma 136,196,12
EX 123
LG 5
Ma 136,200,24
CV 183,122,123
LG 4
Ma 136,204,36
EX 124
Ca 140,192,4,204
EX 125
Ma 140,196,16
EX 126
Ma 140,200,28
TR 216,248,96
CV 190,124,125
Ma 140,204,40
TR 218,248,352
TR 220,248,608
Ca 144,192,8,208
TR 222,248,864
v_add_u32 v248,s25,v221
Ma 144,196,20
EX 127
Ma 144,200,32
CV 191,126,127
Ma 144,204,44
EX 128
LG 6
Zv 24,208,152
EX 129
LG 4
Mv 24,212,156
EX 130
Zv 28,208,160
EX 131
Mv 28,212,164
CV 198,128,129
CV 199,130,131
Zv 32,208,168
EX 136
Mv 32,212,172
EX 137
Za 96,208,244
EX 138
Ma 96,212,248
EX 139
LG 2
Zv 36,216,152
CV 176,136,137
CV 177,138,139
LG 0
Mv 36,220,156
EX 140
s_waitcnt vmcnt(16) lgkmcnt(0)
s_barrier
s_cmp_ge_u32 s21,28
s_cbranch_scc1 It0K_w1
It0K_r_w1:
Zv 40,216,160
RD 192,254,256
RD 196,254,320
s_sub_u32 s23,101376,s23
s_sub_u32 s24,135168,s24
Mv 40,220,164
RD 200,254,384
RD 204,254,448
s_add_u32 s21,s21,1
Zv 44,216,168
EX 141
Mv 44,220,172
EX 142
Za 100,216,244
EX 143
Ma 100,220,248
CV 184,140,141
CV 185,142,143
Zv 104,240,152
EX 144
Mv 104,240,156
EX 145
Zv 108,240,160
EX 146
Mv 108,240,164
EX 147
Zv 112,240,168
CV 192,144,145
CV 193,146,147
Mv 112,240,172
Za 116,240,244
Ma 116,240,248
s_mov_b32 s20,3
LI_w1:
LG 0
Ca 120,192,0,200
s_add_u32 m0,s48,4224
s_mov_b32 s48,s22
Ma 120,196,12
Ma 120,200,24
RD 244,249,6144
RD 248,249,7168
Ma 120,204,36
DM 250,16,0
s_add_u32 m0,m0,800
Ca 124,192,4,204
TR 208,248,128
TR 210,248,384
Ma 124,196,16
TR 212,248,640
TR 214,248,896
Ma 124,200,28
EX 120
Ma 124,204,40
EX 121
Ca 128,192,8,208
TR 216,248,160
CV 154,120,121
Ma 128,196,20
TR 218,248,416
TR 220,248,672
Ma 128,200,32
TR 222,248,928
Ma 128,204,44
EX 122
Ca 132,192,224,212
EX 123
Ma 132,196,228
DM 251,16,256
s_add_u32 m0,m0,800
Ma 132,200,232
RD 192,254,512
CV 155,122,123
Ma 132,204,236
RD 196,254,576
LG 8
Mv 48,208,176
RD 200,254,640
LG 7
Mv 48,212,180
RD 204,254,704
Mv 52,208,184
EX 132
Mv 52,212,188
EX 133
Mv 56,208,192
EX 134
Mv 56,212,196
EX 135
LG 6
Mv 60,216,176
CV 132,132,133
CV 133,134,135
LG 4
Mv 60,220,180
DM 252,16,512
s_add_u32 m0,m0,800
Mv 64,216,184
ds_write_b64 v249,v[132:133] offset:4104
Mv 64,220,188
EX 124
Mv 68,216,192
TR 208,248,192
TR 210,248,448
Mv 68,220,196
TR 212,248,704
TR 214,248,960
LG 8
Ca 136,192,0,200
EX 125
LG 7
Ma 136,196,12
EX 126
LG 6
Ma 136,200,24
EX 127
LG 5
Ma 136,204,36
CV 162,124,125
CV 163,126,127
Ca 140,192,4,204
TR 216,248,224
TR 218,248,480
Ma 140,196,16
DM 253,16,768
s_add_u32 m0,s49,4224
s_add_u32 s16,s16,16384
s_addc_u32 s17,s17,0
Ma 140,200,28
TR 220,248,736
TR 222,248,992
s_mov_b32 s49,s25
Ma 140,204,40
EX 128
Ca 144,192,8,208
EX 129
Ma 144,196,20
EX 130
Ma 144,200,32
RD 192,254,768
CV 170,128,129
Ma 144,204,44
RD 196,254,832
LG 8
Mv 72,208,176
RD 200,254,896
LG 7
Mv 72,212,180
RD 204,254,960
Mv 76,208,184
EX 131
Mv 76,212,188
DM 216,18,0
s_add_u32 m0,m0,800
Mv 80,208,192
CV 171,130,131
Mv 80,212,196
EX 136
LG 6
Mv 84,216,176
EX 137
LG 4
Mv 84,220,180
EX 138
Mv 88,216,184
EX 139
Mv 88,220,188
CV 156,136,137
CV 157,138,139
Mv 92,216,192
TR 208,248,0
TR 210,248,256
Mv 92,220,196
TR 212,248,512
TR 214,248,768
LG 7
Ca 120,192,0,200
EX 140
LG 6
Ma 120,196,12
DM 217,18,256
s_add_u32 m0,m0,800
LG 5
Ma 120,200,24
EX 141
LG 4
Ma 120,204,36
EX 142
Ca 124,192,4,204
TR 216,248,32
CV 164,140,141
Ma 124,196,16
TR 218,248,288
TR 220,248,544
Ma 124,200,28
TR 222,248,800
Ma 124,204,40
EX 143
Ca 128,192,8,208
CV 165,142,143
Ma 128,196,20
EX 144
Ma 128,200,32
RD 192,254,0
Ma 128,204,44
DM 218,18,512
s_add_u32 m0,m0,800
LG 7
Mv 0,208,176
RD 196,254,64
RD 200,254,128
LG 7
Mv 0,212,180
RD 204,254,192
v_add_u32 v254,s23,v220
Mv 4,208,184
EX 145
Mv 4,212,188
EX 146
Mv 8,208,192
EX 147
Mv 8,212,196
CV 172,144,145
CV 173,146,147
LG 6
Mv 12,216,176
EX 120
LG 4
Mv 12,220,180
EX 121
Mv 16,216,184
EX 122
Mv 16,220,188
DM 219,18,768
s_add_u32 s18,s18,16384
s_addc_u32 s19,s19,0
Mv 20,216,192
TR 208,248,64
CV 158,120,121
Mv 20,220,196
TR 210,248,320
TR 212,248,576
LG 6
Ca 136,192,0,200
TR 214,248,832
LG 6
Ma 136,196,12
EX 123
LG 5
Ma 136,200,24
CV 159,122,123
LG 4
Ma 136,204,36
EX 124
Ca 140,192,4,204
EX 125
Ma 140,196,16
EX 126
Ma 140,200,28
TR 216,248,96
CV 166,124,125
Ma 140,204,40
TR 218,248,352
TR 220,248,608
Ca 144,192,8,208
TR 222,248,864
v_add_u32 v248,s24,v221
Ma 144,196,20
EX 127
Ma 144,200,32
CV 167,126,127
Ma 144,204,44
EX 128
LG 6
Mv 24,208,176
EX 129
LG 4
Mv 24,212,180
EX 130
Mv 28,208,184
EX 131
Mv 28,212,188
CV 174,128,129
CV 175,130,131
Mv 32,208,192
EX 136
Mv 32,212,196
EX 137
Ma 96,208,244
EX 138
Ma 96,212,248
EX 139
LG 2
Mv 36,216,176
CV 152,136,137
CV 153,138,139
LG 0
Mv 36,220,180
EX 140
s_waitcnt vmcnt(16) lgkmcnt(0)
s_barrier
s_cmp_ge_u32 s21,28
s_cbranch_scc1 ItOK_w1
ItOK_r_w1:
Mv 40,216,184
RD 192,254,256
RD 196,254,320
s_sub_u32 s22,50688,s22
s_sub_u32 s25,185856,s25
Mv 40,220,188
RD 200,254,384
RD 204,254,448
s_add_u32 s21,s21,1
Mv 44,216,192
EX 141
Mv 44,220,196
EX 142
Ma 100,216,244
EX 143
Ma 100,220,248
CV 160,140,141
CV 161,142,143
Mv 104,240,176
EX 144
Mv 104,240,180
EX 145
Mv 108,240,184
EX 146
Mv 108,240,188
EX 147
Mv 112,240,192
CV 168,144,145
CV 169,146,147
Mv 112,240,196
Ma 116,240,244
Ma 116,240,248
LG 0
Ca 120,192,0,200
s_add_u32 m0,s48,4224
s_mov_b32 s48,s23
Ma 120,196,12
Ma 120,200,24
RD 244,249,4096
RD 248,249,5120
Ma 120,204,36
DM 250,16,0
s_add_u32 m0,m0,800
Ca 124,192,4,204
TR 208,248,128
TR 210,248,384
Ma 124,196,16
TR 212,248,640
TR 214,248,896
Ma 124,200,28
EX 120
Ma 124,204,40
EX 121
Ca 128,192,8,208
TR 216,248,160
CV 178,120,121
Ma 128,196,20
TR 218,248,416
TR 220,248,672
Ma 128,200,32
TR 222,248,928
Ma 128,204,44
EX 122
Ca 132,192,224,212
EX 123
Ma 132,196,228
DM 251,16,256
s_add_u32 m0,m0,800
Ma 132,200,232
RD 192,254,512
CV 179,122,123
Ma 132,204,236
RD 196,254,576
LG 8
Mv 48,208,152
RD 200,254,640
LG 7
Mv 48,212,156
RD 204,254,704
Mv 52,208,160
EX 132
Mv 52,212,164
EX 133
Mv 56,208,168
EX 134
Mv 56,212,172
EX 135
LG 6
Mv 60,216,152
CV 132,132,133
CV 133,134,135
LG 4
Mv 60,220,156
DM 252,16,512
s_add_u32 m0,m0,800
Mv 64,216,160
ds_write_b64 v249,v[132:133] offset:6152
Mv 64,220,164
EX 124
Mv 68,216,168
TR 208,248,192
TR 210,248,448
Mv 68,220,172
TR 212,248,704
TR 214,248,960
LG 8
Ca 136,192,0,200
EX 125
LG 7
Ma 136,196,12
EX 126
LG 6
Ma 136,200,24
EX 127
LG 5
Ma 136,204,36
CV 186,124,125
CV 187,126,127
Ca 140,192,4,204
TR 216,248,224
TR 218,248,480
Ma 140,196,16
DM 253,16,768
s_add_u32 m0,s49,4224
s_add_u32 s16,s16,16384
s_addc_u32 s17,s17,0
Ma 140,200,28
TR 220,248,736
TR 222,248,992
s_mov_b32 s49,s24
Ma 140,204,40
EX 128
Ca 144,192,8,208
EX 129
Ma 144,196,20
EX 130
Ma 144,200,32
RD 192,254,768
CV 194,128,129
Ma 144,204,44
RD 196,254,832
LG 8
Mv 72,208,152
RD 200,254,896
LG 7
Mv 72,212,156
RD 204,254,960
Mv 76,208,160
EX 131
Mv 76,212,164
DM 216,18,0
s_add_u32 m0,m0,800
Mv 80,208,168
CV 195,130,131
Mv 80,212,172
EX 136
LG 6
Mv 84,216,152
EX 137
LG 4
Mv 84,220,156
EX 138
Mv 88,216,160
EX 139
Mv 88,220,164
CV 180,136,137
CV 181,138,139
Mv 92,216,168
TR 208,248,0
TR 210,248,256
Mv 92,220,172
TR 212,248,512
TR 214,248,768
LG 7
Ca 120,192,0,200
EX 140
LG 6
Ma 120,196,12
DM 217,18,256
s_add_u32 m0,m0,800
LG 5
Ma 120,200,24
EX 141
LG 4
Ma 120,204,36
EX 142
Ca 124,192,4,204
TR 216,248,32
CV 188,140,141
Ma 124,196,16
TR 218,248,288
TR 220,248,544
Ma 124,200,28
TR 222,248,800
Ma 124,204,40
EX 143
Ca 128,192,8,208
CV 189,142,143
Ma 128,196,20
EX 144
Ma 128,200,32
RD 192,254,0
Ma 128,204,44
DM 218,18,512
s_add_u32 m0,m0,800
LG 7
Mv 0,208,152
RD 196,254,64
RD 200,254,128
LG 7
Mv 0,212,156
RD 204,254,192
v_add_u32 v254,s22,v220
Mv 4,208,160
EX 145
Mv 4,212,164
EX 146
Mv 8,208,168
EX 147
Mv 8,212,172
CV 196,144,145
CV 197,146,147
LG 6
Mv 12,216,152
EX 120
LG 4
Mv 12,220,156
EX 121
Mv 16,216,160
EX 122
Mv 16,220,164
DM 219,18,768
s_add_u32 s18,s18,16384
s_addc_u32 s19,s19,0
Mv 20,216,168
TR 208,248,64
CV 182,120,121
Mv 20,220,172
TR 210,248,320
TR 212,248,576
LG 6
Ca 136,192,0,200
TR 214,248,832
LG 6
Ma 136,196,12
EX 123
LG 5
Ma 136,200,24
CV 183,122,123
LG 4
Ma 136,204,36
EX 124
Ca 140,192,4,204
EX 125
Ma 140,196,16
EX 126
Ma 140,200,28
TR 216,248,96
CV 190,124,125
Ma 140,204,40
TR 218,248,352
TR 220,248,608
Ca 144,192,8,208
TR 222,248,864
v_add_u32 v248,s25,v221
Ma 144,196,20
EX 127
Ma 144,200,32
CV 191,126,127
Ma 144,204,44
EX 128
LG 6
Mv 24,208,152
EX 129
LG 4
Mv 24,212,156
EX 130
Mv 28,208,160
EX 131
Mv 28,212,164
CV 198,128,129
CV 199,130,131
Mv 32,208,168
EX 136
Mv 32,212,172
EX 137
Ma 96,208,244
EX 138
Ma 96,212,248
EX 139
LG 2
Mv 36,216,152
CV 176,136,137
CV 177,138,139
LG 0
Mv 36,220,156
EX 140
s_waitcnt vmcnt(16) lgkmcnt(0)
s_barrier
s_cmp_ge_u32 s21,28
s_cbranch_scc1 ItEK_w1
ItEK_r_w1:
Mv 40,216,160
RD 192,254,256
RD 196,254,320
s_sub_u32 s23,101376,s23
s_sub_u32 s24,135168,s24
Mv 40,220,164
RD 200,254,384
RD 204,254,448
s_add_u32 s21,s21,1
Mv 44,216,168
EX 141
Mv 44,220,172
EX 142
Ma 100,216,244
EX 143
Ma 100,220,248
CV 184,140,141
CV 185,142,143
Mv 104,240,152
EX 144
Mv 104,240,156
EX 145
Mv 108,240,160
EX 146
Mv 108,240,164
EX 147
Mv 112,240,168
CV 192,144,145
CV 193,146,147
Mv 112,240,172
Ma 116,240,244
Ma 116,240,248
s_sub_u32 s20,s20,1
s_cmp_lg_u32 s20,0
s_cbranch_scc1 LI_w1
LG 0
Mv 104,240,176
RD 244,249,6144
Mv 104,240,180
RD 248,249,7168
Mv 108,240,184
TR 208,248,128
TR 210,248,384
Mv 108,240,188
TR 212,248,640
TR 214,248,896
Mv 112,240,192
TR 216,248,160
TR 218,248,416
Mv 112,240,196
TR 220,248,672
TR 222,248,928
LG 9
Ma 116,240,244
LG 8
Ma 116,240,248
s_nop 7
v_cmp_nge_f32 vcc,s27,v104
v_cmp_nle_f32_e64 s[72:73],v108,s27
s_nop 1
s_or_b64 vcc,vcc,s[72:73]
v_cmp_nle_f32_e64 s[72:73],v112,s27
s_nop 1
s_or_b64 vcc,vcc,s[72:73]
v_cmp_nle_f32_e64 s[72:73],v116,s27
s_nop 1
s_or_b64 vcc,vcc,s[72:73]
s_cbranch_vccnz SLOW_w1
LG 6
Mv 48,208,176
v_rcp_f32 v224,v104
s_add_u32 m0,s48,4224
LG 4
Mv 48,212,180
v_rcp_f32 v226,v108
Mv 52,208,184
v_rcp_f32 v228,v112
Mv 52,212,188
v_rcp_f32 v230,v116
Mv 56,208,192
TR 192,248,192
TR 194,248,448
Mv 56,212,196
TR 196,248,704
TR 198,248,960
LG 6
Mv 60,216,176
DM 250,16,0
s_add_u32 m0,m0,800
LG 4
Mv 60,220,180
TR 200,248,224
MU 48,v224
Mv 64,216,184
TR 202,248,480
MU 49,v224
Mv 64,220,188
DM 251,16,256
s_add_u32 m0,m0,800
Mv 68,216,192
TR 204,248,736
TR 206,248,992
Mv 68,220,196
TR 208,248,0
MU 50,v224
LG 7
Mv 72,192,176
DM 252,16,512
s_add_u32 m0,m0,800
LG 5
Mv 72,196,180
TR 210,248,256
MU 51,v224
Mv 76,192,184
TR 212,248,512
MU 60,v224
Mv 76,196,188
TR 214,248,768
MU 61,v224
Mv 80,192,192
TR 216,248,32
MU 62,v224
Mv 80,196,196
DM 253,16,768
s_add_u32 m0,s49,4224
s_add_u32 s16,s16,16384
s_addc_u32 s17,s17,0
LG 7
Mv 84,200,176
TR 218,248,288
MU 63,v224
LG 6
Mv 84,204,180
TR 220,248,544
CV 48,48,49
Mv 88,200,184
TR 222,248,800
CV 49,50,51
Mv 88,204,188
CV 50,60,61
CV 51,62,63
Mv 92,200,192
DM 216,18,0
s_add_u32 m0,m0,800
Mv 92,204,196
TR 192,248,64
MU 52,v226
LG 7
Mv 0,208,176
TR 194,248,320
MU 53,v226
LG 6
Mv 0,212,180
TR 196,248,576
MU 54,v226
Mv 4,208,184
TR 198,248,832
MU 55,v226
Mv 4,212,188
DM 217,18,256
s_add_u32 m0,m0,800
Mv 8,208,192
MU 64,v226
MU 65,v226
Mv 8,212,196
MU 66,v226
MU 67,v226
LG 6
Mv 12,216,176
TR 200,248,96
CV 52,52,53
LG 5
Mv 12,220,180
TR 202,248,352
CV 53,54,55
Mv 16,216,184
DM 218,18,512
s_add_u32 m0,m0,800
Mv 16,220,188
TR 204,248,608
CV 54,64,65
Mv 20,216,192
TR 206,248,864
CV 55,66,67
Mv 20,220,196
MU 56,v228
MU 57,v228
LG 6
Mv 24,192,176
MU 58,v228
MU 59,v228
LG 4
Mv 24,196,180
DM 219,18,768
s_add_u32 s18,s18,16384
s_addc_u32 s19,s19,0
Mv 28,192,184
MU 68,v228
MU 69,v228
Mv 28,196,188
MU 70,v228
MU 71,v228
Mv 32,192,192
CV 56,56,57
CV 57,58,59
Mv 32,196,196
CV 58,68,69
CV 59,70,71
Ma 96,192,244
MU 72,v224
MU 73,v224
Ma 96,196,248
MU 74,v224
MU 75,v224
LG 2
Mv 36,200,176
MU 84,v224
MU 85,v224
LG 0
Mv 36,204,180
MU 86,v224
MU 87,v224
Mv 40,200,184
CV 72,72,73
CV 73,74,75
Mv 40,204,188
CV 74,84,85
CV 75,86,87
Mv 44,200,192
MU 76,v226
MU 77,v226
Mv 44,204,196
MU 78,v226
MU 79,v226
Ma 100,200,244
MU 88,v226
MU 89,v226
Ma 100,204,248
MU 90,v226
MU 91,v226
CV 76,76,77
CV 77,78,79
CV 78,88,89
CV 79,90,91
MU 80,v228
MU 81,v228
MU 82,v228
MU 83,v228
MU 92,v228
MU 93,v228
MU 94,v228
MU 95,v228
CV 80,80,81
CV 81,82,83
CV 82,92,93
CV 83,94,95
v_pk_mul_f32 v[0:1],v[0:1],v[224:225] op_sel_hi:[1,0]
v_pk_mul_f32 v[2:3],v[2:3],v[224:225] op_sel_hi:[1,0]
v_pk_mul_f32 v[12:13],v[12:13],v[224:225] op_sel_hi:[1,0]
v_pk_mul_f32 v[14:15],v[14:15],v[224:225] op_sel_hi:[1,0]
CV 0,0,1
CV 1,2,3
CV 2,12,13
CV 3,14,15
v_pk_mul_f32 v[4:5],v[4:5],v[226:227] op_sel_hi:[1,0]
v_pk_mul_f32 v[6:7],v[6:7],v[226:227] op_sel_hi:[1,0]
v_pk_mul_f32 v[16:17],v[16:17],v[226:227] op_sel_hi:[1,0]
v_pk_mul_f32 v[18:19],v[18:19],v[226:227] op_sel_hi:[1,0]
CV 4,4,5
CV 5,6,7
CV 6,16,17
CV 7,18,19
v_pk_mul_f32 v[8:9],v[8:9],v[228:229] op_sel_hi:[1,0]
v_pk_mul_f32 v[10:11],v[10:11],v[228:229] op_sel_hi:[1,0]
v_pk_mul_f32 v[20:21],v[20:21],v[228:229] op_sel_hi:[1,0]
v_pk_mul_f32 v[22:23],v[22:23],v[228:229] op_sel_hi:[1,0]
CV 8,8,9
CV 9,10,11
CV 10,20,21
CV 11,22,23
v_pk_mul_f32 v[24:25],v[24:25],v[224:225] op_sel_hi:[1,0]
v_pk_mul_f32 v[26:27],v[26:27],v[224:225] op_sel_hi:[1,0]
v_pk_mul_f32 v[36:37],v[36:37],v[224:225] op_sel_hi:[1,0]
v_pk_mul_f32 v[38:39],v[38:39],v[224:225] op_sel_hi:[1,0]
CV 24,24,25
CV 25,26,27
CV 26,36,37
CV 27,38,39
v_pk_mul_f32 v[28:29],v[28:29],v[226:227] op_sel_hi:[1,0]
v_pk_mul_f32 v[30:31],v[30:31],v[226:227] op_sel_hi:[1,0]
v_pk_mul_f32 v[40:41],v[40:41],v[226:227] op_sel_hi:[1,0]
v_pk_mul_f32 v[42:43],v[42:43],v[226:227] op_sel_hi:[1,0]
CV 28,28,29
CV 29,30,31
CV 30,40,41
CV 31,42,43
v_pk_mul_f32 v[32:33],v[32:33],v[228:229] op_sel_hi:[1,0]
v_pk_mul_f32 v[34:35],v[34:35],v[228:229] op_sel_hi:[1,0]
v_pk_mul_f32 v[44:45],v[44:45],v[228:229] op_sel_hi:[1,0]
v_pk_mul_f32 v[46:47],v[46:47],v[228:229] op_sel_hi:[1,0]
CV 32,32,33
CV 33,34,35
CV 34,44,45
CV 35,46,47
v_pk_mul_f32 v[96:97],v[96:97],v[230:231] op_sel_hi:[1,0]
v_pk_mul_f32 v[98:99],v[98:99],v[230:231] op_sel_hi:[1,0]
v_pk_mul_f32 v[100:101],v[100:101],v[230:231] op_sel_hi:[1,0]
v_pk_mul_f32 v[102:103],v[102:103],v[230:231] op_sel_hi:[1,0]
CV 96,96,97
CV 97,98,99
CV 98,100,101
CV 99,102,103
SLOW_r_w1:
s_cmp_eq_u32 s34,0
s_cbranch_scc0 EB1_w1
v_mov_b32 v254,v220
RD 208,254,0
RD 212,254,64
RD 216,254,128
RD 220,254,192
RD 192,254,256
RD 196,254,320
RD 200,254,384
RD 204,254,448
RD 224,249,20480
RD 228,249,21504
RD 232,249,22528
RD 236,249,23552
ds_write_b128 v249,v[96:99] offset:17408
AM 0,48
AM 1,49
AM 2,50
AM 3,51
AM 4,52
AM 5,53
AM 6,54
AM 7,55
AM 8,56
AM 9,57
AM 10,58
AM 11,59
AM 12,60
AM 13,61
AM 14,62
AM 15,63
AM 16,64
AM 17,65
AM 18,66
AM 19,67
AM 20,68
AM 21,69
AM 22,70
AM 23,71
AM 24,72
AM 25,73
AM 26,74
AM 27,75
AM 28,76
AM 29,77
AM 30,78
AM 31,79
AM 32,80
AM 33,81
AM 34,82
AM 35,83
AM 36,84
AM 37,85
AM 38,86
AM 39,87
AM 40,88
AM 41,89
AM 42,90
AM 43,91
AM 44,92
AM 45,93
AM 46,94
AM 47,95
AW 48,0
AW 49,1
AW 50,2
AW 51,3
AW 52,4
AW 53,5
AW 54,6
AW 55,7
AW 56,8
AW 57,9
AW 58,10
AW 59,11
AW 60,24
AW 61,25
AW 62,26
AW 63,27
AW 64,28
AW 65,29
AW 66,30
AW 67,31
AW 68,32
AW 69,33
AW 70,34
AW 71,35
AW 72,48
AW 73,49
AW 74,50
AW 75,51
AW 76,52
AW 77,53
AW 78,54
AW 79,55
AW 80,56
AW 81,57
AW 82,58
AW 83,59
AW 84,72
AW 85,73
AW 86,74
AW 87,75
AW 88,76
AW 89,77
AW 90,78
AW 91,79
AW 92,80
AW 93,81
AW 94,82
AW 95,83
s_add_u32 s34,s34,1
s_branch LB_w1
EB1_w1:
s_cmp_eq_u32 s34,1
s_cbranch_scc0 EB2_w1
v_mov_b32 v254,v220
LG 12
RD 208,254,0
LG 12
RD 212,254,64
LG 12
RD 216,254,128
LG 12
RD 220,254,192
LG 12
RD 192,254,256
LG 12
RD 196,254,320
LG 12
RD 200,254,384
LG 12
RD 204,254,448
LG 12
RD 224,249,24576
LG 12
RD 228,249,25600
LG 12
RD 232,249,26624
LG 12
RD 236,249,27648
ds_write_b128 v249,v[96:99] offset:21504
AM 0,96
AM 1,97
AM 2,98
AM 3,99
AM 4,100
AM 5,101
AM 6,102
AM 7,103
AM 8,104
AM 9,105
AM 10,106
AM 11,107
AM 12,108
AM 13,109
AM 14,110
AM 15,111
AM 16,112
AM 17,113
AM 18,114
AM 19,115
AM 20,116
AM 21,117
AM 22,118
AM 23,119
AM 24,120
AM 25,121
AM 26,122
AM 27,123
AM 28,124
AM 29,125
AM 30,126
AM 31,127
AM 32,128
AM 33,129
AM 34,130
AM 35,131
AM 36,132
AM 37,133
AM 38,134
AM 39,135
AM 40,136
AM 41,137
AM 42,138
AM 43,139
AM 44,140
AM 45,141
AM 46,142
AM 47,143
AW 96,0
AW 97,1
AW 98,2
AW 99,3
AW 100,4
AW 101,5
AW 102,6
AW 103,7
AW 104,8
AW 105,9
AW 106,10
AW 107,11
AW 108,24
AW 109,25
AW 110,26
AW 111,27
AW 112,28
AW 113,29
AW 114,30
AW 115,31
AW 116,32
AW 117,33
AW 118,34
AW 119,35
AW 120,48
AW 121,49
AW 122,50
AW 123,51
AW 124,52
AW 125,53
AW 126,54
AW 127,55
AW 128,56
AW 129,57
AW 130,58
AW 131,59
AW 132,72
AW 133,73
AW 134,74
AW 135,75
AW 136,76
AW 137,77
AW 138,78
AW 139,79
AW 140,80
AW 141,81
AW 142,82
AW 143,83
s_add_u32 s34,s34,1
s_branch LB_w1
EB2_w1:
s_cmp_eq_u32 s34,2
s_cbranch_scc0 EB3_w1
v_mov_b32 v254,v220
LG 12
RD 208,254,0
LG 12
RD 212,254,64
LG 12
RD 216,254,128
LG 12
RD 220,254,192
LG 12
RD 192,254,256
LG 12
RD 196,254,320
LG 12
RD 200,254,384
LG 12
RD 204,254,448
LG 12
RD 224,249,0
LG 12
RD 228,249,1024
LG 12
RD 232,249,2048
LG 12
RD 236,249,3072
ds_write_b128 v249,v[96:99] offset:25600
AM 0,144
AM 1,145
AM 2,146
AM 3,147
AM 4,148
AM 5,149
AM 6,150
AM 7,151
AM 8,152
AM 9,153
AM 10,154
AM 11,155
AM 12,156
AM 13,157
AM 14,158
AM 15,159
AM 16,160
AM 17,161
AM 18,162
AM 19,163
AM 20,164
AM 21,165
AM 22,166
AM 23,167
AM 24,168
AM 25,169
AM 26,170
AM 27,171
AM 28,172
AM 29,173
AM 30,174
AM 31,175
AM 32,176
AM 33,177
AM 34,178
AM 35,179
AM 36,180
AM 37,181
AM 38,182
AM 39,183
AM 40,184
AM 41,185
AM 42,186
AM 43,187
AM 44,188
AM 45,189
AM 46,190
AM 47,191
AW 144,0
AW 145,1
AW 146,2
AW 147,3
AW 148,4
AW 149,5
AW 150,6
AW 151,7
AW 152,8
AW 153,9
AW 154,10
AW 155,11
AW 156,24
AW 157,25
AW 158,26
AW 159,27
AW 160,28
AW 161,29
AW 162,30
AW 163,31
AW 164,32
AW 165,33
AW 166,34
AW 167,35
AW 168,48
AW 169,49
AW 170,50
AW 171,51
AW 172,52
AW 173,53
AW 174,54
AW 175,55
AW 176,56
AW 177,57
AW 178,58
AW 179,59
AW 180,72
AW 181,73
AW 182,74
AW 183,75
AW 184,76
AW 185,77
AW 186,78
AW 187,79
AW 188,80
AW 189,81
AW 190,82
AW 191,83
s_add_u32 s34,s34,1
s_branch LB_w1
EB3_w1:
ds_write_b128 v249,v[96:99] offset:1024
AW 0,0
AW 1,1
AW 2,2
AW 3,3
AW 4,4
AW 5,5
AW 6,6
AW 7,7
AW 8,8
AW 9,9
AW 10,10
AW 11,11
AW 12,24
AW 13,25
AW 14,26
AW 15,27
AW 16,28
AW 17,29
AW 18,30
AW 19,31
AW 20,32
AW 21,33
AW 22,34
AW 23,35
AW 24,48
AW 25,49
AW 26,50
AW 27,51
AW 28,52
AW 29,53
AW 30,54
AW 31,55
AW 32,56
AW 33,57
AW 34,58
AW 35,59
AW 36,72
AW 37,73
AW 38,74
AW 39,75
AW 40,76
AW 41,77
AW 42,78
AW 43,79
AW 44,80
AW 45,81
AW 46,82
AW 47,83
v_mov_b32 v248,v221
s_mov_b32 s20,0
s_waitcnt vmcnt(20) lgkmcnt(0)
s_barrier
TR 192,248,0
TR 194,248,256
TR 196,248,512
TR 198,248,768
TR 200,248,16896
TR 202,248,17152
TR 204,248,17408
TR 206,248,17664
RD 224,249,16384
RD 228,249,17408
RD 232,249,18432
RD 236,249,19456
s_add_u32 s16,s12,393216
s_addc_u32 s17,s13,0
s_add_u32 s18,s12,458752
s_addc_u32 s19,s13,0
s_mov_b64 s[36:37],0
LC_w1:
LG 0
Za 0,192,48
TR 208,248,32
s_mov_b32 m0,105600
s_add_u32 s32,s14,12288
s_addc_u32 s33,s15,0
Ma 0,196,60
TR 210,248,288
Ma 0,200,72
TR 212,248,544
Ma 0,204,84
TR 214,248,800
Za 4,192,52
DW 250,16,0
s_mov_b32 m0,106400
Ma 4,196,64
TR 216,248,16928
Ma 4,200,76
TR 218,248,17184
Ma 4,204,88
TR 220,248,17440
Za 8,192,56
TR 222,248,17696
Ma 8,196,68
DW 251,16,256
s_mov_b32 m0,107200
Ma 8,200,80
TR 192,248,64
Ma 8,204,92
TR 194,248,320
LG 8
Za 12,208,48
TR 196,248,576
LG 7
Ma 12,212,60
TR 198,248,832
LG 6
Ma 12,216,72
TR 200,248,16960
LG 5
Ma 12,220,84
TR 202,248,17216
Za 16,208,52
TR 204,248,17472
Ma 16,212,64
TR 206,248,17728
Ma 16,216,76
s_mov_b64 exec,s[36:37]
global_store_dwordx4 v249,v[104:107],s[32:33] offset:0 sc1
s_mov_b64 exec,-1
Ma 16,220,88
Za 20,208,56
TR 208,248,96
Ma 20,212,68
TR 210,248,352
Ma 20,216,80
TR 212,248,608
Ma 20,220,92
DW 252,16,512
s_mov_b32 m0,108000
LG 9
Za 24,192,48
TR 214,248,864
LG 8
Ma 24,196,60
TR 216,248,16992
LG 7
Ma 24,200,72
TR 218,248,17248
LG 6
Ma 24,204,84
TR 220,248,17504
Za 28,192,52
TR 222,248,17760
Ma 28,196,64
Ma 28,200,76
DW 253,16,768
s_mov_b32 m0,122496
Ma 28,204,88
Za 32,192,56
Ma 32,196,68
Ma 32,200,80
Ma 32,204,92
Za 96,192,224
TR 192,248,128
Ma 96,196,228
s_mov_b64 exec,s[36:37]
global_store_dwordx4 v249,v[108:111],s[32:33] offset:1024 sc1
s_mov_b64 exec,-1
Ma 96,200,232
TR 194,248,384
Ma 96,204,236
TR 196,248,640
LG 9
Za 36,208,48
TR 198,248,896
LG 8
Ma 36,212,60
TR 200,248,17024
LG 7
Ma 36,216,72
TR 202,248,17280
LG 6
Ma 36,220,84
TR 204,248,17536
Za 40,208,52
DW 250,18,0
s_mov_b32 m0,123296
Ma 40,212,64
TR 206,248,17792
Ma 40,216,76
Ma 40,220,88
Za 44,208,56
Ma 44,212,68
Ma 44,216,80
Ma 44,220,92
DW 251,18,256
s_mov_b32 m0,124096
Za 100,208,224
TR 208,248,160
Ma 100,212,228
TR 210,248,416
Ma 100,216,232
TR 212,248,672
Ma 100,220,236
TR 214,248,928
LG 10
Za 48,192,48
TR 216,248,17056
LG 9
Ma 48,196,60
TR 218,248,17312
LG 8
Ma 48,200,72
s_mov_b64 exec,s[36:37]
global_store_dwordx4 v249,v[112:115],s[32:33] offset:2048 sc1
s_mov_b64 exec,-1
LG 6
Ma 48,204,84
TR 220,248,17568
Za 52,192,52
TR 222,248,17824
Ma 52,196,64
Ma 52,200,76
Ma 52,204,88
Za 56,192,56
TR 192,248,192
Ma 56,196,68
DW 252,18,512
s_mov_b32 m0,124896
Ma 56,200,80
TR 194,248,448
Ma 56,204,92
TR 196,248,704
LG 9
Za 60,208,48
TR 198,248,960
LG 8
Ma 60,212,60
TR 200,248,17088
LG 7
Ma 60,216,72
TR 202,248,17344
LG 6
Ma 60,220,84
TR 204,248,17600
Za 64,208,52
TR 206,248,17856
Ma 64,212,64
DW 253,18,768
s_mov_b32 m0,4224
Ma 64,216,76
Ma 64,220,88
Za 68,208,56
TR 208,248,224
Ma 68,212,68
TR 210,248,480
Ma 68,216,80
TR 212,248,736
Ma 68,220,92
TR 214,248,992
LG 10
Za 72,192,48
TR 216,248,17120
LG 9
Ma 72,196,60
TR 218,248,17376
LG 8
Ma 72,200,72
TR 220,248,17632
LG 7
Ma 72,204,84
TR 222,248,17888
Za 76,192,52
Ma 76,196,64
Ma 76,200,76
Ma 76,204,88
Za 80,192,56
Ma 80,196,68
Ma 80,200,80
Ma 80,204,92
LG 6
Za 84,208,48
LG 4
Ma 84,212,60
LG 2
Ma 84,216,72
LG 0
Ma 84,220,84
s_waitcnt vmcnt(19) lgkmcnt(0)
s_barrier
s_cmp_eq_u32 s20,3
s_cbranch_scc1 Calt1_w1
s_add_u32 s16,s12,256
s_addc_u32 s17,s13,0
s_add_u32 s18,s12,65792
s_addc_u32 s19,s13,0
Calt1_r_w1:
Za 88,208,52
TR 192,248,33792
Ma 88,212,64
TR 194,248,34048
Ma 88,216,76
TR 196,248,34304
Ma 88,220,88
TR 198,248,34560
Za 92,208,56
TR 200,248,50688
TR 202,248,50944
Ma 92,212,68
TR 204,248,51200
TR 206,248,51456
Ma 92,216,80
DW 250,16,0
s_mov_b32 m0,5024
Ma 92,220,92
RD 224,249,20480
LG 7
Ma 0,192,96
RD 228,249,21504
LG 6
Ma 0,196,108
RD 232,249,22528
LG 5
Ma 0,200,120
RD 236,249,23552
LG 4
Ma 0,204,132
TR 208,248,33824
Ma 4,192,100
TR 210,248,34080
Ma 4,196,112
TR 212,248,34336
Ma 4,200,124
TR 214,248,34592
Ma 4,204,136
DW 251,16,256
s_mov_b32 m0,5824
Ma 8,192,104
TR 216,248,50720
TR 218,248,50976
Ma 8,196,116
TR 220,248,51232
TR 222,248,51488
Ma 8,200,128
s_mov_b64 exec,s[36:37]
global_store_dwordx4 v249,v[116:119],s[32:33] offset:3072 sc1
s_mov_b64 exec,-1
s_add_u32 s32,s14,16384
s_addc_u32 s33,s15,0
Ma 8,204,140
TR 192,248,33856
LG 7
Ma 12,208,96
TR 194,248,34112
LG 6
Ma 12,212,108
TR 196,248,34368
LG 5
Ma 12,216,120
TR 198,248,34624
LG 4
Ma 12,220,132
TR 200,248,50752
Ma 16,208,100
TR 202,248,51008
Ma 16,212,112
TR 204,248,51264
Ma 16,216,124
TR 206,248,51520
Ma 16,220,136
DW 252,16,512
s_mov_b32 m0,6624
Ma 20,208,104
TR 208,248,33888
Ma 20,212,116
TR 210,248,34144
Ma 20,216,128
TR 212,248,34400
Ma 20,220,140
DW 253,16,768
s_mov_b32 m0,21120
LG 9
Ma 24,192,96
TR 214,248,34656
LG 8
Ma 24,196,108
TR 216,248,50784
LG 7
Ma 24,200,120
TR 218,248,51040
LG 6
Ma 24,204,132
TR 220,248,51296
Ma 28,192,100
TR 222,248,51552
Ma 28,196,112
Ma 28,200,124
s_mov_b64 exec,s[36:37]
global_store_dwordx4 v249,v[120:123],s[32:33] offset:0 sc1
s_mov_b64 exec,-1
Ma 28,204,136
Ma 32,192,104
Ma 32,196,116
Ma 32,200,128
Ma 32,204,140
Ma 96,192,224
TR 192,248,33920
Ma 96,196,228
DW 250,18,0
s_mov_b32 m0,21920
Ma 96,200,232
TR 194,248,34176
Ma 96,204,236
TR 196,248,34432
LG 9
Ma 36,208,96
TR 198,248,34688
LG 8
Ma 36,212,108
TR 200,248,50816
LG 7
Ma 36,216,120
TR 202,248,51072
LG 6
Ma 36,220,132
TR 204,248,51328
Ma 40,208,100
DW 251,18,256
s_mov_b32 m0,22720
Ma 40,212,112
TR 206,248,51584
Ma 40,216,124
Ma 40,220,136
Ma 44,208,104
Ma 44,212,116
Ma 44,216,128
Ma 44,220,140
s_mov_b64 exec,s[36:37]
global_store_dwordx4 v249,v[124:127],s[32:33] offset:1024 sc1
s_mov_b64 exec,-1
Ma 100,208,224
TR 208,248,33952
Ma 100,212,228
TR 210,248,34208
Ma 100,216,232
TR 212,248,34464
Ma 100,220,236
TR 214,248,34720
LG 10
Ma 48,192,96
TR 216,248,50848
LG 9
Ma 48,196,108
TR 218,248,51104
LG 8
Ma 48,200,120
DW 252,18,512
s_mov_b32 m0,23520
LG 6
Ma 48,204,132
TR 220,248,51360
Ma 52,192,100
TR 222,248,51616
Ma 52,196,112
Ma 52,200,124
Ma 52,204,136
Ma 56,192,104
TR 192,248,33984
Ma 56,196,116
DW 253,18,768
s_mov_b32 m0,38016
Ma 56,200,128
TR 194,248,34240
Ma 56,204,140
TR 196,248,34496
LG 9
Ma 60,208,96
TR 198,248,34752
LG 8
Ma 60,212,108
TR 200,248,50880
LG 7
Ma 60,216,120
TR 202,248,51136
LG 6
Ma 60,220,132
TR 204,248,51392
Ma 64,208,100
TR 206,248,51648
Ma 64,212,112
s_mov_b64 exec,s[36:37]
global_store_dwordx4 v249,v[128:131],s[32:33] offset:2048 sc1
s_mov_b64 exec,-1
Ma 64,216,124
Ma 64,220,136
Ma 68,208,104
TR 208,248,34016
Ma 68,212,116
TR 210,248,34272
Ma 68,216,128
TR 212,248,34528
Ma 68,220,140
TR 214,248,34784
LG 10
Ma 72,192,96
TR 216,248,50912
LG 9
Ma 72,196,108
TR 218,248,51168
LG 8
Ma 72,200,120
TR 220,248,51424
LG 7
Ma 72,204,132
TR 222,248,51680
v_add_u32 v248,67584,v248
Ma 76,192,100
Ma 76,196,112
Ma 76,200,124
Ma 76,204,136
Ma 80,192,104
Ma 80,196,116
Ma 80,200,128
Ma 80,204,140
LG 6
Ma 84,208,96
LG 4
Ma 84,212,108
LG 2
Ma 84,216,120
LG 0
Ma 84,220,132
s_waitcnt vmcnt(20) lgkmcnt(0)
s_barrier
s_cmp_eq_u32 s20,3
s_cbranch_scc1 Calt2_w1
s_add_u32 s16,s12,131328
s_addc_u32 s17,s13,0
s_add_u32 s18,s12,196864
s_addc_u32 s19,s13,0
Calt2_r_w1:
Ma 88,208,100
TR 192,248,0
Ma 88,212,112
TR 194,248,256
Ma 88,216,124
TR 196,248,512
Ma 88,220,136
TR 198,248,768
Ma 92,208,104
TR 200,248,16896
TR 202,248,17152
Ma 92,212,116
TR 204,248,17408
TR 206,248,17664
Ma 92,216,128
DW 250,16,0
s_mov_b32 m0,38816
Ma 92,220,140
RD 224,249,24576
LG 7
Ma 0,192,144
RD 228,249,25600
LG 6
Ma 0,196,156
RD 232,249,26624
LG 5
Ma 0,200,168
RD 236,249,27648
LG 4
Ma 0,204,180
TR 208,248,32
Ma 4,192,148
TR 210,248,288
Ma 4,196,160
TR 212,248,544
Ma 4,200,172
TR 214,248,800
Ma 4,204,184
DW 251,16,256
s_mov_b32 m0,39616
Ma 8,192,152
TR 216,248,16928
TR 218,248,17184
Ma 8,196,164
TR 220,248,17440
TR 222,248,17696
Ma 8,200,176
s_mov_b64 exec,s[36:37]
global_store_dwordx4 v249,v[132:135],s[32:33] offset:3072 sc1
s_mov_b64 exec,-1
s_add_u32 s32,s14,20480
s_addc_u32 s33,s15,0
Ma 8,204,188
TR 192,248,64
LG 7
Ma 12,208,144
TR 194,248,320
LG 6
Ma 12,212,156
TR 196,248,576
LG 5
Ma 12,216,168
TR 198,248,832
LG 4
Ma 12,220,180
TR 200,248,16960
Ma 16,208,148
TR 202,248,17216
Ma 16,212,160
TR 204,248,17472
Ma 16,216,172
TR 206,248,17728
Ma 16,220,184
DW 252,16,512
s_mov_b32 m0,40416
Ma 20,208,152
TR 208,248,96
Ma 20,212,164
TR 210,248,352
Ma 20,216,176
TR 212,248,608
Ma 20,220,188
DW 253,16,768
s_mov_b32 m0,54912
LG 9
Ma 24,192,144
TR 214,248,864
LG 8
Ma 24,196,156
TR 216,248,16992
LG 7
Ma 24,200,168
TR 218,248,17248
LG 6
Ma 24,204,180
TR 220,248,17504
Ma 28,192,148
TR 222,248,17760
Ma 28,196,160
Ma 28,200,172
s_mov_b64 exec,s[36:37]
global_store_dwordx4 v249,v[136:139],s[32:33] offset:0 sc1
s_mov_b64 exec,-1
Ma 28,204,184
Ma 32,192,152
Ma 32,196,164
Ma 32,200,176
Ma 32,204,188
Ma 96,192,224
TR 192,248,128
Ma 96,196,228
DW 250,18,0
s_mov_b32 m0,55712
Ma 96,200,232
TR 194,248,384
Ma 96,204,236
TR 196,248,640
LG 9
Ma 36,208,144
TR 198,248,896
LG 8
Ma 36,212,156
TR 200,248,17024
LG 7
Ma 36,216,168
TR 202,248,17280
LG 6
Ma 36,220,180
TR 204,248,17536
Ma 40,208,148
DW 251,18,256
s_mov_b32 m0,56512
Ma 40,212,160
TR 206,248,17792
Ma 40,216,172
Ma 40,220,184
Ma 44,208,152
Ma 44,212,164
Ma 44,216,176
Ma 44,220,188
s_mov_b64 exec,s[36:37]
global_store_dwordx4 v249,v[140:143],s[32:33] offset:1024 sc1
s_mov_b64 exec,-1
Ma 100,208,224
TR 208,248,160
Ma 100,212,228
TR 210,248,416
Ma 100,216,232
TR 212,248,672
Ma 100,220,236
TR 214,248,928
LG 10
Ma 48,192,144
TR 216,248,17056
LG 9
Ma 48,196,156
TR 218,248,17312
LG 8
Ma 48,200,168
DW 252,18,512
s_mov_b32 m0,57312
LG 6
Ma 48,204,180
TR 220,248,17568
Ma 52,192,148
TR 222,248,17824
Ma 52,196,160
Ma 52,200,172
Ma 52,204,184
Ma 56,192,152
TR 192,248,192
Ma 56,196,164
DW 253,18,768
s_mov_b32 m0,71808
Ma 56,200,176
TR 194,248,448
Ma 56,204,188
TR 196,248,704
LG 9
Ma 60,208,144
TR 198,248,960
LG 8
Ma 60,212,156
TR 200,248,17088
LG 7
Ma 60,216,168
TR 202,248,17344
LG 6
Ma 60,220,180
TR 204,248,17600
Ma 64,208,148
TR 206,248,17856
Ma 64,212,160
Ma 64,216,172
Ma 64,220,184
Ma 68,208,152
TR 208,248,224
Ma 68,212,164
TR 210,248,480
Ma 68,216,176
TR 212,248,736
Ma 68,220,188
TR 214,248,992
LG 10
Ma 72,192,144
TR 216,248,17120
LG 9
Ma 72,196,156
TR 218,248,17376
LG 8
Ma 72,200,168
TR 220,248,17632
LG 7
Ma 72,204,180
TR 222,248,17888
Ma 76,192,148
Ma 76,196,160
Ma 76,200,172
Ma 76,204,184
Ma 80,192,152
Ma 80,196,164
Ma 80,200,176
Ma 80,204,188
LG 6
Ma 84,208,144
LG 4
Ma 84,212,156
LG 2
Ma 84,216,168
LG 0
Ma 84,220,180
s_waitcnt vmcnt(16) lgkmcnt(0)
s_barrier
s_cmp_eq_u32 s20,3
s_cbranch_scc1 Calt3_w1
s_add_u32 s16,s12,262400
s_addc_u32 s17,s13,0
s_add_u32 s18,s12,327936
s_addc_u32 s19,s13,0
Calt3_r_w1:
Ma 88,208,148
TR 192,248,33792
Ma 88,212,160
TR 194,248,34048
Ma 88,216,172
TR 196,248,34304
Ma 88,220,184
TR 198,248,34560
Ma 92,208,152
TR 200,248,50688
TR 202,248,50944
Ma 92,212,164
TR 204,248,51200
TR 206,248,51456
Ma 92,216,176
DW 250,16,0
s_mov_b32 m0,72608
Ma 92,220,188
RD 224,249,0
LG 7
Ma 0,192,0
RD 228,249,1024
LG 6
Ma 0,196,12
RD 232,249,2048
LG 5
Ma 0,200,24
RD 236,249,3072
LG 4
Ma 0,204,36
TR 208,248,33824
Ma 4,192,4
TR 210,248,34080
Ma 4,196,16
TR 212,248,34336
Ma 4,200,28
TR 214,248,34592
s_nop 0
CV 104,0,1
Ma 4,204,40
DW 251,16,256
s_mov_b32 m0,73408
Ma 8,192,8
TR 216,248,50720
TR 218,248,50976
Ma 8,196,20
TR 220,248,51232
TR 222,248,51488
Ma 8,200,32
s_mov_b64 exec,s[36:37]
global_store_dwordx4 v249,v[144:147],s[32:33] offset:2048 sc1
s_mov_b64 exec,-1
Ma 8,204,44
TR 192,248,33856
CV 105,2,3
LG 7
Ma 12,208,0
TR 194,248,34112
CV 120,4,5
LG 6
Ma 12,212,12
TR 196,248,34368
CV 121,6,7
LG 5
Ma 12,216,24
TR 198,248,34624
CV 136,8,9
LG 4
Ma 12,220,36
TR 200,248,50752
CV 137,10,11
Ma 16,208,4
TR 202,248,51008
Ma 16,212,16
TR 204,248,51264
Ma 16,216,28
TR 206,248,51520
CV 106,12,13
Ma 16,220,40
DW 252,16,512
s_mov_b32 m0,74208
Ma 20,208,8
TR 208,248,33888
CV 107,14,15
Ma 20,212,20
TR 210,248,34144
Ma 20,216,32
TR 212,248,34400
CV 122,16,17
Ma 20,220,44
DW 253,16,768
s_mov_b32 m0,88704
LG 9
Ma 24,192,0
TR 214,248,34656
CV 123,18,19
LG 8
Ma 24,196,12
TR 216,248,50784
LG 7
Ma 24,200,24
TR 218,248,51040
CV 138,20,21
LG 6
Ma 24,204,36
TR 220,248,51296
CV 139,22,23
Ma 28,192,4
TR 222,248,51552
Ma 28,196,16
Ma 28,200,28
s_mov_b64 exec,s[36:37]
global_store_dwordx4 v249,v[148:151],s[32:33] offset:3072 sc1
s_mov_b64 exec,-1
s_add_u32 s32,s14,49152
s_addc_u32 s33,s15,0
Ma 28,204,40
CV 108,24,25
CV 109,26,27
Ma 32,192,8
Ma 32,196,20
Ma 32,200,32
s_nop 2
CV 124,28,29
CV 125,30,31
Ma 32,204,44
Ma 96,192,224
TR 192,248,33920
Ma 96,196,228
DW 250,18,0
s_mov_b32 m0,89504
Ma 96,200,232
TR 194,248,34176
s_nop 1
CV 140,32,33
Ma 96,204,236
TR 196,248,34432
CV 141,34,35
LG 9
Ma 36,208,0
TR 198,248,34688
LG 8
Ma 36,212,12
TR 200,248,50816
LG 7
Ma 36,216,24
TR 202,248,51072
LG 6
Ma 36,220,36
TR 204,248,51328
Ma 40,208,4
DW 251,18,256
s_mov_b32 m0,90304
Ma 40,212,16
TR 206,248,51584
Ma 40,216,28
s_nop 1
CV 110,36,37
CV 111,38,39
Ma 40,220,40
Ma 44,208,8
Ma 44,212,20
Ma 44,216,32
s_nop 4
CV 126,40,41
CV 127,42,43
Ma 44,220,44
s_mov_b64 exec,s[36:37]
global_store_dwordx4 v249,v[152:155],s[32:33] offset:1024 sc1
s_mov_b64 exec,-1
Ma 100,208,224
TR 208,248,33952
CV 152,96,97
Ma 100,212,228
TR 210,248,34208
CV 153,98,99
Ma 100,216,232
TR 212,248,34464
CV 142,44,45
Ma 100,220,236
TR 214,248,34720
CV 143,46,47
LG 10
Ma 48,192,0
TR 216,248,50848
LG 9
Ma 48,196,12
TR 218,248,51104
LG 8
Ma 48,200,24
DW 252,18,512
s_mov_b32 m0,91104
LG 6
Ma 48,204,36
TR 220,248,51360
CV 154,100,101
Ma 52,192,4
TR 222,248,51616
CV 155,102,103
Ma 52,196,16
Ma 52,200,28
s_nop 0
CV 112,48,49
CV 113,50,51
Ma 52,204,40
Ma 56,192,8
TR 192,248,33984
Ma 56,196,20
DW 253,18,768
Ma 56,200,32
TR 194,248,34240
s_nop 1
CV 128,52,53
Ma 56,204,44
TR 196,248,34496
CV 129,54,55
LG 9
Ma 60,208,0
TR 198,248,34752
LG 8
Ma 60,212,12
TR 200,248,50880
LG 7
Ma 60,216,24
TR 202,248,51136
CV 144,56,57
LG 6
Ma 60,220,36
TR 204,248,51392
CV 145,58,59
Ma 64,208,4
TR 206,248,51648
Ma 64,212,16
Ma 64,216,28
s_nop 1
CV 114,60,61
CV 115,62,63
Ma 64,220,40
Ma 68,208,8
TR 208,248,34016
Ma 68,212,20
TR 210,248,34272
Ma 68,216,32
TR 212,248,34528
s_nop 1
CV 130,64,65
Ma 68,220,44
TR 214,248,34784
CV 131,66,67
LG 10
Ma 72,192,0
TR 216,248,50912
LG 9
Ma 72,196,12
TR 218,248,51168
LG 8
Ma 72,200,24
TR 220,248,51424
CV 146,68,69
LG 7
Ma 72,204,36
TR 222,248,51680
v_add_u32 v248,4294899712,v248
Ma 76,192,4
CV 147,70,71
Ma 76,196,16
Ma 76,200,28
s_nop 1
CV 116,72,73
CV 117,74,75
Ma 76,204,40
Ma 80,192,8
Ma 80,196,20
Ma 80,200,32
s_nop 4
CV 132,76,77
CV 133,78,79
Ma 80,204,44
LG 6
Ma 84,208,0
LG 4
Ma 84,212,12
LG 2
Ma 84,216,24
s_nop 1
CV 148,80,81
CV 149,82,83
LG 0
Ma 84,220,36
s_waitcnt vmcnt(16) lgkmcnt(0)
s_barrier
s_cmp_eq_u32 s20,3
s_cbranch_scc1 Calt4_w1
s_add_u32 s16,s12,393472
s_addc_u32 s17,s13,0
s_add_u32 s18,s12,459008
s_addc_u32 s19,s13,0
Calt4_r_w1:
Ma 88,208,4
TR 192,248,0
Ma 88,212,16
TR 194,248,256
Ma 88,216,28
TR 196,248,512
TR 198,248,768
Ma 88,220,40
TR 200,248,16896
TR 202,248,17152
Ma 92,208,8
TR 204,248,17408
TR 206,248,17664
Ma 92,212,20
RD 224,249,16384
RD 228,249,17408
Ma 92,216,32
RD 232,249,18432
RD 236,249,19456
Ma 92,220,44
CV 118,84,85
CV 119,86,87
CV 134,88,89
CV 135,90,91
s_nop 3
CV 150,92,93
CV 151,94,95
s_add_u32 s12,s12,256
s_addc_u32 s13,s13,0
s_cmp_eq_u32 s20,0
s_cselect_b32 s28,0,53248
s_add_u32 s14,s14,s28
s_addc_u32 s15,s15,0
s_mov_b64 s[36:37],-1
s_add_u32 s20,s20,1
s_cmp_lg_u32 s20,4
s_cbranch_scc1 LC_w1
s_add_u32 s32,s14,12288
s_addc_u32 s33,s15,0
global_store_dwordx4 v249,v[104:107],s[32:33] offset:0 sc1
global_store_dwordx4 v249,v[108:111],s[32:33] offset:1024 sc1
global_store_dwordx4 v249,v[112:115],s[32:33] offset:2048 sc1
global_store_dwordx4 v249,v[116:119],s[32:33] offset:3072 sc1
s_add_u32 s32,s14,16384
s_addc_u32 s33,s15,0
global_store_dwordx4 v249,v[120:123],s[32:33] offset:0 sc1
global_store_dwordx4 v249,v[124:127],s[32:33] offset:1024 sc1
global_store_dwordx4 v249,v[128:131],s[32:33] offset:2048 sc1
global_store_dwordx4 v249,v[132:135],s[32:33] offset:3072 sc1
s_add_u32 s32,s14,20480
s_addc_u32 s33,s15,0
global_store_dwordx4 v249,v[136:139],s[32:33] offset:0 sc1
global_store_dwordx4 v249,v[140:143],s[32:33] offset:1024 sc1
global_store_dwordx4 v249,v[144:147],s[32:33] offset:2048 sc1
global_store_dwordx4 v249,v[148:151],s[32:33] offset:3072 sc1
s_add_u32 s32,s14,49152
s_addc_u32 s33,s15,0
global_store_dwordx4 v249,v[152:155],s[32:33] offset:1024 sc1
s_waitcnt vmcnt(0) lgkmcnt(0)
s_waitcnt vmcnt(0) lgkmcnt(0)
s_endpgm
ProK_w1:
s_nop 1
v_subrev_u32 v255,135168,v249
v_and_b32 v250,0xf0,v255
v_lshrrev_b32 v255,8,v255
v_lshl_add_u32 v250,v255,14,v250
v_add_u32 v251,768,v250
v_add_u32 v252,1536,v250
v_add_u32 v253,2304,v250
s_mul_hi_u32 s28,s22,254201
s_lshl_b32 s28,s28,16
s_add_u32 s16,s12,s28
s_addc_u32 s17,s13,0
s_cmp_ge_u32 s21,29
s_cbranch_scc0 ProK_r_w1
v_subrev_u32 v255,135168,v249
v_and_b32 v216,0xf0,v255
v_lshrrev_b32 v255,8,v255
v_lshl_add_u32 v216,v255,14,v216
v_add_u32 v217,768,v216
v_add_u32 v218,1536,v216
v_add_u32 v219,2304,v216
s_mul_hi_u32 s28,s25,254201
s_lshl_b32 s28,s28,16
s_add_u32 s18,s12,s28
s_addc_u32 s19,s13,0
s_nop 1
s_branch ProK_r_w1
It0K_w1:
s_nop 1
v_subrev_u32 v255,135168,v249
v_and_b32 v250,0xf0,v255
v_lshrrev_b32 v255,8,v255
v_lshl_add_u32 v250,v255,14,v250
v_add_u32 v251,768,v250
v_add_u32 v252,1536,v250
v_add_u32 v253,2304,v250
s_mul_hi_u32 s28,s23,254201
s_lshl_b32 s28,s28,16
s_add_u32 s16,s12,s28
s_addc_u32 s17,s13,0
s_cmp_ge_u32 s21,29
s_cbranch_scc0 It0K_r_w1
v_subrev_u32 v255,135168,v249
v_and_b32 v216,0xf0,v255
v_lshrrev_b32 v255,8,v255
v_lshl_add_u32 v216,v255,14,v216
v_add_u32 v217,768,v216
v_add_u32 v218,1536,v216
v_add_u32 v219,2304,v216
s_mul_hi_u32 s28,s24,254201
s_lshl_b32 s28,s28,16
s_add_u32 s18,s12,s28
s_addc_u32 s19,s13,0
s_nop 1
s_branch It0K_r_w1
ItOK_w1:
s_nop 1
v_subrev_u32 v255,135168,v249
v_and_b32 v250,0xf0,v255
v_lshrrev_b32 v255,8,v255
v_lshl_add_u32 v250,v255,14,v250
v_add_u32 v251,768,v250
v_add_u32 v252,1536,v250
v_add_u32 v253,2304,v250
s_mul_hi_u32 s28,s22,254201
s_lshl_b32 s28,s28,16
s_add_u32 s16,s12,s28
s_addc_u32 s17,s13,0
s_cmp_ge_u32 s21,29
s_cbranch_scc0 ItOK_r_w1
v_subrev_u32 v255,135168,v249
v_and_b32 v216,0xf0,v255
v_lshrrev_b32 v255,8,v255
v_lshl_add_u32 v216,v255,14,v216
v_add_u32 v217,768,v216
v_add_u32 v218,1536,v216
v_add_u32 v219,2304,v216
s_mul_hi_u32 s28,s25,254201
s_lshl_b32 s28,s28,16
s_add_u32 s18,s12,s28
s_addc_u32 s19,s13,0
s_nop 1
s_branch ItOK_r_w1
ItEK_w1:
s_nop 1
v_subrev_u32 v255,135168,v249
v_and_b32 v250,0xf0,v255
v_lshrrev_b32 v255,8,v255
v_lshl_add_u32 v250,v255,14,v250
v_add_u32 v251,768,v250
v_add_u32 v252,1536,v250
v_add_u32 v253,2304,v250
s_mul_hi_u32 s28,s23,254201
s_lshl_b32 s28,s28,16
s_add_u32 s16,s12,s28
s_addc_u32 s17,s13,0
s_cmp_ge_u32 s21,29
s_cbranch_scc0 ItEK_r_w1
v_subrev_u32 v255,135168,v249
v_and_b32 v216,0xf0,v255
v_lshrrev_b32 v255,8,v255
v_lshl_add_u32 v216,v255,14,v216
v_add_u32 v217,768,v216
v_add_u32 v218,1536,v216
v_add_u32 v219,2304,v216
s_mul_hi_u32 s28,s24,254201
s_lshl_b32 s28,s28,16
s_add_u32 s18,s12,s28
s_addc_u32 s19,s13,0
s_nop 1
s_branch ItEK_r_w1
SLOW_w1:
s_nop 1
LG 0
s_add_u32 m0,s48,4224
s_nop 0
DM 250,16,0
s_add_u32 m0,m0,800
s_nop 0
DM 251,16,256
s_add_u32 m0,m0,800
s_nop 0
DM 252,16,512
s_add_u32 m0,m0,800
s_nop 0
DM 253,16,768
s_add_u32 s16,s16,16384
s_addc_u32 s17,s17,0
s_add_u32 m0,s49,4224
s_nop 0
DM 216,18,0
s_add_u32 m0,m0,800
s_nop 0
DM 217,18,256
s_add_u32 m0,m0,800
s_nop 0
DM 218,18,512
s_add_u32 m0,m0,800
s_nop 0
DM 219,18,768
s_add_u32 s18,s18,16384
s_addc_u32 s19,s19,0
v_subrev_u32 v230,135168,v249
v_lshrrev_b32 v230,4,v230
v_and_b32 v231,15,v230
v_lshrrev_b32 v230,4,v230
v_lshlrev_b32 v228,8,v231
v_lshl_add_u32 v228,v230,4,v228
v_lshlrev_b32 v229,10,v230
v_lshl_add_u32 v229,v231,1,v229
s_lshl_b32 s80,s34,17
s_add_u32 s72,s6,s80
s_addc_u32 s73,s7,0
s_sub_u32 s72,s72,1024
s_subb_u32 s73,s73,0
v_mov_b32 v232,0xff800000
v_mov_b32 v233,0xff800000
v_mov_b32 v234,0xff800000
v_mov_b32 v235,0xff800000
s_mov_b32 s80,0
SL1_w1:
global_load_dwordx4 v[152:155],v228,s[72:73] offset:0
global_load_dwordx4 v[156:159],v228,s[72:73] offset:64
global_load_dwordx4 v[160:163],v228,s[72:73] offset:128
global_load_dwordx4 v[164:167],v228,s[72:73] offset:192
s_waitcnt vmcnt(0)
v_mfma_f32_16x16x32_bf16 v[120:123],v[152:155],a[0:3],0
v_mfma_f32_16x16x32_bf16 v[120:123],v[156:159],a[12:15],v[120:123]
v_mfma_f32_16x16x32_bf16 v[120:123],v[160:163],a[24:27],v[120:123]
v_mfma_f32_16x16x32_bf16 v[120:123],v[164:167],a[36:39],v[120:123]
v_mfma_f32_16x16x32_bf16 v[124:127],v[152:155],a[4:7],0
v_mfma_f32_16x16x32_bf16 v[124:127],v[156:159],a[16:19],v[124:127]
v_mfma_f32_16x16x32_bf16 v[124:127],v[160:163],a[28:31],v[124:127]
v_mfma_f32_16x16x32_bf16 v[124:127],v[164:167],a[40:43],v[124:127]
v_mfma_f32_16x16x32_bf16 v[128:131],v[152:155],a[8:11],0
v_mfma_f32_16x16x32_bf16 v[128:131],v[156:159],a[20:23],v[128:131]
v_mfma_f32_16x16x32_bf16 v[128:131],v[160:163],a[32:35],v[128:131]
v_mfma_f32_16x16x32_bf16 v[128:131],v[164:167],a[44:47],v[128:131]
v_mfma_f32_16x16x32_bf16 v[132:135],v[152:155],a[224:227],0
v_mfma_f32_16x16x32_bf16 v[132:135],v[156:159],a[228:231],v[132:135]
v_mfma_f32_16x16x32_bf16 v[132:135],v[160:163],a[232:235],v[132:135]
v_mfma_f32_16x16x32_bf16 v[132:135],v[164:167],a[236:239],v[132:135]
v_max3_f32 v232,v232,v120,v121
v_max3_f32 v232,v232,v122,v123
v_max3_f32 v233,v233,v124,v125
v_max3_f32 v233,v233,v126,v127
v_max3_f32 v234,v234,v128,v129
v_max3_f32 v234,v234,v130,v131
s_nop 1
v_max3_f32 v235,v235,v132,v133
v_max3_f32 v235,v235,v134,v135
s_add_u32 s72,s72,4096
s_addc_u32 s73,s73,0
s_add_u32 s80,s80,1
s_cmp_lg_u32 s80,32
s_cbranch_scc1 SL1_w1
v_mov_b32 v200,v232
v_mov_b32 v201,v200
s_nop 1
v_permlane16_swap_b32 v200,v201
v_max_f32 v200,v200,v201
v_mov_b32 v201,v200
s_nop 1
v_permlane32_swap_b32 v200,v201
v_max_f32 v200,v200,v201
v_mul_f32 v200,-1.0,v200
v_mov_b32 v201,v200
v_mov_b32 v202,v200
v_mov_b32 v203,v200
v_mov_b32 v204,v233
v_mov_b32 v205,v204
s_nop 1
v_permlane16_swap_b32 v204,v205
v_max_f32 v204,v204,v205
v_mov_b32 v205,v204
s_nop 1
v_permlane32_swap_b32 v204,v205
v_max_f32 v204,v204,v205
v_mul_f32 v204,-1.0,v204
v_mov_b32 v205,v204
v_mov_b32 v206,v204
v_mov_b32 v207,v204
v_mov_b32 v208,v234
v_mov_b32 v209,v208
s_nop 1
v_permlane16_swap_b32 v208,v209
v_max_f32 v208,v208,v209
v_mov_b32 v209,v208
s_nop 1
v_permlane32_swap_b32 v208,v209
v_max_f32 v208,v208,v209
v_mul_f32 v208,-1.0,v208
v_mov_b32 v209,v208
v_mov_b32 v210,v208
v_mov_b32 v211,v208
v_mov_b32 v212,v235
v_mov_b32 v213,v212
s_nop 1
v_permlane16_swap_b32 v212,v213
v_max_f32 v212,v212,v213
v_mov_b32 v213,v212
s_nop 1
v_permlane32_swap_b32 v212,v213
v_max_f32 v212,v212,v213
v_mul_f32 v212,-1.0,v212
v_mov_b32 v213,v212
v_mov_b32 v214,v212
v_mov_b32 v215,v212
s_lshl_b32 s80,s34,17
s_add_u32 s72,s6,s80
s_addc_u32 s73,s7,0
s_sub_u32 s72,s72,1024
s_subb_u32 s73,s73,0
s_lshl_b32 s80,s34,17
s_add_u32 s76,s8,s80
s_addc_u32 s77,s9,0
s_sub_u32 s76,s76,1024
s_subb_u32 s77,s77,0
v_mov_b32 v0,0
v_mov_b32 v1,0
v_mov_b32 v2,0
v_mov_b32 v3,0
v_mov_b32 v4,0
v_mov_b32 v5,0
v_mov_b32 v6,0
v_mov_b32 v7,0
v_mov_b32 v8,0
v_mov_b32 v9,0
v_mov_b32 v10,0
v_mov_b32 v11,0
v_mov_b32 v12,0
v_mov_b32 v13,0
v_mov_b32 v14,0
v_mov_b32 v15,0
v_mov_b32 v16,0
v_mov_b32 v17,0
v_mov_b32 v18,0
v_mov_b32 v19,0
v_mov_b32 v20,0
v_mov_b32 v21,0
v_mov_b32 v22,0
v_mov_b32 v23,0
v_mov_b32 v24,0
v_mov_b32 v25,0
v_mov_b32 v26,0
v_mov_b32 v27,0
v_mov_b32 v28,0
v_mov_b32 v29,0
v_mov_b32 v30,0
v_mov_b32 v31,0
v_mov_b32 v32,0
v_mov_b32 v33,0
v_mov_b32 v34,0
v_mov_b32 v35,0
v_mov_b32 v36,0
v_mov_b32 v37,0
v_mov_b32 v38,0
v_mov_b32 v39,0
v_mov_b32 v40,0
v_mov_b32 v41,0
v_mov_b32 v42,0
v_mov_b32 v43,0
v_mov_b32 v44,0
v_mov_b32 v45,0
v_mov_b32 v46,0
v_mov_b32 v47,0
v_mov_b32 v48,0
v_mov_b32 v49,0
v_mov_b32 v50,0
v_mov_b32 v51,0
v_mov_b32 v52,0
v_mov_b32 v53,0
v_mov_b32 v54,0
v_mov_b32 v55,0
v_mov_b32 v56,0
v_mov_b32 v57,0
v_mov_b32 v58,0
v_mov_b32 v59,0
v_mov_b32 v60,0
v_mov_b32 v61,0
v_mov_b32 v62,0
v_mov_b32 v63,0
v_mov_b32 v64,0
v_mov_b32 v65,0
v_mov_b32 v66,0
v_mov_b32 v67,0
v_mov_b32 v68,0
v_mov_b32 v69,0
v_mov_b32 v70,0
v_mov_b32 v71,0
v_mov_b32 v72,0
v_mov_b32 v73,0
v_mov_b32 v74,0
v_mov_b32 v75,0
v_mov_b32 v76,0
v_mov_b32 v77,0
v_mov_b32 v78,0
v_mov_b32 v79,0
v_mov_b32 v80,0
v_mov_b32 v81,0
v_mov_b32 v82,0
v_mov_b32 v83,0
v_mov_b32 v84,0
v_mov_b32 v85,0
v_mov_b32 v86,0
v_mov_b32 v87,0
v_mov_b32 v88,0
v_mov_b32 v89,0
v_mov_b32 v90,0
v_mov_b32 v91,0
v_mov_b32 v92,0
v_mov_b32 v93,0
v_mov_b32 v94,0
v_mov_b32 v95,0
v_mov_b32 v96,0
v_mov_b32 v97,0
v_mov_b32 v98,0
v_mov_b32 v99,0
v_mov_b32 v100,0
v_mov_b32 v101,0
v_mov_b32 v102,0
v_mov_b32 v103,0
v_mov_b32 v104,0
v_mov_b32 v105,0
v_mov_b32 v106,0
v_mov_b32 v107,0
v_mov_b32 v108,0
v_mov_b32 v109,0
v_mov_b32 v110,0
v_mov_b32 v111,0
v_mov_b32 v112,0
v_mov_b32 v113,0
v_mov_b32 v114,0
v_mov_b32 v115,0
v_mov_b32 v116,0
v_mov_b32 v117,0
v_mov_b32 v118,0
v_mov_b32 v119,0
s_mov_b32 s80,0
SL2_w1:
s_add_u32 s74,s72,4096
s_addc_u32 s75,s73,0
s_add_u32 s78,s76,4096
s_addc_u32 s79,s77,0
global_load_dwordx4 v[152:155],v228,s[72:73] offset:0
global_load_dwordx4 v[156:159],v228,s[72:73] offset:64
global_load_dwordx4 v[160:163],v228,s[72:73] offset:128
global_load_dwordx4 v[164:167],v228,s[72:73] offset:192
global_load_dwordx4 v[168:171],v228,s[74:75] offset:0
global_load_dwordx4 v[172:175],v228,s[74:75] offset:64
global_load_dwordx4 v[176:179],v228,s[74:75] offset:128
global_load_dwordx4 v[180:183],v228,s[74:75] offset:192
s_waitcnt vmcnt(0)
v_mfma_f32_16x16x32_bf16 v[120:123],v[152:155],a[0:3],v[200:203]
v_mfma_f32_16x16x32_bf16 v[120:123],v[156:159],a[12:15],v[120:123]
v_mfma_f32_16x16x32_bf16 v[120:123],v[160:163],a[24:27],v[120:123]
v_mfma_f32_16x16x32_bf16 v[120:123],v[164:167],a[36:39],v[120:123]
v_mfma_f32_16x16x32_bf16 v[124:127],v[152:155],a[4:7],v[204:207]
v_mfma_f32_16x16x32_bf16 v[124:127],v[156:159],a[16:19],v[124:127]
v_mfma_f32_16x16x32_bf16 v[124:127],v[160:163],a[28:31],v[124:127]
v_mfma_f32_16x16x32_bf16 v[124:127],v[164:167],a[40:43],v[124:127]
v_mfma_f32_16x16x32_bf16 v[128:131],v[152:155],a[8:11],v[208:211]
v_mfma_f32_16x16x32_bf16 v[128:131],v[156:159],a[20:23],v[128:131]
v_mfma_f32_16x16x32_bf16 v[128:131],v[160:163],a[32:35],v[128:131]
v_mfma_f32_16x16x32_bf16 v[128:131],v[164:167],a[44:47],v[128:131]
v_mfma_f32_16x16x32_bf16 v[132:135],v[152:155],a[224:227],v[212:215]
v_mfma_f32_16x16x32_bf16 v[132:135],v[156:159],a[228:231],v[132:135]
v_mfma_f32_16x16x32_bf16 v[132:135],v[160:163],a[232:235],v[132:135]
v_mfma_f32_16x16x32_bf16 v[132:135],v[164:167],a[236:239],v[132:135]
v_mfma_f32_16x16x32_bf16 v[136:139],v[168:171],a[0:3],v[200:203]
v_mfma_f32_16x16x32_bf16 v[136:139],v[172:175],a[12:15],v[136:139]
v_mfma_f32_16x16x32_bf16 v[136:139],v[176:179],a[24:27],v[136:139]
v_mfma_f32_16x16x32_bf16 v[136:139],v[180:183],a[36:39],v[136:139]
v_mfma_f32_16x16x32_bf16 v[140:143],v[168:171],a[4:7],v[204:207]
v_mfma_f32_16x16x32_bf16 v[140:143],v[172:175],a[16:19],v[140:143]
v_mfma_f32_16x16x32_bf16 v[140:143],v[176:179],a[28:31],v[140:143]
v_mfma_f32_16x16x32_bf16 v[140:143],v[180:183],a[40:43],v[140:143]
v_mfma_f32_16x16x32_bf16 v[144:147],v[168:171],a[8:11],v[208:211]
v_mfma_f32_16x16x32_bf16 v[144:147],v[172:175],a[20:23],v[144:147]
v_mfma_f32_16x16x32_bf16 v[144:147],v[176:179],a[32:35],v[144:147]
v_mfma_f32_16x16x32_bf16 v[144:147],v[180:183],a[44:47],v[144:147]
v_mfma_f32_16x16x32_bf16 v[148:151],v[168:171],a[224:227],v[212:215]
v_mfma_f32_16x16x32_bf16 v[148:151],v[172:175],a[228:231],v[148:151]
v_mfma_f32_16x16x32_bf16 v[148:151],v[176:179],a[232:235],v[148:151]
v_mfma_f32_16x16x32_bf16 v[148:151],v[180:183],a[236:239],v[148:151]
EX 120
EX 121
EX 122
EX 123
EX 124
EX 125
EX 126
EX 127
EX 128
EX 129
EX 130
EX 131
EX 132
EX 133
EX 134
EX 135
EX 136
EX 137
EX 138
EX 139
EX 140
EX 141
EX 142
EX 143
EX 144
EX 145
EX 146
EX 147
EX 148
EX 149
EX 150
EX 151
CV 184,120,121
CV 185,122,123
CV 188,124,125
CV 189,126,127
CV 192,128,129
CV 193,130,131
CV 196,132,133
CV 197,134,135
CV 186,136,137
CV 187,138,139
CV 190,140,141
CV 191,142,143
CV 194,144,145
CV 195,146,147
CV 198,148,149
CV 199,150,151
global_load_ushort v236,v229,s[76:77] offset:0
global_load_ushort v237,v229,s[76:77] offset:256
global_load_ushort v238,v229,s[76:77] offset:512
global_load_ushort v239,v229,s[76:77] offset:768
global_load_ushort v240,v229,s[78:79] offset:0
global_load_ushort v241,v229,s[78:79] offset:256
global_load_ushort v242,v229,s[78:79] offset:512
global_load_ushort v243,v229,s[78:79] offset:768
s_waitcnt vmcnt(0)
v_lshl_or_b32 v224,v237,16,v236
v_lshl_or_b32 v225,v239,16,v238
v_lshl_or_b32 v226,v241,16,v240
v_lshl_or_b32 v227,v243,16,v242
s_nop 1
v_mfma_f32_16x16x32_bf16 v[0:3],v[224:227],v[184:187],v[0:3]
v_mfma_f32_16x16x32_bf16 v[4:7],v[224:227],v[188:191],v[4:7]
v_mfma_f32_16x16x32_bf16 v[8:11],v[224:227],v[192:195],v[8:11]
s_nop 1
global_load_ushort v236,v229,s[76:77] offset:32
global_load_ushort v237,v229,s[76:77] offset:288
global_load_ushort v238,v229,s[76:77] offset:544
global_load_ushort v239,v229,s[76:77] offset:800
global_load_ushort v240,v229,s[78:79] offset:32
global_load_ushort v241,v229,s[78:79] offset:288
global_load_ushort v242,v229,s[78:79] offset:544
global_load_ushort v243,v229,s[78:79] offset:800
s_waitcnt vmcnt(0)
v_lshl_or_b32 v224,v237,16,v236
v_lshl_or_b32 v225,v239,16,v238
v_lshl_or_b32 v226,v241,16,v240
v_lshl_or_b32 v227,v243,16,v242
s_nop 1
v_mfma_f32_16x16x32_bf16 v[12:15],v[224:227],v[184:187],v[12:15]
v_mfma_f32_16x16x32_bf16 v[16:19],v[224:227],v[188:191],v[16:19]
v_mfma_f32_16x16x32_bf16 v[20:23],v[224:227],v[192:195],v[20:23]
s_nop 1
global_load_ushort v236,v229,s[76:77] offset:64
global_load_ushort v237,v229,s[76:77] offset:320
global_load_ushort v238,v229,s[76:77] offset:576
global_load_ushort v239,v229,s[76:77] offset:832
global_load_ushort v240,v229,s[78:79] offset:64
global_load_ushort v241,v229,s[78:79] offset:320
global_load_ushort v242,v229,s[78:79] offset:576
global_load_ushort v243,v229,s[78:79] offset:832
s_waitcnt vmcnt(0)
v_lshl_or_b32 v224,v237,16,v236
v_lshl_or_b32 v225,v239,16,v238
v_lshl_or_b32 v226,v241,16,v240
v_lshl_or_b32 v227,v243,16,v242
s_nop 1
v_mfma_f32_16x16x32_bf16 v[24:27],v[224:227],v[184:187],v[24:27]
v_mfma_f32_16x16x32_bf16 v[28:31],v[224:227],v[188:191],v[28:31]
v_mfma_f32_16x16x32_bf16 v[32:35],v[224:227],v[192:195],v[32:35]
v_mfma_f32_16x16x32_bf16 v[96:99],v[224:227],v[196:199],v[96:99]
s_nop 1
global_load_ushort v236,v229,s[76:77] offset:96
global_load_ushort v237,v229,s[76:77] offset:352
global_load_ushort v238,v229,s[76:77] offset:608
global_load_ushort v239,v229,s[76:77] offset:864
global_load_ushort v240,v229,s[78:79] offset:96
global_load_ushort v241,v229,s[78:79] offset:352
global_load_ushort v242,v229,s[78:79] offset:608
global_load_ushort v243,v229,s[78:79] offset:864
s_waitcnt vmcnt(0)
v_lshl_or_b32 v224,v237,16,v236
v_lshl_or_b32 v225,v239,16,v238
v_lshl_or_b32 v226,v241,16,v240
v_lshl_or_b32 v227,v243,16,v242
s_nop 1
v_mfma_f32_16x16x32_bf16 v[36:39],v[224:227],v[184:187],v[36:39]
v_mfma_f32_16x16x32_bf16 v[40:43],v[224:227],v[188:191],v[40:43]
v_mfma_f32_16x16x32_bf16 v[44:47],v[224:227],v[192:195],v[44:47]
v_mfma_f32_16x16x32_bf16 v[100:103],v[224:227],v[196:199],v[100:103]
s_nop 1
global_load_ushort v236,v229,s[76:77] offset:128
global_load_ushort v237,v229,s[76:77] offset:384
global_load_ushort v238,v229,s[76:77] offset:640
global_load_ushort v239,v229,s[76:77] offset:896
global_load_ushort v240,v229,s[78:79] offset:128
global_load_ushort v241,v229,s[78:79] offset:384
global_load_ushort v242,v229,s[78:79] offset:640
global_load_ushort v243,v229,s[78:79] offset:896
s_waitcnt vmcnt(0)
v_lshl_or_b32 v224,v237,16,v236
v_lshl_or_b32 v225,v239,16,v238
v_lshl_or_b32 v226,v241,16,v240
v_lshl_or_b32 v227,v243,16,v242
s_nop 1
v_mfma_f32_16x16x32_bf16 v[48:51],v[224:227],v[184:187],v[48:51]
v_mfma_f32_16x16x32_bf16 v[52:55],v[224:227],v[188:191],v[52:55]
v_mfma_f32_16x16x32_bf16 v[56:59],v[224:227],v[192:195],v[56:59]
s_nop 1
global_load_ushort v236,v229,s[76:77] offset:160
global_load_ushort v237,v229,s[76:77] offset:416
global_load_ushort v238,v229,s[76:77] offset:672
global_load_ushort v239,v229,s[76:77] offset:928
global_load_ushort v240,v229,s[78:79] offset:160
global_load_ushort v241,v229,s[78:79] offset:416
global_load_ushort v242,v229,s[78:79] offset:672
global_load_ushort v243,v229,s[78:79] offset:928
s_waitcnt vmcnt(0)
v_lshl_or_b32 v224,v237,16,v236
v_lshl_or_b32 v225,v239,16,v238
v_lshl_or_b32 v226,v241,16,v240
v_lshl_or_b32 v227,v243,16,v242
s_nop 1
v_mfma_f32_16x16x32_bf16 v[60:63],v[224:227],v[184:187],v[60:63]
v_mfma_f32_16x16x32_bf16 v[64:67],v[224:227],v[188:191],v[64:67]
v_mfma_f32_16x16x32_bf16 v[68:71],v[224:227],v[192:195],v[68:71]
s_nop 1
global_load_ushort v236,v229,s[76:77] offset:192
global_load_ushort v237,v229,s[76:77] offset:448
global_load_ushort v238,v229,s[76:77] offset:704
global_load_ushort v239,v229,s[76:77] offset:960
global_load_ushort v240,v229,s[78:79] offset:192
global_load_ushort v241,v229,s[78:79] offset:448
global_load_ushort v242,v229,s[78:79] offset:704
global_load_ushort v243,v229,s[78:79] offset:960
s_waitcnt vmcnt(0)
v_lshl_or_b32 v224,v237,16,v236
v_lshl_or_b32 v225,v239,16,v238
v_lshl_or_b32 v226,v241,16,v240
v_lshl_or_b32 v227,v243,16,v242
s_nop 1
v_mfma_f32_16x16x32_bf16 v[72:75],v[224:227],v[184:187],v[72:75]
v_mfma_f32_16x16x32_bf16 v[76:79],v[224:227],v[188:191],v[76:79]
v_mfma_f32_16x16x32_bf16 v[80:83],v[224:227],v[192:195],v[80:83]
s_nop 1
global_load_ushort v236,v229,s[76:77] offset:224
global_load_ushort v237,v229,s[76:77] offset:480
global_load_ushort v238,v229,s[76:77] offset:736
global_load_ushort v239,v229,s[76:77] offset:992
global_load_ushort v240,v229,s[78:79] offset:224
global_load_ushort v241,v229,s[78:79] offset:480
global_load_ushort v242,v229,s[78:79] offset:736
global_load_ushort v243,v229,s[78:79] offset:992
s_waitcnt vmcnt(0)
v_lshl_or_b32 v224,v237,16,v236
v_lshl_or_b32 v225,v239,16,v238
v_lshl_or_b32 v226,v241,16,v240
v_lshl_or_b32 v227,v243,16,v242
s_nop 1
v_mfma_f32_16x16x32_bf16 v[84:87],v[224:227],v[184:187],v[84:87]
v_mfma_f32_16x16x32_bf16 v[88:91],v[224:227],v[188:191],v[88:91]
v_mfma_f32_16x16x32_bf16 v[92:95],v[224:227],v[192:195],v[92:95]
s_nop 1
v_mfma_f32_16x16x32_bf16 v[104:107],a[240:243],v[184:187],v[104:107]
v_mfma_f32_16x16x32_bf16 v[108:111],a[240:243],v[188:191],v[108:111]
v_mfma_f32_16x16x32_bf16 v[112:115],a[240:243],v[192:195],v[112:115]
v_mfma_f32_16x16x32_bf16 v[116:119],a[240:243],v[196:199],v[116:119]
s_add_u32 s72,s72,8192
s_addc_u32 s73,s73,0
s_add_u32 s76,s76,8192
s_addc_u32 s77,s77,0
s_add_u32 s80,s80,1
s_cmp_lg_u32 s80,16
s_cbranch_scc1 SL2_w1
s_nop 7
s_nop 7
v_rcp_f32 v224,v104
v_rcp_f32 v226,v108
v_rcp_f32 v228,v112
v_rcp_f32 v230,v116
v_pk_mul_f32 v[0:1],v[0:1],v[224:225] op_sel_hi:[1,0]
v_pk_mul_f32 v[2:3],v[2:3],v[224:225] op_sel_hi:[1,0]
v_pk_mul_f32 v[12:13],v[12:13],v[224:225] op_sel_hi:[1,0]
v_pk_mul_f32 v[14:15],v[14:15],v[224:225] op_sel_hi:[1,0]
CV 0,0,1
CV 1,2,3
CV 2,12,13
CV 3,14,15
v_pk_mul_f32 v[4:5],v[4:5],v[226:227] op_sel_hi:[1,0]
v_pk_mul_f32 v[6:7],v[6:7],v[226:227] op_sel_hi:[1,0]
v_pk_mul_f32 v[16:17],v[16:17],v[226:227] op_sel_hi:[1,0]
v_pk_mul_f32 v[18:19],v[18:19],v[226:227] op_sel_hi:[1,0]
CV 4,4,5
CV 5,6,7
CV 6,16,17
CV 7,18,19
v_pk_mul_f32 v[8:9],v[8:9],v[228:229] op_sel_hi:[1,0]
v_pk_mul_f32 v[10:11],v[10:11],v[228:229] op_sel_hi:[1,0]
v_pk_mul_f32 v[20:21],v[20:21],v[228:229] op_sel_hi:[1,0]
v_pk_mul_f32 v[22:23],v[22:23],v[228:229] op_sel_hi:[1,0]
CV 8,8,9
CV 9,10,11
CV 10,20,21
CV 11,22,23
v_pk_mul_f32 v[24:25],v[24:25],v[224:225] op_sel_hi:[1,0]
v_pk_mul_f32 v[26:27],v[26:27],v[224:225] op_sel_hi:[1,0]
v_pk_mul_f32 v[36:37],v[36:37],v[224:225] op_sel_hi:[1,0]
v_pk_mul_f32 v[38:39],v[38:39],v[224:225] op_sel_hi:[1,0]
CV 24,24,25
CV 25,26,27
CV 26,36,37
CV 27,38,39
v_pk_mul_f32 v[28:29],v[28:29],v[226:227] op_sel_hi:[1,0]
v_pk_mul_f32 v[30:31],v[30:31],v[226:227] op_sel_hi:[1,0]
v_pk_mul_f32 v[40:41],v[40:41],v[226:227] op_sel_hi:[1,0]
v_pk_mul_f32 v[42:43],v[42:43],v[226:227] op_sel_hi:[1,0]
CV 28,28,29
CV 29,30,31
CV 30,40,41
CV 31,42,43
v_pk_mul_f32 v[32:33],v[32:33],v[228:229] op_sel_hi:[1,0]
v_pk_mul_f32 v[34:35],v[34:35],v[228:229] op_sel_hi:[1,0]
v_pk_mul_f32 v[44:45],v[44:45],v[228:229] op_sel_hi:[1,0]
v_pk_mul_f32 v[46:47],v[46:47],v[228:229] op_sel_hi:[1,0]
CV 32,32,33
CV 33,34,35
CV 34,44,45
CV 35,46,47
v_pk_mul_f32 v[48:49],v[48:49],v[224:225] op_sel_hi:[1,0]
v_pk_mul_f32 v[50:51],v[50:51],v[224:225] op_sel_hi:[1,0]
v_pk_mul_f32 v[60:61],v[60:61],v[224:225] op_sel_hi:[1,0]
v_pk_mul_f32 v[62:63],v[62:63],v[224:225] op_sel_hi:[1,0]
CV 48,48,49
CV 49,50,51
CV 50,60,61
CV 51,62,63
v_pk_mul_f32 v[52:53],v[52:53],v[226:227] op_sel_hi:[1,0]
v_pk_mul_f32 v[54:55],v[54:55],v[226:227] op_sel_hi:[1,0]
v_pk_mul_f32 v[64:65],v[64:65],v[226:227] op_sel_hi:[1,0]
v_pk_mul_f32 v[66:67],v[66:67],v[226:227] op_sel_hi:[1,0]
CV 52,52,53
CV 53,54,55
CV 54,64,65
CV 55,66,67
v_pk_mul_f32 v[56:57],v[56:57],v[228:229] op_sel_hi:[1,0]
v_pk_mul_f32 v[58:59],v[58:59],v[228:229] op_sel_hi:[1,0]
v_pk_mul_f32 v[68:69],v[68:69],v[228:229] op_sel_hi:[1,0]
v_pk_mul_f32 v[70:71],v[70:71],v[228:229] op_sel_hi:[1,0]
CV 56,56,57
CV 57,58,59
CV 58,68,69
CV 59,70,71
v_pk_mul_f32 v[72:73],v[72:73],v[224:225] op_sel_hi:[1,0]
v_pk_mul_f32 v[74:75],v[74:75],v[224:225] op_sel_hi:[1,0]
v_pk_mul_f32 v[84:85],v[84:85],v[224:225] op_sel_hi:[1,0]
v_pk_mul_f32 v[86:87],v[86:87],v[224:225] op_sel_hi:[1,0]
CV 72,72,73
CV 73,74,75
CV 74,84,85
CV 75,86,87
v_pk_mul_f32 v[76:77],v[76:77],v[226:227] op_sel_hi:[1,0]
v_pk_mul_f32 v[78:79],v[78:79],v[226:227] op_sel_hi:[1,0]
v_pk_mul_f32 v[88:89],v[88:89],v[226:227] op_sel_hi:[1,0]
v_pk_mul_f32 v[90:91],v[90:91],v[226:227] op_sel_hi:[1,0]
CV 76,76,77
CV 77,78,79
CV 78,88,89
CV 79,90,91
v_pk_mul_f32 v[80:81],v[80:81],v[228:229] op_sel_hi:[1,0]
v_pk_mul_f32 v[82:83],v[82:83],v[228:229] op_sel_hi:[1,0]
v_pk_mul_f32 v[92:93],v[92:93],v[228:229] op_sel_hi:[1,0]
v_pk_mul_f32 v[94:95],v[94:95],v[228:229] op_sel_hi:[1,0]
CV 80,80,81
CV 81,82,83
CV 82,92,93
CV 83,94,95
v_pk_mul_f32 v[96:97],v[96:97],v[230:231] op_sel_hi:[1,0]
v_pk_mul_f32 v[98:99],v[98:99],v[230:231] op_sel_hi:[1,0]
v_pk_mul_f32 v[100:101],v[100:101],v[230:231] op_sel_hi:[1,0]
v_pk_mul_f32 v[102:103],v[102:103],v[230:231] op_sel_hi:[1,0]
CV 96,96,97
CV 97,98,99
CV 98,100,101
CV 99,102,103
s_nop 1
s_branch SLOW_r_w1
Calt1_w1:
s_nop 1
v_mov_b32 v250,0
v_mov_b32 v251,0
v_mov_b32 v252,0
v_mov_b32 v253,0
s_add_u32 s16,s12,0
s_addc_u32 s17,s13,0
s_add_u32 s18,s12,0
s_addc_u32 s19,s13,0
s_nop 1
s_branch Calt1_r_w1
Calt2_w1:
s_nop 1
s_add_u32 s16,s12,0
s_addc_u32 s17,s13,0
s_add_u32 s18,s12,0
s_addc_u32 s19,s13,0
s_nop 1
s_branch Calt2_r_w1
Calt3_w1:
s_nop 1
s_add_u32 s16,s12,0
s_addc_u32 s17,s13,0
s_add_u32 s18,s12,0
s_addc_u32 s19,s13,0
s_nop 1
s_branch Calt3_r_w1
Calt4_w1:
s_nop 1
s_add_u32 s16,s12,0
s_addc_u32 s17,s13,0
s_add_u32 s18,s12,0
s_addc_u32 s19,s13,0
s_nop 1
s_branch Calt4_r_w1
.p2align 6
W2:
s_and_b32 s28,s2,7
s_lshr_b32 s29,s2,3
s_lshr_b32 s30,s29,3
s_lshl_b32 s28,s28,2
s_add_u32 s28,s28,s30
s_and_b32 s29,s29,7
s_mul_i32 s30,s28,212992
s_add_u32 s4,s4,s30
s_addc_u32 s5,s5,0
s_lshl_b32 s30,s28,22
s_lshl_b32 s31,s29,19
s_add_u32 s30,s30,s31
s_add_u32 s30,s30,2048
s_add_u32 s6,s6,s30
s_addc_u32 s7,s7,0
s_add_u32 s8,s8,s30
s_addc_u32 s9,s9,0
s_lshl_b32 s30,s29,10
s_add_u32 s30,s30,32768
s_add_u32 s10,s10,s30
s_addc_u32 s11,s11,0
s_add_u32 s30,s31,8192
s_add_u32 s12,s12,s30
s_addc_u32 s13,s13,0
s_lshl_b32 s30,s28,3
s_add_u32 s30,s30,s29
s_mul_i32 s30,s30,212992
s_add_u32 s14,s14,s30
s_addc_u32 s15,s15,0
s_sub_u32 s14,s14,135168
s_subb_u32 s15,s15,0
s_mov_b32 s26,0x3e0293ee
s_mov_b32 s27,0x4f800000
s_mov_b32 s20,0
v_and_b32 v255,63,v0
v_lshlrev_b32 v249,4,v255
v_add_u32 v249,135168,v249
v_bfe_u32 v0,v255,2,3
v_mul_u32_u24 v248,1056,v0
v_lshrrev_b32 v0,5,v255
v_lshlrev_b32 v0,8,v0
v_and_b32 v1,3,v255
v_lshlrev_b32 v1,3,v1
v_add3_u32 v248,v248,v0,v1
v_lshrrev_b32 v0,4,v255
v_lshlrev_b32 v0,17,v0
v_and_b32 v1,15,v255
v_lshl_add_u32 v250,v1,4,v0
v_add_u32 v251,7936,v250
v_add_u32 v252,15872,v250
v_add_u32 v253,23808,v250
s_mov_b32 s31,0x3f803f80
v_accvgpr_write_b32 a240,s31
v_accvgpr_write_b32 a241,s31
v_accvgpr_write_b32 a242,s31
v_accvgpr_write_b32 a243,s31
v_lshrrev_b32 v4,3,v255
v_lshrrev_b32 v5,1,v4
v_and_b32 v6,7,v255
v_xor_b32 v7,v5,v6
v_lshlrev_b32 v7,4,v7
v_lshl_add_u32 v108,v4,10,v7
v_xor_b32 v109,64,v108
v_add_u32 v109,8192,v109
v_and_b32 v4,15,v255
v_lshrrev_b32 v5,4,v255
v_lshrrev_b32 v6,1,v4
v_xor_b32 v7,v5,v6
v_lshlrev_b32 v7,4,v7
v_lshl_add_u32 v104,v4,7,v7
v_xor_b32 v105,64,v104
v_add_u32 v106,67584,v104
v_add_u32 v107,67584,v105
v_lshrrev_b32 v6,2,v4
v_sub_u32 v6,4,v6
v_and_b32 v6,3,v6
v_xor_b32 v7,v5,v6
v_lshlrev_b32 v7,4,v7
v_lshl_add_u32 v254,v4,6,v7
v_add_u32 v254,135168,v254
v_lshrrev_b32 v4,2,v255
v_sub_u32 v6,4,v5
v_and_b32 v6,3,v6
v_and_b32 v7,3,v255
v_xor_b32 v7,v6,v7
v_lshlrev_b32 v7,4,v7
v_lshl_add_u32 v110,v4,10,v7
s_add_u32 s40,s4,98304
s_addc_u32 s41,s5,0
s_add_u32 s42,s4,114688
s_addc_u32 s43,s5,0
s_add_u32 s44,s4,131072
s_addc_u32 s45,s5,0
s_add_u32 s46,s4,197120
s_addc_u32 s47,s5,0
s_add_u32 s16,s10,0
s_addc_u32 s17,s11,0
s_mov_b32 m0,8448
s_nop 0
DW 250,16,0
s_mov_b32 m0,9248
s_nop 0
DW 251,16,256
s_mov_b32 m0,10048
s_nop 0
DW 252,16,512
s_mov_b32 m0,10848
s_nop 0
DW 253,16,768
s_mov_b32 m0,25088
s_nop 0
DW 108,40,0
s_mov_b32 m0,26112
s_nop 0
DW 109,40,0
s_mov_b32 m0,27136
s_nop 0
DW 108,42,0
s_mov_b32 m0,28160
s_nop 0
DW 109,42,0
s_add_u32 s40,s40,128
s_addc_u32 s41,s41,0
s_add_u32 s42,s42,128
s_addc_u32 s43,s43,0
s_mov_b32 m0,37888
s_nop 0
DW 108,44,0
s_mov_b32 m0,38912
s_nop 0
DW 109,44,0
s_add_u32 s44,s44,128
s_addc_u32 s45,s45,0
s_mov_b32 m0,143360
s_nop 0
DW 110,46,0
s_mov_b32 m0,144320
s_nop 0
DW 110,46,64
s_mov_b32 m0,145280
s_nop 0
DW 110,46,128
s_mov_b32 m0,146240
s_nop 0
DW 110,46,192
s_add_u32 s16,s10,524288
s_addc_u32 s17,s11,0
s_mov_b32 m0,59136
s_nop 0
DW 250,16,0
s_mov_b32 m0,59936
s_nop 0
DW 251,16,256
s_mov_b32 m0,60736
s_nop 0
DW 252,16,512
s_mov_b32 m0,61536
s_nop 0
DW 253,16,768
s_mov_b32 m0,75776
s_nop 0
DW 108,40,0
s_mov_b32 m0,76800
s_nop 0
DW 109,40,0
s_mov_b32 m0,77824
s_nop 0
DW 108,42,0
s_mov_b32 m0,78848
s_nop 0
DW 109,42,0
s_add_u32 s40,s40,128
s_addc_u32 s41,s41,0
s_add_u32 s42,s42,128
s_addc_u32 s43,s43,0
s_mov_b32 m0,88576
s_nop 0
DW 108,44,0
s_mov_b32 m0,89600
s_nop 0
DW 109,44,0
s_add_u32 s44,s44,128
s_addc_u32 s45,s45,0
s_add_u32 s16,s10,1048576
s_addc_u32 s17,s11,0
s_mov_b32 m0,109824
s_nop 0
DW 250,16,0
s_mov_b32 m0,110624
s_nop 0
DW 251,16,256
s_mov_b32 m0,111424
s_nop 0
DW 252,16,512
s_mov_b32 m0,112224
s_nop 0
DW 253,16,768
s_mov_b32 m0,126464
s_nop 0
DW 108,40,0
s_mov_b32 m0,127488
s_nop 0
DW 109,40,0
s_mov_b32 m0,128512
s_nop 0
DW 108,42,0
s_mov_b32 m0,129536
s_nop 0
DW 109,42,0
s_add_u32 s40,s40,128
s_addc_u32 s41,s41,0
s_add_u32 s42,s42,128
s_addc_u32 s43,s43,0
s_waitcnt vmcnt(18) lgkmcnt(0)
s_barrier
TR 192,248,0
TR 194,248,8448
TR 196,248,512
TR 198,248,8960
TR 200,248,32
TR 202,248,8480
TR 204,248,544
TR 206,248,8992
RD 0,104,25088
RD 12,105,25088
RD 4,104,27136
RD 16,105,27136
RD 8,104,37888
RD 20,105,37888
RD 224,254,0
LG 14
RD 228,254,1024
LG 0
Za 0,192,0
TR 208,248,64
v_subrev_u32 v255,135168,v249
s_mov_b32 m0,4096
s_add_u32 s16,s10,1572864
s_addc_u32 s17,s11,0
Ma 0,196,12
TR 210,248,8512
v_lshrrev_b32 v255,6,v255
s_lshl_b32 s30,s20,17
s_add_u32 s38,s6,s30
s_addc_u32 s39,s7,0
Za 4,192,4
TR 212,248,576
v_lshlrev_b32 v255,11,v255
s_add_u32 s38,s38,63488
s_addc_u32 s39,s39,0
s_lshl_b32 s30,s20,17
Ma 4,196,16
TR 214,248,9024
s_add_u32 s18,s10,3670272
s_addc_u32 s19,s11,0
Za 8,192,8
TR 216,248,96
Ma 8,196,20
TR 218,248,8544
Za 12,200,0
TR 220,248,608
Ma 12,204,12
TR 222,248,9056
Za 16,200,4
TR 192,248,128
Ma 16,204,16
TR 194,248,8576
Za 20,200,8
TR 196,248,640
Ma 20,204,20
TR 198,248,9088
LG 10
Za 24,208,0
TR 200,248,160
LG 9
Ma 24,212,12
TR 202,248,8608
Za 28,208,4
TR 204,248,672
Ma 28,212,16
TR 206,248,9120
Za 32,208,8
Ma 32,212,20
LG 10
Za 36,216,0
LG 8
Ma 36,220,12
Za 40,216,4
TR 208,248,192
Ma 40,220,16
TR 210,248,8640
Za 44,216,8
TR 212,248,704
Ma 44,220,20
TR 214,248,9152
LG 10
Za 48,192,0
TR 216,248,224
LG 9
Ma 48,196,12
TR 218,248,8672
Za 52,192,4
TR 220,248,736
Ma 52,196,16
TR 222,248,9184
Za 56,192,8
Ma 56,196,20
Za 96,192,224
Ma 96,196,228
LG 10
Za 60,200,0
LG 8
Ma 60,204,12
Za 64,200,4
Ma 64,204,16
Za 68,200,8
Ma 68,204,20
Za 100,200,224
Ma 100,204,228
s_waitcnt vmcnt(8) lgkmcnt(0)
s_barrier
Za 72,208,0
TR 192,248,50688
Ma 72,212,12
TR 194,248,59136
Za 76,208,4
TR 196,248,51200
Ma 76,212,16
TR 198,248,59648
Za 80,208,8
TR 200,248,50720
Ma 80,212,20
TR 202,248,59168
Za 84,216,0
TR 204,248,51232
TR 206,248,59680
Ma 84,220,12
RD 24,106,8192
RD 36,107,8192
Za 88,216,4
RD 28,106,10240
Ma 88,220,16
RD 40,107,10240
Za 92,216,8
DW 108,44,0
s_mov_b32 m0,5120
Ma 92,220,20
RD 32,106,20992
RD 44,107,20992
LG 5
Ma 0,192,24
DW 109,44,0
s_mov_b32 m0,25344
s_add_u32 s44,s44,128
s_addc_u32 s45,s45,0
LG 4
Ma 0,196,36
DW 250,16,0
s_mov_b32 m0,26144
LG 3
Ma 4,192,28
RD 232,254,2048
LG 3
Ma 4,196,40
RD 236,254,3072
LG 3
Ma 8,192,32
TR 208,248,50752
LG 3
Ma 8,196,44
TR 210,248,59200
Ma 12,200,24
TR 212,248,51264
Ma 12,204,36
TR 214,248,59712
Ma 16,200,28
DW 251,16,256
s_mov_b32 m0,26944
Ma 16,204,40
TR 216,248,50784
Ma 20,200,32
TR 218,248,59232
Ma 20,204,44
DW 252,16,512
s_mov_b32 m0,27744
LG 4
Ma 24,208,24
TR 220,248,51296
LG 3
Ma 24,212,36
TR 222,248,59744
Ma 28,208,28
DW 253,16,768
s_mov_b32 m0,41984
s_add_u32 s16,s10,2097152
s_addc_u32 s17,s11,0
Ma 28,212,40
TR 192,248,50816
Ma 32,208,32
TR 194,248,59264
Ma 32,212,44
TR 196,248,51328
LG 5
Ma 36,216,24
TR 198,248,59776
LG 4
Ma 36,220,36
DW 108,40,0
s_mov_b32 m0,43008
Ma 40,216,28
DW 109,40,0
s_mov_b32 m0,44032
s_add_u32 s40,s40,128
s_addc_u32 s41,s41,0
Ma 40,220,40
TR 200,248,50848
Ma 44,216,32
TR 202,248,59296
Ma 44,220,44
TR 204,248,51360
LG 5
Ma 48,192,24
TR 206,248,59808
LG 4
Ma 48,196,36
DW 108,42,0
s_mov_b32 m0,45056
Ma 52,192,28
TR 208,248,50880
Ma 52,196,40
DW 109,42,0
s_mov_b32 m0,54784
s_add_u32 s42,s42,128
s_addc_u32 s43,s43,0
Ma 56,192,32
TR 210,248,59328
Ma 56,196,44
TR 212,248,51392
Ma 96,192,232
TR 214,248,59840
Ma 96,196,236
TR 216,248,50912
LG 7
Ma 60,200,24
TR 218,248,59360
LG 6
Ma 60,204,36
TR 220,248,51424
Ma 64,200,28
TR 222,248,59872
v_add_u32 v248,67584,v248
Ma 64,204,40
Ma 68,200,32
Ma 68,204,44
Ma 100,200,232
Ma 100,204,236
s_waitcnt vmcnt(8) lgkmcnt(0)
s_barrier
Ma 72,208,24
TR 192,248,33792
Ma 72,212,36
TR 194,248,42240
Ma 76,208,28
TR 196,248,34304
Ma 76,212,40
TR 198,248,42752
Ma 80,208,32
TR 200,248,33824
Ma 80,212,44
TR 202,248,42272
Ma 84,216,24
TR 204,248,34336
TR 206,248,42784
Ma 84,220,36
RD 48,106,58880
RD 60,107,58880
Ma 88,216,28
RD 52,106,60928
Ma 88,220,40
RD 64,107,60928
Ma 92,216,32
DW 108,44,0
s_mov_b32 m0,55808
Ma 92,220,44
RD 56,104,4096
RD 68,105,4096
LG 5
Ma 0,192,48
DW 109,44,0
s_mov_b32 m0,76032
s_add_u32 s44,s44,128
s_addc_u32 s45,s45,0
LG 4
Ma 0,196,60
DW 250,16,0
s_mov_b32 m0,76832
LG 3
Ma 4,192,52
RD 224,254,4096
LG 3
Ma 4,196,64
RD 228,254,5120
LG 3
Ma 8,192,56
TR 208,248,33856
LG 3
Ma 8,196,68
TR 210,248,42304
Ma 12,200,48
TR 212,248,34368
Ma 12,204,60
TR 214,248,42816
Ma 16,200,52
DW 251,16,256
s_mov_b32 m0,77632
Ma 16,204,64
TR 216,248,33888
Ma 20,200,56
TR 218,248,42336
Ma 20,204,68
DW 252,16,512
s_mov_b32 m0,78432
LG 4
Ma 24,208,48
TR 220,248,34400
LG 3
Ma 24,212,60
TR 222,248,42848
Ma 28,208,52
DW 253,16,768
s_mov_b32 m0,92672
s_add_u32 s16,s10,2621440
s_addc_u32 s17,s11,0
Ma 28,212,64
TR 192,248,33920
Ma 32,208,56
TR 194,248,42368
Ma 32,212,68
TR 196,248,34432
LG 5
Ma 36,216,48
TR 198,248,42880
LG 4
Ma 36,220,60
DW 108,40,0
s_mov_b32 m0,93696
Ma 40,216,52
DW 109,40,0
s_mov_b32 m0,94720
s_add_u32 s40,s40,128
s_addc_u32 s41,s41,0
Ma 40,220,64
TR 200,248,33952
Ma 44,216,56
TR 202,248,42400
Ma 44,220,68
TR 204,248,34464
LG 5
Ma 48,192,48
TR 206,248,42912
LG 4
Ma 48,196,60
DW 108,42,0
s_mov_b32 m0,95744
Ma 52,192,52
TR 208,248,33984
Ma 52,196,64
DW 109,42,0
s_mov_b32 m0,105472
s_add_u32 s42,s42,128
s_addc_u32 s43,s43,0
Ma 56,192,56
TR 210,248,42432
Ma 56,196,68
TR 212,248,34496
Ma 96,192,224
TR 214,248,42944
Ma 96,196,228
TR 216,248,34016
LG 7
Ma 60,200,48
TR 218,248,42464
LG 6
Ma 60,204,60
TR 220,248,34528
Ma 64,200,52
TR 222,248,42976
v_add_u32 v248,4294899712,v248
Ma 64,204,64
Ma 68,200,56
Ma 68,204,68
Ma 100,200,224
Ma 100,204,228
s_waitcnt vmcnt(8) lgkmcnt(0)
s_barrier
Ma 72,208,48
TR 192,248,16896
Ma 72,212,60
TR 194,248,25344
Ma 76,208,52
TR 196,248,17408
Ma 76,212,64
TR 198,248,25856
Ma 80,208,56
TR 200,248,16928
Ma 80,212,68
TR 202,248,25376
Ma 84,216,48
TR 204,248,17440
TR 206,248,25888
Ma 84,220,60
RD 72,104,41984
RD 84,105,41984
Ma 88,216,52
RD 76,104,44032
Ma 88,220,64
RD 88,105,44032
Ma 92,216,56
DW 108,44,0
s_mov_b32 m0,106496
Ma 92,220,68
RD 80,104,54784
RD 92,105,54784
LG 5
Ma 0,192,72
DW 109,44,0
s_mov_b32 m0,126720
s_add_u32 s44,s44,128
s_addc_u32 s45,s45,0
LG 4
Ma 0,196,84
DW 250,16,0
s_mov_b32 m0,127520
LG 3
Ma 4,192,76
RD 232,254,6144
LG 3
Ma 4,196,88
RD 236,254,7168
LG 3
Ma 8,192,80
TR 208,248,16960
LG 3
Ma 8,196,92
TR 210,248,25408
Ma 12,200,72
TR 212,248,17472
Ma 12,204,84
TR 214,248,25920
Ma 16,200,76
DW 251,16,256
s_mov_b32 m0,128320
Ma 16,204,88
TR 216,248,16992
Ma 20,200,80
TR 218,248,25440
Ma 20,204,92
DW 252,16,512
s_mov_b32 m0,129120
LG 4
Ma 24,208,72
TR 220,248,17504
LG 3
Ma 24,212,84
TR 222,248,25952
Ma 28,208,76
DW 253,16,768
s_mov_b32 m0,8192
s_add_u32 s16,s10,3145728
s_addc_u32 s17,s11,0
Ma 28,212,88
TR 192,248,17024
Ma 32,208,80
TR 194,248,25472
Ma 32,212,92
TR 196,248,17536
LG 5
Ma 36,216,72
TR 198,248,25984
LG 4
Ma 36,220,84
DW 108,40,0
s_mov_b32 m0,9216
Ma 40,216,76
DW 109,40,0
s_mov_b32 m0,10240
s_add_u32 s40,s40,128
s_addc_u32 s41,s41,0
Ma 40,220,88
TR 200,248,17056
Ma 44,216,80
TR 202,248,25504
Ma 44,220,92
TR 204,248,17568
LG 5
Ma 48,192,72
TR 206,248,26016
LG 4
Ma 48,196,84
DW 108,42,0
s_mov_b32 m0,11264
Ma 52,192,76
TR 208,248,17088
Ma 52,196,88
DW 109,42,0
s_mov_b32 m0,20992
s_add_u32 s42,s42,128
s_addc_u32 s43,s43,0
Ma 56,192,80
TR 210,248,25536
Ma 56,196,92
TR 212,248,17600
Ma 96,192,232
TR 214,248,26048
Ma 96,196,236
TR 216,248,17120
LG 7
Ma 60,200,72
TR 218,248,25568
LG 6
Ma 60,204,84
TR 220,248,17632
Ma 64,200,76
TR 222,248,26080
v_add_u32 v248,67584,v248
Ma 64,204,88
Ma 68,200,80
Ma 68,204,92
Ma 100,200,232
Ma 100,204,236
s_waitcnt vmcnt(8) lgkmcnt(0)
s_barrier
Ma 72,208,72
TR 192,248,0
Ma 72,212,84
TR 194,248,8448
Ma 76,208,76
TR 196,248,512
Ma 76,212,88
TR 198,248,8960
Ma 80,208,80
TR 200,248,32
Ma 80,212,92
TR 202,248,8480
Ma 84,216,72
TR 204,248,544
TR 206,248,8992
Ma 84,220,84
RD 96,106,25088
RD 108,107,25088
Ma 88,216,76
RD 100,106,27136
Ma 88,220,88
RD 112,107,27136
Ma 92,216,80
DW 108,44,0
s_mov_b32 m0,22016
Ma 92,220,92
RD 104,106,37888
RD 116,107,37888
LG 5
Ma 0,192,96
DW 109,44,0
s_mov_b32 m0,42240
s_add_u32 s44,s44,128
s_addc_u32 s45,s45,0
LG 4
Ma 0,196,108
DW 250,16,0
s_mov_b32 m0,43040
LG 3
Ma 4,192,100
RD 224,254,8192
LG 3
Ma 4,196,112
RD 228,254,9216
LG 3
Ma 8,192,104
TR 208,248,64
LG 3
Ma 8,196,116
TR 210,248,8512
Ma 12,200,96
TR 212,248,576
Ma 12,204,108
TR 214,248,9024
Ma 16,200,100
DW 251,16,256
s_mov_b32 m0,43840
Ma 16,204,112
TR 216,248,96
Ma 20,200,104
TR 218,248,8544
Ma 20,204,116
DW 252,16,512
s_mov_b32 m0,44640
LG 4
Ma 24,208,96
TR 220,248,608
LG 3
Ma 24,212,108
TR 222,248,9056
Ma 28,208,100
DW 253,16,768
s_mov_b32 m0,58880
s_add_u32 s16,s10,3670016
s_addc_u32 s17,s11,0
Ma 28,212,112
TR 192,248,128
Ma 32,208,104
TR 194,248,8576
Ma 32,212,116
TR 196,248,640
LG 5
Ma 36,216,96
TR 198,248,9088
LG 4
Ma 36,220,108
DW 108,40,0
s_mov_b32 m0,59904
Ma 40,216,100
DW 109,40,0
s_mov_b32 m0,60928
s_add_u32 s40,s40,128
s_addc_u32 s41,s41,0
Ma 40,220,112
TR 200,248,160
Ma 44,216,104
TR 202,248,8608
Ma 44,220,116
TR 204,248,672
LG 5
Ma 48,192,96
TR 206,248,9120
LG 4
Ma 48,196,108
DW 108,42,0
s_mov_b32 m0,61952
Ma 52,192,100
TR 208,248,192
Ma 52,196,112
DW 109,42,0
s_mov_b32 m0,71680
s_add_u32 s42,s42,128
s_addc_u32 s43,s43,0
Ma 56,192,104
TR 210,248,8640
Ma 56,196,116
TR 212,248,704
Ma 96,192,224
TR 214,248,9152
Ma 96,196,228
TR 216,248,224
LG 7
Ma 60,200,96
TR 218,248,8672
LG 6
Ma 60,204,108
TR 220,248,736
Ma 64,200,100
TR 222,248,9184
Ma 64,204,112
Ma 68,200,104
Ma 68,204,116
Ma 100,200,224
Ma 100,204,228
s_waitcnt vmcnt(8) lgkmcnt(0)
s_barrier
Ma 72,208,96
TR 192,248,50688
Ma 72,212,108
TR 194,248,59136
Ma 76,208,100
TR 196,248,51200
Ma 76,212,112
TR 198,248,59648
Ma 80,208,104
TR 200,248,50720
Ma 80,212,116
TR 202,248,59168
Ma 84,216,96
TR 204,248,51232
TR 206,248,59680
Ma 84,220,108
RD 120,104,8192
RD 132,105,8192
Ma 88,216,100
RD 124,104,10240
Ma 88,220,112
RD 136,105,10240
Ma 92,216,104
DW 108,44,0
s_mov_b32 m0,72704
Ma 92,220,116
RD 128,104,20992
RD 140,105,20992
LG 5
Ma 0,192,120
DW 109,44,0
s_mov_b32 m0,92928
s_add_u32 s44,s44,128
s_addc_u32 s45,s45,0
LG 4
Ma 0,196,132
DW 250,16,0
s_mov_b32 m0,93728
LG 3
Ma 4,192,124
RD 232,254,10240
LG 3
Ma 4,196,136
RD 236,254,11264
LG 3
Ma 8,192,128
TR 208,248,50752
LG 3
Ma 8,196,140
TR 210,248,59200
Ma 12,200,120
TR 212,248,51264
Ma 12,204,132
TR 214,248,59712
Ma 16,200,124
DW 251,16,256
s_mov_b32 m0,94528
Ma 16,204,136
TR 216,248,50784
Ma 20,200,128
TR 218,248,59232
Ma 20,204,140
DW 252,16,512
s_mov_b32 m0,95328
LG 4
Ma 24,208,120
TR 220,248,51296
LG 3
Ma 24,212,132
TR 222,248,59744
Ma 28,208,124
DW 253,16,768
s_mov_b32 m0,109568
s_add_u32 s16,s10,256
s_addc_u32 s17,s11,0
Ma 28,212,136
TR 192,248,50816
Ma 32,208,128
TR 194,248,59264
Ma 32,212,140
TR 196,248,51328
LG 5
Ma 36,216,120
TR 198,248,59776
LG 4
Ma 36,220,132
DW 108,40,0
s_mov_b32 m0,110592
Ma 40,216,124
DW 109,40,0
s_mov_b32 m0,111616
s_add_u32 s40,s40,128
s_addc_u32 s41,s41,0
Ma 40,220,136
TR 200,248,50848
Ma 44,216,128
TR 202,248,59296
Ma 44,220,140
TR 204,248,51360
LG 5
Ma 48,192,120
TR 206,248,59808
LG 4
Ma 48,196,132
DW 108,42,0
s_mov_b32 m0,112640
Ma 52,192,124
TR 208,248,50880
Ma 52,196,136
DW 109,42,0
s_mov_b32 m0,122368
s_add_u32 s42,s42,128
s_addc_u32 s43,s43,0
Ma 56,192,128
TR 210,248,59328
Ma 56,196,140
TR 212,248,51392
Ma 96,192,232
TR 214,248,59840
Ma 96,196,236
TR 216,248,50912
LG 7
Ma 60,200,120
TR 218,248,59360
LG 6
Ma 60,204,132
TR 220,248,51424
Ma 64,200,124
TR 222,248,59872
v_add_u32 v248,4294899712,v248
Ma 64,204,136
Ma 68,200,128
Ma 68,204,140
Ma 100,200,232
Ma 100,204,236
s_waitcnt vmcnt(8) lgkmcnt(0)
s_barrier
Ma 72,208,120
TR 192,248,33792
Ma 72,212,132
TR 194,248,42240
Ma 76,208,124
TR 196,248,34304
Ma 76,212,136
TR 198,248,42752
Ma 80,208,128
TR 200,248,33824
Ma 80,212,140
TR 202,248,42272
Ma 84,216,120
TR 204,248,34336
TR 206,248,42784
Ma 84,220,132
RD 144,104,58880
RD 156,105,58880
Ma 88,216,124
RD 148,104,60928
Ma 88,220,136
RD 160,105,60928
Ma 92,216,128
DW 108,44,0
s_mov_b32 m0,123392
Ma 92,220,140
RD 152,106,4096
RD 164,107,4096
LG 5
Ma 0,192,144
DW 109,44,0
s_mov_b32 m0,8448
s_add_u32 s44,s44,128
s_addc_u32 s45,s45,0
LG 4
Ma 0,196,156
DW 250,16,0
s_mov_b32 m0,9248
LG 3
Ma 4,192,148
RD 224,254,12288
LG 3
Ma 4,196,160
RD 228,254,13312
LG 3
Ma 8,192,152
TR 208,248,33856
LG 3
Ma 8,196,164
TR 210,248,42304
Ma 12,200,144
TR 212,248,34368
Ma 12,204,156
TR 214,248,42816
Ma 16,200,148
DW 251,16,256
s_mov_b32 m0,10048
Ma 16,204,160
TR 216,248,33888
Ma 20,200,152
TR 218,248,42336
Ma 20,204,164
DW 252,16,512
s_mov_b32 m0,10848
LG 4
Ma 24,208,144
TR 220,248,34400
LG 3
Ma 24,212,156
TR 222,248,42848
Ma 28,208,148
DW 253,16,768
s_add_u32 s16,s10,524544
s_addc_u32 s17,s11,0
s_mov_b32 m0,25344
Ma 28,212,160
TR 192,248,33920
Ma 32,208,152
TR 194,248,42368
Ma 32,212,164
DW 250,16,0
s_mov_b32 m0,26144
LG 4
Ma 36,216,144
TR 196,248,34432
LG 3
Ma 36,220,156
DW 251,16,256
s_mov_b32 m0,26944
Ma 40,216,148
TR 198,248,42880
Ma 40,220,160
TR 200,248,33952
Ma 44,216,152
TR 202,248,42400
Ma 44,220,164
DW 252,16,512
s_mov_b32 m0,27744
LG 4
Ma 48,192,144
TR 204,248,34464
LG 3
Ma 48,196,156
TR 206,248,42912
Ma 52,192,148
TR 208,248,33984
Ma 52,196,160
DW 253,16,768
s_add_u32 s16,s10,1048832
s_addc_u32 s17,s11,0
s_mov_b32 m0,42240
Ma 56,192,152
global_load_dword a253,v255,s[38:39]
s_add_u32 s38,s8,s30
s_addc_u32 s39,s9,0
s_add_u32 s38,s38,63488
s_addc_u32 s39,s39,0
Ma 56,196,164
TR 210,248,42432
v_subrev_u32 v255,135168,v249
Ma 96,192,224
TR 212,248,34496
v_lshrrev_b32 v255,6,v255
Ma 96,196,228
TR 214,248,42944
v_lshlrev_b32 v255,11,v255
LG 6
Ma 60,200,144
TR 216,248,34016
LG 5
Ma 60,204,156
TR 218,248,42464
Ma 64,200,148
TR 220,248,34528
TR 222,248,42976
Ma 64,204,160
v_add_u32 v248,67584,v248
Ma 68,200,152
Ma 68,204,164
Ma 100,200,224
Ma 100,204,228
s_waitcnt vmcnt(9) lgkmcnt(0)
s_barrier
Ma 72,208,144
TR 192,248,16896
Ma 72,212,156
TR 194,248,25344
Ma 76,208,148
TR 196,248,17408
Ma 76,212,160
TR 198,248,25856
Ma 80,208,152
TR 200,248,16928
Ma 80,212,164
TR 202,248,25376
Ma 84,216,144
TR 204,248,17440
TR 206,248,25888
Ma 84,220,156
RD 168,106,41984
RD 180,107,41984
Ma 88,216,148
RD 172,106,44032
Ma 88,220,160
RD 184,107,44032
Ma 92,216,152
DW 250,16,0
s_mov_b32 m0,43040
Ma 92,220,164
RD 176,106,54784
RD 188,107,54784
LG 5
Ma 0,192,168
DW 251,16,256
s_mov_b32 m0,43840
LG 4
Ma 0,196,180
DW 252,16,512
s_mov_b32 m0,44640
LG 3
Ma 4,192,172
RD 232,254,14336
LG 3
Ma 4,196,184
RD 236,254,15360
LG 3
Ma 8,192,176
TR 208,248,16960
MU 0,s26
LG 3
Ma 8,196,188
TR 210,248,25408
MU 1,s26
Ma 12,200,168
TR 212,248,17472
MU 2,s26
Ma 12,204,180
TR 214,248,25920
MU 3,s26
Ma 16,200,172
DW 253,16,768
s_add_u32 s16,s10,1573120
s_addc_u32 s17,s11,0
s_mov_b32 m0,59136
Ma 16,204,184
TR 216,248,16992
CV 0,0,1
Ma 20,200,176
TR 218,248,25440
MU 12,s26
Ma 20,204,188
DW 250,16,0
s_mov_b32 m0,59936
LG 4
Ma 24,208,168
TR 220,248,17504
MU 13,s26
LG 3
Ma 24,212,180
TR 222,248,25952
MU 14,s26
Ma 28,208,172
DW 251,16,256
s_mov_b32 m0,60736
Ma 28,212,184
TR 192,248,17024
MU 15,s26
Ma 32,208,176
TR 194,248,25472
CV 1,2,3
Ma 32,212,188
DW 252,16,512
s_mov_b32 m0,61536
LG 4
Ma 36,216,168
TR 196,248,17536
CV 2,12,13
LG 3
Ma 36,220,180
DW 253,16,768
s_add_u32 s16,s10,2097408
s_addc_u32 s17,s11,0
s_mov_b32 m0,76032
Ma 40,216,172
TR 198,248,25984
CV 3,14,15
Ma 40,220,184
TR 200,248,17056
v_permlane32_swap_b32 v0,v2
Ma 44,216,176
TR 202,248,25504
v_permlane32_swap_b32 v1,v3
Ma 44,220,188
DW 250,16,0
s_mov_b32 m0,76832
LG 4
Ma 48,192,168
TR 204,248,17568
v_permlane16_swap_b32 v0,v2
LG 3
Ma 48,196,180
TR 206,248,26016
v_permlane16_swap_b32 v1,v3
Ma 52,192,172
TR 208,248,17088
MU 4,s26
Ma 52,196,184
DW 251,16,256
s_mov_b32 m0,77632
Ma 56,192,176
TR 210,248,25536
MU 5,s26
Ma 56,196,188
TR 212,248,17600
MU 6,s26
Ma 96,192,232
TR 214,248,26048
MU 7,s26
Ma 96,196,236
DW 252,16,512
s_mov_b32 m0,78432
LG 6
Ma 60,200,168
TR 216,248,17120
MU 16,s26
LG 5
Ma 60,204,180
TR 218,248,25568
MU 17,s26
Ma 64,200,172
TR 220,248,17632
TR 222,248,26080
Ma 64,204,184
DW 253,16,768
s_add_u32 s16,s10,2621696
s_addc_u32 s17,s11,0
s_mov_b32 m0,92928
Ma 68,200,176
global_load_dword a253,v255,s[38:39]
Ma 68,204,188
v_add_u32 v248,4294899712,v248
MU 18,s26
Ma 100,200,232
MU 19,s26
CV 4,4,5
Ma 100,204,236
CV 5,6,7
CV 6,16,17
s_waitcnt vmcnt(14) lgkmcnt(0)
s_barrier
Ma 72,208,168
TR 192,248,0
CV 7,18,19
Ma 72,212,180
TR 194,248,8448
v_permlane32_swap_b32 v4,v6
Ma 76,208,172
TR 196,248,512
v_permlane32_swap_b32 v5,v7
Ma 76,212,184
TR 198,248,8960
v_permlane16_swap_b32 v4,v6
Ma 80,208,176
TR 200,248,16896
v_permlane16_swap_b32 v5,v7
Ma 80,212,188
TR 202,248,25344
MU 8,s26
Ma 84,216,168
TR 204,248,17408
TR 206,248,25856
Ma 84,220,180
RD 224,254,0
RD 228,254,1024
Ma 88,216,172
RD 232,254,2048
RD 236,254,3072
Ma 88,220,184
DW 250,16,0
s_mov_b32 m0,93728
Ma 92,216,176
DW 251,16,256
s_mov_b32 m0,94528
Ma 92,220,188
DW 252,16,512
s_mov_b32 m0,95328
s_nop 0
DW 253,16,768
s_add_u32 s16,s10,3145984
s_addc_u32 s17,s11,0
MU 9,s26
MU 10,s26
MU 11,s26
MU 20,s26
MU 21,s26
MU 22,s26
MU 23,s26
CV 8,8,9
CV 9,10,11
CV 10,20,21
CV 11,22,23
s_nop 0
v_permlane32_swap_b32 v8,v10
v_permlane32_swap_b32 v9,v11
s_nop 0
v_permlane16_swap_b32 v8,v10
v_permlane16_swap_b32 v9,v11
MU 24,s26
MU 25,s26
MU 26,s26
MU 27,s26
MU 36,s26
MU 37,s26
MU 38,s26
MU 39,s26
CV 24,24,25
CV 25,26,27
CV 26,36,37
CV 27,38,39
s_nop 0
v_permlane32_swap_b32 v24,v26
v_permlane32_swap_b32 v25,v27
s_nop 0
v_permlane16_swap_b32 v24,v26
v_permlane16_swap_b32 v25,v27
MU 28,s26
MU 29,s26
MU 30,s26
MU 31,s26
MU 40,s26
MU 41,s26
MU 42,s26
MU 43,s26
CV 28,28,29
CV 29,30,31
CV 30,40,41
CV 31,42,43
s_nop 0
v_permlane32_swap_b32 v28,v30
v_permlane32_swap_b32 v29,v31
s_nop 0
v_permlane16_swap_b32 v28,v30
v_permlane16_swap_b32 v29,v31
MU 32,s26
MU 33,s26
MU 34,s26
MU 35,s26
MU 44,s26
MU 45,s26
MU 46,s26
MU 47,s26
CV 32,32,33
CV 33,34,35
CV 34,44,45
CV 35,46,47
s_nop 0
v_permlane32_swap_b32 v32,v34
v_permlane32_swap_b32 v33,v35
s_nop 0
v_permlane16_swap_b32 v32,v34
v_permlane16_swap_b32 v33,v35
v_pk_mul_f32 v[48:49],v[48:49],s[26:27] op_sel_hi:[1,0]
v_pk_mul_f32 v[50:51],v[50:51],s[26:27] op_sel_hi:[1,0]
v_pk_mul_f32 v[60:61],v[60:61],s[26:27] op_sel_hi:[1,0]
v_pk_mul_f32 v[62:63],v[62:63],s[26:27] op_sel_hi:[1,0]
CV 48,48,49
CV 49,50,51
CV 50,60,61
CV 51,62,63
s_nop 0
v_permlane32_swap_b32 v48,v50
v_permlane32_swap_b32 v49,v51
s_nop 0
v_permlane16_swap_b32 v48,v50
v_permlane16_swap_b32 v49,v51
v_pk_mul_f32 v[52:53],v[52:53],s[26:27] op_sel_hi:[1,0]
v_pk_mul_f32 v[54:55],v[54:55],s[26:27] op_sel_hi:[1,0]
v_pk_mul_f32 v[64:65],v[64:65],s[26:27] op_sel_hi:[1,0]
v_pk_mul_f32 v[66:67],v[66:67],s[26:27] op_sel_hi:[1,0]
CV 52,52,53
CV 53,54,55
CV 54,64,65
CV 55,66,67
s_nop 0
v_permlane32_swap_b32 v52,v54
v_permlane32_swap_b32 v53,v55
s_nop 0
v_permlane16_swap_b32 v52,v54
v_permlane16_swap_b32 v53,v55
v_pk_mul_f32 v[56:57],v[56:57],s[26:27] op_sel_hi:[1,0]
v_pk_mul_f32 v[58:59],v[58:59],s[26:27] op_sel_hi:[1,0]
v_pk_mul_f32 v[68:69],v[68:69],s[26:27] op_sel_hi:[1,0]
v_pk_mul_f32 v[70:71],v[70:71],s[26:27] op_sel_hi:[1,0]
CV 56,56,57
CV 57,58,59
CV 58,68,69
CV 59,70,71
s_nop 0
v_permlane32_swap_b32 v56,v58
v_permlane32_swap_b32 v57,v59
s_nop 0
v_permlane16_swap_b32 v56,v58
v_permlane16_swap_b32 v57,v59
v_pk_mul_f32 v[72:73],v[72:73],s[26:27] op_sel_hi:[1,0]
v_pk_mul_f32 v[74:75],v[74:75],s[26:27] op_sel_hi:[1,0]
v_pk_mul_f32 v[84:85],v[84:85],s[26:27] op_sel_hi:[1,0]
v_pk_mul_f32 v[86:87],v[86:87],s[26:27] op_sel_hi:[1,0]
CV 72,72,73
CV 73,74,75
CV 74,84,85
CV 75,86,87
s_nop 0
v_permlane32_swap_b32 v72,v74
v_permlane32_swap_b32 v73,v75
s_nop 0
v_permlane16_swap_b32 v72,v74
v_permlane16_swap_b32 v73,v75
v_pk_mul_f32 v[76:77],v[76:77],s[26:27] op_sel_hi:[1,0]
v_pk_mul_f32 v[78:79],v[78:79],s[26:27] op_sel_hi:[1,0]
v_pk_mul_f32 v[88:89],v[88:89],s[26:27] op_sel_hi:[1,0]
v_pk_mul_f32 v[90:91],v[90:91],s[26:27] op_sel_hi:[1,0]
CV 76,76,77
CV 77,78,79
CV 78,88,89
CV 79,90,91
s_nop 0
v_permlane32_swap_b32 v76,v78
v_permlane32_swap_b32 v77,v79
s_nop 0
v_permlane16_swap_b32 v76,v78
v_permlane16_swap_b32 v77,v79
v_pk_mul_f32 v[80:81],v[80:81],s[26:27] op_sel_hi:[1,0]
v_pk_mul_f32 v[82:83],v[82:83],s[26:27] op_sel_hi:[1,0]
v_pk_mul_f32 v[92:93],v[92:93],s[26:27] op_sel_hi:[1,0]
v_pk_mul_f32 v[94:95],v[94:95],s[26:27] op_sel_hi:[1,0]
CV 80,80,81
CV 81,82,83
CV 82,92,93
CV 83,94,95
s_nop 0
v_permlane32_swap_b32 v80,v82
v_permlane32_swap_b32 v81,v83
s_nop 0
v_permlane16_swap_b32 v80,v82
v_permlane16_swap_b32 v81,v83
v_pk_mul_f32 v[96:97],v[96:97],s[26:27] op_sel_hi:[1,0]
v_pk_mul_f32 v[98:99],v[98:99],s[26:27] op_sel_hi:[1,0]
v_pk_mul_f32 v[100:101],v[100:101],s[26:27] op_sel_hi:[1,0]
v_pk_mul_f32 v[102:103],v[102:103],s[26:27] op_sel_hi:[1,0]
CV 96,96,97
CV 97,98,99
CV 98,100,101
CV 99,102,103
s_nop 0
v_permlane32_swap_b32 v96,v98
v_permlane32_swap_b32 v97,v99
s_nop 0
v_permlane16_swap_b32 v96,v98
v_permlane16_swap_b32 v97,v99
ds_write_b128 v249,v[96:99] offset:18432
v_mov_b32 v104,v0
v_mov_b32 v105,v1
v_mov_b32 v106,v2
v_mov_b32 v107,v3
v_mov_b32 v108,v4
v_mov_b32 v109,v5
v_mov_b32 v110,v6
v_mov_b32 v111,v7
v_mov_b32 v112,v8
v_mov_b32 v113,v9
v_mov_b32 v114,v10
v_mov_b32 v115,v11
v_mov_b32 v116,v24
v_mov_b32 v117,v25
v_mov_b32 v118,v26
v_mov_b32 v119,v27
v_mov_b32 v120,v28
v_mov_b32 v121,v29
v_mov_b32 v122,v30
v_mov_b32 v123,v31
v_mov_b32 v124,v32
v_mov_b32 v125,v33
v_mov_b32 v126,v34
v_mov_b32 v127,v35
v_mov_b32 v128,v48
v_mov_b32 v129,v49
v_mov_b32 v130,v50
v_mov_b32 v131,v51
v_mov_b32 v132,v52
v_mov_b32 v133,v53
v_mov_b32 v134,v54
v_mov_b32 v135,v55
v_mov_b32 v136,v56
v_mov_b32 v137,v57
v_mov_b32 v138,v58
v_mov_b32 v139,v59
v_mov_b32 v140,v72
v_mov_b32 v141,v73
v_mov_b32 v142,v74
v_mov_b32 v143,v75
v_mov_b32 v144,v76
v_mov_b32 v145,v77
v_mov_b32 v146,v78
v_mov_b32 v147,v79
v_mov_b32 v148,v80
v_mov_b32 v149,v81
v_mov_b32 v150,v82
v_mov_b32 v151,v83
s_add_u32 s10,s10,256
s_addc_u32 s11,s11,0
s_add_u32 s20,s20,1
LA_w2:
LG 0
Za 0,192,0
TR 208,248,32
v_subrev_u32 v255,135168,v249
s_mov_b32 m0,109824
s_lshl_b32 s30,s20,17
Ma 0,196,12
TR 210,248,8480
v_lshrrev_b32 v255,6,v255
s_add_u32 s38,s6,s30
s_addc_u32 s39,s7,0
s_add_u32 s38,s38,63488
s_addc_u32 s39,s39,0
Ma 0,200,24
TR 212,248,544
v_lshlrev_b32 v255,11,v255
s_lshl_b32 s30,s20,17
Ma 0,204,36
TR 214,248,8992
Za 4,192,4
TR 216,248,16928
Ma 4,196,16
TR 218,248,25376
Ma 4,200,28
TR 220,248,17440
Ma 4,204,40
TR 222,248,25888
Za 8,192,8
DW 250,16,0
s_mov_b32 m0,110624
Ma 8,196,20
TR 192,248,64
Ma 8,200,32
TR 194,248,8512
Ma 8,204,44
TR 196,248,576
LG 9
Za 12,208,0
TR 198,248,9024
LG 8
Ma 12,212,12
TR 200,248,16960
LG 7
Ma 12,216,24
TR 202,248,25408
LG 6
Ma 12,220,36
DW 251,16,256
s_mov_b32 m0,111424
Za 16,208,4
TR 204,248,17472
Ma 16,212,16
TR 206,248,25920
Ma 16,216,28
Ma 16,220,40
Za 20,208,8
TR 208,248,96
Ma 20,212,20
TR 210,248,8544
Ma 20,216,32
TR 212,248,608
Ma 20,220,44
TR 214,248,9056
LG 10
Za 24,192,0
TR 216,248,16992
LG 9
Ma 24,196,12
DW 252,16,512
s_mov_b32 m0,112224
LG 7
Ma 24,200,24
TR 218,248,25440
LG 6
Ma 24,204,36
TR 220,248,17504
Za 28,192,4
TR 222,248,25952
Ma 28,196,16
Ma 28,200,28
Ma 28,204,40
Za 32,192,8
TR 192,248,128
Ma 32,196,20
TR 194,248,8576
Ma 32,200,32
TR 196,248,640
Ma 32,204,44
DW 253,16,768
s_mov_b32 m0,126720
s_add_u32 s16,s10,256
s_addc_u32 s17,s11,0
LG 9
Za 36,208,0
TR 198,248,9088
LG 8
Ma 36,212,12
TR 200,248,17024
LG 7
Ma 36,216,24
TR 202,248,25472
LG 6
Ma 36,220,36
TR 204,248,17536
Za 40,208,4
TR 206,248,25984
Ma 40,212,16
Ma 40,216,28
Ma 40,220,40
Za 44,208,8
TR 208,248,160
Ma 44,212,20
DW 250,18,0
s_mov_b32 m0,127520
Ma 44,216,32
TR 210,248,8608
Ma 44,220,44
TR 212,248,672
LG 9
Za 48,192,0
TR 214,248,9120
LG 8
Ma 48,196,12
TR 216,248,17056
LG 7
Ma 48,200,24
TR 218,248,25504
LG 6
Ma 48,204,36
TR 220,248,17568
Za 52,192,4
TR 222,248,26016
Ma 52,196,16
Ma 52,200,28
Ma 52,204,40
DW 251,18,256
s_mov_b32 m0,128320
Za 56,192,8
Ma 56,196,20
Ma 56,200,32
Ma 56,204,44
Za 96,192,224
TR 192,248,192
Ma 96,196,228
TR 194,248,8640
Ma 96,200,232
TR 196,248,704
Ma 96,204,236
TR 198,248,9152
LG 10
Za 60,208,0
TR 200,248,17088
LG 9
Ma 60,212,12
DW 252,18,512
s_mov_b32 m0,129120
LG 7
Ma 60,216,24
TR 202,248,25536
LG 6
Ma 60,220,36
TR 204,248,17600
Za 64,208,4
TR 206,248,26048
Ma 64,212,16
Ma 64,216,28
Ma 64,220,40
Za 68,208,8
Ma 68,212,20
Ma 68,216,32
Ma 68,220,44
DW 253,18,768
s_mov_b32 m0,8448
s_add_u32 s18,s10,524544
s_addc_u32 s19,s11,0
Za 100,208,224
TR 208,248,224
Ma 100,212,228
TR 210,248,8672
Ma 100,216,232
TR 212,248,736
Ma 100,220,236
TR 214,248,9184
LG 10
Za 72,192,0
TR 216,248,17120
LG 9
Ma 72,196,12
TR 218,248,25568
LG 8
Ma 72,200,24
TR 220,248,17632
LG 7
Ma 72,204,36
TR 222,248,26080
Za 76,192,4
Ma 76,196,16
Ma 76,200,28
Ma 76,204,40
Za 80,192,8
Ma 80,196,20
Ma 80,200,32
Ma 80,204,44
LG 6
Za 84,208,0
LG 4
Ma 84,212,12
LG 2
Ma 84,216,24
LG 0
Ma 84,220,36
s_waitcnt vmcnt(17) lgkmcnt(0)
s_barrier
Za 88,208,4
TR 192,248,33792
Ma 88,212,16
TR 194,248,42240
Ma 88,216,28
TR 196,248,34304
Ma 88,220,40
TR 198,248,42752
Za 92,208,8
TR 200,248,50688
TR 202,248,59136
Ma 92,212,20
TR 204,248,51200
TR 206,248,59648
Ma 92,216,32
DW 250,16,0
s_mov_b32 m0,9248
Ma 92,220,44
RD 224,254,4096
LG 7
Ma 0,192,48
RD 228,254,5120
LG 6
Ma 0,196,60
RD 232,254,6144
LG 5
Ma 0,200,72
RD 236,254,7168
LG 4
Ma 0,204,84
TR 208,248,33824
Ma 4,192,52
TR 210,248,42272
Ma 4,196,64
TR 212,248,34336
Ma 4,200,76
TR 214,248,42784
Ma 4,204,88
TR 216,248,50720
Ma 8,192,56
TR 218,248,59168
Ma 8,196,68
TR 220,248,51232
TR 222,248,59680
Ma 8,200,80
DW 251,16,256
s_mov_b32 m0,10048
Ma 8,204,92
TR 192,248,33856
LG 7
Ma 12,208,48
TR 194,248,42304
LG 6
Ma 12,212,60
TR 196,248,34368
LG 5
Ma 12,216,72
TR 198,248,42816
LG 4
Ma 12,220,84
TR 200,248,50752
Ma 16,208,52
TR 202,248,59200
Ma 16,212,64
TR 204,248,51264
Ma 16,216,76
TR 206,248,59712
Ma 16,220,88
Ma 20,208,56
DW 252,16,512
s_mov_b32 m0,10848
Ma 20,212,68
TR 208,248,33888
Ma 20,216,80
TR 210,248,42336
Ma 20,220,92
TR 212,248,34400
LG 9
Ma 24,192,48
TR 214,248,42848
LG 8
Ma 24,196,60
TR 216,248,50784
LG 7
Ma 24,200,72
TR 218,248,59232
LG 6
Ma 24,204,84
TR 220,248,51296
Ma 28,192,52
TR 222,248,59744
Ma 28,196,64
Ma 28,200,76
Ma 28,204,88
DW 253,16,768
s_mov_b32 m0,25344
s_add_u32 s16,s10,1048832
s_addc_u32 s17,s11,0
Ma 32,192,56
TR 192,248,33920
Ma 32,196,68
TR 194,248,42368
Ma 32,200,80
TR 196,248,34432
Ma 32,204,92
TR 198,248,42880
LG 10
Ma 36,208,48
TR 200,248,50816
LG 9
Ma 36,212,60
TR 202,248,59264
LG 8
Ma 36,216,72
TR 204,248,51328
LG 7
Ma 36,220,84
TR 206,248,59776
Ma 40,208,52
Ma 40,212,64
Ma 40,216,76
DW 250,18,0
s_mov_b32 m0,26144
Ma 40,220,88
Ma 44,208,56
TR 208,248,33952
Ma 44,212,68
TR 210,248,42400
Ma 44,216,80
TR 212,248,34464
Ma 44,220,92
TR 214,248,42912
LG 10
Ma 48,192,48
TR 216,248,50848
LG 9
Ma 48,196,60
TR 218,248,59296
LG 8
Ma 48,200,72
TR 220,248,51360
LG 7
Ma 48,204,84
TR 222,248,59808
Ma 52,192,52
Ma 52,196,64
DW 251,18,256
s_mov_b32 m0,26944
Ma 52,200,76
Ma 52,204,88
Ma 56,192,56
Ma 56,196,68
Ma 56,200,80
Ma 56,204,92
Ma 96,192,224
TR 192,248,33984
Ma 96,196,228
TR 194,248,42432
Ma 96,200,232
TR 196,248,34496
Ma 96,204,236
TR 198,248,42944
LG 10
Ma 60,208,48
DW 252,18,512
s_mov_b32 m0,27744
LG 8
Ma 60,212,60
TR 200,248,50880
LG 7
Ma 60,216,72
TR 202,248,59328
LG 6
Ma 60,220,84
TR 204,248,51392
Ma 64,208,52
TR 206,248,59840
Ma 64,212,64
Ma 64,216,76
Ma 64,220,88
Ma 68,208,56
Ma 68,212,68
Ma 68,216,80
Ma 68,220,92
DW 253,18,768
s_mov_b32 m0,42240
s_add_u32 s18,s10,1573120
s_addc_u32 s19,s11,0
Ma 100,208,224
global_load_dword a253,v255,s[38:39]
s_add_u32 s38,s8,s30
s_addc_u32 s39,s9,0
s_add_u32 s38,s38,63488
s_addc_u32 s39,s39,0
Ma 100,212,228
TR 208,248,34016
v_subrev_u32 v255,135168,v249
Ma 100,216,232
TR 210,248,42464
v_lshrrev_b32 v255,6,v255
Ma 100,220,236
TR 212,248,34528
v_lshlrev_b32 v255,11,v255
LG 9
Ma 72,192,48
TR 214,248,42976
LG 8
Ma 72,196,60
TR 216,248,50912
LG 7
Ma 72,200,72
TR 218,248,59360
LG 6
Ma 72,204,84
TR 220,248,51424
Ma 76,192,52
TR 222,248,59872
v_add_u32 v248,67584,v248
Ma 76,196,64
Ma 76,200,76
Ma 76,204,88
Ma 80,192,56
Ma 80,196,68
Ma 80,200,80
Ma 80,204,92
LG 6
Ma 84,208,48
LG 4
Ma 84,212,60
LG 2
Ma 84,216,72
LG 0
Ma 84,220,84
s_waitcnt vmcnt(17) lgkmcnt(0)
s_barrier
Ma 88,208,52
TR 192,248,0
Ma 88,212,64
TR 194,248,8448
Ma 88,216,76
TR 196,248,512
Ma 88,220,88
TR 198,248,8960
Ma 92,208,56
TR 200,248,16896
TR 202,248,25344
Ma 92,212,68
TR 204,248,17408
TR 206,248,25856
Ma 92,216,80
DW 250,16,0
s_mov_b32 m0,43040
Ma 92,220,92
RD 224,254,8192
LG 7
Ma 0,192,96
RD 228,254,9216
LG 6
Ma 0,196,108
RD 232,254,10240
LG 5
Ma 0,200,120
RD 236,254,11264
LG 4
Ma 0,204,132
TR 208,248,32
Ma 4,192,100
TR 210,248,8480
Ma 4,196,112
TR 212,248,544
Ma 4,200,124
TR 214,248,8992
Ma 4,204,136
TR 216,248,16928
Ma 8,192,104
TR 218,248,25376
Ma 8,196,116
TR 220,248,17440
TR 222,248,25888
Ma 8,200,128
DW 251,16,256
s_mov_b32 m0,43840
Ma 8,204,140
TR 192,248,64
LG 7
Ma 12,208,96
TR 194,248,8512
LG 6
Ma 12,212,108
TR 196,248,576
LG 5
Ma 12,216,120
TR 198,248,9024
LG 4
Ma 12,220,132
TR 200,248,16960
Ma 16,208,100
TR 202,248,25408
Ma 16,212,112
TR 204,248,17472
Ma 16,216,124
TR 206,248,25920
Ma 16,220,136
Ma 20,208,104
DW 252,16,512
s_mov_b32 m0,44640
Ma 20,212,116
TR 208,248,96
Ma 20,216,128
TR 210,248,8544
Ma 20,220,140
TR 212,248,608
LG 9
Ma 24,192,96
TR 214,248,9056
LG 8
Ma 24,196,108
TR 216,248,16992
LG 7
Ma 24,200,120
TR 218,248,25440
LG 6
Ma 24,204,132
TR 220,248,17504
Ma 28,192,100
TR 222,248,25952
Ma 28,196,112
Ma 28,200,124
Ma 28,204,136
DW 253,16,768
s_mov_b32 m0,59136
s_add_u32 s16,s10,2097408
s_addc_u32 s17,s11,0
Ma 32,192,104
TR 192,248,128
Ma 32,196,116
TR 194,248,8576
Ma 32,200,128
TR 196,248,640
Ma 32,204,140
TR 198,248,9088
LG 10
Ma 36,208,96
TR 200,248,17024
LG 9
Ma 36,212,108
TR 202,248,25472
LG 8
Ma 36,216,120
TR 204,248,17536
LG 7
Ma 36,220,132
TR 206,248,25984
Ma 40,208,100
Ma 40,212,112
Ma 40,216,124
DW 250,18,0
s_mov_b32 m0,59936
Ma 40,220,136
Ma 44,208,104
TR 208,248,160
Ma 44,212,116
TR 210,248,8608
Ma 44,216,128
TR 212,248,672
Ma 44,220,140
TR 214,248,9120
LG 10
Ma 48,192,96
TR 216,248,17056
LG 9
Ma 48,196,108
TR 218,248,25504
LG 8
Ma 48,200,120
TR 220,248,17568
LG 7
Ma 48,204,132
TR 222,248,26016
Ma 52,192,100
Ma 52,196,112
DW 251,18,256
s_mov_b32 m0,60736
Ma 52,200,124
Ma 52,204,136
Ma 56,192,104
Ma 56,196,116
Ma 56,200,128
Ma 56,204,140
Ma 96,192,224
TR 192,248,192
Ma 96,196,228
TR 194,248,8640
Ma 96,200,232
TR 196,248,704
Ma 96,204,236
TR 198,248,9152
LG 10
Ma 60,208,96
DW 252,18,512
s_mov_b32 m0,61536
LG 8
Ma 60,212,108
TR 200,248,17088
LG 7
Ma 60,216,120
TR 202,248,25536
LG 6
Ma 60,220,132
TR 204,248,17600
Ma 64,208,100
TR 206,248,26048
Ma 64,212,112
Ma 64,216,124
Ma 64,220,136
Ma 68,208,104
Ma 68,212,116
Ma 68,216,128
Ma 68,220,140
DW 253,18,768
s_mov_b32 m0,76032
s_add_u32 s18,s10,2621696
s_addc_u32 s19,s11,0
Ma 100,208,224
global_load_dword a253,v255,s[38:39]
Ma 100,212,228
TR 208,248,224
Ma 100,216,232
TR 210,248,8672
Ma 100,220,236
TR 212,248,736
LG 9
Ma 72,192,96
TR 214,248,9184
LG 8
Ma 72,196,108
TR 216,248,17120
LG 7
Ma 72,200,120
TR 218,248,25568
LG 6
Ma 72,204,132
TR 220,248,17632
Ma 76,192,100
TR 222,248,26080
Ma 76,196,112
Ma 76,200,124
Ma 76,204,136
Ma 80,192,104
Ma 80,196,116
Ma 80,200,128
Ma 80,204,140
LG 6
Ma 84,208,96
LG 4
Ma 84,212,108
LG 2
Ma 84,216,120
LG 0
Ma 84,220,132
s_waitcnt vmcnt(18) lgkmcnt(0)
s_barrier
Ma 88,208,100
TR 192,248,33792
Ma 88,212,112
TR 194,248,42240
Ma 88,216,124
TR 196,248,34304
Ma 88,220,136
TR 198,248,42752
Ma 92,208,104
TR 200,248,50688
TR 202,248,59136
Ma 92,212,116
TR 204,248,51200
TR 206,248,59648
Ma 92,216,128
DW 250,16,0
s_mov_b32 m0,76832
Ma 92,220,140
RD 224,254,12288
LG 7
Ma 0,192,144
RD 228,254,13312
LG 6
Ma 0,196,156
RD 232,254,14336
LG 5
Ma 0,200,168
RD 236,254,15360
LG 4
Ma 0,204,180
TR 208,248,33824
Ma 4,192,148
TR 210,248,42272
Ma 4,196,160
TR 212,248,34336
Ma 4,200,172
TR 214,248,42784
s_nop 0
MU 0,s26
Ma 4,204,184
TR 216,248,50720
MU 1,s26
Ma 8,192,152
TR 218,248,59168
MU 2,s26
Ma 8,196,164
TR 220,248,51232
TR 222,248,59680
Ma 8,200,176
DW 251,16,256
s_mov_b32 m0,77632
Ma 8,204,188
TR 192,248,33856
MU 3,s26
LG 7
Ma 12,208,144
TR 194,248,42304
CV 0,0,1
LG 6
Ma 12,212,156
TR 196,248,34368
CV 1,2,3
LG 5
Ma 12,216,168
TR 198,248,42816
MU 4,s26
LG 4
Ma 12,220,180
TR 200,248,50752
MU 5,s26
Ma 16,208,148
TR 202,248,59200
MU 6,s26
Ma 16,212,160
TR 204,248,51264
MU 7,s26
Ma 16,216,172
TR 206,248,59712
MU 12,s26
Ma 16,220,184
MU 13,s26
MU 14,s26
Ma 20,208,152
DW 252,16,512
s_mov_b32 m0,78432
Ma 20,212,164
TR 208,248,33888
MU 15,s26
Ma 20,216,176
TR 210,248,42336
CV 2,12,13
Ma 20,220,188
TR 212,248,34400
CV 3,14,15
LG 9
Ma 24,192,144
TR 214,248,42848
v_permlane32_swap_b32 v0,v2
LG 8
Ma 24,196,156
TR 216,248,50784
v_permlane32_swap_b32 v1,v3
LG 7
Ma 24,200,168
TR 218,248,59232
v_permlane16_swap_b32 v0,v2
LG 6
Ma 24,204,180
TR 220,248,51296
v_permlane16_swap_b32 v1,v3
Ma 28,192,148
TR 222,248,59744
MU 16,s26
Ma 28,196,160
MU 17,s26
MU 18,s26
Ma 28,200,172
MU 19,s26
CV 4,4,5
Ma 28,204,184
DW 253,16,768
s_mov_b32 m0,92928
s_add_u32 s16,s10,3145984
s_addc_u32 s17,s11,0
Ma 32,192,152
TR 192,248,33920
CV 5,6,7
Ma 32,196,164
TR 194,248,42368
CV 6,16,17
Ma 32,200,176
TR 196,248,34432
CV 7,18,19
Ma 32,204,188
TR 198,248,42880
v_permlane32_swap_b32 v4,v6
LG 10
Ma 36,208,144
TR 200,248,50816
v_permlane32_swap_b32 v5,v7
LG 9
Ma 36,212,156
TR 202,248,59264
v_permlane16_swap_b32 v4,v6
LG 8
Ma 36,216,168
TR 204,248,51328
v_permlane16_swap_b32 v5,v7
LG 7
Ma 36,220,180
TR 206,248,59776
MU 8,s26
Ma 40,208,148
MU 9,s26
MU 10,s26
Ma 40,212,160
MU 11,s26
MU 20,s26
Ma 40,216,172
DW 250,18,0
s_mov_b32 m0,93728
Ma 40,220,184
MU 21,s26
MU 22,s26
Ma 44,208,152
TR 208,248,33952
MU 23,s26
Ma 44,212,164
TR 210,248,42400
CV 8,8,9
Ma 44,216,176
TR 212,248,34464
CV 9,10,11
Ma 44,220,188
TR 214,248,42912
CV 10,20,21
LG 10
Ma 48,192,144
TR 216,248,50848
CV 11,22,23
LG 9
Ma 48,196,156
TR 218,248,59296
v_permlane32_swap_b32 v8,v10
LG 8
Ma 48,200,168
TR 220,248,51360
v_permlane32_swap_b32 v9,v11
LG 7
Ma 48,204,180
TR 222,248,59808
v_permlane16_swap_b32 v8,v10
Ma 52,192,148
v_permlane16_swap_b32 v9,v11
MU 24,s26
Ma 52,196,160
DW 251,18,256
s_mov_b32 m0,94528
Ma 52,200,172
MU 25,s26
MU 26,s26
Ma 52,204,184
MU 27,s26
MU 36,s26
Ma 56,192,152
MU 37,s26
MU 38,s26
Ma 56,196,164
MU 39,s26
CV 24,24,25
Ma 56,200,176
CV 25,26,27
CV 26,36,37
Ma 56,204,188
CV 27,38,39
v_permlane32_swap_b32 v24,v26
Ma 96,192,224
TR 192,248,33984
v_permlane32_swap_b32 v25,v27
Ma 96,196,228
TR 194,248,42432
v_permlane16_swap_b32 v24,v26
Ma 96,200,232
TR 196,248,34496
v_permlane16_swap_b32 v25,v27
Ma 96,204,236
TR 198,248,42944
MU 28,s26
LG 10
Ma 60,208,144
DW 252,18,512
s_mov_b32 m0,95328
LG 8
Ma 60,212,156
TR 200,248,50880
MU 29,s26
LG 7
Ma 60,216,168
TR 202,248,59328
MU 30,s26
LG 6
Ma 60,220,180
TR 204,248,51392
MU 31,s26
Ma 64,208,148
TR 206,248,59840
MU 40,s26
Ma 64,212,160
MU 41,s26
MU 42,s26
Ma 64,216,172
MU 43,s26
CV 28,28,29
Ma 64,220,184
CV 29,30,31
CV 30,40,41
Ma 68,208,152
CV 31,42,43
v_permlane32_swap_b32 v28,v30
Ma 68,212,164
v_permlane32_swap_b32 v29,v31
v_permlane16_swap_b32 v28,v30
Ma 68,216,176
v_permlane16_swap_b32 v29,v31
MU 32,s26
Ma 68,220,188
DW 253,18,768
s_add_u32 s18,s10,3670272
s_addc_u32 s19,s11,0
Ma 100,208,224
TR 208,248,34016
MU 33,s26
Ma 100,212,228
TR 210,248,42464
MU 34,s26
Ma 100,216,232
TR 212,248,34528
MU 35,s26
Ma 100,220,236
TR 214,248,42976
MU 44,s26
LG 10
Ma 72,192,144
TR 216,248,50912
MU 45,s26
LG 9
Ma 72,196,156
TR 218,248,59360
MU 46,s26
LG 8
Ma 72,200,168
TR 220,248,51424
MU 47,s26
LG 7
Ma 72,204,180
TR 222,248,59872
v_add_u32 v248,4294899712,v248
Ma 76,192,148
CV 32,32,33
CV 33,34,35
Ma 76,196,160
CV 34,44,45
CV 35,46,47
Ma 76,200,172
v_permlane32_swap_b32 v32,v34
v_permlane32_swap_b32 v33,v35
Ma 76,204,184
v_permlane16_swap_b32 v32,v34
v_permlane16_swap_b32 v33,v35
Ma 80,192,152
Ma 80,196,164
Ma 80,200,176
Ma 80,204,188
LG 6
Ma 84,208,144
LG 4
Ma 84,212,156
LG 2
Ma 84,216,168
LG 0
Ma 84,220,180
s_waitcnt vmcnt(18) lgkmcnt(0)
s_barrier
Ma 88,208,148
TR 192,248,0
Ma 88,212,160
TR 194,248,8448
Ma 88,216,172
TR 196,248,512
TR 198,248,8960
Ma 88,220,184
TR 200,248,16896
TR 202,248,25344
Ma 92,208,152
TR 204,248,17408
TR 206,248,25856
Ma 92,212,164
RD 224,254,0
RD 228,254,1024
Ma 92,216,176
RD 232,254,2048
RD 236,254,3072
Ma 92,220,188
v_pk_mul_f32 v[48:49],v[48:49],s[26:27] op_sel_hi:[1,0]
v_pk_mul_f32 v[50:51],v[50:51],s[26:27] op_sel_hi:[1,0]
v_pk_mul_f32 v[60:61],v[60:61],s[26:27] op_sel_hi:[1,0]
v_pk_mul_f32 v[62:63],v[62:63],s[26:27] op_sel_hi:[1,0]
CV 48,48,49
CV 49,50,51
CV 50,60,61
CV 51,62,63
s_nop 0
v_permlane32_swap_b32 v48,v50
v_permlane32_swap_b32 v49,v51
s_nop 0
v_permlane16_swap_b32 v48,v50
v_permlane16_swap_b32 v49,v51
v_pk_mul_f32 v[52:53],v[52:53],s[26:27] op_sel_hi:[1,0]
v_pk_mul_f32 v[54:55],v[54:55],s[26:27] op_sel_hi:[1,0]
v_pk_mul_f32 v[64:65],v[64:65],s[26:27] op_sel_hi:[1,0]
v_pk_mul_f32 v[66:67],v[66:67],s[26:27] op_sel_hi:[1,0]
CV 52,52,53
CV 53,54,55
CV 54,64,65
CV 55,66,67
s_nop 0
v_permlane32_swap_b32 v52,v54
v_permlane32_swap_b32 v53,v55
s_nop 0
v_permlane16_swap_b32 v52,v54
v_permlane16_swap_b32 v53,v55
v_pk_mul_f32 v[56:57],v[56:57],s[26:27] op_sel_hi:[1,0]
v_pk_mul_f32 v[58:59],v[58:59],s[26:27] op_sel_hi:[1,0]
v_pk_mul_f32 v[68:69],v[68:69],s[26:27] op_sel_hi:[1,0]
v_pk_mul_f32 v[70:71],v[70:71],s[26:27] op_sel_hi:[1,0]
CV 56,56,57
CV 57,58,59
CV 58,68,69
CV 59,70,71
s_nop 0
v_permlane32_swap_b32 v56,v58
v_permlane32_swap_b32 v57,v59
s_nop 0
v_permlane16_swap_b32 v56,v58
v_permlane16_swap_b32 v57,v59
v_pk_mul_f32 v[72:73],v[72:73],s[26:27] op_sel_hi:[1,0]
v_pk_mul_f32 v[74:75],v[74:75],s[26:27] op_sel_hi:[1,0]
v_pk_mul_f32 v[84:85],v[84:85],s[26:27] op_sel_hi:[1,0]
v_pk_mul_f32 v[86:87],v[86:87],s[26:27] op_sel_hi:[1,0]
CV 72,72,73
CV 73,74,75
CV 74,84,85
CV 75,86,87
s_nop 0
v_permlane32_swap_b32 v72,v74
v_permlane32_swap_b32 v73,v75
s_nop 0
v_permlane16_swap_b32 v72,v74
v_permlane16_swap_b32 v73,v75
v_pk_mul_f32 v[76:77],v[76:77],s[26:27] op_sel_hi:[1,0]
v_pk_mul_f32 v[78:79],v[78:79],s[26:27] op_sel_hi:[1,0]
v_pk_mul_f32 v[88:89],v[88:89],s[26:27] op_sel_hi:[1,0]
v_pk_mul_f32 v[90:91],v[90:91],s[26:27] op_sel_hi:[1,0]
CV 76,76,77
CV 77,78,79
CV 78,88,89
CV 79,90,91
s_nop 0
v_permlane32_swap_b32 v76,v78
v_permlane32_swap_b32 v77,v79
s_nop 0
v_permlane16_swap_b32 v76,v78
v_permlane16_swap_b32 v77,v79
v_pk_mul_f32 v[80:81],v[80:81],s[26:27] op_sel_hi:[1,0]
v_pk_mul_f32 v[82:83],v[82:83],s[26:27] op_sel_hi:[1,0]
v_pk_mul_f32 v[92:93],v[92:93],s[26:27] op_sel_hi:[1,0]
v_pk_mul_f32 v[94:95],v[94:95],s[26:27] op_sel_hi:[1,0]
CV 80,80,81
CV 81,82,83
CV 82,92,93
CV 83,94,95
s_nop 0
v_permlane32_swap_b32 v80,v82
v_permlane32_swap_b32 v81,v83
s_nop 0
v_permlane16_swap_b32 v80,v82
v_permlane16_swap_b32 v81,v83
v_pk_mul_f32 v[96:97],v[96:97],s[26:27] op_sel_hi:[1,0]
v_pk_mul_f32 v[98:99],v[98:99],s[26:27] op_sel_hi:[1,0]
v_pk_mul_f32 v[100:101],v[100:101],s[26:27] op_sel_hi:[1,0]
v_pk_mul_f32 v[102:103],v[102:103],s[26:27] op_sel_hi:[1,0]
CV 96,96,97
CV 97,98,99
CV 98,100,101
CV 99,102,103
s_nop 0
v_permlane32_swap_b32 v96,v98
v_permlane32_swap_b32 v97,v99
s_nop 0
v_permlane16_swap_b32 v96,v98
v_permlane16_swap_b32 v97,v99
s_cmp_eq_u32 s20,1
s_cbranch_scc0 EA2_w2
ds_write_b128 v249,v[96:99] offset:22528
v_mov_b32 v152,v0
v_mov_b32 v153,v1
v_mov_b32 v154,v2
v_mov_b32 v155,v3
v_mov_b32 v156,v4
v_mov_b32 v157,v5
v_mov_b32 v158,v6
v_mov_b32 v159,v7
v_mov_b32 v160,v8
v_mov_b32 v161,v9
v_mov_b32 v162,v10
v_mov_b32 v163,v11
v_mov_b32 v164,v24
v_mov_b32 v165,v25
v_mov_b32 v166,v26
v_mov_b32 v167,v27
v_mov_b32 v168,v28
v_mov_b32 v169,v29
v_mov_b32 v170,v30
v_mov_b32 v171,v31
v_mov_b32 v172,v32
v_mov_b32 v173,v33
v_mov_b32 v174,v34
v_mov_b32 v175,v35
v_mov_b32 v176,v48
v_mov_b32 v177,v49
v_mov_b32 v178,v50
v_mov_b32 v179,v51
v_mov_b32 v180,v52
v_mov_b32 v181,v53
v_mov_b32 v182,v54
v_mov_b32 v183,v55
v_mov_b32 v184,v56
v_mov_b32 v185,v57
v_mov_b32 v186,v58
v_mov_b32 v187,v59
v_mov_b32 v188,v72
v_mov_b32 v189,v73
v_mov_b32 v190,v74
v_mov_b32 v191,v75
v_mov_b32 v192,v76
v_mov_b32 v193,v77
v_mov_b32 v194,v78
v_mov_b32 v195,v79
v_mov_b32 v196,v80
v_mov_b32 v197,v81
v_mov_b32 v198,v82
v_mov_b32 v199,v83
s_add_u32 s10,s10,256
s_addc_u32 s11,s11,0
s_add_u32 s20,s20,1
s_branch LA_w2
EA2_w2:
ds_write_b128 v249,v[96:99] offset:26624
v_mov_b32 v200,v0
v_mov_b32 v201,v1
v_mov_b32 v202,v2
v_mov_b32 v203,v3
v_mov_b32 v204,v4
v_mov_b32 v205,v5
v_mov_b32 v206,v6
v_mov_b32 v207,v7
v_mov_b32 v208,v8
v_mov_b32 v209,v9
v_mov_b32 v210,v10
v_mov_b32 v211,v11
v_mov_b32 v212,v24
v_mov_b32 v213,v25
v_mov_b32 v214,v26
v_mov_b32 v215,v27
v_mov_b32 v216,v28
v_mov_b32 v217,v29
v_mov_b32 v218,v30
v_mov_b32 v219,v31
v_mov_b32 v220,v32
v_mov_b32 v221,v33
v_mov_b32 v222,v34
v_mov_b32 v223,v35
v_mov_b32 v224,v48
v_mov_b32 v225,v49
v_mov_b32 v226,v50
v_mov_b32 v227,v51
v_mov_b32 v228,v52
v_mov_b32 v229,v53
v_mov_b32 v230,v54
v_mov_b32 v231,v55
v_mov_b32 v232,v56
v_mov_b32 v233,v57
v_mov_b32 v234,v58
v_mov_b32 v235,v59
v_mov_b32 v236,v72
v_mov_b32 v237,v73
v_mov_b32 v238,v74
v_mov_b32 v239,v75
v_mov_b32 v240,v76
v_mov_b32 v241,v77
v_mov_b32 v242,v78
v_mov_b32 v243,v79
v_mov_b32 v244,v80
v_mov_b32 v245,v81
v_mov_b32 v246,v82
v_mov_b32 v247,v83
s_add_u32 s10,s10,256
s_addc_u32 s11,s11,0
s_add_u32 s20,s20,1
LG 0
Za 0,192,0
TR 208,248,32
v_subrev_u32 v255,135168,v249
s_mov_b32 m0,109824
Ma 0,196,12
TR 210,248,8480
Ma 0,200,24
TR 212,248,544
Ma 0,204,36
TR 214,248,8992
Za 4,192,4
TR 216,248,16928
Ma 4,196,16
TR 218,248,25376
Ma 4,200,28
TR 220,248,17440
Ma 4,204,40
TR 222,248,25888
Za 8,192,8
DW 250,16,0
s_mov_b32 m0,110624
Ma 8,196,20
TR 192,248,64
Ma 8,200,32
TR 194,248,8512
Ma 8,204,44
TR 196,248,576
LG 9
Za 12,208,0
TR 198,248,9024
LG 8
Ma 12,212,12
TR 200,248,16960
LG 7
Ma 12,216,24
TR 202,248,25408
LG 6
Ma 12,220,36
DW 251,16,256
s_mov_b32 m0,111424
Za 16,208,4
TR 204,248,17472
Ma 16,212,16
TR 206,248,25920
Ma 16,216,28
Ma 16,220,40
Za 20,208,8
TR 208,248,96
Ma 20,212,20
TR 210,248,8544
Ma 20,216,32
TR 212,248,608
Ma 20,220,44
TR 214,248,9056
LG 10
Za 24,192,0
TR 216,248,16992
LG 9
Ma 24,196,12
DW 252,16,512
s_mov_b32 m0,112224
LG 7
Ma 24,200,24
TR 218,248,25440
LG 6
Ma 24,204,36
TR 220,248,17504
Za 28,192,4
TR 222,248,25952
Ma 28,196,16
Ma 28,200,28
Ma 28,204,40
Za 32,192,8
TR 192,248,128
Ma 32,196,20
TR 194,248,8576
Ma 32,200,32
TR 196,248,640
Ma 32,204,44
DW 253,16,768
s_mov_b32 m0,126720
s_add_u32 s16,s6,0
s_addc_u32 s17,s7,0
LG 9
Za 36,208,0
TR 198,248,9088
LG 8
Ma 36,212,12
TR 200,248,17024
LG 7
Ma 36,216,24
TR 202,248,25472
LG 6
Ma 36,220,36
TR 204,248,17536
Za 40,208,4
TR 206,248,25984
Ma 40,212,16
Ma 40,216,28
Ma 40,220,40
Za 44,208,8
TR 208,248,160
Ma 44,212,20
DW 250,18,0
s_mov_b32 m0,127520
Ma 44,216,32
TR 210,248,8608
v_and_b32 v250,0xf0,v255
Ma 44,220,44
TR 212,248,672
v_lshrrev_b32 v255,8,v255
LG 9
Za 48,192,0
TR 214,248,9120
v_lshl_add_u32 v250,v255,12,v250
LG 8
Ma 48,196,12
TR 216,248,17056
LG 7
Ma 48,200,24
TR 218,248,25504
LG 6
Ma 48,204,36
TR 220,248,17568
Za 52,192,4
TR 222,248,26016
Ma 52,196,16
Ma 52,200,28
Ma 52,204,40
DW 251,18,256
s_mov_b32 m0,128320
Za 56,192,8
v_mov_b32 v251,v250
Ma 56,196,20
Ma 56,200,32
Ma 56,204,44
Za 96,192,224
TR 192,248,192
Ma 96,196,228
TR 194,248,8640
Ma 96,200,232
TR 196,248,704
Ma 96,204,236
TR 198,248,9152
LG 10
Za 60,208,0
TR 200,248,17088
LG 9
Ma 60,212,12
DW 252,18,512
s_mov_b32 m0,129120
LG 7
Ma 60,216,24
TR 202,248,25536
v_mov_b32 v252,v250
LG 6
Ma 60,220,36
TR 204,248,17600
Za 64,208,4
TR 206,248,26048
Ma 64,212,16
Ma 64,216,28
Ma 64,220,40
Za 68,208,8
Ma 68,212,20
Ma 68,216,32
Ma 68,220,44
DW 253,18,768
s_mov_b32 m0,8448
s_add_u32 s18,s6,16384
s_addc_u32 s19,s7,0
Za 100,208,224
TR 208,248,224
v_mov_b32 v253,v250
Ma 100,212,228
TR 210,248,8672
Ma 100,216,232
TR 212,248,736
Ma 100,220,236
TR 214,248,9184
LG 10
Za 72,192,0
TR 216,248,17120
LG 9
Ma 72,196,12
TR 218,248,25568
LG 8
Ma 72,200,24
TR 220,248,17632
LG 7
Ma 72,204,36
TR 222,248,26080
Za 76,192,4
Ma 76,196,16
Ma 76,200,28
Ma 76,204,40
Za 80,192,8
Ma 80,196,20
Ma 80,200,32
Ma 80,204,44
LG 6
Za 84,208,0
AW 0,104
AW 1,105
LG 4
Ma 84,212,12
AW 2,106
AW 3,107
LG 2
Ma 84,216,24
AW 12,116
AW 13,117
LG 0
Ma 84,220,36
AW 14,118
AW 15,119
s_waitcnt vmcnt(17) lgkmcnt(0)
s_barrier
Za 88,208,4
TR 192,248,33792
AW 4,108
Ma 88,212,16
TR 194,248,42240
AW 5,109
Ma 88,216,28
TR 196,248,34304
AW 6,110
Ma 88,220,40
TR 198,248,42752
AW 7,111
Za 92,208,8
TR 200,248,50688
TR 202,248,59136
Ma 92,212,20
TR 204,248,51200
TR 206,248,59648
Ma 92,216,32
DM 250,16,0
s_mov_b32 m0,9248
Ma 92,220,44
RD 224,254,4096
AW 8,112
LG 7
Ma 0,192,48
RD 228,254,5120
AW 9,113
LG 6
Ma 0,196,60
RD 232,254,6144
AW 10,114
LG 5
Ma 0,200,72
RD 236,254,7168
AW 11,115
LG 4
Ma 0,204,84
TR 208,248,33824
AW 16,120
Ma 4,192,52
TR 210,248,42272
AW 17,121
Ma 4,196,64
TR 212,248,34336
AW 18,122
Ma 4,200,76
TR 214,248,42784
AW 19,123
Ma 4,204,88
TR 216,248,50720
AW 20,124
Ma 8,192,56
TR 218,248,59168
AW 21,125
Ma 8,196,68
TR 220,248,51232
TR 222,248,59680
Ma 8,200,80
DM 251,16,256
s_mov_b32 m0,10048
Ma 8,204,92
TR 192,248,33856
AW 22,126
LG 7
Ma 12,208,48
TR 194,248,42304
AW 23,127
LG 6
Ma 12,212,60
TR 196,248,34368
AW 24,128
LG 5
Ma 12,216,72
TR 198,248,42816
AW 25,129
LG 4
Ma 12,220,84
TR 200,248,50752
AW 26,130
Ma 16,208,52
TR 202,248,59200
AW 27,131
Ma 16,212,64
TR 204,248,51264
AW 28,132
Ma 16,216,76
TR 206,248,59712
AW 29,133
Ma 16,220,88
AW 30,134
AW 31,135
Ma 20,208,56
DM 252,16,512
s_mov_b32 m0,10848
Ma 20,212,68
TR 208,248,33888
AW 32,136
Ma 20,216,80
TR 210,248,42336
AW 33,137
Ma 20,220,92
TR 212,248,34400
AW 34,138
LG 9
Ma 24,192,48
TR 214,248,42848
AW 35,139
LG 8
Ma 24,196,60
TR 216,248,50784
AW 36,140
LG 7
Ma 24,200,72
TR 218,248,59232
AW 37,141
LG 6
Ma 24,204,84
TR 220,248,51296
AW 38,142
Ma 28,192,52
TR 222,248,59744
AW 39,143
Ma 28,196,64
AW 40,144
AW 41,145
Ma 28,200,76
AW 42,146
AW 43,147
Ma 28,204,88
DM 253,16,768
s_mov_b32 m0,25344
s_add_u32 s16,s8,0
s_addc_u32 s17,s9,0
Ma 32,192,56
TR 192,248,33920
AW 44,148
Ma 32,196,68
TR 194,248,42368
AW 45,149
Ma 32,200,80
TR 196,248,34432
AW 46,150
Ma 32,204,92
TR 198,248,42880
AW 47,151
LG 10
Ma 36,208,48
TR 200,248,50816
LG 9
Ma 36,212,60
TR 202,248,59264
LG 8
Ma 36,216,72
TR 204,248,51328
LG 7
Ma 36,220,84
TR 206,248,59776
Ma 40,208,52
Ma 40,212,64
Ma 40,216,76
DM 250,18,0
s_mov_b32 m0,26144
Ma 40,220,88
Ma 44,208,56
TR 208,248,33952
Ma 44,212,68
TR 210,248,42400
Ma 44,216,80
TR 212,248,34464
Ma 44,220,92
TR 214,248,42912
LG 10
Ma 48,192,48
TR 216,248,50848
LG 9
Ma 48,196,60
TR 218,248,59296
LG 8
Ma 48,200,72
TR 220,248,51360
LG 7
Ma 48,204,84
TR 222,248,59808
Ma 52,192,52
Ma 52,196,64
DM 251,18,256
s_mov_b32 m0,26944
Ma 52,200,76
Ma 52,204,88
Ma 56,192,56
Ma 56,196,68
Ma 56,200,80
Ma 56,204,92
Ma 96,192,224
TR 192,248,33984
Ma 96,196,228
TR 194,248,42432
Ma 96,200,232
TR 196,248,34496
Ma 96,204,236
TR 198,248,42944
LG 10
Ma 60,208,48
DM 252,18,512
s_mov_b32 m0,27744
LG 8
Ma 60,212,60
TR 200,248,50880
LG 7
Ma 60,216,72
TR 202,248,59328
LG 6
Ma 60,220,84
TR 204,248,51392
Ma 64,208,52
TR 206,248,59840
Ma 64,212,64
Ma 64,216,76
Ma 64,220,88
Ma 68,208,56
Ma 68,212,68
Ma 68,216,80
Ma 68,220,92
DM 253,18,768
s_mov_b32 m0,42240
s_add_u32 s18,s6,32768
s_addc_u32 s19,s7,0
Ma 100,208,224
TR 208,248,34016
Ma 100,212,228
TR 210,248,42464
Ma 100,216,232
TR 212,248,34528
Ma 100,220,236
TR 214,248,42976
LG 10
Ma 72,192,48
TR 216,248,50912
LG 9
Ma 72,196,60
TR 218,248,59360
LG 8
Ma 72,200,72
TR 220,248,51424
LG 7
Ma 72,204,84
TR 222,248,59872
v_add_u32 v248,67584,v248
Ma 76,192,52
Ma 76,196,64
Ma 76,200,76
Ma 76,204,88
Ma 80,192,56
Ma 80,196,68
Ma 80,200,80
Ma 80,204,92
LG 6
Ma 84,208,48
AW 48,152
AW 49,153
LG 4
Ma 84,212,60
AW 50,154
AW 51,155
LG 2
Ma 84,216,72
AW 60,164
AW 61,165
LG 0
Ma 84,220,84
AW 62,166
AW 63,167
s_waitcnt vmcnt(16) lgkmcnt(0)
s_barrier
Ma 88,208,52
TR 192,248,0
AW 52,156
Ma 88,212,64
TR 194,248,8448
AW 53,157
Ma 88,216,76
TR 196,248,512
AW 54,158
Ma 88,220,88
TR 198,248,8960
AW 55,159
Ma 92,208,56
TR 200,248,16896
TR 202,248,25344
Ma 92,212,68
TR 204,248,17408
TR 206,248,25856
Ma 92,216,80
DM 250,16,0
s_mov_b32 m0,43040
Ma 92,220,92
RD 224,254,8192
AW 56,160
LG 7
Ma 0,192,96
RD 228,254,9216
AW 57,161
LG 6
Ma 0,196,108
RD 232,254,10240
AW 58,162
LG 5
Ma 0,200,120
RD 236,254,11264
AW 59,163
LG 4
Ma 0,204,132
TR 208,248,32
AW 64,168
Ma 4,192,100
TR 210,248,8480
AW 65,169
Ma 4,196,112
TR 212,248,544
AW 66,170
Ma 4,200,124
TR 214,248,8992
AW 67,171
Ma 4,204,136
TR 216,248,16928
AW 68,172
Ma 8,192,104
TR 218,248,25376
AW 69,173
Ma 8,196,116
TR 220,248,17440
TR 222,248,25888
Ma 8,200,128
DM 251,16,256
s_mov_b32 m0,43840
Ma 8,204,140
TR 192,248,64
AW 70,174
LG 7
Ma 12,208,96
TR 194,248,8512
AW 71,175
LG 6
Ma 12,212,108
TR 196,248,576
AW 72,176
LG 5
Ma 12,216,120
TR 198,248,9024
AW 73,177
LG 4
Ma 12,220,132
TR 200,248,16960
AW 74,178
Ma 16,208,100
TR 202,248,25408
AW 75,179
Ma 16,212,112
TR 204,248,17472
AW 76,180
Ma 16,216,124
TR 206,248,25920
AW 77,181
Ma 16,220,136
AW 78,182
AW 79,183
Ma 20,208,104
DM 252,16,512
s_mov_b32 m0,44640
Ma 20,212,116
TR 208,248,96
AW 80,184
Ma 20,216,128
TR 210,248,8544
AW 81,185
Ma 20,220,140
TR 212,248,608
AW 82,186
LG 9
Ma 24,192,96
TR 214,248,9056
AW 83,187
LG 8
Ma 24,196,108
TR 216,248,16992
AW 84,188
LG 7
Ma 24,200,120
TR 218,248,25440
AW 85,189
LG 6
Ma 24,204,132
TR 220,248,17504
AW 86,190
Ma 28,192,100
TR 222,248,25952
AW 87,191
Ma 28,196,112
AW 88,192
AW 89,193
Ma 28,200,124
AW 90,194
AW 91,195
Ma 28,204,136
DM 253,16,768
s_mov_b32 m0,59136
s_add_u32 s16,s8,16384
s_addc_u32 s17,s9,0
Ma 32,192,104
TR 192,248,128
AW 92,196
Ma 32,196,116
TR 194,248,8576
AW 93,197
Ma 32,200,128
TR 196,248,640
AW 94,198
Ma 32,204,140
TR 198,248,9088
AW 95,199
LG 10
Ma 36,208,96
TR 200,248,17024
LG 9
Ma 36,212,108
TR 202,248,25472
LG 8
Ma 36,216,120
TR 204,248,17536
LG 7
Ma 36,220,132
TR 206,248,25984
Ma 40,208,100
Ma 40,212,112
Ma 40,216,124
DM 250,18,0
s_mov_b32 m0,59936
Ma 40,220,136
Ma 44,208,104
TR 208,248,160
Ma 44,212,116
TR 210,248,8608
Ma 44,216,128
TR 212,248,672
Ma 44,220,140
TR 214,248,9120
LG 10
Ma 48,192,96
TR 216,248,17056
LG 9
Ma 48,196,108
TR 218,248,25504
LG 8
Ma 48,200,120
TR 220,248,17568
LG 7
Ma 48,204,132
TR 222,248,26016
Ma 52,192,100
Ma 52,196,112
DM 251,18,256
s_mov_b32 m0,60736
Ma 52,200,124
Ma 52,204,136
Ma 56,192,104
Ma 56,196,116
Ma 56,200,128
Ma 56,204,140
Ma 96,192,224
TR 192,248,192
Ma 96,196,228
TR 194,248,8640
Ma 96,200,232
TR 196,248,704
Ma 96,204,236
TR 198,248,9152
LG 10
Ma 60,208,96
DM 252,18,512
s_mov_b32 m0,61536
LG 8
Ma 60,212,108
TR 200,248,17088
LG 7
Ma 60,216,120
TR 202,248,25536
LG 6
Ma 60,220,132
TR 204,248,17600
Ma 64,208,100
TR 206,248,26048
Ma 64,212,112
Ma 64,216,124
Ma 64,220,136
Ma 68,208,104
Ma 68,212,116
Ma 68,216,128
Ma 68,220,140
DM 253,18,768
s_mov_b32 m0,76032
s_add_u32 s18,s6,49152
s_addc_u32 s19,s7,0
Ma 100,208,224
TR 208,248,224
Ma 100,212,228
TR 210,248,8672
Ma 100,216,232
TR 212,248,736
Ma 100,220,236
TR 214,248,9184
LG 10
Ma 72,192,96
TR 216,248,17120
LG 9
Ma 72,196,108
TR 218,248,25568
LG 8
Ma 72,200,120
TR 220,248,17632
LG 7
Ma 72,204,132
TR 222,248,26080
Ma 76,192,100
Ma 76,196,112
Ma 76,200,124
Ma 76,204,136
Ma 80,192,104
Ma 80,196,116
Ma 80,200,128
Ma 80,204,140
LG 6
Ma 84,208,96
AW 96,200
AW 97,201
LG 4
Ma 84,212,108
AW 98,202
AW 99,203
LG 2
Ma 84,216,120
AW 108,212
AW 109,213
LG 0
Ma 84,220,132
AW 110,214
AW 111,215
s_waitcnt vmcnt(16) lgkmcnt(0)
s_barrier
Ma 88,208,100
TR 192,248,33792
AW 100,204
Ma 88,212,112
TR 194,248,42240
AW 101,205
Ma 88,216,124
TR 196,248,34304
AW 102,206
Ma 88,220,136
TR 198,248,42752
AW 103,207
Ma 92,208,104
TR 200,248,50688
TR 202,248,59136
Ma 92,212,116
TR 204,248,51200
TR 206,248,59648
Ma 92,216,128
DM 250,16,0
s_mov_b32 m0,76832
Ma 92,220,140
RD 224,254,12288
AW 104,208
LG 7
Ma 0,192,144
RD 228,254,13312
AW 105,209
LG 6
Ma 0,196,156
RD 232,254,14336
AW 106,210
LG 5
Ma 0,200,168
RD 236,254,15360
AW 107,211
LG 4
Ma 0,204,180
TR 208,248,33824
AW 112,216
Ma 4,192,148
TR 210,248,42272
AW 113,217
Ma 4,196,160
TR 212,248,34336
AW 114,218
Ma 4,200,172
TR 214,248,42784
AW 115,219
Ma 4,204,184
TR 216,248,50720
AW 116,220
Ma 8,192,152
TR 218,248,59168
AW 117,221
Ma 8,196,164
TR 220,248,51232
TR 222,248,59680
Ma 8,200,176
DM 251,16,256
s_mov_b32 m0,77632
Ma 8,204,188
TR 192,248,33856
AW 118,222
LG 7
Ma 12,208,144
TR 194,248,42304
AW 119,223
LG 6
Ma 12,212,156
TR 196,248,34368
AW 120,224
LG 5
Ma 12,216,168
TR 198,248,42816
AW 121,225
LG 4
Ma 12,220,180
TR 200,248,50752
AW 122,226
Ma 16,208,148
TR 202,248,59200
AW 123,227
Ma 16,212,160
TR 204,248,51264
AW 124,228
Ma 16,216,172
TR 206,248,59712
AW 125,229
Ma 16,220,184
AW 126,230
AW 127,231
Ma 20,208,152
DM 252,16,512
s_mov_b32 m0,78432
Ma 20,212,164
TR 208,248,33888
AW 128,232
Ma 20,216,176
TR 210,248,42336
AW 129,233
Ma 20,220,188
TR 212,248,34400
AW 130,234
LG 9
Ma 24,192,144
TR 214,248,42848
AW 131,235
LG 8
Ma 24,196,156
TR 216,248,50784
AW 132,236
LG 7
Ma 24,200,168
TR 218,248,59232
AW 133,237
LG 6
Ma 24,204,180
TR 220,248,51296
AW 134,238
Ma 28,192,148
TR 222,248,59744
AW 135,239
Ma 28,196,160
AW 136,240
AW 137,241
Ma 28,200,172
AW 138,242
AW 139,243
Ma 28,204,184
DM 253,16,768
s_mov_b32 m0,92928
s_add_u32 s16,s8,32768
s_addc_u32 s17,s9,0
Ma 32,192,152
TR 192,248,33920
AW 140,244
Ma 32,196,164
TR 194,248,42368
AW 141,245
Ma 32,200,176
TR 196,248,34432
AW 142,246
Ma 32,204,188
TR 198,248,42880
AW 143,247
LG 10
Ma 36,208,144
TR 200,248,50816
MU 0,s26
LG 9
Ma 36,212,156
TR 202,248,59264
MU 1,s26
LG 8
Ma 36,216,168
TR 204,248,51328
MU 2,s26
LG 7
Ma 36,220,180
TR 206,248,59776
MU 3,s26
Ma 40,208,148
MU 12,s26
MU 13,s26
Ma 40,212,160
MU 14,s26
MU 15,s26
Ma 40,216,172
DM 250,18,0
s_mov_b32 m0,93728
Ma 40,220,184
CV 0,0,1
CV 1,2,3
Ma 44,208,152
TR 208,248,33952
CV 2,12,13
Ma 44,212,164
TR 210,248,42400
CV 3,14,15
Ma 44,216,176
TR 212,248,34464
v_permlane32_swap_b32 v0,v2
Ma 44,220,188
TR 214,248,42912
v_permlane32_swap_b32 v1,v3
LG 10
Ma 48,192,144
TR 216,248,50848
v_permlane16_swap_b32 v0,v2
LG 9
Ma 48,196,156
TR 218,248,59296
v_permlane16_swap_b32 v1,v3
LG 8
Ma 48,200,168
TR 220,248,51360
MU 4,s26
LG 7
Ma 48,204,180
TR 222,248,59808
MU 5,s26
Ma 52,192,148
MU 6,s26
MU 7,s26
Ma 52,196,160
DM 251,18,256
s_mov_b32 m0,94528
Ma 52,200,172
MU 16,s26
MU 17,s26
Ma 52,204,184
MU 18,s26
MU 19,s26
Ma 56,192,152
CV 4,4,5
CV 5,6,7
Ma 56,196,164
CV 6,16,17
CV 7,18,19
Ma 56,200,176
v_permlane32_swap_b32 v4,v6
v_permlane32_swap_b32 v5,v7
Ma 56,204,188
v_permlane16_swap_b32 v4,v6
v_permlane16_swap_b32 v5,v7
Ma 96,192,224
TR 192,248,33984
MU 8,s26
Ma 96,196,228
TR 194,248,42432
MU 9,s26
Ma 96,200,232
TR 196,248,34496
MU 10,s26
Ma 96,204,236
TR 198,248,42944
MU 11,s26
LG 10
Ma 60,208,144
DM 252,18,512
s_mov_b32 m0,95328
LG 8
Ma 60,212,156
TR 200,248,50880
MU 20,s26
LG 7
Ma 60,216,168
TR 202,248,59328
MU 21,s26
LG 6
Ma 60,220,180
TR 204,248,51392
MU 22,s26
Ma 64,208,148
TR 206,248,59840
MU 23,s26
Ma 64,212,160
CV 8,8,9
CV 9,10,11
Ma 64,216,172
CV 10,20,21
CV 11,22,23
Ma 64,220,184
v_permlane32_swap_b32 v8,v10
v_permlane32_swap_b32 v9,v11
Ma 68,208,152
v_permlane16_swap_b32 v8,v10
v_permlane16_swap_b32 v9,v11
Ma 68,212,164
MU 24,s26
MU 25,s26
Ma 68,216,176
MU 26,s26
MU 27,s26
Ma 68,220,188
DM 253,18,768
Ma 100,208,224
TR 208,248,34016
MU 36,s26
Ma 100,212,228
TR 210,248,42464
MU 37,s26
Ma 100,216,232
TR 212,248,34528
MU 38,s26
Ma 100,220,236
TR 214,248,42976
MU 39,s26
LG 10
Ma 72,192,144
TR 216,248,50912
CV 24,24,25
LG 9
Ma 72,196,156
TR 218,248,59360
CV 25,26,27
LG 8
Ma 72,200,168
TR 220,248,51424
CV 26,36,37
LG 7
Ma 72,204,180
TR 222,248,59872
v_add_u32 v248,4294899712,v248
Ma 76,192,148
CV 27,38,39
v_permlane32_swap_b32 v24,v26
Ma 76,196,160
v_permlane32_swap_b32 v25,v27
v_permlane16_swap_b32 v24,v26
Ma 76,200,172
v_permlane16_swap_b32 v25,v27
MU 28,s26
Ma 76,204,184
MU 29,s26
MU 30,s26
Ma 80,192,152
MU 31,s26
MU 40,s26
Ma 80,196,164
MU 41,s26
MU 42,s26
Ma 80,200,176
MU 43,s26
CV 28,28,29
Ma 80,204,188
CV 29,30,31
CV 30,40,41
LG 6
Ma 84,208,144
CV 31,42,43
v_permlane32_swap_b32 v28,v30
LG 4
Ma 84,212,156
v_permlane32_swap_b32 v29,v31
v_permlane16_swap_b32 v28,v30
LG 2
Ma 84,216,168
v_permlane16_swap_b32 v29,v31
MU 32,s26
LG 0
Ma 84,220,180
MU 33,s26
MU 34,s26
s_waitcnt vmcnt(24) lgkmcnt(0)
s_barrier
Ma 88,208,148
TR 192,248,0
MU 35,s26
Ma 88,212,160
TR 194,248,8448
MU 44,s26
Ma 88,216,172
TR 196,248,512
TR 198,248,8960
Ma 88,220,184
TR 200,248,16896
TR 202,248,25344
Ma 92,208,152
TR 204,248,17408
TR 206,248,25856
Ma 92,212,164
RD 224,254,0
RD 228,254,1024
Ma 92,216,176
RD 232,254,2048
RD 236,254,3072
Ma 92,220,188
MU 45,s26
MU 46,s26
MU 47,s26
CV 32,32,33
CV 33,34,35
CV 34,44,45
CV 35,46,47
s_nop 0
v_permlane32_swap_b32 v32,v34
v_permlane32_swap_b32 v33,v35
s_nop 0
v_permlane16_swap_b32 v32,v34
v_permlane16_swap_b32 v33,v35
v_pk_mul_f32 v[48:49],v[48:49],s[26:27] op_sel_hi:[1,0]
v_pk_mul_f32 v[50:51],v[50:51],s[26:27] op_sel_hi:[1,0]
v_pk_mul_f32 v[60:61],v[60:61],s[26:27] op_sel_hi:[1,0]
v_pk_mul_f32 v[62:63],v[62:63],s[26:27] op_sel_hi:[1,0]
CV 48,48,49
CV 49,50,51
CV 50,60,61
CV 51,62,63
s_nop 0
v_permlane32_swap_b32 v48,v50
v_permlane32_swap_b32 v49,v51
s_nop 0
v_permlane16_swap_b32 v48,v50
v_permlane16_swap_b32 v49,v51
v_pk_mul_f32 v[52:53],v[52:53],s[26:27] op_sel_hi:[1,0]
v_pk_mul_f32 v[54:55],v[54:55],s[26:27] op_sel_hi:[1,0]
v_pk_mul_f32 v[64:65],v[64:65],s[26:27] op_sel_hi:[1,0]
v_pk_mul_f32 v[66:67],v[66:67],s[26:27] op_sel_hi:[1,0]
CV 52,52,53
CV 53,54,55
CV 54,64,65
CV 55,66,67
s_nop 0
v_permlane32_swap_b32 v52,v54
v_permlane32_swap_b32 v53,v55
s_nop 0
v_permlane16_swap_b32 v52,v54
v_permlane16_swap_b32 v53,v55
v_pk_mul_f32 v[56:57],v[56:57],s[26:27] op_sel_hi:[1,0]
v_pk_mul_f32 v[58:59],v[58:59],s[26:27] op_sel_hi:[1,0]
v_pk_mul_f32 v[68:69],v[68:69],s[26:27] op_sel_hi:[1,0]
v_pk_mul_f32 v[70:71],v[70:71],s[26:27] op_sel_hi:[1,0]
CV 56,56,57
CV 57,58,59
CV 58,68,69
CV 59,70,71
s_nop 0
v_permlane32_swap_b32 v56,v58
v_permlane32_swap_b32 v57,v59
s_nop 0
v_permlane16_swap_b32 v56,v58
v_permlane16_swap_b32 v57,v59
v_pk_mul_f32 v[72:73],v[72:73],s[26:27] op_sel_hi:[1,0]
v_pk_mul_f32 v[74:75],v[74:75],s[26:27] op_sel_hi:[1,0]
v_pk_mul_f32 v[84:85],v[84:85],s[26:27] op_sel_hi:[1,0]
v_pk_mul_f32 v[86:87],v[86:87],s[26:27] op_sel_hi:[1,0]
CV 72,72,73
CV 73,74,75
CV 74,84,85
CV 75,86,87
s_nop 0
v_permlane32_swap_b32 v72,v74
v_permlane32_swap_b32 v73,v75
s_nop 0
v_permlane16_swap_b32 v72,v74
v_permlane16_swap_b32 v73,v75
v_pk_mul_f32 v[76:77],v[76:77],s[26:27] op_sel_hi:[1,0]
v_pk_mul_f32 v[78:79],v[78:79],s[26:27] op_sel_hi:[1,0]
v_pk_mul_f32 v[88:89],v[88:89],s[26:27] op_sel_hi:[1,0]
v_pk_mul_f32 v[90:91],v[90:91],s[26:27] op_sel_hi:[1,0]
CV 76,76,77
CV 77,78,79
CV 78,88,89
CV 79,90,91
s_nop 0
v_permlane32_swap_b32 v76,v78
v_permlane32_swap_b32 v77,v79
s_nop 0
v_permlane16_swap_b32 v76,v78
v_permlane16_swap_b32 v77,v79
v_pk_mul_f32 v[80:81],v[80:81],s[26:27] op_sel_hi:[1,0]
v_pk_mul_f32 v[82:83],v[82:83],s[26:27] op_sel_hi:[1,0]
v_pk_mul_f32 v[92:93],v[92:93],s[26:27] op_sel_hi:[1,0]
v_pk_mul_f32 v[94:95],v[94:95],s[26:27] op_sel_hi:[1,0]
CV 80,80,81
CV 81,82,83
CV 82,92,93
CV 83,94,95
s_nop 0
v_permlane32_swap_b32 v80,v82
v_permlane32_swap_b32 v81,v83
s_nop 0
v_permlane16_swap_b32 v80,v82
v_permlane16_swap_b32 v81,v83
v_pk_mul_f32 v[96:97],v[96:97],s[26:27] op_sel_hi:[1,0]
v_pk_mul_f32 v[98:99],v[98:99],s[26:27] op_sel_hi:[1,0]
v_pk_mul_f32 v[100:101],v[100:101],s[26:27] op_sel_hi:[1,0]
v_pk_mul_f32 v[102:103],v[102:103],s[26:27] op_sel_hi:[1,0]
CV 96,96,97
CV 97,98,99
CV 98,100,101
CV 99,102,103
s_nop 0
v_permlane32_swap_b32 v96,v98
v_permlane32_swap_b32 v97,v99
s_nop 0
v_permlane16_swap_b32 v96,v98
v_permlane16_swap_b32 v97,v99
ds_write_b128 v249,v[96:99] offset:2048
AW 144,0
AW 145,1
AW 146,2
AW 147,3
AW 148,4
AW 149,5
AW 150,6
AW 151,7
AW 152,8
AW 153,9
AW 154,10
AW 155,11
AW 156,24
AW 157,25
AW 158,26
AW 159,27
AW 160,28
AW 161,29
AW 162,30
AW 163,31
AW 164,32
AW 165,33
AW 166,34
AW 167,35
AW 168,48
AW 169,49
AW 170,50
AW 171,51
AW 172,52
AW 173,53
AW 174,54
AW 175,55
AW 176,56
AW 177,57
AW 178,58
AW 179,59
AW 180,72
AW 181,73
AW 182,74
AW 183,75
AW 184,76
AW 185,77
AW 186,78
AW 187,79
AW 188,80
AW 189,81
AW 190,82
AW 191,83
v_subrev_u32 v224,135168,v249
v_lshrrev_b32 v224,4,v224
v_and_b32 v225,15,v224
v_mul_u32_u24 v220,1056,v225
v_lshrrev_b32 v226,4,v224
v_lshl_add_u32 v220,v226,4,v220
v_lshrrev_b32 v225,2,v224
v_mul_u32_u24 v221,1056,v225
v_and_b32 v226,3,v224
v_lshl_add_u32 v221,v226,3,v221
v_lshrrev_b32 v225,4,v224
v_lshlrev_b32 v225,12,v225
v_and_b32 v226,15,v224
v_lshl_add_u32 v250,v226,4,v225
v_add_u32 v251,0,v250
v_add_u32 v252,0,v250
v_add_u32 v253,0,v250
v_mov_b32 v216,v250
v_mov_b32 v217,v250
v_mov_b32 v218,v250
v_mov_b32 v219,v250
s_mov_b32 s22,0
s_mov_b32 s23,16896
s_mov_b32 s24,33792
s_mov_b32 s25,118272
s_mov_b32 s21,0
s_mov_b32 s34,0
s_add_u32 s18,s8,32768
s_addc_u32 s19,s9,0
s_mov_b32 m0,109824
s_nop 0
DW 250,18,0
s_mov_b32 m0,110624
s_nop 0
DW 251,18,256
s_mov_b32 m0,111424
s_nop 0
DW 252,18,512
s_mov_b32 m0,112224
s_nop 0
DW 253,18,768
s_add_u32 s16,s6,65536
s_addc_u32 s17,s7,0
s_add_u32 s18,s8,49152
s_addc_u32 s19,s9,0
s_waitcnt vmcnt(24) lgkmcnt(0)
s_barrier
v_mov_b32 v254,v220
RD 208,254,0
RD 212,254,64
RD 216,254,128
RD 220,254,192
RD 192,254,256
RD 196,254,320
RD 200,254,384
RD 204,254,448
RD 224,249,16384
RD 228,249,17408
RD 232,249,18432
RD 236,249,19456
LB_w2:
LG 0
Za 136,208,0
v_add_u32 v248,s24,v221
s_mov_b32 s48,s22
s_mov_b32 s49,s25
Ma 136,212,12
Ma 136,216,24
Ma 136,220,36
Za 140,208,4
Ma 140,212,16
Ma 140,216,28
s_nop 4
v_max3_f32 v200,v136,v137,v138
v_max_f32 v200,v200,v139
Ma 140,220,40
v_mov_b32 v201,v200
s_nop 1
v_permlane16_swap_b32 v200,v201
Za 144,208,8
v_max_f32 v200,v200,v201
v_mov_b32 v201,v200
Ma 144,212,20
s_nop 0
v_permlane32_swap_b32 v200,v201
v_max_f32 v200,v200,v201
Ma 144,216,32
v_mul_f32 v200,-1.0,v200
v_mov_b32 v201,v200
Ma 144,220,44
v_mov_b32 v202,v200
v_mov_b32 v203,v200
Za 148,208,224
v_max3_f32 v204,v140,v141,v142
RD 208,254,512
Ma 148,212,228
v_max_f32 v204,v204,v143
RD 212,254,576
Ma 148,216,232
v_mov_b32 v205,v204
RD 216,254,640
Ma 148,220,236
v_permlane16_swap_b32 v204,v205
RD 220,254,704
Ca 120,192,0,200
v_max_f32 v204,v204,v205
v_mov_b32 v205,v204
Ma 120,196,12
s_nop 0
v_permlane32_swap_b32 v204,v205
v_max_f32 v204,v204,v205
Ma 120,200,24
v_mul_f32 v204,-1.0,v204
v_mov_b32 v205,v204
Ma 120,204,36
v_mov_b32 v206,v204
v_mov_b32 v207,v204
s_nop 1
Ca 124,192,4,204
v_max3_f32 v208,v144,v145,v146
v_max_f32 v208,v208,v147
Ma 124,196,16
v_mov_b32 v209,v208
s_nop 1
v_permlane16_swap_b32 v208,v209
Ma 124,200,28
v_max_f32 v208,v208,v209
v_mov_b32 v209,v208
Ma 124,204,40
s_nop 0
v_permlane32_swap_b32 v208,v209
v_max_f32 v208,v208,v209
v_mul_f32 v208,-1.0,v208
v_mov_b32 v209,v208
v_mov_b32 v210,v208
v_mov_b32 v211,v208
s_nop 1
Ca 128,192,8,208
v_add_f32 v136,v136,v200
v_add_f32 v137,v137,v200
Ma 128,196,20
v_add_f32 v138,v138,v200
v_add_f32 v139,v139,v200
Ma 128,200,32
EX 136
Ma 128,204,44
EX 137
EX 138
EX 139
CV 152,136,137
CV 153,138,139
LG 3
Ca 136,208,0,200
v_add_f32 v140,v140,v204
v_add_f32 v141,v141,v204
LG 2
Ma 136,212,12
v_add_f32 v142,v142,v204
v_add_f32 v143,v143,v204
LG 1
Ma 136,216,24
EX 140
LG 0
Ma 136,220,36
EX 141
EX 142
EX 143
CV 160,140,141
CV 161,142,143
Ca 140,208,4,204
v_add_f32 v144,v144,v208
v_add_f32 v145,v145,v208
Ma 140,212,16
v_add_f32 v146,v146,v208
v_add_f32 v147,v147,v208
Ma 140,216,28
EX 144
Ma 140,220,40
EX 145
EX 146
EX 147
CV 168,144,145
CV 169,146,147
Ca 144,208,8,208
RD 192,254,768
RD 196,254,832
Ma 144,212,20
RD 200,254,896
v_max3_f32 v212,v148,v149,v150
Ma 144,216,32
v_max_f32 v212,v212,v151
v_mov_b32 v213,v212
Ma 144,220,44
RD 204,254,960
v_permlane16_swap_b32 v212,v213
v_max_f32 v212,v212,v213
v_mov_b32 v213,v212
s_nop 1
v_permlane32_swap_b32 v212,v213
v_max_f32 v212,v212,v213
v_mul_f32 v212,-1.0,v212
v_mov_b32 v213,v212
v_mov_b32 v214,v212
v_mov_b32 v215,v212
s_nop 1
Ca 148,208,224,212
EX 120
Ma 148,212,228
EX 121
Ma 148,216,232
EX 122
Ma 148,220,236
EX 123
CV 154,120,121
CV 155,122,123
LG 3
Ca 120,192,0,200
EX 124
LG 2
Ma 120,196,12
EX 125
LG 1
Ma 120,200,24
EX 148
LG 0
Ma 120,204,36
EX 149
EX 126
EX 127
CV 162,124,125
CV 163,126,127
Ca 124,192,4,204
EX 150
Ma 124,196,16
EX 151
Ma 124,200,28
CV 148,148,149
CV 149,150,151
Ma 124,204,40
ds_write_b64 v249,v[148:149] offset:5120
v_add_u32 v254,s23,v220
EX 128
EX 129
EX 130
EX 131
CV 170,128,129
CV 171,130,131
Ca 128,192,8,208
EX 136
Ma 128,196,20
EX 137
Ma 128,200,32
EX 138
Ma 128,204,44
EX 139
s_waitcnt vmcnt(16) lgkmcnt(0)
s_barrier
s_cmp_ge_u32 s21,28
s_cbranch_scc1 ProK_w2
ProK_r_w2:
CV 156,136,137
CV 157,138,139
EX 140
EX 141
EX 142
EX 143
CV 164,140,141
CV 165,142,143
EX 144
EX 145
EX 146
EX 147
CV 172,144,145
CV 173,146,147
EX 120
EX 121
EX 122
EX 123
CV 158,120,121
CV 159,122,123
EX 124
EX 125
EX 126
EX 127
CV 166,124,125
CV 167,126,127
EX 128
EX 129
EX 130
EX 131
CV 174,128,129
CV 175,130,131
s_sub_u32 s22,50688,s22
s_sub_u32 s25,185856,s25
s_add_u32 s21,s21,1
RD 192,254,512
RD 196,254,576
RD 200,254,640
RD 204,254,704
LG 0
Ca 120,192,0,200
s_add_u32 m0,s48,8448
s_mov_b32 s48,s23
Ma 120,196,12
Ma 120,200,24
RD 244,249,4096
RD 248,249,5120
Ma 120,204,36
TR 208,248,192
TR 210,248,448
Ca 124,192,4,204
TR 212,248,704
TR 214,248,960
Ma 124,196,16
DM 250,16,0
s_add_u32 m0,m0,800
Ma 124,200,28
EX 120
Ma 124,204,40
EX 121
Ca 128,192,8,208
TR 216,248,224
CV 180,120,121
Ma 128,196,20
TR 218,248,480
TR 220,248,736
Ma 128,200,32
TR 222,248,992
Ma 128,204,44
EX 122
Ca 132,192,224,212
EX 123
Ma 132,196,228
CV 181,122,123
Ma 132,200,232
RD 192,254,768
Ma 132,204,236
DM 251,16,256
s_add_u32 m0,m0,800
LG 7
Zv 72,208,152
RD 196,254,832
RD 200,254,896
LG 7
Mv 72,212,156
RD 204,254,960
Zv 76,208,160
EX 132
Mv 76,212,164
EX 133
Zv 80,208,168
EX 134
Mv 80,212,172
EX 135
LG 6
Zv 84,216,152
CV 132,132,133
CV 133,134,135
LG 4
Mv 84,220,156
ds_write_b64 v249,v[132:133] offset:7168
Zv 88,216,160
EX 124
Mv 88,220,164
DM 252,16,512
s_add_u32 m0,m0,800
Zv 92,216,168
TR 208,248,0
TR 210,248,256
Mv 92,220,172
TR 212,248,512
TR 214,248,768
LG 8
Ca 136,192,0,200
EX 125
LG 7
Ma 136,196,12
EX 126
LG 6
Ma 136,200,24
EX 127
LG 5
Ma 136,204,36
CV 188,124,125
CV 189,126,127
Ca 140,192,4,204
TR 216,248,32
TR 218,248,288
Ma 140,196,16
TR 220,248,544
TR 222,248,800
Ma 140,200,28
EX 128
Ma 140,204,40
DM 253,16,768
s_add_u32 m0,s49,8448
s_add_u32 s16,s16,16384
s_addc_u32 s17,s17,0
Ca 144,192,8,208
EX 129
s_mov_b32 s49,s24
Ma 144,196,20
EX 130
Ma 144,200,32
RD 192,254,0
CV 196,128,129
Ma 144,204,44
RD 196,254,64
LG 8
Zv 0,208,152
RD 200,254,128
LG 7
Mv 0,212,156
RD 204,254,192
Zv 4,208,160
EX 131
Mv 4,212,164
CV 197,130,131
Zv 8,208,168
EX 136
Mv 8,212,172
DM 216,18,0
s_add_u32 m0,m0,800
LG 6
Zv 12,216,152
EX 137
LG 4
Mv 12,220,156
EX 138
Zv 16,216,160
EX 139
Mv 16,220,164
CV 182,136,137
CV 183,138,139
Zv 20,216,168
TR 208,248,64
TR 210,248,320
Mv 20,220,172
TR 212,248,576
TR 214,248,832
LG 7
Ca 120,192,0,200
EX 140
LG 6
Ma 120,196,12
EX 141
LG 5
Ma 120,200,24
EX 142
LG 4
Ma 120,204,36
DM 217,18,256
s_add_u32 m0,m0,800
Ca 124,192,4,204
TR 216,248,96
CV 190,140,141
Ma 124,196,16
TR 218,248,352
TR 220,248,608
Ma 124,200,28
TR 222,248,864
Ma 124,204,40
EX 143
Ca 128,192,8,208
CV 191,142,143
Ma 128,196,20
EX 144
Ma 128,200,32
RD 192,254,256
Ma 128,204,44
RD 196,254,320
LG 8
Zv 24,208,152
RD 200,254,384
LG 7
Mv 24,212,156
DM 218,18,512
s_add_u32 m0,m0,800
Zv 28,208,160
RD 204,254,448
v_add_u32 v254,s22,v220
Mv 28,212,164
EX 145
Zv 32,208,168
EX 146
Mv 32,212,172
EX 147
LG 6
Zv 36,216,152
CV 198,144,145
CV 199,146,147
LG 4
Mv 36,220,156
EX 120
Zv 40,216,160
EX 121
Mv 40,220,164
EX 122
Zv 44,216,168
TR 208,248,128
CV 176,120,121
Mv 44,220,172
DM 219,18,768
s_add_u32 s18,s18,16384
s_addc_u32 s19,s19,0
LG 4
Ca 136,192,0,200
TR 210,248,384
TR 212,248,640
LG 5
Ma 136,196,12
TR 214,248,896
LG 5
Ma 136,200,24
EX 123
LG 4
Ma 136,204,36
CV 177,122,123
Ca 140,192,4,204
EX 124
Ma 140,196,16
EX 125
Ma 140,200,28
TR 216,248,160
CV 184,124,125
Ma 140,204,40
TR 218,248,416
TR 220,248,672
Ca 144,192,8,208
TR 222,248,928
v_add_u32 v248,s25,v221
Ma 144,196,20
EX 126
Ma 144,200,32
EX 127
Ma 144,204,44
CV 185,126,127
LG 6
Zv 48,208,152
EX 128
LG 4
Mv 48,212,156
EX 129
Zv 52,208,160
EX 130
Mv 52,212,164
EX 131
Zv 56,208,168
CV 192,128,129
CV 193,130,131
Mv 56,212,172
EX 136
Za 96,208,244
EX 137
Ma 96,212,248
EX 138
LG 2
Zv 60,216,152
EX 139
LG 0
Mv 60,220,156
CV 178,136,137
CV 179,138,139
s_waitcnt vmcnt(16) lgkmcnt(0)
s_barrier
s_cmp_ge_u32 s21,28
s_cbranch_scc1 It0K_w2
It0K_r_w2:
Zv 64,216,160
RD 192,254,512
RD 196,254,576
s_sub_u32 s23,101376,s23
s_sub_u32 s24,135168,s24
Mv 64,220,164
RD 200,254,640
RD 204,254,704
s_add_u32 s21,s21,1
Zv 68,216,168
EX 140
Mv 68,220,172
EX 141
Za 100,216,244
EX 142
Ma 100,220,248
EX 143
Zv 104,240,152
CV 186,140,141
CV 187,142,143
Mv 104,240,156
EX 144
Zv 108,240,160
EX 145
Mv 108,240,164
EX 146
Zv 112,240,168
EX 147
Mv 112,240,172
CV 194,144,145
CV 195,146,147
Za 116,240,244
Ma 116,240,248
s_mov_b32 s20,3
LI_w2:
LG 0
Ca 120,192,0,200
s_add_u32 m0,s48,8448
s_mov_b32 s48,s22
Ma 120,196,12
Ma 120,200,24
RD 244,249,6144
RD 248,249,7168
Ma 120,204,36
TR 208,248,192
TR 210,248,448
Ca 124,192,4,204
TR 212,248,704
TR 214,248,960
Ma 124,196,16
DM 250,16,0
s_add_u32 m0,m0,800
Ma 124,200,28
EX 120
Ma 124,204,40
EX 121
Ca 128,192,8,208
TR 216,248,224
CV 156,120,121
Ma 128,196,20
TR 218,248,480
TR 220,248,736
Ma 128,200,32
TR 222,248,992
Ma 128,204,44
EX 122
Ca 132,192,224,212
EX 123
Ma 132,196,228
CV 157,122,123
Ma 132,200,232
RD 192,254,768
Ma 132,204,236
DM 251,16,256
s_add_u32 m0,m0,800
LG 7
Mv 72,208,176
RD 196,254,832
RD 200,254,896
LG 7
Mv 72,212,180
RD 204,254,960
Mv 76,208,184
EX 132
Mv 76,212,188
EX 133
Mv 80,208,192
EX 134
Mv 80,212,196
EX 135
LG 6
Mv 84,216,176
CV 132,132,133
CV 133,134,135
LG 4
Mv 84,220,180
ds_write_b64 v249,v[132:133] offset:5120
Mv 88,216,184
EX 124
Mv 88,220,188
DM 252,16,512
s_add_u32 m0,m0,800
Mv 92,216,192
TR 208,248,0
TR 210,248,256
Mv 92,220,196
TR 212,248,512
TR 214,248,768
LG 8
Ca 136,192,0,200
EX 125
LG 7
Ma 136,196,12
EX 126
LG 6
Ma 136,200,24
EX 127
LG 5
Ma 136,204,36
CV 164,124,125
CV 165,126,127
Ca 140,192,4,204
TR 216,248,32
TR 218,248,288
Ma 140,196,16
TR 220,248,544
TR 222,248,800
Ma 140,200,28
EX 128
Ma 140,204,40
DM 253,16,768
s_add_u32 m0,s49,8448
s_add_u32 s16,s16,16384
s_addc_u32 s17,s17,0
Ca 144,192,8,208
EX 129
s_mov_b32 s49,s25
Ma 144,196,20
EX 130
Ma 144,200,32
RD 192,254,0
CV 172,128,129
Ma 144,204,44
RD 196,254,64
LG 8
Mv 0,208,176
RD 200,254,128
LG 7
Mv 0,212,180
RD 204,254,192
Mv 4,208,184
EX 131
Mv 4,212,188
CV 173,130,131
Mv 8,208,192
EX 136
Mv 8,212,196
DM 216,18,0
s_add_u32 m0,m0,800
LG 6
Mv 12,216,176
EX 137
LG 4
Mv 12,220,180
EX 138
Mv 16,216,184
EX 139
Mv 16,220,188
CV 158,136,137
CV 159,138,139
Mv 20,216,192
TR 208,248,64
TR 210,248,320
Mv 20,220,196
TR 212,248,576
TR 214,248,832
LG 7
Ca 120,192,0,200
EX 140
LG 6
Ma 120,196,12
EX 141
LG 5
Ma 120,200,24
EX 142
LG 4
Ma 120,204,36
DM 217,18,256
s_add_u32 m0,m0,800
Ca 124,192,4,204
TR 216,248,96
CV 166,140,141
Ma 124,196,16
TR 218,248,352
TR 220,248,608
Ma 124,200,28
TR 222,248,864
Ma 124,204,40
EX 143
Ca 128,192,8,208
CV 167,142,143
Ma 128,196,20
EX 144
Ma 128,200,32
RD 192,254,256
Ma 128,204,44
RD 196,254,320
LG 8
Mv 24,208,176
RD 200,254,384
LG 7
Mv 24,212,180
DM 218,18,512
s_add_u32 m0,m0,800
Mv 28,208,184
RD 204,254,448
v_add_u32 v254,s23,v220
Mv 28,212,188
EX 145
Mv 32,208,192
EX 146
Mv 32,212,196
EX 147
LG 6
Mv 36,216,176
CV 174,144,145
CV 175,146,147
LG 4
Mv 36,220,180
EX 120
Mv 40,216,184
EX 121
Mv 40,220,188
EX 122
Mv 44,216,192
TR 208,248,128
CV 152,120,121
Mv 44,220,196
DM 219,18,768
s_add_u32 s18,s18,16384
s_addc_u32 s19,s19,0
LG 4
Ca 136,192,0,200
TR 210,248,384
TR 212,248,640
LG 5
Ma 136,196,12
TR 214,248,896
LG 5
Ma 136,200,24
EX 123
LG 4
Ma 136,204,36
CV 153,122,123
Ca 140,192,4,204
EX 124
Ma 140,196,16
EX 125
Ma 140,200,28
TR 216,248,160
CV 160,124,125
Ma 140,204,40
TR 218,248,416
TR 220,248,672
Ca 144,192,8,208
TR 222,248,928
v_add_u32 v248,s24,v221
Ma 144,196,20
EX 126
Ma 144,200,32
EX 127
Ma 144,204,44
CV 161,126,127
LG 6
Mv 48,208,176
EX 128
LG 4
Mv 48,212,180
EX 129
Mv 52,208,184
EX 130
Mv 52,212,188
EX 131
Mv 56,208,192
CV 168,128,129
CV 169,130,131
Mv 56,212,196
EX 136
Ma 96,208,244
EX 137
Ma 96,212,248
EX 138
LG 2
Mv 60,216,176
EX 139
LG 0
Mv 60,220,180
CV 154,136,137
CV 155,138,139
s_waitcnt vmcnt(16) lgkmcnt(0)
s_barrier
s_cmp_ge_u32 s21,28
s_cbranch_scc1 ItOK_w2
ItOK_r_w2:
Mv 64,216,184
RD 192,254,512
RD 196,254,576
s_sub_u32 s22,50688,s22
s_sub_u32 s25,185856,s25
Mv 64,220,188
RD 200,254,640
RD 204,254,704
s_add_u32 s21,s21,1
Mv 68,216,192
EX 140
Mv 68,220,196
EX 141
Ma 100,216,244
EX 142
Ma 100,220,248
EX 143
Mv 104,240,176
CV 162,140,141
CV 163,142,143
Mv 104,240,180
EX 144
Mv 108,240,184
EX 145
Mv 108,240,188
EX 146
Mv 112,240,192
EX 147
Mv 112,240,196
CV 170,144,145
CV 171,146,147
Ma 116,240,244
Ma 116,240,248
LG 0
Ca 120,192,0,200
s_add_u32 m0,s48,8448
s_mov_b32 s48,s23
Ma 120,196,12
Ma 120,200,24
RD 244,249,4096
RD 248,249,5120
Ma 120,204,36
TR 208,248,192
TR 210,248,448
Ca 124,192,4,204
TR 212,248,704
TR 214,248,960
Ma 124,196,16
DM 250,16,0
s_add_u32 m0,m0,800
Ma 124,200,28
EX 120
Ma 124,204,40
EX 121
Ca 128,192,8,208
TR 216,248,224
CV 180,120,121
Ma 128,196,20
TR 218,248,480
TR 220,248,736
Ma 128,200,32
TR 222,248,992
Ma 128,204,44
EX 122
Ca 132,192,224,212
EX 123
Ma 132,196,228
CV 181,122,123
Ma 132,200,232
RD 192,254,768
Ma 132,204,236
DM 251,16,256
s_add_u32 m0,m0,800
LG 7
Mv 72,208,152
RD 196,254,832
RD 200,254,896
LG 7
Mv 72,212,156
RD 204,254,960
Mv 76,208,160
EX 132
Mv 76,212,164
EX 133
Mv 80,208,168
EX 134
Mv 80,212,172
EX 135
LG 6
Mv 84,216,152
CV 132,132,133
CV 133,134,135
LG 4
Mv 84,220,156
ds_write_b64 v249,v[132:133] offset:7168
Mv 88,216,160
EX 124
Mv 88,220,164
DM 252,16,512
s_add_u32 m0,m0,800
Mv 92,216,168
TR 208,248,0
TR 210,248,256
Mv 92,220,172
TR 212,248,512
TR 214,248,768
LG 8
Ca 136,192,0,200
EX 125
LG 7
Ma 136,196,12
EX 126
LG 6
Ma 136,200,24
EX 127
LG 5
Ma 136,204,36
CV 188,124,125
CV 189,126,127
Ca 140,192,4,204
TR 216,248,32
TR 218,248,288
Ma 140,196,16
TR 220,248,544
TR 222,248,800
Ma 140,200,28
EX 128
Ma 140,204,40
DM 253,16,768
s_add_u32 m0,s49,8448
s_add_u32 s16,s16,16384
s_addc_u32 s17,s17,0
Ca 144,192,8,208
EX 129
s_mov_b32 s49,s24
Ma 144,196,20
EX 130
Ma 144,200,32
RD 192,254,0
CV 196,128,129
Ma 144,204,44
RD 196,254,64
LG 8
Mv 0,208,152
RD 200,254,128
LG 7
Mv 0,212,156
RD 204,254,192
Mv 4,208,160
EX 131
Mv 4,212,164
CV 197,130,131
Mv 8,208,168
EX 136
Mv 8,212,172
DM 216,18,0
s_add_u32 m0,m0,800
LG 6
Mv 12,216,152
EX 137
LG 4
Mv 12,220,156
EX 138
Mv 16,216,160
EX 139
Mv 16,220,164
CV 182,136,137
CV 183,138,139
Mv 20,216,168
TR 208,248,64
TR 210,248,320
Mv 20,220,172
TR 212,248,576
TR 214,248,832
LG 7
Ca 120,192,0,200
EX 140
LG 6
Ma 120,196,12
EX 141
LG 5
Ma 120,200,24
EX 142
LG 4
Ma 120,204,36
DM 217,18,256
s_add_u32 m0,m0,800
Ca 124,192,4,204
TR 216,248,96
CV 190,140,141
Ma 124,196,16
TR 218,248,352
TR 220,248,608
Ma 124,200,28
TR 222,248,864
Ma 124,204,40
EX 143
Ca 128,192,8,208
CV 191,142,143
Ma 128,196,20
EX 144
Ma 128,200,32
RD 192,254,256
Ma 128,204,44
RD 196,254,320
LG 8
Mv 24,208,152
RD 200,254,384
LG 7
Mv 24,212,156
DM 218,18,512
s_add_u32 m0,m0,800
Mv 28,208,160
RD 204,254,448
v_add_u32 v254,s22,v220
Mv 28,212,164
EX 145
Mv 32,208,168
EX 146
Mv 32,212,172
EX 147
LG 6
Mv 36,216,152
CV 198,144,145
CV 199,146,147
LG 4
Mv 36,220,156
EX 120
Mv 40,216,160
EX 121
Mv 40,220,164
EX 122
Mv 44,216,168
TR 208,248,128
CV 176,120,121
Mv 44,220,172
DM 219,18,768
s_add_u32 s18,s18,16384
s_addc_u32 s19,s19,0
LG 4
Ca 136,192,0,200
TR 210,248,384
TR 212,248,640
LG 5
Ma 136,196,12
TR 214,248,896
LG 5
Ma 136,200,24
EX 123
LG 4
Ma 136,204,36
CV 177,122,123
Ca 140,192,4,204
EX 124
Ma 140,196,16
EX 125
Ma 140,200,28
TR 216,248,160
CV 184,124,125
Ma 140,204,40
TR 218,248,416
TR 220,248,672
Ca 144,192,8,208
TR 222,248,928
v_add_u32 v248,s25,v221
Ma 144,196,20
EX 126
Ma 144,200,32
EX 127
Ma 144,204,44
CV 185,126,127
LG 6
Mv 48,208,152
EX 128
LG 4
Mv 48,212,156
EX 129
Mv 52,208,160
EX 130
Mv 52,212,164
EX 131
Mv 56,208,168
CV 192,128,129
CV 193,130,131
Mv 56,212,172
EX 136
Ma 96,208,244
EX 137
Ma 96,212,248
EX 138
LG 2
Mv 60,216,152
EX 139
LG 0
Mv 60,220,156
CV 178,136,137
CV 179,138,139
s_waitcnt vmcnt(16) lgkmcnt(0)
s_barrier
s_cmp_ge_u32 s21,28
s_cbranch_scc1 ItEK_w2
ItEK_r_w2:
Mv 64,216,160
RD 192,254,512
RD 196,254,576
s_sub_u32 s23,101376,s23
s_sub_u32 s24,135168,s24
Mv 64,220,164
RD 200,254,640
RD 204,254,704
s_add_u32 s21,s21,1
Mv 68,216,168
EX 140
Mv 68,220,172
EX 141
Ma 100,216,244
EX 142
Ma 100,220,248
EX 143
Mv 104,240,152
CV 186,140,141
CV 187,142,143
Mv 104,240,156
EX 144
Mv 108,240,160
EX 145
Mv 108,240,164
EX 146
Mv 112,240,168
EX 147
Mv 112,240,172
CV 194,144,145
CV 195,146,147
Ma 116,240,244
Ma 116,240,248
s_sub_u32 s20,s20,1
s_cmp_lg_u32 s20,0
s_cbranch_scc1 LI_w2
LG 0
Mv 104,240,176
RD 244,249,6144
Mv 104,240,180
RD 248,249,7168
Mv 108,240,184
TR 208,248,192
TR 210,248,448
Mv 108,240,188
TR 212,248,704
TR 214,248,960
Mv 112,240,192
TR 216,248,224
TR 218,248,480
Mv 112,240,196
TR 220,248,736
TR 222,248,992
LG 9
Ma 116,240,244
LG 8
Ma 116,240,248
s_nop 7
v_cmp_nge_f32 vcc,s27,v104
v_cmp_nle_f32_e64 s[72:73],v108,s27
s_nop 1
s_or_b64 vcc,vcc,s[72:73]
v_cmp_nle_f32_e64 s[72:73],v112,s27
s_nop 1
s_or_b64 vcc,vcc,s[72:73]
v_cmp_nle_f32_e64 s[72:73],v116,s27
s_nop 1
s_or_b64 vcc,vcc,s[72:73]
s_cbranch_vccnz SLOW_w2
LG 6
Mv 72,208,176
v_rcp_f32 v224,v104
s_add_u32 m0,s48,8448
LG 4
Mv 72,212,180
v_rcp_f32 v226,v108
Mv 76,208,184
v_rcp_f32 v228,v112
Mv 76,212,188
v_rcp_f32 v230,v116
Mv 80,208,192
TR 192,248,0
TR 194,248,256
Mv 80,212,196
TR 196,248,512
TR 198,248,768
LG 6
Mv 84,216,176
DM 250,16,0
s_add_u32 m0,m0,800
LG 4
Mv 84,220,180
TR 200,248,32
MU 72,v224
Mv 88,216,184
TR 202,248,288
MU 73,v224
Mv 88,220,188
TR 204,248,544
MU 74,v224
Mv 92,216,192
TR 206,248,800
MU 75,v224
Mv 92,220,196
DM 251,16,256
s_add_u32 m0,m0,800
LG 6
Mv 0,192,176
TR 208,248,64
MU 84,v224
LG 5
Mv 0,196,180
TR 210,248,320
MU 85,v224
Mv 4,192,184
DM 252,16,512
s_add_u32 m0,m0,800
Mv 4,196,188
TR 212,248,576
MU 86,v224
Mv 8,192,192
TR 214,248,832
MU 87,v224
Mv 8,196,196
TR 216,248,96
CV 72,72,73
LG 7
Mv 12,200,176
DM 253,16,768
s_add_u32 m0,s49,8448
s_add_u32 s16,s16,16384
s_addc_u32 s17,s17,0
LG 5
Mv 12,204,180
TR 218,248,352
CV 73,74,75
Mv 16,200,184
TR 220,248,608
CV 74,84,85
Mv 16,204,188
TR 222,248,864
CV 75,86,87
Mv 20,200,192
TR 192,248,128
MU 76,v226
Mv 20,204,196
DM 216,18,0
s_add_u32 m0,m0,800
LG 7
Mv 24,208,176
TR 194,248,384
MU 77,v226
LG 6
Mv 24,212,180
TR 196,248,640
MU 78,v226
Mv 28,208,184
TR 198,248,896
MU 79,v226
Mv 28,212,188
MU 88,v226
MU 89,v226
Mv 32,208,192
DM 217,18,256
s_add_u32 m0,m0,800
Mv 32,212,196
MU 90,v226
MU 91,v226
LG 6
Mv 36,216,176
TR 200,248,160
CV 76,76,77
LG 5
Mv 36,220,180
TR 202,248,416
CV 77,78,79
Mv 40,216,184
TR 204,248,672
CV 78,88,89
Mv 40,220,188
DM 218,18,512
s_add_u32 m0,m0,800
Mv 44,216,192
TR 206,248,928
CV 79,90,91
Mv 44,220,196
MU 80,v228
MU 81,v228
LG 6
Mv 48,192,176
MU 82,v228
MU 83,v228
LG 4
Mv 48,196,180
MU 92,v228
MU 93,v228
Mv 52,192,184
DM 219,18,768
s_add_u32 s18,s18,16384
s_addc_u32 s19,s19,0
Mv 52,196,188
MU 94,v228
MU 95,v228
Mv 56,192,192
CV 80,80,81
CV 81,82,83
Mv 56,196,196
CV 82,92,93
CV 83,94,95
Ma 96,192,244
MU 0,v224
MU 1,v224
Ma 96,196,248
MU 2,v224
MU 3,v224
LG 2
Mv 60,200,176
MU 12,v224
MU 13,v224
LG 0
Mv 60,204,180
MU 14,v224
MU 15,v224
Mv 64,200,184
CV 0,0,1
CV 1,2,3
Mv 64,204,188
CV 2,12,13
CV 3,14,15
Mv 68,200,192
MU 4,v226
MU 5,v226
Mv 68,204,196
MU 6,v226
MU 7,v226
Ma 100,200,244
MU 16,v226
MU 17,v226
Ma 100,204,248
MU 18,v226
MU 19,v226
CV 4,4,5
CV 5,6,7
CV 6,16,17
CV 7,18,19
MU 8,v228
MU 9,v228
MU 10,v228
MU 11,v228
MU 20,v228
MU 21,v228
MU 22,v228
MU 23,v228
CV 8,8,9
CV 9,10,11
CV 10,20,21
CV 11,22,23
v_pk_mul_f32 v[24:25],v[24:25],v[224:225] op_sel_hi:[1,0]
v_pk_mul_f32 v[26:27],v[26:27],v[224:225] op_sel_hi:[1,0]
v_pk_mul_f32 v[36:37],v[36:37],v[224:225] op_sel_hi:[1,0]
v_pk_mul_f32 v[38:39],v[38:39],v[224:225] op_sel_hi:[1,0]
CV 24,24,25
CV 25,26,27
CV 26,36,37
CV 27,38,39
v_pk_mul_f32 v[28:29],v[28:29],v[226:227] op_sel_hi:[1,0]
v_pk_mul_f32 v[30:31],v[30:31],v[226:227] op_sel_hi:[1,0]
v_pk_mul_f32 v[40:41],v[40:41],v[226:227] op_sel_hi:[1,0]
v_pk_mul_f32 v[42:43],v[42:43],v[226:227] op_sel_hi:[1,0]
CV 28,28,29
CV 29,30,31
CV 30,40,41
CV 31,42,43
v_pk_mul_f32 v[32:33],v[32:33],v[228:229] op_sel_hi:[1,0]
v_pk_mul_f32 v[34:35],v[34:35],v[228:229] op_sel_hi:[1,0]
v_pk_mul_f32 v[44:45],v[44:45],v[228:229] op_sel_hi:[1,0]
v_pk_mul_f32 v[46:47],v[46:47],v[228:229] op_sel_hi:[1,0]
CV 32,32,33
CV 33,34,35
CV 34,44,45
CV 35,46,47
v_pk_mul_f32 v[48:49],v[48:49],v[224:225] op_sel_hi:[1,0]
v_pk_mul_f32 v[50:51],v[50:51],v[224:225] op_sel_hi:[1,0]
v_pk_mul_f32 v[60:61],v[60:61],v[224:225] op_sel_hi:[1,0]
v_pk_mul_f32 v[62:63],v[62:63],v[224:225] op_sel_hi:[1,0]
CV 48,48,49
CV 49,50,51
CV 50,60,61
CV 51,62,63
v_pk_mul_f32 v[52:53],v[52:53],v[226:227] op_sel_hi:[1,0]
v_pk_mul_f32 v[54:55],v[54:55],v[226:227] op_sel_hi:[1,0]
v_pk_mul_f32 v[64:65],v[64:65],v[226:227] op_sel_hi:[1,0]
v_pk_mul_f32 v[66:67],v[66:67],v[226:227] op_sel_hi:[1,0]
CV 52,52,53
CV 53,54,55
CV 54,64,65
CV 55,66,67
v_pk_mul_f32 v[56:57],v[56:57],v[228:229] op_sel_hi:[1,0]
v_pk_mul_f32 v[58:59],v[58:59],v[228:229] op_sel_hi:[1,0]
v_pk_mul_f32 v[68:69],v[68:69],v[228:229] op_sel_hi:[1,0]
v_pk_mul_f32 v[70:71],v[70:71],v[228:229] op_sel_hi:[1,0]
CV 56,56,57
CV 57,58,59
CV 58,68,69
CV 59,70,71
v_pk_mul_f32 v[96:97],v[96:97],v[230:231] op_sel_hi:[1,0]
v_pk_mul_f32 v[98:99],v[98:99],v[230:231] op_sel_hi:[1,0]
v_pk_mul_f32 v[100:101],v[100:101],v[230:231] op_sel_hi:[1,0]
v_pk_mul_f32 v[102:103],v[102:103],v[230:231] op_sel_hi:[1,0]
CV 96,96,97
CV 97,98,99
CV 98,100,101
CV 99,102,103
SLOW_r_w2:
s_cmp_eq_u32 s34,0
s_cbranch_scc0 EB1_w2
v_mov_b32 v254,v220
RD 208,254,0
RD 212,254,64
RD 216,254,128
RD 220,254,192
RD 192,254,256
RD 196,254,320
RD 200,254,384
RD 204,254,448
RD 224,249,20480
RD 228,249,21504
RD 232,249,22528
RD 236,249,23552
ds_write_b128 v249,v[96:99] offset:18432
AM 0,48
AM 1,49
AM 2,50
AM 3,51
AM 4,52
AM 5,53
AM 6,54
AM 7,55
AM 8,56
AM 9,57
AM 10,58
AM 11,59
AM 12,60
AM 13,61
AM 14,62
AM 15,63
AM 16,64
AM 17,65
AM 18,66
AM 19,67
AM 20,68
AM 21,69
AM 22,70
AM 23,71
AM 24,72
AM 25,73
AM 26,74
AM 27,75
AM 28,76
AM 29,77
AM 30,78
AM 31,79
AM 32,80
AM 33,81
AM 34,82
AM 35,83
AM 36,84
AM 37,85
AM 38,86
AM 39,87
AM 40,88
AM 41,89
AM 42,90
AM 43,91
AM 44,92
AM 45,93
AM 46,94
AM 47,95
AW 48,0
AW 49,1
AW 50,2
AW 51,3
AW 52,4
AW 53,5
AW 54,6
AW 55,7
AW 56,8
AW 57,9
AW 58,10
AW 59,11
AW 60,24
AW 61,25
AW 62,26
AW 63,27
AW 64,28
AW 65,29
AW 66,30
AW 67,31
AW 68,32
AW 69,33
AW 70,34
AW 71,35
AW 72,48
AW 73,49
AW 74,50
AW 75,51
AW 76,52
AW 77,53
AW 78,54
AW 79,55
AW 80,56
AW 81,57
AW 82,58
AW 83,59
AW 84,72
AW 85,73
AW 86,74
AW 87,75
AW 88,76
AW 89,77
AW 90,78
AW 91,79
AW 92,80
AW 93,81
AW 94,82
AW 95,83
s_add_u32 s34,s34,1
s_branch LB_w2
EB1_w2:
s_cmp_eq_u32 s34,1
s_cbranch_scc0 EB2_w2
v_mov_b32 v254,v220
LG 12
RD 208,254,0
LG 12
RD 212,254,64
LG 12
RD 216,254,128
LG 12
RD 220,254,192
LG 12
RD 192,254,256
LG 12
RD 196,254,320
LG 12
RD 200,254,384
LG 12
RD 204,254,448
LG 12
RD 224,249,24576
LG 12
RD 228,249,25600
LG 12
RD 232,249,26624
LG 12
RD 236,249,27648
ds_write_b128 v249,v[96:99] offset:22528
AM 0,96
AM 1,97
AM 2,98
AM 3,99
AM 4,100
AM 5,101
AM 6,102
AM 7,103
AM 8,104
AM 9,105
AM 10,106
AM 11,107
AM 12,108
AM 13,109
AM 14,110
AM 15,111
AM 16,112
AM 17,113
AM 18,114
AM 19,115
AM 20,116
AM 21,117
AM 22,118
AM 23,119
AM 24,120
AM 25,121
AM 26,122
AM 27,123
AM 28,124
AM 29,125
AM 30,126
AM 31,127
AM 32,128
AM 33,129
AM 34,130
AM 35,131
AM 36,132
AM 37,133
AM 38,134
AM 39,135
AM 40,136
AM 41,137
AM 42,138
AM 43,139
AM 44,140
AM 45,141
AM 46,142
AM 47,143
AW 96,0
AW 97,1
AW 98,2
AW 99,3
AW 100,4
AW 101,5
AW 102,6
AW 103,7
AW 104,8
AW 105,9
AW 106,10
AW 107,11
AW 108,24
AW 109,25
AW 110,26
AW 111,27
AW 112,28
AW 113,29
AW 114,30
AW 115,31
AW 116,32
AW 117,33
AW 118,34
AW 119,35
AW 120,48
AW 121,49
AW 122,50
AW 123,51
AW 124,52
AW 125,53
AW 126,54
AW 127,55
AW 128,56
AW 129,57
AW 130,58
AW 131,59
AW 132,72
AW 133,73
AW 134,74
AW 135,75
AW 136,76
AW 137,77
AW 138,78
AW 139,79
AW 140,80
AW 141,81
AW 142,82
AW 143,83
s_add_u32 s34,s34,1
s_branch LB_w2
EB2_w2:
s_cmp_eq_u32 s34,2
s_cbranch_scc0 EB3_w2
v_mov_b32 v254,v220
LG 12
RD 208,254,0
LG 12
RD 212,254,64
LG 12
RD 216,254,128
LG 12
RD 220,254,192
LG 12
RD 192,254,256
LG 12
RD 196,254,320
LG 12
RD 200,254,384
LG 12
RD 204,254,448
LG 12
RD 224,249,0
LG 12
RD 228,249,1024
LG 12
RD 232,249,2048
LG 12
RD 236,249,3072
ds_write_b128 v249,v[96:99] offset:26624
AM 0,144
AM 1,145
AM 2,146
AM 3,147
AM 4,148
AM 5,149
AM 6,150
AM 7,151
AM 8,152
AM 9,153
AM 10,154
AM 11,155
AM 12,156
AM 13,157
AM 14,158
AM 15,159
AM 16,160
AM 17,161
AM 18,162
AM 19,163
AM 20,164
AM 21,165
AM 22,166
AM 23,167
AM 24,168
AM 25,169
AM 26,170
AM 27,171
AM 28,172
AM 29,173
AM 30,174
AM 31,175
AM 32,176
AM 33,177
AM 34,178
AM 35,179
AM 36,180
AM 37,181
AM 38,182
AM 39,183
AM 40,184
AM 41,185
AM 42,186
AM 43,187
AM 44,188
AM 45,189
AM 46,190
AM 47,191
AW 144,0
AW 145,1
AW 146,2
AW 147,3
AW 148,4
AW 149,5
AW 150,6
AW 151,7
AW 152,8
AW 153,9
AW 154,10
AW 155,11
AW 156,24
AW 157,25
AW 158,26
AW 159,27
AW 160,28
AW 161,29
AW 162,30
AW 163,31
AW 164,32
AW 165,33
AW 166,34
AW 167,35
AW 168,48
AW 169,49
AW 170,50
AW 171,51
AW 172,52
AW 173,53
AW 174,54
AW 175,55
AW 176,56
AW 177,57
AW 178,58
AW 179,59
AW 180,72
AW 181,73
AW 182,74
AW 183,75
AW 184,76
AW 185,77
AW 186,78
AW 187,79
AW 188,80
AW 189,81
AW 190,82
AW 191,83
s_add_u32 s34,s34,1
s_branch LB_w2
EB3_w2:
ds_write_b128 v249,v[96:99] offset:2048
AW 0,0
AW 1,1
AW 2,2
AW 3,3
AW 4,4
AW 5,5
AW 6,6
AW 7,7
AW 8,8
AW 9,9
AW 10,10
AW 11,11
AW 12,24
AW 13,25
AW 14,26
AW 15,27
AW 16,28
AW 17,29
AW 18,30
AW 19,31
AW 20,32
AW 21,33
AW 22,34
AW 23,35
AW 24,48
AW 25,49
AW 26,50
AW 27,51
AW 28,52
AW 29,53
AW 30,54
AW 31,55
AW 32,56
AW 33,57
AW 34,58
AW 35,59
AW 36,72
AW 37,73
AW 38,74
AW 39,75
AW 40,76
AW 41,77
AW 42,78
AW 43,79
AW 44,80
AW 45,81
AW 46,82
AW 47,83
v_mov_b32 v248,v221
s_mov_b32 s20,0
s_waitcnt vmcnt(20) lgkmcnt(0)
s_barrier
TR 192,248,0
TR 194,248,256
TR 196,248,512
TR 198,248,768
TR 200,248,16896
TR 202,248,17152
TR 204,248,17408
TR 206,248,17664
RD 224,249,16384
RD 228,249,17408
RD 232,249,18432
RD 236,249,19456
s_add_u32 s16,s12,393216
s_addc_u32 s17,s13,0
s_add_u32 s18,s12,458752
s_addc_u32 s19,s13,0
s_mov_b64 s[36:37],0
LC_w2:
LG 0
Za 0,192,48
TR 208,248,32
s_mov_b32 m0,109824
s_add_u32 s32,s14,24576
s_addc_u32 s33,s15,0
Ma 0,196,60
TR 210,248,288
Ma 0,200,72
TR 212,248,544
Ma 0,204,84
TR 214,248,800
Za 4,192,52
TR 216,248,16928
Ma 4,196,64
TR 218,248,17184
Ma 4,200,76
DW 250,16,0
s_mov_b32 m0,110624
Ma 4,204,88
TR 220,248,17440
Za 8,192,56
TR 222,248,17696
Ma 8,196,68
TR 192,248,64
Ma 8,200,80
DW 251,16,256
s_mov_b32 m0,111424
Ma 8,204,92
TR 194,248,320
LG 8
Za 12,208,48
TR 196,248,576
LG 7
Ma 12,212,60
TR 198,248,832
LG 6
Ma 12,216,72
TR 200,248,16960
LG 5
Ma 12,220,84
TR 202,248,17216
Za 16,208,52
TR 204,248,17472
Ma 16,212,64
TR 206,248,17728
Ma 16,216,76
s_mov_b64 exec,s[36:37]
global_store_dwordx4 v249,v[104:107],s[32:33] offset:0 sc1
s_mov_b64 exec,-1
Ma 16,220,88
Za 20,208,56
TR 208,248,96
Ma 20,212,68
TR 210,248,352
Ma 20,216,80
TR 212,248,608
Ma 20,220,92
TR 214,248,864
LG 10
Za 24,192,48
DW 252,16,512
s_mov_b32 m0,112224
LG 8
Ma 24,196,60
TR 216,248,16992
LG 7
Ma 24,200,72
TR 218,248,17248
LG 6
Ma 24,204,84
TR 220,248,17504
Za 28,192,52
TR 222,248,17760
Ma 28,196,64
Ma 28,200,76
Ma 28,204,88
DW 253,16,768
s_mov_b32 m0,126720
Za 32,192,56
TR 192,248,128
Ma 32,196,68
TR 194,248,384
Ma 32,200,80
TR 196,248,640
Ma 32,204,92
TR 198,248,896
LG 10
Za 36,208,48
TR 200,248,17024
LG 9
Ma 36,212,60
TR 202,248,17280
LG 8
Ma 36,216,72
s_mov_b64 exec,s[36:37]
global_store_dwordx4 v249,v[108:111],s[32:33] offset:1024 sc1
s_mov_b64 exec,-1
LG 6
Ma 36,220,84
TR 204,248,17536
Za 40,208,52
TR 206,248,17792
Ma 40,212,64
Ma 40,216,76
Ma 40,220,88
Za 44,208,56
TR 208,248,160
Ma 44,212,68
DW 250,18,0
s_mov_b32 m0,127520
Ma 44,216,80
TR 210,248,416
Ma 44,220,92
TR 212,248,672
LG 9
Za 48,192,48
TR 214,248,928
LG 8
Ma 48,196,60
TR 216,248,17056
LG 7
Ma 48,200,72
TR 218,248,17312
LG 6
Ma 48,204,84
TR 220,248,17568
Za 52,192,52
DW 251,18,256
s_mov_b32 m0,128320
Ma 52,196,64
TR 222,248,17824
Ma 52,200,76
Ma 52,204,88
Za 56,192,56
Ma 56,196,68
Ma 56,200,80
Ma 56,204,92
s_mov_b64 exec,s[36:37]
global_store_dwordx4 v249,v[112:115],s[32:33] offset:2048 sc1
s_mov_b64 exec,-1
Za 96,192,224
TR 192,248,192
Ma 96,196,228
TR 194,248,448
Ma 96,200,232
TR 196,248,704
Ma 96,204,236
TR 198,248,960
LG 10
Za 60,208,48
TR 200,248,17088
LG 9
Ma 60,212,60
TR 202,248,17344
LG 8
Ma 60,216,72
DW 252,18,512
s_mov_b32 m0,129120
LG 6
Ma 60,220,84
TR 204,248,17600
Za 64,208,52
TR 206,248,17856
Ma 64,212,64
Ma 64,216,76
Ma 64,220,88
Za 68,208,56
Ma 68,212,68
DW 253,18,768
s_mov_b32 m0,8448
Ma 68,216,80
Ma 68,220,92
Za 100,208,224
TR 208,248,224
Ma 100,212,228
TR 210,248,480
Ma 100,216,232
TR 212,248,736
Ma 100,220,236
TR 214,248,992
LG 10
Za 72,192,48
TR 216,248,17120
LG 9
Ma 72,196,60
TR 218,248,17376
LG 8
Ma 72,200,72
TR 220,248,17632
LG 7
Ma 72,204,84
TR 222,248,17888
Za 76,192,52
Ma 76,196,64
Ma 76,200,76
Ma 76,204,88
Za 80,192,56
Ma 80,196,68
Ma 80,200,80
Ma 80,204,92
LG 6
Za 84,208,48
LG 4
Ma 84,212,60
LG 2
Ma 84,216,72
LG 0
Ma 84,220,84
s_waitcnt vmcnt(19) lgkmcnt(0)
s_barrier
s_cmp_eq_u32 s20,3
s_cbranch_scc1 Calt1_w2
s_add_u32 s16,s12,256
s_addc_u32 s17,s13,0
s_add_u32 s18,s12,65792
s_addc_u32 s19,s13,0
Calt1_r_w2:
Za 88,208,52
TR 192,248,33792
Ma 88,212,64
TR 194,248,34048
Ma 88,216,76
TR 196,248,34304
Ma 88,220,88
TR 198,248,34560
Za 92,208,56
TR 200,248,50688
TR 202,248,50944
Ma 92,212,68
TR 204,248,51200
TR 206,248,51456
Ma 92,216,80
DW 250,16,0
s_mov_b32 m0,9248
Ma 92,220,92
RD 224,249,20480
LG 7
Ma 0,192,96
RD 228,249,21504
LG 6
Ma 0,196,108
RD 232,249,22528
LG 5
Ma 0,200,120
RD 236,249,23552
LG 4
Ma 0,204,132
TR 208,248,33824
Ma 4,192,100
TR 210,248,34080
Ma 4,196,112
TR 212,248,34336
Ma 4,200,124
TR 214,248,34592
Ma 4,204,136
TR 216,248,50720
Ma 8,192,104
TR 218,248,50976
Ma 8,196,116
DW 251,16,256
s_mov_b32 m0,10048
Ma 8,200,128
TR 220,248,51232
TR 222,248,51488
Ma 8,204,140
s_mov_b64 exec,s[36:37]
global_store_dwordx4 v249,v[116:119],s[32:33] offset:3072 sc1
s_mov_b64 exec,-1
s_add_u32 s32,s14,28672
s_addc_u32 s33,s15,0
LG 6
Ma 12,208,96
TR 192,248,33856
LG 5
Ma 12,212,108
TR 194,248,34112
LG 4
Ma 12,216,120
TR 196,248,34368
LG 3
Ma 12,220,132
TR 198,248,34624
Ma 16,208,100
TR 200,248,50752
Ma 16,212,112
TR 202,248,51008
Ma 16,216,124
TR 204,248,51264
Ma 16,220,136
TR 206,248,51520
Ma 20,208,104
DW 252,16,512
s_mov_b32 m0,10848
Ma 20,212,116
TR 208,248,33888
Ma 20,216,128
TR 210,248,34144
Ma 20,220,140
TR 212,248,34400
LG 9
Ma 24,192,96
DW 253,16,768
s_mov_b32 m0,25344
LG 7
Ma 24,196,108
TR 214,248,34656
LG 6
Ma 24,200,120
TR 216,248,50784
LG 5
Ma 24,204,132
TR 218,248,51040
Ma 28,192,100
TR 220,248,51296
Ma 28,196,112
TR 222,248,51552
Ma 28,200,124
Ma 28,204,136
s_mov_b64 exec,s[36:37]
global_store_dwordx4 v249,v[120:123],s[32:33] offset:0 sc1
s_mov_b64 exec,-1
Ma 32,192,104
TR 192,248,33920
Ma 32,196,116
TR 194,248,34176
Ma 32,200,128
TR 196,248,34432
Ma 32,204,140
TR 198,248,34688
LG 10
Ma 36,208,96
TR 200,248,50816
LG 9
Ma 36,212,108
TR 202,248,51072
LG 8
Ma 36,216,120
DW 250,18,0
s_mov_b32 m0,26144
LG 6
Ma 36,220,132
TR 204,248,51328
Ma 40,208,100
TR 206,248,51584
Ma 40,212,112
Ma 40,216,124
Ma 40,220,136
Ma 44,208,104
TR 208,248,33952
Ma 44,212,116
DW 251,18,256
s_mov_b32 m0,26944
Ma 44,216,128
TR 210,248,34208
Ma 44,220,140
TR 212,248,34464
LG 9
Ma 48,192,96
TR 214,248,34720
LG 8
Ma 48,196,108
TR 216,248,50848
LG 7
Ma 48,200,120
TR 218,248,51104
LG 6
Ma 48,204,132
TR 220,248,51360
Ma 52,192,100
s_mov_b64 exec,s[36:37]
global_store_dwordx4 v249,v[124:127],s[32:33] offset:1024 sc1
s_mov_b64 exec,-1
Ma 52,196,112
TR 222,248,51616
Ma 52,200,124
Ma 52,204,136
Ma 56,192,104
Ma 56,196,116
Ma 56,200,128
Ma 56,204,140
DW 252,18,512
s_mov_b32 m0,27744
Ma 96,192,224
TR 192,248,33984
Ma 96,196,228
TR 194,248,34240
Ma 96,200,232
TR 196,248,34496
Ma 96,204,236
TR 198,248,34752
LG 10
Ma 60,208,96
TR 200,248,50880
LG 9
Ma 60,212,108
TR 202,248,51136
LG 8
Ma 60,216,120
DW 253,18,768
s_mov_b32 m0,42240
LG 6
Ma 60,220,132
TR 204,248,51392
Ma 64,208,100
TR 206,248,51648
Ma 64,212,112
Ma 64,216,124
Ma 64,220,136
Ma 68,208,104
Ma 68,212,116
s_mov_b64 exec,s[36:37]
global_store_dwordx4 v249,v[128:131],s[32:33] offset:2048 sc1
s_mov_b64 exec,-1
Ma 68,216,128
Ma 68,220,140
Ma 100,208,224
TR 208,248,34016
Ma 100,212,228
TR 210,248,34272
Ma 100,216,232
TR 212,248,34528
Ma 100,220,236
TR 214,248,34784
LG 10
Ma 72,192,96
TR 216,248,50912
LG 9
Ma 72,196,108
TR 218,248,51168
LG 8
Ma 72,200,120
TR 220,248,51424
LG 7
Ma 72,204,132
TR 222,248,51680
v_add_u32 v248,67584,v248
Ma 76,192,100
Ma 76,196,112
Ma 76,200,124
Ma 76,204,136
Ma 80,192,104
Ma 80,196,116
Ma 80,200,128
Ma 80,204,140
LG 6
Ma 84,208,96
LG 4
Ma 84,212,108
LG 2
Ma 84,216,120
LG 0
Ma 84,220,132
s_waitcnt vmcnt(20) lgkmcnt(0)
s_barrier
s_cmp_eq_u32 s20,3
s_cbranch_scc1 Calt2_w2
s_add_u32 s16,s12,131328
s_addc_u32 s17,s13,0
s_add_u32 s18,s12,196864
s_addc_u32 s19,s13,0
Calt2_r_w2:
Ma 88,208,100
TR 192,248,0
Ma 88,212,112
TR 194,248,256
Ma 88,216,124
TR 196,248,512
Ma 88,220,136
TR 198,248,768
Ma 92,208,104
TR 200,248,16896
TR 202,248,17152
Ma 92,212,116
TR 204,248,17408
TR 206,248,17664
Ma 92,216,128
DW 250,16,0
s_mov_b32 m0,43040
Ma 92,220,140
RD 224,249,24576
LG 7
Ma 0,192,144
RD 228,249,25600
LG 6
Ma 0,196,156
RD 232,249,26624
LG 5
Ma 0,200,168
RD 236,249,27648
LG 4
Ma 0,204,180
TR 208,248,32
Ma 4,192,148
TR 210,248,288
Ma 4,196,160
TR 212,248,544
Ma 4,200,172
TR 214,248,800
Ma 4,204,184
TR 216,248,16928
Ma 8,192,152
TR 218,248,17184
Ma 8,196,164
DW 251,16,256
s_mov_b32 m0,43840
Ma 8,200,176
TR 220,248,17440
TR 222,248,17696
Ma 8,204,188
s_mov_b64 exec,s[36:37]
global_store_dwordx4 v249,v[132:135],s[32:33] offset:3072 sc1
s_mov_b64 exec,-1
s_add_u32 s32,s14,32768
s_addc_u32 s33,s15,0
LG 6
Ma 12,208,144
TR 192,248,64
LG 5
Ma 12,212,156
TR 194,248,320
LG 4
Ma 12,216,168
TR 196,248,576
LG 3
Ma 12,220,180
TR 198,248,832
Ma 16,208,148
TR 200,248,16960
Ma 16,212,160
TR 202,248,17216
Ma 16,216,172
TR 204,248,17472
Ma 16,220,184
TR 206,248,17728
Ma 20,208,152
DW 252,16,512
s_mov_b32 m0,44640
Ma 20,212,164
TR 208,248,96
Ma 20,216,176
TR 210,248,352
Ma 20,220,188
TR 212,248,608
LG 9
Ma 24,192,144
DW 253,16,768
s_mov_b32 m0,59136
LG 7
Ma 24,196,156
TR 214,248,864
LG 6
Ma 24,200,168
TR 216,248,16992
LG 5
Ma 24,204,180
TR 218,248,17248
Ma 28,192,148
TR 220,248,17504
Ma 28,196,160
TR 222,248,17760
Ma 28,200,172
Ma 28,204,184
s_mov_b64 exec,s[36:37]
global_store_dwordx4 v249,v[136:139],s[32:33] offset:0 sc1
s_mov_b64 exec,-1
Ma 32,192,152
TR 192,248,128
Ma 32,196,164
TR 194,248,384
Ma 32,200,176
TR 196,248,640
Ma 32,204,188
TR 198,248,896
LG 10
Ma 36,208,144
TR 200,248,17024
LG 9
Ma 36,212,156
TR 202,248,17280
LG 8
Ma 36,216,168
DW 250,18,0
s_mov_b32 m0,59936
LG 6
Ma 36,220,180
TR 204,248,17536
Ma 40,208,148
TR 206,248,17792
Ma 40,212,160
Ma 40,216,172
Ma 40,220,184
Ma 44,208,152
TR 208,248,160
Ma 44,212,164
DW 251,18,256
s_mov_b32 m0,60736
Ma 44,216,176
TR 210,248,416
Ma 44,220,188
TR 212,248,672
LG 9
Ma 48,192,144
TR 214,248,928
LG 8
Ma 48,196,156
TR 216,248,17056
LG 7
Ma 48,200,168
TR 218,248,17312
LG 6
Ma 48,204,180
TR 220,248,17568
Ma 52,192,148
s_mov_b64 exec,s[36:37]
global_store_dwordx4 v249,v[140:143],s[32:33] offset:1024 sc1
s_mov_b64 exec,-1
Ma 52,196,160
TR 222,248,17824
Ma 52,200,172
Ma 52,204,184
Ma 56,192,152
Ma 56,196,164
Ma 56,200,176
Ma 56,204,188
DW 252,18,512
s_mov_b32 m0,61536
Ma 96,192,224
TR 192,248,192
Ma 96,196,228
TR 194,248,448
Ma 96,200,232
TR 196,248,704
Ma 96,204,236
TR 198,248,960
LG 10
Ma 60,208,144
TR 200,248,17088
LG 9
Ma 60,212,156
TR 202,248,17344
LG 8
Ma 60,216,168
DW 253,18,768
s_mov_b32 m0,76032
LG 6
Ma 60,220,180
TR 204,248,17600
Ma 64,208,148
TR 206,248,17856
Ma 64,212,160
Ma 64,216,172
Ma 64,220,184
Ma 68,208,152
Ma 68,212,164
Ma 68,216,176
Ma 68,220,188
Ma 100,208,224
TR 208,248,224
Ma 100,212,228
TR 210,248,480
Ma 100,216,232
TR 212,248,736
Ma 100,220,236
TR 214,248,992
LG 10
Ma 72,192,144
TR 216,248,17120
LG 9
Ma 72,196,156
TR 218,248,17376
LG 8
Ma 72,200,168
TR 220,248,17632
LG 7
Ma 72,204,180
TR 222,248,17888
Ma 76,192,148
Ma 76,196,160
Ma 76,200,172
Ma 76,204,184
Ma 80,192,152
Ma 80,196,164
Ma 80,200,176
Ma 80,204,188
LG 6
Ma 84,208,144
LG 4
Ma 84,212,156
LG 2
Ma 84,216,168
LG 0
Ma 84,220,180
s_waitcnt vmcnt(16) lgkmcnt(0)
s_barrier
s_cmp_eq_u32 s20,3
s_cbranch_scc1 Calt3_w2
s_add_u32 s16,s12,262400
s_addc_u32 s17,s13,0
s_add_u32 s18,s12,327936
s_addc_u32 s19,s13,0
Calt3_r_w2:
Ma 88,208,148
TR 192,248,33792
Ma 88,212,160
TR 194,248,34048
Ma 88,216,172
TR 196,248,34304
Ma 88,220,184
TR 198,248,34560
Ma 92,208,152
TR 200,248,50688
TR 202,248,50944
Ma 92,212,164
TR 204,248,51200
TR 206,248,51456
Ma 92,216,176
DW 250,16,0
s_mov_b32 m0,76832
Ma 92,220,188
RD 224,249,0
LG 7
Ma 0,192,0
RD 228,249,1024
LG 6
Ma 0,196,12
RD 232,249,2048
LG 5
Ma 0,200,24
RD 236,249,3072
LG 4
Ma 0,204,36
TR 208,248,33824
Ma 4,192,4
TR 210,248,34080
Ma 4,196,16
TR 212,248,34336
Ma 4,200,28
TR 214,248,34592
s_nop 0
CV 104,0,1
Ma 4,204,40
TR 216,248,50720
CV 105,2,3
Ma 8,192,8
TR 218,248,50976
Ma 8,196,20
DW 251,16,256
s_mov_b32 m0,77632
Ma 8,200,32
TR 220,248,51232
TR 222,248,51488
Ma 8,204,44
s_mov_b64 exec,s[36:37]
global_store_dwordx4 v249,v[144:147],s[32:33] offset:2048 sc1
s_mov_b64 exec,-1
LG 6
Ma 12,208,0
TR 192,248,33856
CV 120,4,5
LG 5
Ma 12,212,12
TR 194,248,34112
CV 121,6,7
LG 4
Ma 12,216,24
TR 196,248,34368
CV 136,8,9
LG 3
Ma 12,220,36
TR 198,248,34624
CV 137,10,11
Ma 16,208,4
TR 200,248,50752
Ma 16,212,16
TR 202,248,51008
Ma 16,216,28
TR 204,248,51264
CV 106,12,13
Ma 16,220,40
TR 206,248,51520
CV 107,14,15
Ma 20,208,8
DW 252,16,512
s_mov_b32 m0,78432
Ma 20,212,20
TR 208,248,33888
Ma 20,216,32
TR 210,248,34144
CV 122,16,17
Ma 20,220,44
TR 212,248,34400
CV 123,18,19
LG 9
Ma 24,192,0
DW 253,16,768
s_mov_b32 m0,92928
LG 7
Ma 24,196,12
TR 214,248,34656
LG 6
Ma 24,200,24
TR 216,248,50784
CV 138,20,21
LG 5
Ma 24,204,36
TR 218,248,51040
CV 139,22,23
Ma 28,192,4
TR 220,248,51296
Ma 28,196,16
TR 222,248,51552
Ma 28,200,28
s_nop 0
CV 108,24,25
CV 109,26,27
Ma 28,204,40
s_mov_b64 exec,s[36:37]
global_store_dwordx4 v249,v[148:151],s[32:33] offset:3072 sc1
s_mov_b64 exec,-1
s_add_u32 s32,s14,49152
s_addc_u32 s33,s15,0
Ma 32,192,8
TR 192,248,33920
Ma 32,196,20
TR 194,248,34176
Ma 32,200,32
TR 196,248,34432
CV 124,28,29
Ma 32,204,44
TR 198,248,34688
CV 125,30,31
LG 10
Ma 36,208,0
TR 200,248,50816
LG 9
Ma 36,212,12
TR 202,248,51072
LG 8
Ma 36,216,24
DW 250,18,0
s_mov_b32 m0,93728
LG 6
Ma 36,220,36
TR 204,248,51328
CV 140,32,33
Ma 40,208,4
TR 206,248,51584
CV 141,34,35
Ma 40,212,16
Ma 40,216,28
s_nop 0
CV 110,36,37
CV 111,38,39
Ma 40,220,40
Ma 44,208,8
TR 208,248,33952
Ma 44,212,20
DW 251,18,256
s_mov_b32 m0,94528
Ma 44,216,32
TR 210,248,34208
s_nop 1
CV 126,40,41
Ma 44,220,44
TR 212,248,34464
CV 127,42,43
LG 9
Ma 48,192,0
TR 214,248,34720
LG 8
Ma 48,196,12
TR 216,248,50848
LG 7
Ma 48,200,24
TR 218,248,51104
CV 142,44,45
LG 6
Ma 48,204,36
TR 220,248,51360
CV 143,46,47
Ma 52,192,4
s_mov_b64 exec,s[36:37]
global_store_dwordx4 v249,v[152:155],s[32:33] offset:2048 sc1
s_mov_b64 exec,-1
Ma 52,196,16
TR 222,248,51616
Ma 52,200,28
CV 112,48,49
CV 113,50,51
Ma 52,204,40
Ma 56,192,8
Ma 56,196,20
Ma 56,200,32
s_nop 4
CV 128,52,53
CV 129,54,55
Ma 56,204,44
DW 252,18,512
s_mov_b32 m0,95328
Ma 96,192,224
TR 192,248,33984
Ma 96,196,228
TR 194,248,34240
Ma 96,200,232
TR 196,248,34496
s_nop 0
CV 144,56,57
Ma 96,204,236
TR 198,248,34752
CV 145,58,59
LG 10
Ma 60,208,0
TR 200,248,50880
LG 9
Ma 60,212,12
TR 202,248,51136
LG 8
Ma 60,216,24
DW 253,18,768
LG 6
Ma 60,220,36
TR 204,248,51392
CV 152,96,97
Ma 64,208,4
TR 206,248,51648
CV 153,98,99
Ma 64,212,16
Ma 64,216,28
s_nop 0
CV 114,60,61
CV 115,62,63
Ma 64,220,40
Ma 68,208,8
Ma 68,212,20
Ma 68,216,32
s_nop 4
CV 130,64,65
CV 131,66,67
Ma 68,220,44
Ma 100,208,224
TR 208,248,34016
Ma 100,212,228
TR 210,248,34272
Ma 100,216,232
TR 212,248,34528
s_nop 1
CV 146,68,69
Ma 100,220,236
TR 214,248,34784
CV 147,70,71
LG 10
Ma 72,192,0
TR 216,248,50912
LG 9
Ma 72,196,12
TR 218,248,51168
LG 8
Ma 72,200,24
TR 220,248,51424
CV 154,100,101
LG 7
Ma 72,204,36
TR 222,248,51680
v_add_u32 v248,4294899712,v248
Ma 76,192,4
CV 155,102,103
Ma 76,196,16
Ma 76,200,28
s_nop 1
CV 116,72,73
CV 117,74,75
Ma 76,204,40
Ma 80,192,8
Ma 80,196,20
Ma 80,200,32
s_nop 4
CV 132,76,77
CV 133,78,79
Ma 80,204,44
LG 6
Ma 84,208,0
LG 4
Ma 84,212,12
LG 2
Ma 84,216,24
s_nop 1
CV 148,80,81
CV 149,82,83
LG 0
Ma 84,220,36
s_waitcnt vmcnt(16) lgkmcnt(0)
s_barrier
s_cmp_eq_u32 s20,3
s_cbranch_scc1 Calt4_w2
s_add_u32 s16,s12,393472
s_addc_u32 s17,s13,0
s_add_u32 s18,s12,459008
s_addc_u32 s19,s13,0
Calt4_r_w2:
Ma 88,208,4
TR 192,248,0
Ma 88,212,16
TR 194,248,256
Ma 88,216,28
TR 196,248,512
TR 198,248,768
Ma 88,220,40
TR 200,248,16896
TR 202,248,17152
Ma 92,208,8
TR 204,248,17408
TR 206,248,17664
Ma 92,212,20
RD 224,249,16384
RD 228,249,17408
Ma 92,216,32
RD 232,249,18432
RD 236,249,19456
Ma 92,220,44
CV 118,84,85
CV 119,86,87
CV 134,88,89
CV 135,90,91
s_nop 3
CV 150,92,93
CV 151,94,95
s_add_u32 s12,s12,256
s_addc_u32 s13,s13,0
s_cmp_eq_u32 s20,0
s_cselect_b32 s28,0,53248
s_add_u32 s14,s14,s28
s_addc_u32 s15,s15,0
s_mov_b64 s[36:37],-1
s_add_u32 s20,s20,1
s_cmp_lg_u32 s20,4
s_cbranch_scc1 LC_w2
s_add_u32 s32,s14,24576
s_addc_u32 s33,s15,0
global_store_dwordx4 v249,v[104:107],s[32:33] offset:0 sc1
global_store_dwordx4 v249,v[108:111],s[32:33] offset:1024 sc1
global_store_dwordx4 v249,v[112:115],s[32:33] offset:2048 sc1
global_store_dwordx4 v249,v[116:119],s[32:33] offset:3072 sc1
s_add_u32 s32,s14,28672
s_addc_u32 s33,s15,0
global_store_dwordx4 v249,v[120:123],s[32:33] offset:0 sc1
global_store_dwordx4 v249,v[124:127],s[32:33] offset:1024 sc1
global_store_dwordx4 v249,v[128:131],s[32:33] offset:2048 sc1
global_store_dwordx4 v249,v[132:135],s[32:33] offset:3072 sc1
s_add_u32 s32,s14,32768
s_addc_u32 s33,s15,0
global_store_dwordx4 v249,v[136:139],s[32:33] offset:0 sc1
global_store_dwordx4 v249,v[140:143],s[32:33] offset:1024 sc1
global_store_dwordx4 v249,v[144:147],s[32:33] offset:2048 sc1
global_store_dwordx4 v249,v[148:151],s[32:33] offset:3072 sc1
s_add_u32 s32,s14,49152
s_addc_u32 s33,s15,0
global_store_dwordx4 v249,v[152:155],s[32:33] offset:2048 sc1
s_waitcnt vmcnt(0) lgkmcnt(0)
s_waitcnt vmcnt(0) lgkmcnt(0)
s_endpgm
ProK_w2:
s_nop 1
v_subrev_u32 v255,135168,v249
v_and_b32 v250,0xf0,v255
v_lshrrev_b32 v255,8,v255
v_lshl_add_u32 v250,v255,14,v250
v_add_u32 v251,768,v250
v_add_u32 v252,1536,v250
v_add_u32 v253,2304,v250
s_mul_hi_u32 s28,s22,254201
s_lshl_b32 s28,s28,16
s_add_u32 s16,s12,s28
s_addc_u32 s17,s13,0
s_cmp_ge_u32 s21,29
s_cbranch_scc0 ProK_r_w2
v_subrev_u32 v255,135168,v249
v_and_b32 v216,0xf0,v255
v_lshrrev_b32 v255,8,v255
v_lshl_add_u32 v216,v255,14,v216
v_add_u32 v217,768,v216
v_add_u32 v218,1536,v216
v_add_u32 v219,2304,v216
s_mul_hi_u32 s28,s25,254201
s_lshl_b32 s28,s28,16
s_add_u32 s18,s12,s28
s_addc_u32 s19,s13,0
s_nop 1
s_branch ProK_r_w2
It0K_w2:
s_nop 1
v_subrev_u32 v255,135168,v249
v_and_b32 v250,0xf0,v255
v_lshrrev_b32 v255,8,v255
v_lshl_add_u32 v250,v255,14,v250
v_add_u32 v251,768,v250
v_add_u32 v252,1536,v250
v_add_u32 v253,2304,v250
s_mul_hi_u32 s28,s23,254201
s_lshl_b32 s28,s28,16
s_add_u32 s16,s12,s28
s_addc_u32 s17,s13,0
s_cmp_ge_u32 s21,29
s_cbranch_scc0 It0K_r_w2
v_subrev_u32 v255,135168,v249
v_and_b32 v216,0xf0,v255
v_lshrrev_b32 v255,8,v255
v_lshl_add_u32 v216,v255,14,v216
v_add_u32 v217,768,v216
v_add_u32 v218,1536,v216
v_add_u32 v219,2304,v216
s_mul_hi_u32 s28,s24,254201
s_lshl_b32 s28,s28,16
s_add_u32 s18,s12,s28
s_addc_u32 s19,s13,0
s_nop 1
s_branch It0K_r_w2
ItOK_w2:
s_nop 1
v_subrev_u32 v255,135168,v249
v_and_b32 v250,0xf0,v255
v_lshrrev_b32 v255,8,v255
v_lshl_add_u32 v250,v255,14,v250
v_add_u32 v251,768,v250
v_add_u32 v252,1536,v250
v_add_u32 v253,2304,v250
s_mul_hi_u32 s28,s22,254201
s_lshl_b32 s28,s28,16
s_add_u32 s16,s12,s28
s_addc_u32 s17,s13,0
s_cmp_ge_u32 s21,29
s_cbranch_scc0 ItOK_r_w2
v_subrev_u32 v255,135168,v249
v_and_b32 v216,0xf0,v255
v_lshrrev_b32 v255,8,v255
v_lshl_add_u32 v216,v255,14,v216
v_add_u32 v217,768,v216
v_add_u32 v218,1536,v216
v_add_u32 v219,2304,v216
s_mul_hi_u32 s28,s25,254201
s_lshl_b32 s28,s28,16
s_add_u32 s18,s12,s28
s_addc_u32 s19,s13,0
s_nop 1
s_branch ItOK_r_w2
ItEK_w2:
s_nop 1
v_subrev_u32 v255,135168,v249
v_and_b32 v250,0xf0,v255
v_lshrrev_b32 v255,8,v255
v_lshl_add_u32 v250,v255,14,v250
v_add_u32 v251,768,v250
v_add_u32 v252,1536,v250
v_add_u32 v253,2304,v250
s_mul_hi_u32 s28,s23,254201
s_lshl_b32 s28,s28,16
s_add_u32 s16,s12,s28
s_addc_u32 s17,s13,0
s_cmp_ge_u32 s21,29
s_cbranch_scc0 ItEK_r_w2
v_subrev_u32 v255,135168,v249
v_and_b32 v216,0xf0,v255
v_lshrrev_b32 v255,8,v255
v_lshl_add_u32 v216,v255,14,v216
v_add_u32 v217,768,v216
v_add_u32 v218,1536,v216
v_add_u32 v219,2304,v216
s_mul_hi_u32 s28,s24,254201
s_lshl_b32 s28,s28,16
s_add_u32 s18,s12,s28
s_addc_u32 s19,s13,0
s_nop 1
s_branch ItEK_r_w2
SLOW_w2:
s_nop 1
LG 0
s_add_u32 m0,s48,8448
s_nop 0
DM 250,16,0
s_add_u32 m0,m0,800
s_nop 0
DM 251,16,256
s_add_u32 m0,m0,800
s_nop 0
DM 252,16,512
s_add_u32 m0,m0,800
s_nop 0
DM 253,16,768
s_add_u32 s16,s16,16384
s_addc_u32 s17,s17,0
s_add_u32 m0,s49,8448
s_nop 0
DM 216,18,0
s_add_u32 m0,m0,800
s_nop 0
DM 217,18,256
s_add_u32 m0,m0,800
s_nop 0
DM 218,18,512
s_add_u32 m0,m0,800
s_nop 0
DM 219,18,768
s_add_u32 s18,s18,16384
s_addc_u32 s19,s19,0
v_subrev_u32 v230,135168,v249
v_lshrrev_b32 v230,4,v230
v_and_b32 v231,15,v230
v_lshrrev_b32 v230,4,v230
v_lshlrev_b32 v228,8,v231
v_lshl_add_u32 v228,v230,4,v228
v_lshlrev_b32 v229,10,v230
v_lshl_add_u32 v229,v231,1,v229
s_lshl_b32 s80,s34,17
s_add_u32 s72,s6,s80
s_addc_u32 s73,s7,0
s_sub_u32 s72,s72,2048
s_subb_u32 s73,s73,0
v_mov_b32 v232,0xff800000
v_mov_b32 v233,0xff800000
v_mov_b32 v234,0xff800000
v_mov_b32 v235,0xff800000
s_mov_b32 s80,0
SL1_w2:
global_load_dwordx4 v[152:155],v228,s[72:73] offset:0
global_load_dwordx4 v[156:159],v228,s[72:73] offset:64
global_load_dwordx4 v[160:163],v228,s[72:73] offset:128
global_load_dwordx4 v[164:167],v228,s[72:73] offset:192
s_waitcnt vmcnt(0)
v_mfma_f32_16x16x32_bf16 v[120:123],v[152:155],a[0:3],0
v_mfma_f32_16x16x32_bf16 v[120:123],v[156:159],a[12:15],v[120:123]
v_mfma_f32_16x16x32_bf16 v[120:123],v[160:163],a[24:27],v[120:123]
v_mfma_f32_16x16x32_bf16 v[120:123],v[164:167],a[36:39],v[120:123]
v_mfma_f32_16x16x32_bf16 v[124:127],v[152:155],a[4:7],0
v_mfma_f32_16x16x32_bf16 v[124:127],v[156:159],a[16:19],v[124:127]
v_mfma_f32_16x16x32_bf16 v[124:127],v[160:163],a[28:31],v[124:127]
v_mfma_f32_16x16x32_bf16 v[124:127],v[164:167],a[40:43],v[124:127]
v_mfma_f32_16x16x32_bf16 v[128:131],v[152:155],a[8:11],0
v_mfma_f32_16x16x32_bf16 v[128:131],v[156:159],a[20:23],v[128:131]
v_mfma_f32_16x16x32_bf16 v[128:131],v[160:163],a[32:35],v[128:131]
v_mfma_f32_16x16x32_bf16 v[128:131],v[164:167],a[44:47],v[128:131]
v_mfma_f32_16x16x32_bf16 v[132:135],v[152:155],a[224:227],0
v_mfma_f32_16x16x32_bf16 v[132:135],v[156:159],a[228:231],v[132:135]
v_mfma_f32_16x16x32_bf16 v[132:135],v[160:163],a[232:235],v[132:135]
v_mfma_f32_16x16x32_bf16 v[132:135],v[164:167],a[236:239],v[132:135]
v_max3_f32 v232,v232,v120,v121
v_max3_f32 v232,v232,v122,v123
v_max3_f32 v233,v233,v124,v125
v_max3_f32 v233,v233,v126,v127
v_max3_f32 v234,v234,v128,v129
v_max3_f32 v234,v234,v130,v131
s_nop 1
v_max3_f32 v235,v235,v132,v133
v_max3_f32 v235,v235,v134,v135
s_add_u32 s72,s72,4096
s_addc_u32 s73,s73,0
s_add_u32 s80,s80,1
s_cmp_lg_u32 s80,32
s_cbranch_scc1 SL1_w2
v_mov_b32 v200,v232
v_mov_b32 v201,v200
s_nop 1
v_permlane16_swap_b32 v200,v201
v_max_f32 v200,v200,v201
v_mov_b32 v201,v200
s_nop 1
v_permlane32_swap_b32 v200,v201
v_max_f32 v200,v200,v201
v_mul_f32 v200,-1.0,v200
v_mov_b32 v201,v200
v_mov_b32 v202,v200
v_mov_b32 v203,v200
v_mov_b32 v204,v233
v_mov_b32 v205,v204
s_nop 1
v_permlane16_swap_b32 v204,v205
v_max_f32 v204,v204,v205
v_mov_b32 v205,v204
s_nop 1
v_permlane32_swap_b32 v204,v205
v_max_f32 v204,v204,v205
v_mul_f32 v204,-1.0,v204
v_mov_b32 v205,v204
v_mov_b32 v206,v204
v_mov_b32 v207,v204
v_mov_b32 v208,v234
v_mov_b32 v209,v208
s_nop 1
v_permlane16_swap_b32 v208,v209
v_max_f32 v208,v208,v209
v_mov_b32 v209,v208
s_nop 1
v_permlane32_swap_b32 v208,v209
v_max_f32 v208,v208,v209
v_mul_f32 v208,-1.0,v208
v_mov_b32 v209,v208
v_mov_b32 v210,v208
v_mov_b32 v211,v208
v_mov_b32 v212,v235
v_mov_b32 v213,v212
s_nop 1
v_permlane16_swap_b32 v212,v213
v_max_f32 v212,v212,v213
v_mov_b32 v213,v212
s_nop 1
v_permlane32_swap_b32 v212,v213
v_max_f32 v212,v212,v213
v_mul_f32 v212,-1.0,v212
v_mov_b32 v213,v212
v_mov_b32 v214,v212
v_mov_b32 v215,v212
s_lshl_b32 s80,s34,17
s_add_u32 s72,s6,s80
s_addc_u32 s73,s7,0
s_sub_u32 s72,s72,2048
s_subb_u32 s73,s73,0
s_lshl_b32 s80,s34,17
s_add_u32 s76,s8,s80
s_addc_u32 s77,s9,0
s_sub_u32 s76,s76,2048
s_subb_u32 s77,s77,0
v_mov_b32 v0,0
v_mov_b32 v1,0
v_mov_b32 v2,0
v_mov_b32 v3,0
v_mov_b32 v4,0
v_mov_b32 v5,0
v_mov_b32 v6,0
v_mov_b32 v7,0
v_mov_b32 v8,0
v_mov_b32 v9,0
v_mov_b32 v10,0
v_mov_b32 v11,0
v_mov_b32 v12,0
v_mov_b32 v13,0
v_mov_b32 v14,0
v_mov_b32 v15,0
v_mov_b32 v16,0
v_mov_b32 v17,0
v_mov_b32 v18,0
v_mov_b32 v19,0
v_mov_b32 v20,0
v_mov_b32 v21,0
v_mov_b32 v22,0
v_mov_b32 v23,0
v_mov_b32 v24,0
v_mov_b32 v25,0
v_mov_b32 v26,0
v_mov_b32 v27,0
v_mov_b32 v28,0
v_mov_b32 v29,0
v_mov_b32 v30,0
v_mov_b32 v31,0
v_mov_b32 v32,0
v_mov_b32 v33,0
v_mov_b32 v34,0
v_mov_b32 v35,0
v_mov_b32 v36,0
v_mov_b32 v37,0
v_mov_b32 v38,0
v_mov_b32 v39,0
v_mov_b32 v40,0
v_mov_b32 v41,0
v_mov_b32 v42,0
v_mov_b32 v43,0
v_mov_b32 v44,0
v_mov_b32 v45,0
v_mov_b32 v46,0
v_mov_b32 v47,0
v_mov_b32 v48,0
v_mov_b32 v49,0
v_mov_b32 v50,0
v_mov_b32 v51,0
v_mov_b32 v52,0
v_mov_b32 v53,0
v_mov_b32 v54,0
v_mov_b32 v55,0
v_mov_b32 v56,0
v_mov_b32 v57,0
v_mov_b32 v58,0
v_mov_b32 v59,0
v_mov_b32 v60,0
v_mov_b32 v61,0
v_mov_b32 v62,0
v_mov_b32 v63,0
v_mov_b32 v64,0
v_mov_b32 v65,0
v_mov_b32 v66,0
v_mov_b32 v67,0
v_mov_b32 v68,0
v_mov_b32 v69,0
v_mov_b32 v70,0
v_mov_b32 v71,0
v_mov_b32 v72,0
v_mov_b32 v73,0
v_mov_b32 v74,0
v_mov_b32 v75,0
v_mov_b32 v76,0
v_mov_b32 v77,0
v_mov_b32 v78,0
v_mov_b32 v79,0
v_mov_b32 v80,0
v_mov_b32 v81,0
v_mov_b32 v82,0
v_mov_b32 v83,0
v_mov_b32 v84,0
v_mov_b32 v85,0
v_mov_b32 v86,0
v_mov_b32 v87,0
v_mov_b32 v88,0
v_mov_b32 v89,0
v_mov_b32 v90,0
v_mov_b32 v91,0
v_mov_b32 v92,0
v_mov_b32 v93,0
v_mov_b32 v94,0
v_mov_b32 v95,0
v_mov_b32 v96,0
v_mov_b32 v97,0
v_mov_b32 v98,0
v_mov_b32 v99,0
v_mov_b32 v100,0
v_mov_b32 v101,0
v_mov_b32 v102,0
v_mov_b32 v103,0
v_mov_b32 v104,0
v_mov_b32 v105,0
v_mov_b32 v106,0
v_mov_b32 v107,0
v_mov_b32 v108,0
v_mov_b32 v109,0
v_mov_b32 v110,0
v_mov_b32 v111,0
v_mov_b32 v112,0
v_mov_b32 v113,0
v_mov_b32 v114,0
v_mov_b32 v115,0
v_mov_b32 v116,0
v_mov_b32 v117,0
v_mov_b32 v118,0
v_mov_b32 v119,0
s_mov_b32 s80,0
SL2_w2:
s_add_u32 s74,s72,4096
s_addc_u32 s75,s73,0
s_add_u32 s78,s76,4096
s_addc_u32 s79,s77,0
global_load_dwordx4 v[152:155],v228,s[72:73] offset:0
global_load_dwordx4 v[156:159],v228,s[72:73] offset:64
global_load_dwordx4 v[160:163],v228,s[72:73] offset:128
global_load_dwordx4 v[164:167],v228,s[72:73] offset:192
global_load_dwordx4 v[168:171],v228,s[74:75] offset:0
global_load_dwordx4 v[172:175],v228,s[74:75] offset:64
global_load_dwordx4 v[176:179],v228,s[74:75] offset:128
global_load_dwordx4 v[180:183],v228,s[74:75] offset:192
s_waitcnt vmcnt(0)
v_mfma_f32_16x16x32_bf16 v[120:123],v[152:155],a[0:3],v[200:203]
v_mfma_f32_16x16x32_bf16 v[120:123],v[156:159],a[12:15],v[120:123]
v_mfma_f32_16x16x32_bf16 v[120:123],v[160:163],a[24:27],v[120:123]
v_mfma_f32_16x16x32_bf16 v[120:123],v[164:167],a[36:39],v[120:123]
v_mfma_f32_16x16x32_bf16 v[124:127],v[152:155],a[4:7],v[204:207]
v_mfma_f32_16x16x32_bf16 v[124:127],v[156:159],a[16:19],v[124:127]
v_mfma_f32_16x16x32_bf16 v[124:127],v[160:163],a[28:31],v[124:127]
v_mfma_f32_16x16x32_bf16 v[124:127],v[164:167],a[40:43],v[124:127]
v_mfma_f32_16x16x32_bf16 v[128:131],v[152:155],a[8:11],v[208:211]
v_mfma_f32_16x16x32_bf16 v[128:131],v[156:159],a[20:23],v[128:131]
v_mfma_f32_16x16x32_bf16 v[128:131],v[160:163],a[32:35],v[128:131]
v_mfma_f32_16x16x32_bf16 v[128:131],v[164:167],a[44:47],v[128:131]
v_mfma_f32_16x16x32_bf16 v[132:135],v[152:155],a[224:227],v[212:215]
v_mfma_f32_16x16x32_bf16 v[132:135],v[156:159],a[228:231],v[132:135]
v_mfma_f32_16x16x32_bf16 v[132:135],v[160:163],a[232:235],v[132:135]
v_mfma_f32_16x16x32_bf16 v[132:135],v[164:167],a[236:239],v[132:135]
v_mfma_f32_16x16x32_bf16 v[136:139],v[168:171],a[0:3],v[200:203]
v_mfma_f32_16x16x32_bf16 v[136:139],v[172:175],a[12:15],v[136:139]
v_mfma_f32_16x16x32_bf16 v[136:139],v[176:179],a[24:27],v[136:139]
v_mfma_f32_16x16x32_bf16 v[136:139],v[180:183],a[36:39],v[136:139]
v_mfma_f32_16x16x32_bf16 v[140:143],v[168:171],a[4:7],v[204:207]
v_mfma_f32_16x16x32_bf16 v[140:143],v[172:175],a[16:19],v[140:143]
v_mfma_f32_16x16x32_bf16 v[140:143],v[176:179],a[28:31],v[140:143]
v_mfma_f32_16x16x32_bf16 v[140:143],v[180:183],a[40:43],v[140:143]
v_mfma_f32_16x16x32_bf16 v[144:147],v[168:171],a[8:11],v[208:211]
v_mfma_f32_16x16x32_bf16 v[144:147],v[172:175],a[20:23],v[144:147]
v_mfma_f32_16x16x32_bf16 v[144:147],v[176:179],a[32:35],v[144:147]
v_mfma_f32_16x16x32_bf16 v[144:147],v[180:183],a[44:47],v[144:147]
v_mfma_f32_16x16x32_bf16 v[148:151],v[168:171],a[224:227],v[212:215]
v_mfma_f32_16x16x32_bf16 v[148:151],v[172:175],a[228:231],v[148:151]
v_mfma_f32_16x16x32_bf16 v[148:151],v[176:179],a[232:235],v[148:151]
v_mfma_f32_16x16x32_bf16 v[148:151],v[180:183],a[236:239],v[148:151]
EX 120
EX 121
EX 122
EX 123
EX 124
EX 125
EX 126
EX 127
EX 128
EX 129
EX 130
EX 131
EX 132
EX 133
EX 134
EX 135
EX 136
EX 137
EX 138
EX 139
EX 140
EX 141
EX 142
EX 143
EX 144
EX 145
EX 146
EX 147
EX 148
EX 149
EX 150
EX 151
CV 184,120,121
CV 185,122,123
CV 188,124,125
CV 189,126,127
CV 192,128,129
CV 193,130,131
CV 196,132,133
CV 197,134,135
CV 186,136,137
CV 187,138,139
CV 190,140,141
CV 191,142,143
CV 194,144,145
CV 195,146,147
CV 198,148,149
CV 199,150,151
global_load_ushort v236,v229,s[76:77] offset:0
global_load_ushort v237,v229,s[76:77] offset:256
global_load_ushort v238,v229,s[76:77] offset:512
global_load_ushort v239,v229,s[76:77] offset:768
global_load_ushort v240,v229,s[78:79] offset:0
global_load_ushort v241,v229,s[78:79] offset:256
global_load_ushort v242,v229,s[78:79] offset:512
global_load_ushort v243,v229,s[78:79] offset:768
s_waitcnt vmcnt(0)
v_lshl_or_b32 v224,v237,16,v236
v_lshl_or_b32 v225,v239,16,v238
v_lshl_or_b32 v226,v241,16,v240
v_lshl_or_b32 v227,v243,16,v242
s_nop 1
v_mfma_f32_16x16x32_bf16 v[0:3],v[224:227],v[184:187],v[0:3]
v_mfma_f32_16x16x32_bf16 v[4:7],v[224:227],v[188:191],v[4:7]
v_mfma_f32_16x16x32_bf16 v[8:11],v[224:227],v[192:195],v[8:11]
s_nop 1
global_load_ushort v236,v229,s[76:77] offset:32
global_load_ushort v237,v229,s[76:77] offset:288
global_load_ushort v238,v229,s[76:77] offset:544
global_load_ushort v239,v229,s[76:77] offset:800
global_load_ushort v240,v229,s[78:79] offset:32
global_load_ushort v241,v229,s[78:79] offset:288
global_load_ushort v242,v229,s[78:79] offset:544
global_load_ushort v243,v229,s[78:79] offset:800
s_waitcnt vmcnt(0)
v_lshl_or_b32 v224,v237,16,v236
v_lshl_or_b32 v225,v239,16,v238
v_lshl_or_b32 v226,v241,16,v240
v_lshl_or_b32 v227,v243,16,v242
s_nop 1
v_mfma_f32_16x16x32_bf16 v[12:15],v[224:227],v[184:187],v[12:15]
v_mfma_f32_16x16x32_bf16 v[16:19],v[224:227],v[188:191],v[16:19]
v_mfma_f32_16x16x32_bf16 v[20:23],v[224:227],v[192:195],v[20:23]
s_nop 1
global_load_ushort v236,v229,s[76:77] offset:64
global_load_ushort v237,v229,s[76:77] offset:320
global_load_ushort v238,v229,s[76:77] offset:576
global_load_ushort v239,v229,s[76:77] offset:832
global_load_ushort v240,v229,s[78:79] offset:64
global_load_ushort v241,v229,s[78:79] offset:320
global_load_ushort v242,v229,s[78:79] offset:576
global_load_ushort v243,v229,s[78:79] offset:832
s_waitcnt vmcnt(0)
v_lshl_or_b32 v224,v237,16,v236
v_lshl_or_b32 v225,v239,16,v238
v_lshl_or_b32 v226,v241,16,v240
v_lshl_or_b32 v227,v243,16,v242
s_nop 1
v_mfma_f32_16x16x32_bf16 v[24:27],v[224:227],v[184:187],v[24:27]
v_mfma_f32_16x16x32_bf16 v[28:31],v[224:227],v[188:191],v[28:31]
v_mfma_f32_16x16x32_bf16 v[32:35],v[224:227],v[192:195],v[32:35]
s_nop 1
global_load_ushort v236,v229,s[76:77] offset:96
global_load_ushort v237,v229,s[76:77] offset:352
global_load_ushort v238,v229,s[76:77] offset:608
global_load_ushort v239,v229,s[76:77] offset:864
global_load_ushort v240,v229,s[78:79] offset:96
global_load_ushort v241,v229,s[78:79] offset:352
global_load_ushort v242,v229,s[78:79] offset:608
global_load_ushort v243,v229,s[78:79] offset:864
s_waitcnt vmcnt(0)
v_lshl_or_b32 v224,v237,16,v236
v_lshl_or_b32 v225,v239,16,v238
v_lshl_or_b32 v226,v241,16,v240
v_lshl_or_b32 v227,v243,16,v242
s_nop 1
v_mfma_f32_16x16x32_bf16 v[36:39],v[224:227],v[184:187],v[36:39]
v_mfma_f32_16x16x32_bf16 v[40:43],v[224:227],v[188:191],v[40:43]
v_mfma_f32_16x16x32_bf16 v[44:47],v[224:227],v[192:195],v[44:47]
s_nop 1
global_load_ushort v236,v229,s[76:77] offset:128
global_load_ushort v237,v229,s[76:77] offset:384
global_load_ushort v238,v229,s[76:77] offset:640
global_load_ushort v239,v229,s[76:77] offset:896
global_load_ushort v240,v229,s[78:79] offset:128
global_load_ushort v241,v229,s[78:79] offset:384
global_load_ushort v242,v229,s[78:79] offset:640
global_load_ushort v243,v229,s[78:79] offset:896
s_waitcnt vmcnt(0)
v_lshl_or_b32 v224,v237,16,v236
v_lshl_or_b32 v225,v239,16,v238
v_lshl_or_b32 v226,v241,16,v240
v_lshl_or_b32 v227,v243,16,v242
s_nop 1
v_mfma_f32_16x16x32_bf16 v[48:51],v[224:227],v[184:187],v[48:51]
v_mfma_f32_16x16x32_bf16 v[52:55],v[224:227],v[188:191],v[52:55]
v_mfma_f32_16x16x32_bf16 v[56:59],v[224:227],v[192:195],v[56:59]
v_mfma_f32_16x16x32_bf16 v[96:99],v[224:227],v[196:199],v[96:99]
s_nop 1
global_load_ushort v236,v229,s[76:77] offset:160
global_load_ushort v237,v229,s[76:77] offset:416
global_load_ushort v238,v229,s[76:77] offset:672
global_load_ushort v239,v229,s[76:77] offset:928
global_load_ushort v240,v229,s[78:79] offset:160
global_load_ushort v241,v229,s[78:79] offset:416
global_load_ushort v242,v229,s[78:79] offset:672
global_load_ushort v243,v229,s[78:79] offset:928
s_waitcnt vmcnt(0)
v_lshl_or_b32 v224,v237,16,v236
v_lshl_or_b32 v225,v239,16,v238
v_lshl_or_b32 v226,v241,16,v240
v_lshl_or_b32 v227,v243,16,v242
s_nop 1
v_mfma_f32_16x16x32_bf16 v[60:63],v[224:227],v[184:187],v[60:63]
v_mfma_f32_16x16x32_bf16 v[64:67],v[224:227],v[188:191],v[64:67]
v_mfma_f32_16x16x32_bf16 v[68:71],v[224:227],v[192:195],v[68:71]
v_mfma_f32_16x16x32_bf16 v[100:103],v[224:227],v[196:199],v[100:103]
s_nop 1
global_load_ushort v236,v229,s[76:77] offset:192
global_load_ushort v237,v229,s[76:77] offset:448
global_load_ushort v238,v229,s[76:77] offset:704
global_load_ushort v239,v229,s[76:77] offset:960
global_load_ushort v240,v229,s[78:79] offset:192
global_load_ushort v241,v229,s[78:79] offset:448
global_load_ushort v242,v229,s[78:79] offset:704
global_load_ushort v243,v229,s[78:79] offset:960
s_waitcnt vmcnt(0)
v_lshl_or_b32 v224,v237,16,v236
v_lshl_or_b32 v225,v239,16,v238
v_lshl_or_b32 v226,v241,16,v240
v_lshl_or_b32 v227,v243,16,v242
s_nop 1
v_mfma_f32_16x16x32_bf16 v[72:75],v[224:227],v[184:187],v[72:75]
v_mfma_f32_16x16x32_bf16 v[76:79],v[224:227],v[188:191],v[76:79]
v_mfma_f32_16x16x32_bf16 v[80:83],v[224:227],v[192:195],v[80:83]
s_nop 1
global_load_ushort v236,v229,s[76:77] offset:224
global_load_ushort v237,v229,s[76:77] offset:480
global_load_ushort v238,v229,s[76:77] offset:736
global_load_ushort v239,v229,s[76:77] offset:992
global_load_ushort v240,v229,s[78:79] offset:224
global_load_ushort v241,v229,s[78:79] offset:480
global_load_ushort v242,v229,s[78:79] offset:736
global_load_ushort v243,v229,s[78:79] offset:992
s_waitcnt vmcnt(0)
v_lshl_or_b32 v224,v237,16,v236
v_lshl_or_b32 v225,v239,16,v238
v_lshl_or_b32 v226,v241,16,v240
v_lshl_or_b32 v227,v243,16,v242
s_nop 1
v_mfma_f32_16x16x32_bf16 v[84:87],v[224:227],v[184:187],v[84:87]
v_mfma_f32_16x16x32_bf16 v[88:91],v[224:227],v[188:191],v[88:91]
v_mfma_f32_16x16x32_bf16 v[92:95],v[224:227],v[192:195],v[92:95]
s_nop 1
v_mfma_f32_16x16x32_bf16 v[104:107],a[240:243],v[184:187],v[104:107]
v_mfma_f32_16x16x32_bf16 v[108:111],a[240:243],v[188:191],v[108:111]
v_mfma_f32_16x16x32_bf16 v[112:115],a[240:243],v[192:195],v[112:115]
v_mfma_f32_16x16x32_bf16 v[116:119],a[240:243],v[196:199],v[116:119]
s_add_u32 s72,s72,8192
s_addc_u32 s73,s73,0
s_add_u32 s76,s76,8192
s_addc_u32 s77,s77,0
s_add_u32 s80,s80,1
s_cmp_lg_u32 s80,16
s_cbranch_scc1 SL2_w2
s_nop 7
s_nop 7
v_rcp_f32 v224,v104
v_rcp_f32 v226,v108
v_rcp_f32 v228,v112
v_rcp_f32 v230,v116
v_pk_mul_f32 v[0:1],v[0:1],v[224:225] op_sel_hi:[1,0]
v_pk_mul_f32 v[2:3],v[2:3],v[224:225] op_sel_hi:[1,0]
v_pk_mul_f32 v[12:13],v[12:13],v[224:225] op_sel_hi:[1,0]
v_pk_mul_f32 v[14:15],v[14:15],v[224:225] op_sel_hi:[1,0]
CV 0,0,1
CV 1,2,3
CV 2,12,13
CV 3,14,15
v_pk_mul_f32 v[4:5],v[4:5],v[226:227] op_sel_hi:[1,0]
v_pk_mul_f32 v[6:7],v[6:7],v[226:227] op_sel_hi:[1,0]
v_pk_mul_f32 v[16:17],v[16:17],v[226:227] op_sel_hi:[1,0]
v_pk_mul_f32 v[18:19],v[18:19],v[226:227] op_sel_hi:[1,0]
CV 4,4,5
CV 5,6,7
CV 6,16,17
CV 7,18,19
v_pk_mul_f32 v[8:9],v[8:9],v[228:229] op_sel_hi:[1,0]
v_pk_mul_f32 v[10:11],v[10:11],v[228:229] op_sel_hi:[1,0]
v_pk_mul_f32 v[20:21],v[20:21],v[228:229] op_sel_hi:[1,0]
v_pk_mul_f32 v[22:23],v[22:23],v[228:229] op_sel_hi:[1,0]
CV 8,8,9
CV 9,10,11
CV 10,20,21
CV 11,22,23
v_pk_mul_f32 v[24:25],v[24:25],v[224:225] op_sel_hi:[1,0]
v_pk_mul_f32 v[26:27],v[26:27],v[224:225] op_sel_hi:[1,0]
v_pk_mul_f32 v[36:37],v[36:37],v[224:225] op_sel_hi:[1,0]
v_pk_mul_f32 v[38:39],v[38:39],v[224:225] op_sel_hi:[1,0]
CV 24,24,25
CV 25,26,27
CV 26,36,37
CV 27,38,39
v_pk_mul_f32 v[28:29],v[28:29],v[226:227] op_sel_hi:[1,0]
v_pk_mul_f32 v[30:31],v[30:31],v[226:227] op_sel_hi:[1,0]
v_pk_mul_f32 v[40:41],v[40:41],v[226:227] op_sel_hi:[1,0]
v_pk_mul_f32 v[42:43],v[42:43],v[226:227] op_sel_hi:[1,0]
CV 28,28,29
CV 29,30,31
CV 30,40,41
CV 31,42,43
v_pk_mul_f32 v[32:33],v[32:33],v[228:229] op_sel_hi:[1,0]
v_pk_mul_f32 v[34:35],v[34:35],v[228:229] op_sel_hi:[1,0]
v_pk_mul_f32 v[44:45],v[44:45],v[228:229] op_sel_hi:[1,0]
v_pk_mul_f32 v[46:47],v[46:47],v[228:229] op_sel_hi:[1,0]
CV 32,32,33
CV 33,34,35
CV 34,44,45
CV 35,46,47
v_pk_mul_f32 v[48:49],v[48:49],v[224:225] op_sel_hi:[1,0]
v_pk_mul_f32 v[50:51],v[50:51],v[224:225] op_sel_hi:[1,0]
v_pk_mul_f32 v[60:61],v[60:61],v[224:225] op_sel_hi:[1,0]
v_pk_mul_f32 v[62:63],v[62:63],v[224:225] op_sel_hi:[1,0]
CV 48,48,49
CV 49,50,51
CV 50,60,61
CV 51,62,63
v_pk_mul_f32 v[52:53],v[52:53],v[226:227] op_sel_hi:[1,0]
v_pk_mul_f32 v[54:55],v[54:55],v[226:227] op_sel_hi:[1,0]
v_pk_mul_f32 v[64:65],v[64:65],v[226:227] op_sel_hi:[1,0]
v_pk_mul_f32 v[66:67],v[66:67],v[226:227] op_sel_hi:[1,0]
CV 52,52,53
CV 53,54,55
CV 54,64,65
CV 55,66,67
v_pk_mul_f32 v[56:57],v[56:57],v[228:229] op_sel_hi:[1,0]
v_pk_mul_f32 v[58:59],v[58:59],v[228:229] op_sel_hi:[1,0]
v_pk_mul_f32 v[68:69],v[68:69],v[228:229] op_sel_hi:[1,0]
v_pk_mul_f32 v[70:71],v[70:71],v[228:229] op_sel_hi:[1,0]
CV 56,56,57
CV 57,58,59
CV 58,68,69
CV 59,70,71
v_pk_mul_f32 v[72:73],v[72:73],v[224:225] op_sel_hi:[1,0]
v_pk_mul_f32 v[74:75],v[74:75],v[224:225] op_sel_hi:[1,0]
v_pk_mul_f32 v[84:85],v[84:85],v[224:225] op_sel_hi:[1,0]
v_pk_mul_f32 v[86:87],v[86:87],v[224:225] op_sel_hi:[1,0]
CV 72,72,73
CV 73,74,75
CV 74,84,85
CV 75,86,87
v_pk_mul_f32 v[76:77],v[76:77],v[226:227] op_sel_hi:[1,0]
v_pk_mul_f32 v[78:79],v[78:79],v[226:227] op_sel_hi:[1,0]
v_pk_mul_f32 v[88:89],v[88:89],v[226:227] op_sel_hi:[1,0]
v_pk_mul_f32 v[90:91],v[90:91],v[226:227] op_sel_hi:[1,0]
CV 76,76,77
CV 77,78,79
CV 78,88,89
CV 79,90,91
v_pk_mul_f32 v[80:81],v[80:81],v[228:229] op_sel_hi:[1,0]
v_pk_mul_f32 v[82:83],v[82:83],v[228:229] op_sel_hi:[1,0]
v_pk_mul_f32 v[92:93],v[92:93],v[228:229] op_sel_hi:[1,0]
v_pk_mul_f32 v[94:95],v[94:95],v[228:229] op_sel_hi:[1,0]
CV 80,80,81
CV 81,82,83
CV 82,92,93
CV 83,94,95
v_pk_mul_f32 v[96:97],v[96:97],v[230:231] op_sel_hi:[1,0]
v_pk_mul_f32 v[98:99],v[98:99],v[230:231] op_sel_hi:[1,0]
v_pk_mul_f32 v[100:101],v[100:101],v[230:231] op_sel_hi:[1,0]
v_pk_mul_f32 v[102:103],v[102:103],v[230:231] op_sel_hi:[1,0]
CV 96,96,97
CV 97,98,99
CV 98,100,101
CV 99,102,103
s_nop 1
s_branch SLOW_r_w2
Calt1_w2:
s_nop 1
v_mov_b32 v250,0
v_mov_b32 v251,0
v_mov_b32 v252,0
v_mov_b32 v253,0
s_add_u32 s16,s12,0
s_addc_u32 s17,s13,0
s_add_u32 s18,s12,0
s_addc_u32 s19,s13,0
s_nop 1
s_branch Calt1_r_w2
Calt2_w2:
s_nop 1
s_add_u32 s16,s12,0
s_addc_u32 s17,s13,0
s_add_u32 s18,s12,0
s_addc_u32 s19,s13,0
s_nop 1
s_branch Calt2_r_w2
Calt3_w2:
s_nop 1
s_add_u32 s16,s12,0
s_addc_u32 s17,s13,0
s_add_u32 s18,s12,0
s_addc_u32 s19,s13,0
s_nop 1
s_branch Calt3_r_w2
Calt4_w2:
s_nop 1
s_add_u32 s16,s12,0
s_addc_u32 s17,s13,0
s_add_u32 s18,s12,0
s_addc_u32 s19,s13,0
s_nop 1
s_branch Calt4_r_w2
.p2align 6
W3:
s_and_b32 s28,s2,7
s_lshr_b32 s29,s2,3
s_lshr_b32 s30,s29,3
s_lshl_b32 s28,s28,2
s_add_u32 s28,s28,s30
s_and_b32 s29,s29,7
s_mul_i32 s30,s28,212992
s_add_u32 s4,s4,s30
s_addc_u32 s5,s5,0
s_lshl_b32 s30,s28,22
s_lshl_b32 s31,s29,19
s_add_u32 s30,s30,s31
s_add_u32 s30,s30,3072
s_add_u32 s6,s6,s30
s_addc_u32 s7,s7,0
s_add_u32 s8,s8,s30
s_addc_u32 s9,s9,0
s_lshl_b32 s30,s29,10
s_add_u32 s30,s30,98304
s_add_u32 s10,s10,s30
s_addc_u32 s11,s11,0
s_add_u32 s30,s31,12288
s_add_u32 s12,s12,s30
s_addc_u32 s13,s13,0
s_lshl_b32 s30,s28,3
s_add_u32 s30,s30,s29
s_mul_i32 s30,s30,212992
s_add_u32 s14,s14,s30
s_addc_u32 s15,s15,0
s_sub_u32 s14,s14,135168
s_subb_u32 s15,s15,0
s_mov_b32 s26,0x3e0293ee
s_mov_b32 s27,0x4f800000
s_mov_b32 s20,0
v_and_b32 v255,63,v0
v_lshlrev_b32 v249,4,v255
v_add_u32 v249,135168,v249
v_bfe_u32 v0,v255,2,3
v_mul_u32_u24 v248,1056,v0
v_lshrrev_b32 v0,5,v255
v_lshlrev_b32 v0,8,v0
v_and_b32 v1,3,v255
v_lshlrev_b32 v1,3,v1
v_add3_u32 v248,v248,v0,v1
v_lshrrev_b32 v0,4,v255
v_lshlrev_b32 v0,17,v0
v_and_b32 v1,15,v255
v_lshl_add_u32 v250,v1,4,v0
v_add_u32 v251,7936,v250
v_add_u32 v252,15872,v250
v_add_u32 v253,23808,v250
s_mov_b32 s31,0x3f803f80
v_accvgpr_write_b32 a240,s31
v_accvgpr_write_b32 a241,s31
v_accvgpr_write_b32 a242,s31
v_accvgpr_write_b32 a243,s31
v_lshrrev_b32 v4,3,v255
v_lshrrev_b32 v5,1,v4
v_and_b32 v6,7,v255
v_xor_b32 v7,v5,v6
v_lshlrev_b32 v7,4,v7
v_lshl_add_u32 v108,v4,10,v7
v_xor_b32 v109,64,v108
v_add_u32 v109,8192,v109
v_and_b32 v4,15,v255
v_lshrrev_b32 v5,4,v255
v_lshrrev_b32 v6,1,v4
v_xor_b32 v7,v5,v6
v_lshlrev_b32 v7,4,v7
v_lshl_add_u32 v104,v4,7,v7
v_xor_b32 v105,64,v104
v_add_u32 v106,67584,v104
v_add_u32 v107,67584,v105
v_lshrrev_b32 v6,2,v4
v_sub_u32 v6,4,v6
v_and_b32 v6,3,v6
v_xor_b32 v7,v5,v6
v_lshlrev_b32 v7,4,v7
v_lshl_add_u32 v254,v4,6,v7
v_add_u32 v254,135168,v254
v_lshrrev_b32 v4,2,v255
v_sub_u32 v6,4,v5
v_and_b32 v6,3,v6
v_and_b32 v7,3,v255
v_xor_b32 v7,v6,v7
v_lshlrev_b32 v7,4,v7
v_lshl_add_u32 v110,v4,10,v7
s_add_u32 s40,s4,147456
s_addc_u32 s41,s5,0
s_add_u32 s42,s4,163840
s_addc_u32 s43,s5,0
s_add_u32 s44,s4,180224
s_addc_u32 s45,s5,0
s_add_u32 s46,s4,197376
s_addc_u32 s47,s5,0
s_add_u32 s16,s10,0
s_addc_u32 s17,s11,0
s_mov_b32 m0,12672
s_nop 0
DW 250,16,0
s_mov_b32 m0,13472
s_nop 0
DW 251,16,256
s_mov_b32 m0,14272
s_nop 0
DW 252,16,512
s_mov_b32 m0,15072
s_nop 0
DW 253,16,768
s_mov_b32 m0,29184
s_nop 0
DW 108,40,0
s_mov_b32 m0,30208
s_nop 0
DW 109,40,0
s_mov_b32 m0,31232
s_nop 0
DW 108,42,0
s_mov_b32 m0,32256
s_nop 0
DW 109,42,0
s_add_u32 s40,s40,128
s_addc_u32 s41,s41,0
s_add_u32 s42,s42,128
s_addc_u32 s43,s43,0
s_mov_b32 m0,39936
s_nop 0
DW 108,44,0
s_mov_b32 m0,40960
s_nop 0
DW 109,44,0
s_add_u32 s44,s44,128
s_addc_u32 s45,s45,0
s_mov_b32 m0,147456
s_nop 0
DW 110,46,0
s_mov_b32 m0,148416
s_nop 0
DW 110,46,64
s_mov_b32 m0,149376
s_nop 0
DW 110,46,128
s_mov_b32 m0,150336
s_nop 0
DW 110,46,192
s_add_u32 s16,s10,524288
s_addc_u32 s17,s11,0
s_mov_b32 m0,63360
s_nop 0
DW 250,16,0
s_mov_b32 m0,64160
s_nop 0
DW 251,16,256
s_mov_b32 m0,64960
s_nop 0
DW 252,16,512
s_mov_b32 m0,65760
s_nop 0
DW 253,16,768
s_mov_b32 m0,79872
s_nop 0
DW 108,40,0
s_mov_b32 m0,80896
s_nop 0
DW 109,40,0
s_mov_b32 m0,81920
s_nop 0
DW 108,42,0
s_mov_b32 m0,82944
s_nop 0
DW 109,42,0
s_add_u32 s40,s40,128
s_addc_u32 s41,s41,0
s_add_u32 s42,s42,128
s_addc_u32 s43,s43,0
s_mov_b32 m0,90624
s_nop 0
DW 108,44,0
s_mov_b32 m0,91648
s_nop 0
DW 109,44,0
s_add_u32 s44,s44,128
s_addc_u32 s45,s45,0
s_add_u32 s16,s10,1048576
s_addc_u32 s17,s11,0
s_mov_b32 m0,114048
s_nop 0
DW 250,16,0
s_mov_b32 m0,114848
s_nop 0
DW 251,16,256
s_mov_b32 m0,115648
s_nop 0
DW 252,16,512
s_mov_b32 m0,116448
s_nop 0
DW 253,16,768
s_mov_b32 m0,130560
s_nop 0
DW 108,40,0
s_mov_b32 m0,131584
s_nop 0
DW 109,40,0
s_mov_b32 m0,132608
s_nop 0
DW 108,42,0
s_mov_b32 m0,133632
s_nop 0
DW 109,42,0
s_add_u32 s40,s40,128
s_addc_u32 s41,s41,0
s_add_u32 s42,s42,128
s_addc_u32 s43,s43,0
s_waitcnt vmcnt(18) lgkmcnt(0)
s_barrier
TR 192,248,0
TR 194,248,8448
TR 196,248,512
TR 198,248,8960
TR 200,248,32
TR 202,248,8480
TR 204,248,544
TR 206,248,8992
RD 0,104,29184
RD 12,105,29184
RD 4,104,31232
RD 16,105,31232
RD 8,104,39936
RD 20,105,39936
RD 224,254,0
LG 14
RD 228,254,1024
LG 0
Za 0,192,0
TR 208,248,64
v_subrev_u32 v255,135168,v249
s_mov_b32 m0,6144
s_add_u32 s16,s10,1572864
s_addc_u32 s17,s11,0
Ma 0,196,12
TR 210,248,8512
v_lshrrev_b32 v255,6,v255
s_lshl_b32 s30,s20,17
s_add_u32 s38,s6,s30
s_addc_u32 s39,s7,0
Za 4,192,4
TR 212,248,576
v_lshlrev_b32 v255,11,v255
s_add_u32 s38,s38,95232
s_addc_u32 s39,s39,0
s_lshl_b32 s30,s20,17
Ma 4,196,16
TR 214,248,9024
s_add_u32 s18,s10,3670272
s_addc_u32 s19,s11,0
Za 8,192,8
TR 216,248,96
Ma 8,196,20
TR 218,248,8544
Za 12,200,0
TR 220,248,608
Ma 12,204,12
TR 222,248,9056
Za 16,200,4
TR 192,248,128
Ma 16,204,16
TR 194,248,8576
Za 20,200,8
TR 196,248,640
Ma 20,204,20
TR 198,248,9088
LG 10
Za 24,208,0
TR 200,248,160
LG 9
Ma 24,212,12
TR 202,248,8608
Za 28,208,4
TR 204,248,672
Ma 28,212,16
TR 206,248,9120
Za 32,208,8
TR 208,248,192
Ma 32,212,20
TR 210,248,8640
LG 12
Za 36,216,0
TR 212,248,704
LG 11
Ma 36,220,12
TR 214,248,9152
Za 40,216,4
Ma 40,220,16
Za 44,216,8
TR 216,248,224
Ma 44,220,20
TR 218,248,8672
LG 12
Za 48,192,0
TR 220,248,736
LG 11
Ma 48,196,12
TR 222,248,9184
Za 52,192,4
Ma 52,196,16
Za 56,192,8
Ma 56,196,20
LG 10
Za 60,200,0
LG 8
Ma 60,204,12
Za 64,200,4
Ma 64,204,16
Za 68,200,8
Ma 68,204,20
s_waitcnt vmcnt(8) lgkmcnt(0)
s_barrier
Za 72,208,0
TR 192,248,50688
Ma 72,212,12
TR 194,248,59136
Za 76,208,4
TR 196,248,51200
Ma 76,212,16
TR 198,248,59648
Za 80,208,8
TR 200,248,50720
Ma 80,212,20
TR 202,248,59168
Za 96,208,224
TR 204,248,51232
Ma 96,212,228
TR 206,248,59680
Za 84,216,0
RD 24,106,12288
Ma 84,220,12
DW 108,44,0
s_mov_b32 m0,7168
Za 88,216,4
RD 36,107,12288
Ma 88,220,16
RD 28,106,14336
Za 92,216,8
RD 40,107,14336
Ma 92,220,20
RD 32,106,23040
Za 100,216,224
DW 109,44,0
s_mov_b32 m0,29568
s_add_u32 s44,s44,128
s_addc_u32 s45,s45,0
Ma 100,220,228
RD 44,107,23040
LG 5
Ma 0,192,24
DW 250,16,0
s_mov_b32 m0,30368
LG 4
Ma 0,196,36
RD 232,254,2048
LG 4
Ma 4,192,28
RD 236,254,3072
LG 4
Ma 4,196,40
DW 251,16,256
s_mov_b32 m0,31168
LG 3
Ma 8,192,32
TR 208,248,50752
LG 3
Ma 8,196,44
TR 210,248,59200
Ma 12,200,24
TR 212,248,51264
Ma 12,204,36
TR 214,248,59712
Ma 16,200,28
DW 252,16,512
s_mov_b32 m0,31968
Ma 16,204,40
TR 216,248,50784
Ma 20,200,32
TR 218,248,59232
Ma 20,204,44
TR 220,248,51296
LG 5
Ma 24,208,24
TR 222,248,59744
LG 4
Ma 24,212,36
DW 253,16,768
s_mov_b32 m0,46080
s_add_u32 s16,s10,2097152
s_addc_u32 s17,s11,0
Ma 28,208,28
DW 108,40,0
s_mov_b32 m0,47104
Ma 28,212,40
TR 192,248,50816
Ma 32,208,32
TR 194,248,59264
Ma 32,212,44
TR 196,248,51328
LG 5
Ma 36,216,24
TR 198,248,59776
LG 4
Ma 36,220,36
DW 109,40,0
s_mov_b32 m0,48128
s_add_u32 s40,s40,128
s_addc_u32 s41,s41,0
Ma 40,216,28
TR 200,248,50848
Ma 40,220,40
TR 202,248,59296
Ma 44,216,32
TR 204,248,51360
Ma 44,220,44
TR 206,248,59808
LG 6
Ma 48,192,24
DW 108,42,0
s_mov_b32 m0,49152
LG 4
Ma 48,196,36
DW 109,42,0
s_mov_b32 m0,56832
s_add_u32 s42,s42,128
s_addc_u32 s43,s43,0
Ma 52,192,28
TR 208,248,50880
Ma 52,196,40
TR 210,248,59328
Ma 56,192,32
TR 212,248,51392
Ma 56,196,44
TR 214,248,59840
LG 6
Ma 60,200,24
TR 216,248,50912
TR 218,248,59360
LG 6
Ma 60,204,36
TR 220,248,51424
TR 222,248,59872
Ma 64,200,28
v_add_u32 v248,67584,v248
Ma 64,204,40
Ma 68,200,32
Ma 68,204,44
s_waitcnt vmcnt(8) lgkmcnt(0)
s_barrier
Ma 72,208,24
TR 192,248,33792
Ma 72,212,36
TR 194,248,42240
Ma 76,208,28
TR 196,248,34304
Ma 76,212,40
TR 198,248,42752
Ma 80,208,32
TR 200,248,33824
Ma 80,212,44
TR 202,248,42272
Ma 96,208,232
TR 204,248,34336
Ma 96,212,236
TR 206,248,42784
Ma 84,216,24
RD 48,106,62976
Ma 84,220,36
DW 108,44,0
s_mov_b32 m0,57856
Ma 88,216,28
RD 60,107,62976
Ma 88,220,40
RD 52,106,65024
Ma 92,216,32
RD 64,107,65024
Ma 92,220,44
RD 56,104,6144
Ma 100,216,232
DW 109,44,0
s_mov_b32 m0,80256
s_add_u32 s44,s44,128
s_addc_u32 s45,s45,0
Ma 100,220,236
RD 68,105,6144
LG 5
Ma 0,192,48
DW 250,16,0
s_mov_b32 m0,81056
LG 4
Ma 0,196,60
RD 224,254,4096
LG 4
Ma 4,192,52
RD 228,254,5120
LG 4
Ma 4,196,64
DW 251,16,256
s_mov_b32 m0,81856
LG 3
Ma 8,192,56
TR 208,248,33856
LG 3
Ma 8,196,68
TR 210,248,42304
Ma 12,200,48
TR 212,248,34368
Ma 12,204,60
TR 214,248,42816
Ma 16,200,52
DW 252,16,512
s_mov_b32 m0,82656
Ma 16,204,64
TR 216,248,33888
Ma 20,200,56
TR 218,248,42336
Ma 20,204,68
TR 220,248,34400
LG 5
Ma 24,208,48
TR 222,248,42848
LG 4
Ma 24,212,60
DW 253,16,768
s_mov_b32 m0,96768
s_add_u32 s16,s10,2621440
s_addc_u32 s17,s11,0
Ma 28,208,52
DW 108,40,0
s_mov_b32 m0,97792
Ma 28,212,64
TR 192,248,33920
Ma 32,208,56
TR 194,248,42368
Ma 32,212,68
TR 196,248,34432
LG 5
Ma 36,216,48
TR 198,248,42880
LG 4
Ma 36,220,60
DW 109,40,0
s_mov_b32 m0,98816
s_add_u32 s40,s40,128
s_addc_u32 s41,s41,0
Ma 40,216,52
TR 200,248,33952
Ma 40,220,64
TR 202,248,42400
Ma 44,216,56
TR 204,248,34464
Ma 44,220,68
TR 206,248,42912
LG 6
Ma 48,192,48
DW 108,42,0
s_mov_b32 m0,99840
LG 4
Ma 48,196,60
DW 109,42,0
s_mov_b32 m0,107520
s_add_u32 s42,s42,128
s_addc_u32 s43,s43,0
Ma 52,192,52
TR 208,248,33984
Ma 52,196,64
TR 210,248,42432
Ma 56,192,56
TR 212,248,34496
Ma 56,196,68
TR 214,248,42944
LG 6
Ma 60,200,48
TR 216,248,34016
TR 218,248,42464
LG 6
Ma 60,204,60
TR 220,248,34528
TR 222,248,42976
Ma 64,200,52
v_add_u32 v248,4294899712,v248
Ma 64,204,64
Ma 68,200,56
Ma 68,204,68
s_waitcnt vmcnt(8) lgkmcnt(0)
s_barrier
Ma 72,208,48
TR 192,248,16896
Ma 72,212,60
TR 194,248,25344
Ma 76,208,52
TR 196,248,17408
Ma 76,212,64
TR 198,248,25856
Ma 80,208,56
TR 200,248,16928
Ma 80,212,68
TR 202,248,25376
Ma 96,208,224
TR 204,248,17440
Ma 96,212,228
TR 206,248,25888
Ma 84,216,48
RD 72,104,46080
Ma 84,220,60
DW 108,44,0
s_mov_b32 m0,108544
Ma 88,216,52
RD 84,105,46080
Ma 88,220,64
RD 76,104,48128
Ma 92,216,56
RD 88,105,48128
Ma 92,220,68
RD 80,104,56832
Ma 100,216,224
DW 109,44,0
s_mov_b32 m0,130944
s_add_u32 s44,s44,128
s_addc_u32 s45,s45,0
Ma 100,220,228
RD 92,105,56832
LG 5
Ma 0,192,72
DW 250,16,0
s_mov_b32 m0,131744
LG 4
Ma 0,196,84
RD 232,254,6144
LG 4
Ma 4,192,76
RD 236,254,7168
LG 4
Ma 4,196,88
DW 251,16,256
s_mov_b32 m0,132544
LG 3
Ma 8,192,80
TR 208,248,16960
LG 3
Ma 8,196,92
TR 210,248,25408
Ma 12,200,72
TR 212,248,17472
Ma 12,204,84
TR 214,248,25920
Ma 16,200,76
DW 252,16,512
s_mov_b32 m0,133344
Ma 16,204,88
TR 216,248,16992
Ma 20,200,80
TR 218,248,25440
Ma 20,204,92
TR 220,248,17504
LG 5
Ma 24,208,72
TR 222,248,25952
LG 4
Ma 24,212,84
DW 253,16,768
s_mov_b32 m0,12288
s_add_u32 s16,s10,3145728
s_addc_u32 s17,s11,0
Ma 28,208,76
DW 108,40,0
s_mov_b32 m0,13312
Ma 28,212,88
TR 192,248,17024
Ma 32,208,80
TR 194,248,25472
Ma 32,212,92
TR 196,248,17536
LG 5
Ma 36,216,72
TR 198,248,25984
LG 4
Ma 36,220,84
DW 109,40,0
s_mov_b32 m0,14336
s_add_u32 s40,s40,128
s_addc_u32 s41,s41,0
Ma 40,216,76
TR 200,248,17056
Ma 40,220,88
TR 202,248,25504
Ma 44,216,80
TR 204,248,17568
Ma 44,220,92
TR 206,248,26016
LG 6
Ma 48,192,72
DW 108,42,0
s_mov_b32 m0,15360
LG 4
Ma 48,196,84
DW 109,42,0
s_mov_b32 m0,23040
s_add_u32 s42,s42,128
s_addc_u32 s43,s43,0
Ma 52,192,76
TR 208,248,17088
Ma 52,196,88
TR 210,248,25536
Ma 56,192,80
TR 212,248,17600
Ma 56,196,92
TR 214,248,26048
LG 6
Ma 60,200,72
TR 216,248,17120
TR 218,248,25568
LG 6
Ma 60,204,84
TR 220,248,17632
TR 222,248,26080
Ma 64,200,76
v_add_u32 v248,67584,v248
Ma 64,204,88
Ma 68,200,80
Ma 68,204,92
s_waitcnt vmcnt(8) lgkmcnt(0)
s_barrier
Ma 72,208,72
TR 192,248,0
Ma 72,212,84
TR 194,248,8448
Ma 76,208,76
TR 196,248,512
Ma 76,212,88
TR 198,248,8960
Ma 80,208,80
TR 200,248,32
Ma 80,212,92
TR 202,248,8480
Ma 96,208,232
TR 204,248,544
Ma 96,212,236
TR 206,248,8992
Ma 84,216,72
RD 96,106,29184
Ma 84,220,84
DW 108,44,0
s_mov_b32 m0,24064
Ma 88,216,76
RD 108,107,29184
Ma 88,220,88
RD 100,106,31232
Ma 92,216,80
RD 112,107,31232
Ma 92,220,92
RD 104,106,39936
Ma 100,216,232
DW 109,44,0
s_mov_b32 m0,46464
s_add_u32 s44,s44,128
s_addc_u32 s45,s45,0
Ma 100,220,236
RD 116,107,39936
LG 5
Ma 0,192,96
DW 250,16,0
s_mov_b32 m0,47264
LG 4
Ma 0,196,108
RD 224,254,8192
LG 4
Ma 4,192,100
RD 228,254,9216
LG 4
Ma 4,196,112
DW 251,16,256
s_mov_b32 m0,48064
LG 3
Ma 8,192,104
TR 208,248,64
LG 3
Ma 8,196,116
TR 210,248,8512
Ma 12,200,96
TR 212,248,576
Ma 12,204,108
TR 214,248,9024
Ma 16,200,100
DW 252,16,512
s_mov_b32 m0,48864
Ma 16,204,112
TR 216,248,96
Ma 20,200,104
TR 218,248,8544
Ma 20,204,116
TR 220,248,608
LG 5
Ma 24,208,96
TR 222,248,9056
LG 4
Ma 24,212,108
DW 253,16,768
s_mov_b32 m0,62976
s_add_u32 s16,s10,3670016
s_addc_u32 s17,s11,0
Ma 28,208,100
DW 108,40,0
s_mov_b32 m0,64000
Ma 28,212,112
TR 192,248,128
Ma 32,208,104
TR 194,248,8576
Ma 32,212,116
TR 196,248,640
LG 5
Ma 36,216,96
TR 198,248,9088
LG 4
Ma 36,220,108
DW 109,40,0
s_mov_b32 m0,65024
s_add_u32 s40,s40,128
s_addc_u32 s41,s41,0
Ma 40,216,100
TR 200,248,160
Ma 40,220,112
TR 202,248,8608
Ma 44,216,104
TR 204,248,672
Ma 44,220,116
TR 206,248,9120
LG 6
Ma 48,192,96
DW 108,42,0
s_mov_b32 m0,66048
LG 4
Ma 48,196,108
DW 109,42,0
s_mov_b32 m0,73728
s_add_u32 s42,s42,128
s_addc_u32 s43,s43,0
Ma 52,192,100
TR 208,248,192
Ma 52,196,112
TR 210,248,8640
Ma 56,192,104
TR 212,248,704
Ma 56,196,116
TR 214,248,9152
LG 6
Ma 60,200,96
TR 216,248,224
TR 218,248,8672
LG 6
Ma 60,204,108
TR 220,248,736
TR 222,248,9184
Ma 64,200,100
Ma 64,204,112
Ma 68,200,104
Ma 68,204,116
s_waitcnt vmcnt(8) lgkmcnt(0)
s_barrier
Ma 72,208,96
TR 192,248,50688
Ma 72,212,108
TR 194,248,59136
Ma 76,208,100
TR 196,248,51200
Ma 76,212,112
TR 198,248,59648
Ma 80,208,104
TR 200,248,50720
Ma 80,212,116
TR 202,248,59168
Ma 96,208,224
TR 204,248,51232
Ma 96,212,228
TR 206,248,59680
Ma 84,216,96
RD 120,104,12288
Ma 84,220,108
DW 108,44,0
s_mov_b32 m0,74752
Ma 88,216,100
RD 132,105,12288
Ma 88,220,112
RD 124,104,14336
Ma 92,216,104
RD 136,105,14336
Ma 92,220,116
RD 128,104,23040
Ma 100,216,224
DW 109,44,0
s_mov_b32 m0,97152
s_add_u32 s44,s44,128
s_addc_u32 s45,s45,0
Ma 100,220,228
RD 140,105,23040
LG 5
Ma 0,192,120
DW 250,16,0
s_mov_b32 m0,97952
LG 4
Ma 0,196,132
RD 232,254,10240
LG 4
Ma 4,192,124
RD 236,254,11264
LG 4
Ma 4,196,136
DW 251,16,256
s_mov_b32 m0,98752
LG 3
Ma 8,192,128
TR 208,248,50752
LG 3
Ma 8,196,140
TR 210,248,59200
Ma 12,200,120
TR 212,248,51264
Ma 12,204,132
TR 214,248,59712
Ma 16,200,124
DW 252,16,512
s_mov_b32 m0,99552
Ma 16,204,136
TR 216,248,50784
Ma 20,200,128
TR 218,248,59232
Ma 20,204,140
TR 220,248,51296
LG 5
Ma 24,208,120
TR 222,248,59744
LG 4
Ma 24,212,132
DW 253,16,768
s_mov_b32 m0,113664
s_add_u32 s16,s10,256
s_addc_u32 s17,s11,0
Ma 28,208,124
DW 108,40,0
s_mov_b32 m0,114688
Ma 28,212,136
TR 192,248,50816
Ma 32,208,128
TR 194,248,59264
Ma 32,212,140
TR 196,248,51328
LG 5
Ma 36,216,120
TR 198,248,59776
LG 4
Ma 36,220,132
DW 109,40,0
s_mov_b32 m0,115712
s_add_u32 s40,s40,128
s_addc_u32 s41,s41,0
Ma 40,216,124
TR 200,248,50848
Ma 40,220,136
TR 202,248,59296
Ma 44,216,128
TR 204,248,51360
Ma 44,220,140
TR 206,248,59808
LG 6
Ma 48,192,120
DW 108,42,0
s_mov_b32 m0,116736
LG 4
Ma 48,196,132
DW 109,42,0
s_mov_b32 m0,124416
s_add_u32 s42,s42,128
s_addc_u32 s43,s43,0
Ma 52,192,124
TR 208,248,50880
Ma 52,196,136
TR 210,248,59328
Ma 56,192,128
TR 212,248,51392
Ma 56,196,140
TR 214,248,59840
LG 6
Ma 60,200,120
TR 216,248,50912
TR 218,248,59360
LG 6
Ma 60,204,132
TR 220,248,51424
TR 222,248,59872
Ma 64,200,124
v_add_u32 v248,4294899712,v248
Ma 64,204,136
Ma 68,200,128
Ma 68,204,140
s_waitcnt vmcnt(8) lgkmcnt(0)
s_barrier
Ma 72,208,120
TR 192,248,33792
Ma 72,212,132
TR 194,248,42240
Ma 76,208,124
TR 196,248,34304
Ma 76,212,136
TR 198,248,42752
Ma 80,208,128
TR 200,248,33824
Ma 80,212,140
TR 202,248,42272
Ma 96,208,232
TR 204,248,34336
Ma 96,212,236
TR 206,248,42784
Ma 84,216,120
RD 144,104,62976
Ma 84,220,132
DW 108,44,0
s_mov_b32 m0,125440
Ma 88,216,124
RD 156,105,62976
Ma 88,220,136
RD 148,104,65024
Ma 92,216,128
RD 160,105,65024
Ma 92,220,140
RD 152,106,6144
Ma 100,216,232
DW 109,44,0
s_mov_b32 m0,12672
s_add_u32 s44,s44,128
s_addc_u32 s45,s45,0
Ma 100,220,236
RD 164,107,6144
LG 5
Ma 0,192,144
DW 250,16,0
s_mov_b32 m0,13472
LG 4
Ma 0,196,156
RD 224,254,12288
LG 4
Ma 4,192,148
RD 228,254,13312
LG 4
Ma 4,196,160
DW 251,16,256
s_mov_b32 m0,14272
LG 3
Ma 8,192,152
TR 208,248,33856
LG 3
Ma 8,196,164
TR 210,248,42304
Ma 12,200,144
TR 212,248,34368
Ma 12,204,156
TR 214,248,42816
Ma 16,200,148
DW 252,16,512
s_mov_b32 m0,15072
Ma 16,204,160
TR 216,248,33888
Ma 20,200,152
TR 218,248,42336
Ma 20,204,164
TR 220,248,34400
LG 5
Ma 24,208,144
TR 222,248,42848
LG 4
Ma 24,212,156
DW 253,16,768
s_add_u32 s16,s10,524544
s_addc_u32 s17,s11,0
s_mov_b32 m0,29568
Ma 28,208,148
DW 250,16,0
s_mov_b32 m0,30368
Ma 28,212,160
TR 192,248,33920
Ma 32,208,152
DW 251,16,256
s_mov_b32 m0,31168
Ma 32,212,164
TR 194,248,42368
LG 4
Ma 36,216,144
TR 196,248,34432
LG 3
Ma 36,220,156
TR 198,248,42880
Ma 40,216,148
DW 252,16,512
s_mov_b32 m0,31968
Ma 40,220,160
TR 200,248,33952
Ma 44,216,152
TR 202,248,42400
Ma 44,220,164
TR 204,248,34464
LG 5
Ma 48,192,144
DW 253,16,768
s_add_u32 s16,s10,1048832
s_addc_u32 s17,s11,0
s_mov_b32 m0,46464
LG 3
Ma 48,196,156
global_load_dword a253,v255,s[38:39]
s_add_u32 s38,s8,s30
s_addc_u32 s39,s9,0
s_add_u32 s38,s38,95232
s_addc_u32 s39,s39,0
Ma 52,192,148
TR 206,248,42912
v_subrev_u32 v255,135168,v249
Ma 52,196,160
TR 208,248,33984
v_lshrrev_b32 v255,6,v255
Ma 56,192,152
TR 210,248,42432
v_lshlrev_b32 v255,11,v255
Ma 56,196,164
TR 212,248,34496
LG 5
Ma 60,200,144
TR 214,248,42944
TR 216,248,34016
LG 5
Ma 60,204,156
TR 218,248,42464
TR 220,248,34528
Ma 64,200,148
TR 222,248,42976
v_add_u32 v248,67584,v248
Ma 64,204,160
Ma 68,200,152
Ma 68,204,164
s_waitcnt vmcnt(9) lgkmcnt(0)
s_barrier
Ma 72,208,144
TR 192,248,16896
Ma 72,212,156
TR 194,248,25344
Ma 76,208,148
TR 196,248,17408
Ma 76,212,160
TR 198,248,25856
Ma 80,208,152
TR 200,248,16928
Ma 80,212,164
TR 202,248,25376
Ma 96,208,224
TR 204,248,17440
Ma 96,212,228
TR 206,248,25888
Ma 84,216,144
RD 168,106,46080
Ma 84,220,156
DW 250,16,0
s_mov_b32 m0,47264
Ma 88,216,148
RD 180,107,46080
Ma 88,220,160
RD 172,106,48128
Ma 92,216,152
RD 184,107,48128
Ma 92,220,164
RD 176,106,56832
Ma 100,216,224
DW 251,16,256
s_mov_b32 m0,48064
Ma 100,220,228
RD 188,107,56832
LG 5
Ma 0,192,168
DW 252,16,512
s_mov_b32 m0,48864
LG 4
Ma 0,196,180
RD 232,254,14336
LG 4
Ma 4,192,172
RD 236,254,15360
LG 4
Ma 4,196,184
DW 253,16,768
s_add_u32 s16,s10,1573120
s_addc_u32 s17,s11,0
s_mov_b32 m0,63360
LG 3
Ma 8,192,176
TR 208,248,16960
MU 0,s26
LG 3
Ma 8,196,188
TR 210,248,25408
MU 1,s26
Ma 12,200,168
TR 212,248,17472
MU 2,s26
Ma 12,204,180
TR 214,248,25920
MU 3,s26
Ma 16,200,172
DW 250,16,0
s_mov_b32 m0,64160
Ma 16,204,184
TR 216,248,16992
CV 0,0,1
Ma 20,200,176
TR 218,248,25440
MU 12,s26
Ma 20,204,188
TR 220,248,17504
MU 13,s26
LG 5
Ma 24,208,168
TR 222,248,25952
MU 14,s26
LG 4
Ma 24,212,180
DW 251,16,256
s_mov_b32 m0,64960
Ma 28,208,172
DW 252,16,512
s_mov_b32 m0,65760
Ma 28,212,184
TR 192,248,17024
MU 15,s26
Ma 32,208,176
DW 253,16,768
s_add_u32 s16,s10,2097408
s_addc_u32 s17,s11,0
s_mov_b32 m0,80256
Ma 32,212,188
TR 194,248,25472
CV 1,2,3
LG 4
Ma 36,216,168
TR 196,248,17536
CV 2,12,13
LG 3
Ma 36,220,180
TR 198,248,25984
CV 3,14,15
Ma 40,216,172
DW 250,16,0
s_mov_b32 m0,81056
Ma 40,220,184
TR 200,248,17056
v_permlane32_swap_b32 v0,v2
Ma 44,216,176
TR 202,248,25504
v_permlane32_swap_b32 v1,v3
Ma 44,220,188
TR 204,248,17568
v_permlane16_swap_b32 v0,v2
LG 5
Ma 48,192,168
DW 251,16,256
s_mov_b32 m0,81856
LG 3
Ma 48,196,180
TR 206,248,26016
v_permlane16_swap_b32 v1,v3
Ma 52,192,172
TR 208,248,17088
MU 4,s26
Ma 52,196,184
TR 210,248,25536
MU 5,s26
Ma 56,192,176
DW 252,16,512
s_mov_b32 m0,82656
Ma 56,196,188
TR 212,248,17600
MU 6,s26
LG 5
Ma 60,200,168
TR 214,248,26048
TR 216,248,17120
LG 5
Ma 60,204,180
TR 218,248,25568
TR 220,248,17632
Ma 64,200,172
DW 253,16,768
s_add_u32 s16,s10,2621696
s_addc_u32 s17,s11,0
s_mov_b32 m0,97152
Ma 64,204,184
global_load_dword a253,v255,s[38:39]
Ma 68,200,176
TR 222,248,26080
v_add_u32 v248,4294899712,v248
Ma 68,204,188
MU 7,s26
MU 16,s26
s_waitcnt vmcnt(14) lgkmcnt(0)
s_barrier
Ma 72,208,168
TR 192,248,0
MU 17,s26
Ma 72,212,180
TR 194,248,8448
MU 18,s26
Ma 76,208,172
TR 196,248,512
MU 19,s26
Ma 76,212,184
TR 198,248,8960
CV 4,4,5
Ma 80,208,176
TR 200,248,16896
CV 5,6,7
Ma 80,212,188
TR 202,248,25344
CV 6,16,17
Ma 96,208,232
TR 204,248,17408
CV 7,18,19
Ma 96,212,236
TR 206,248,25856
v_permlane32_swap_b32 v4,v6
Ma 84,216,168
DW 250,16,0
s_mov_b32 m0,97952
Ma 84,220,180
DW 251,16,256
s_mov_b32 m0,98752
Ma 88,216,172
v_permlane32_swap_b32 v5,v7
v_permlane16_swap_b32 v4,v6
Ma 88,220,184
v_permlane16_swap_b32 v5,v7
MU 8,s26
Ma 92,216,176
DW 252,16,512
s_mov_b32 m0,99552
Ma 92,220,188
MU 9,s26
MU 10,s26
Ma 100,216,232
MU 11,s26
MU 20,s26
Ma 100,220,236
MU 21,s26
MU 22,s26
DW 253,16,768
s_add_u32 s16,s10,3145984
s_addc_u32 s17,s11,0
MU 23,s26
CV 8,8,9
CV 9,10,11
CV 10,20,21
CV 11,22,23
s_nop 0
v_permlane32_swap_b32 v8,v10
v_permlane32_swap_b32 v9,v11
s_nop 0
v_permlane16_swap_b32 v8,v10
v_permlane16_swap_b32 v9,v11
MU 24,s26
MU 25,s26
MU 26,s26
MU 27,s26
MU 36,s26
MU 37,s26
MU 38,s26
MU 39,s26
CV 24,24,25
CV 25,26,27
CV 26,36,37
CV 27,38,39
s_nop 0
v_permlane32_swap_b32 v24,v26
v_permlane32_swap_b32 v25,v27
s_nop 0
v_permlane16_swap_b32 v24,v26
v_permlane16_swap_b32 v25,v27
MU 28,s26
MU 29,s26
MU 30,s26
MU 31,s26
MU 40,s26
MU 41,s26
MU 42,s26
MU 43,s26
CV 28,28,29
CV 29,30,31
CV 30,40,41
CV 31,42,43
s_nop 0
v_permlane32_swap_b32 v28,v30
v_permlane32_swap_b32 v29,v31
s_nop 0
v_permlane16_swap_b32 v28,v30
v_permlane16_swap_b32 v29,v31
MU 32,s26
MU 33,s26
MU 34,s26
MU 35,s26
MU 44,s26
MU 45,s26
MU 46,s26
MU 47,s26
CV 32,32,33
CV 33,34,35
CV 34,44,45
CV 35,46,47
s_nop 0
v_permlane32_swap_b32 v32,v34
v_permlane32_swap_b32 v33,v35
s_nop 0
v_permlane16_swap_b32 v32,v34
v_permlane16_swap_b32 v33,v35
v_pk_mul_f32 v[48:49],v[48:49],s[26:27] op_sel_hi:[1,0]
v_pk_mul_f32 v[50:51],v[50:51],s[26:27] op_sel_hi:[1,0]
v_pk_mul_f32 v[60:61],v[60:61],s[26:27] op_sel_hi:[1,0]
v_pk_mul_f32 v[62:63],v[62:63],s[26:27] op_sel_hi:[1,0]
CV 48,48,49
CV 49,50,51
CV 50,60,61
CV 51,62,63
s_nop 0
v_permlane32_swap_b32 v48,v50
v_permlane32_swap_b32 v49,v51
s_nop 0
v_permlane16_swap_b32 v48,v50
v_permlane16_swap_b32 v49,v51
v_pk_mul_f32 v[52:53],v[52:53],s[26:27] op_sel_hi:[1,0]
v_pk_mul_f32 v[54:55],v[54:55],s[26:27] op_sel_hi:[1,0]
v_pk_mul_f32 v[64:65],v[64:65],s[26:27] op_sel_hi:[1,0]
v_pk_mul_f32 v[66:67],v[66:67],s[26:27] op_sel_hi:[1,0]
CV 52,52,53
CV 53,54,55
CV 54,64,65
CV 55,66,67
s_nop 0
v_permlane32_swap_b32 v52,v54
v_permlane32_swap_b32 v53,v55
s_nop 0
v_permlane16_swap_b32 v52,v54
v_permlane16_swap_b32 v53,v55
v_pk_mul_f32 v[56:57],v[56:57],s[26:27] op_sel_hi:[1,0]
v_pk_mul_f32 v[58:59],v[58:59],s[26:27] op_sel_hi:[1,0]
v_pk_mul_f32 v[68:69],v[68:69],s[26:27] op_sel_hi:[1,0]
v_pk_mul_f32 v[70:71],v[70:71],s[26:27] op_sel_hi:[1,0]
CV 56,56,57
CV 57,58,59
CV 58,68,69
CV 59,70,71
s_nop 0
v_permlane32_swap_b32 v56,v58
v_permlane32_swap_b32 v57,v59
s_nop 0
v_permlane16_swap_b32 v56,v58
v_permlane16_swap_b32 v57,v59
v_pk_mul_f32 v[72:73],v[72:73],s[26:27] op_sel_hi:[1,0]
v_pk_mul_f32 v[74:75],v[74:75],s[26:27] op_sel_hi:[1,0]
v_pk_mul_f32 v[84:85],v[84:85],s[26:27] op_sel_hi:[1,0]
v_pk_mul_f32 v[86:87],v[86:87],s[26:27] op_sel_hi:[1,0]
CV 72,72,73
CV 73,74,75
CV 74,84,85
CV 75,86,87
s_nop 0
v_permlane32_swap_b32 v72,v74
v_permlane32_swap_b32 v73,v75
s_nop 0
v_permlane16_swap_b32 v72,v74
v_permlane16_swap_b32 v73,v75
v_pk_mul_f32 v[76:77],v[76:77],s[26:27] op_sel_hi:[1,0]
v_pk_mul_f32 v[78:79],v[78:79],s[26:27] op_sel_hi:[1,0]
v_pk_mul_f32 v[88:89],v[88:89],s[26:27] op_sel_hi:[1,0]
v_pk_mul_f32 v[90:91],v[90:91],s[26:27] op_sel_hi:[1,0]
CV 76,76,77
CV 77,78,79
CV 78,88,89
CV 79,90,91
s_nop 0
v_permlane32_swap_b32 v76,v78
v_permlane32_swap_b32 v77,v79
s_nop 0
v_permlane16_swap_b32 v76,v78
v_permlane16_swap_b32 v77,v79
v_pk_mul_f32 v[80:81],v[80:81],s[26:27] op_sel_hi:[1,0]
v_pk_mul_f32 v[82:83],v[82:83],s[26:27] op_sel_hi:[1,0]
v_pk_mul_f32 v[92:93],v[92:93],s[26:27] op_sel_hi:[1,0]
v_pk_mul_f32 v[94:95],v[94:95],s[26:27] op_sel_hi:[1,0]
CV 80,80,81
CV 81,82,83
CV 82,92,93
CV 83,94,95
s_nop 0
v_permlane32_swap_b32 v80,v82
v_permlane32_swap_b32 v81,v83
s_nop 0
v_permlane16_swap_b32 v80,v82
v_permlane16_swap_b32 v81,v83
v_pk_mul_f32 v[96:97],v[96:97],s[26:27] op_sel_hi:[1,0]
v_pk_mul_f32 v[98:99],v[98:99],s[26:27] op_sel_hi:[1,0]
v_pk_mul_f32 v[100:101],v[100:101],s[26:27] op_sel_hi:[1,0]
v_pk_mul_f32 v[102:103],v[102:103],s[26:27] op_sel_hi:[1,0]
CV 96,96,97
CV 97,98,99
CV 98,100,101
CV 99,102,103
s_nop 0
v_permlane32_swap_b32 v96,v98
v_permlane32_swap_b32 v97,v99
s_nop 0
v_permlane16_swap_b32 v96,v98
v_permlane16_swap_b32 v97,v99
ds_write_b128 v249,v[96:99] offset:19456
v_mov_b32 v104,v0
v_mov_b32 v105,v1
v_mov_b32 v106,v2
v_mov_b32 v107,v3
v_mov_b32 v108,v4
v_mov_b32 v109,v5
v_mov_b32 v110,v6
v_mov_b32 v111,v7
v_mov_b32 v112,v8
v_mov_b32 v113,v9
v_mov_b32 v114,v10
v_mov_b32 v115,v11
v_mov_b32 v116,v24
v_mov_b32 v117,v25
v_mov_b32 v118,v26
v_mov_b32 v119,v27
v_mov_b32 v120,v28
v_mov_b32 v121,v29
v_mov_b32 v122,v30
v_mov_b32 v123,v31
v_mov_b32 v124,v32
v_mov_b32 v125,v33
v_mov_b32 v126,v34
v_mov_b32 v127,v35
v_mov_b32 v128,v48
v_mov_b32 v129,v49
v_mov_b32 v130,v50
v_mov_b32 v131,v51
v_mov_b32 v132,v52
v_mov_b32 v133,v53
v_mov_b32 v134,v54
v_mov_b32 v135,v55
v_mov_b32 v136,v56
v_mov_b32 v137,v57
v_mov_b32 v138,v58
v_mov_b32 v139,v59
v_mov_b32 v140,v72
v_mov_b32 v141,v73
v_mov_b32 v142,v74
v_mov_b32 v143,v75
v_mov_b32 v144,v76
v_mov_b32 v145,v77
v_mov_b32 v146,v78
v_mov_b32 v147,v79
v_mov_b32 v148,v80
v_mov_b32 v149,v81
v_mov_b32 v150,v82
v_mov_b32 v151,v83
s_add_u32 s10,s10,256
s_addc_u32 s11,s11,0
s_add_u32 s20,s20,1
LA_w3:
LG 0
Za 0,192,0
RD 224,254,0
v_subrev_u32 v255,135168,v249
s_mov_b32 m0,114048
s_lshl_b32 s30,s20,17
Ma 0,196,12
RD 228,254,1024
v_lshrrev_b32 v255,6,v255
s_add_u32 s38,s6,s30
s_addc_u32 s39,s7,0
s_add_u32 s38,s38,95232
s_addc_u32 s39,s39,0
Ma 0,200,24
RD 232,254,2048
v_lshlrev_b32 v255,11,v255
s_lshl_b32 s30,s20,17
Ma 0,204,36
RD 236,254,3072
Za 4,192,4
TR 208,248,32
Ma 4,196,16
TR 210,248,8480
Ma 4,200,28
TR 212,248,544
Ma 4,204,40
TR 214,248,8992
Za 8,192,8
TR 216,248,16928
TR 218,248,25376
Ma 8,196,20
TR 220,248,17440
TR 222,248,25888
Ma 8,200,32
DW 250,16,0
s_mov_b32 m0,114848
Ma 8,204,44
TR 192,248,64
LG 7
Za 12,208,0
TR 194,248,8512
LG 6
Ma 12,212,12
TR 196,248,576
LG 5
Ma 12,216,24
TR 198,248,9024
LG 4
Ma 12,220,36
TR 200,248,16960
Za 16,208,4
TR 202,248,25408
Ma 16,212,16
TR 204,248,17472
Ma 16,216,28
TR 206,248,25920
Ma 16,220,40
DW 251,16,256
s_mov_b32 m0,115648
Za 20,208,8
TR 208,248,96
Ma 20,212,20
TR 210,248,8544
Ma 20,216,32
TR 212,248,608
Ma 20,220,44
TR 214,248,9056
LG 10
Za 24,192,0
TR 216,248,16992
LG 9
Ma 24,196,12
TR 218,248,25440
LG 8
Ma 24,200,24
TR 220,248,17504
LG 7
Ma 24,204,36
DW 252,16,512
s_mov_b32 m0,116448
Za 28,192,4
TR 222,248,25952
Ma 28,196,16
Ma 28,200,28
Ma 28,204,40
Za 32,192,8
TR 192,248,128
Ma 32,196,20
TR 194,248,8576
Ma 32,200,32
TR 196,248,640
Ma 32,204,44
TR 198,248,9088
LG 10
Za 36,208,0
TR 200,248,17024
LG 9
Ma 36,212,12
DW 253,16,768
s_mov_b32 m0,130944
s_add_u32 s16,s10,256
s_addc_u32 s17,s11,0
LG 7
Ma 36,216,24
TR 202,248,25472
LG 6
Ma 36,220,36
TR 204,248,17536
Za 40,208,4
TR 206,248,25984
Ma 40,212,16
Ma 40,216,28
Ma 40,220,40
Za 44,208,8
TR 208,248,160
Ma 44,212,20
TR 210,248,8608
Ma 44,216,32
TR 212,248,672
Ma 44,220,44
DW 250,18,0
s_mov_b32 m0,131744
LG 9
Za 48,192,0
TR 214,248,9120
LG 8
Ma 48,196,12
TR 216,248,17056
LG 7
Ma 48,200,24
TR 218,248,25504
LG 6
Ma 48,204,36
TR 220,248,17568
Za 52,192,4
TR 222,248,26016
Ma 52,196,16
Ma 52,200,28
Ma 52,204,40
Za 56,192,8
TR 192,248,192
Ma 56,196,20
DW 251,18,256
s_mov_b32 m0,132544
Ma 56,200,32
TR 194,248,8640
Ma 56,204,44
TR 196,248,704
LG 9
Za 60,208,0
TR 198,248,9152
LG 8
Ma 60,212,12
TR 200,248,17088
LG 7
Ma 60,216,24
TR 202,248,25536
LG 6
Ma 60,220,36
TR 204,248,17600
Za 64,208,4
TR 206,248,26048
Ma 64,212,16
Ma 64,216,28
Ma 64,220,40
DW 252,18,512
s_mov_b32 m0,133344
Za 68,208,8
TR 208,248,224
Ma 68,212,20
TR 210,248,8672
Ma 68,216,32
TR 212,248,736
Ma 68,220,44
TR 214,248,9184
LG 10
Za 72,192,0
TR 216,248,17120
LG 9
Ma 72,196,12
TR 218,248,25568
LG 8
Ma 72,200,24
TR 220,248,17632
LG 7
Ma 72,204,36
TR 222,248,26080
Za 76,192,4
Ma 76,196,16
DW 253,18,768
s_mov_b32 m0,12672
s_add_u32 s18,s10,524544
s_addc_u32 s19,s11,0
Ma 76,200,28
Ma 76,204,40
Za 80,192,8
Ma 80,196,20
Ma 80,200,32
Ma 80,204,44
Za 96,192,224
Ma 96,196,228
Ma 96,200,232
Ma 96,204,236
LG 6
Za 84,208,0
LG 4
Ma 84,212,12
LG 2
Ma 84,216,24
LG 0
Ma 84,220,36
s_waitcnt vmcnt(17) lgkmcnt(0)
s_barrier
Za 88,208,4
TR 192,248,33792
Ma 88,212,16
TR 194,248,42240
Ma 88,216,28
TR 196,248,34304
Ma 88,220,40
TR 198,248,42752
Za 92,208,8
TR 200,248,50688
Ma 92,212,20
TR 202,248,59136
Ma 92,216,32
TR 204,248,51200
Ma 92,220,44
TR 206,248,59648
Za 100,208,224
DW 250,16,0
s_mov_b32 m0,13472
Ma 100,212,228
RD 224,254,4096
Ma 100,216,232
RD 228,254,5120
Ma 100,220,236
RD 232,254,6144
LG 9
Ma 0,192,48
RD 236,254,7168
LG 8
Ma 0,196,60
TR 208,248,33824
LG 7
Ma 0,200,72
TR 210,248,42272
LG 6
Ma 0,204,84
TR 212,248,34336
Ma 4,192,52
TR 214,248,42784
Ma 4,196,64
TR 216,248,50720
Ma 4,200,76
TR 218,248,59168
Ma 4,204,88
TR 220,248,51232
Ma 8,192,56
TR 222,248,59680
Ma 8,196,68
DW 251,16,256
s_mov_b32 m0,14272
Ma 8,200,80
TR 192,248,33856
Ma 8,204,92
TR 194,248,42304
LG 8
Ma 12,208,48
TR 196,248,34368
LG 7
Ma 12,212,60
TR 198,248,42816
LG 6
Ma 12,216,72
TR 200,248,50752
LG 5
Ma 12,220,84
TR 202,248,59200
Ma 16,208,52
TR 204,248,51264
Ma 16,212,64
TR 206,248,59712
Ma 16,216,76
DW 252,16,512
s_mov_b32 m0,15072
Ma 16,220,88
Ma 20,208,56
TR 208,248,33888
Ma 20,212,68
TR 210,248,42336
Ma 20,216,80
TR 212,248,34400
Ma 20,220,92
TR 214,248,42848
LG 10
Ma 24,192,48
TR 216,248,50784
LG 9
Ma 24,196,60
TR 218,248,59232
LG 8
Ma 24,200,72
TR 220,248,51296
LG 7
Ma 24,204,84
TR 222,248,59744
Ma 28,192,52
Ma 28,196,64
DW 253,16,768
s_mov_b32 m0,29568
s_add_u32 s16,s10,1048832
s_addc_u32 s17,s11,0
Ma 28,200,76
Ma 28,204,88
Ma 32,192,56
TR 192,248,33920
Ma 32,196,68
TR 194,248,42368
Ma 32,200,80
TR 196,248,34432
Ma 32,204,92
TR 198,248,42880
LG 10
Ma 36,208,48
TR 200,248,50816
LG 9
Ma 36,212,60
TR 202,248,59264
LG 8
Ma 36,216,72
TR 204,248,51328
LG 7
Ma 36,220,84
TR 206,248,59776
Ma 40,208,52
DW 250,18,0
s_mov_b32 m0,30368
Ma 40,212,64
Ma 40,216,76
Ma 40,220,88
Ma 44,208,56
TR 208,248,33952
Ma 44,212,68
TR 210,248,42400
Ma 44,216,80
TR 212,248,34464
Ma 44,220,92
TR 214,248,42912
LG 10
Ma 48,192,48
TR 216,248,50848
LG 9
Ma 48,196,60
TR 218,248,59296
LG 8
Ma 48,200,72
TR 220,248,51360
LG 7
Ma 48,204,84
DW 251,18,256
s_mov_b32 m0,31168
Ma 52,192,52
TR 222,248,59808
Ma 52,196,64
Ma 52,200,76
Ma 52,204,88
Ma 56,192,56
TR 192,248,33984
Ma 56,196,68
TR 194,248,42432
Ma 56,200,80
TR 196,248,34496
Ma 56,204,92
TR 198,248,42944
LG 10
Ma 60,208,48
TR 200,248,50880
LG 9
Ma 60,212,60
TR 202,248,59328
LG 8
Ma 60,216,72
DW 252,18,512
s_mov_b32 m0,31968
LG 6
Ma 60,220,84
TR 204,248,51392
Ma 64,208,52
TR 206,248,59840
Ma 64,212,64
Ma 64,216,76
Ma 64,220,88
Ma 68,208,56
TR 208,248,34016
Ma 68,212,68
TR 210,248,42464
Ma 68,216,80
TR 212,248,34528
Ma 68,220,92
TR 214,248,42976
LG 10
Ma 72,192,48
TR 216,248,50912
LG 9
Ma 72,196,60
DW 253,18,768
s_mov_b32 m0,46464
s_add_u32 s18,s10,1573120
s_addc_u32 s19,s11,0
LG 7
Ma 72,200,72
global_load_dword a253,v255,s[38:39]
s_add_u32 s38,s8,s30
s_addc_u32 s39,s9,0
s_add_u32 s38,s38,95232
s_addc_u32 s39,s39,0
LG 5
Ma 72,204,84
TR 218,248,59360
v_subrev_u32 v255,135168,v249
Ma 76,192,52
TR 220,248,51424
v_lshrrev_b32 v255,6,v255
Ma 76,196,64
TR 222,248,59872
v_add_u32 v248,67584,v248
Ma 76,200,76
v_lshlrev_b32 v255,11,v255
Ma 76,204,88
Ma 80,192,56
Ma 80,196,68
Ma 80,200,80
Ma 80,204,92
Ma 96,192,224
Ma 96,196,228
Ma 96,200,232
Ma 96,204,236
LG 6
Ma 84,208,48
LG 4
Ma 84,212,60
LG 2
Ma 84,216,72
LG 0
Ma 84,220,84
s_waitcnt vmcnt(17) lgkmcnt(0)
s_barrier
Ma 88,208,52
TR 192,248,0
Ma 88,212,64
TR 194,248,8448
Ma 88,216,76
TR 196,248,512
Ma 88,220,88
TR 198,248,8960
Ma 92,208,56
TR 200,248,16896
Ma 92,212,68
TR 202,248,25344
Ma 92,216,80
TR 204,248,17408
Ma 92,220,92
TR 206,248,25856
Ma 100,208,224
DW 250,16,0
s_mov_b32 m0,47264
Ma 100,212,228
RD 224,254,8192
Ma 100,216,232
RD 228,254,9216
Ma 100,220,236
RD 232,254,10240
LG 9
Ma 0,192,96
RD 236,254,11264
LG 8
Ma 0,196,108
TR 208,248,32
LG 7
Ma 0,200,120
TR 210,248,8480
LG 6
Ma 0,204,132
TR 212,248,544
Ma 4,192,100
TR 214,248,8992
Ma 4,196,112
TR 216,248,16928
Ma 4,200,124
TR 218,248,25376
Ma 4,204,136
TR 220,248,17440
Ma 8,192,104
TR 222,248,25888
Ma 8,196,116
DW 251,16,256
s_mov_b32 m0,48064
Ma 8,200,128
TR 192,248,64
Ma 8,204,140
TR 194,248,8512
LG 8
Ma 12,208,96
TR 196,248,576
LG 7
Ma 12,212,108
TR 198,248,9024
LG 6
Ma 12,216,120
TR 200,248,16960
LG 5
Ma 12,220,132
TR 202,248,25408
Ma 16,208,100
TR 204,248,17472
Ma 16,212,112
TR 206,248,25920
Ma 16,216,124
DW 252,16,512
s_mov_b32 m0,48864
Ma 16,220,136
Ma 20,208,104
TR 208,248,96
Ma 20,212,116
TR 210,248,8544
Ma 20,216,128
TR 212,248,608
Ma 20,220,140
TR 214,248,9056
LG 10
Ma 24,192,96
TR 216,248,16992
LG 9
Ma 24,196,108
TR 218,248,25440
LG 8
Ma 24,200,120
TR 220,248,17504
LG 7
Ma 24,204,132
TR 222,248,25952
Ma 28,192,100
Ma 28,196,112
DW 253,16,768
s_mov_b32 m0,63360
s_add_u32 s16,s10,2097408
s_addc_u32 s17,s11,0
Ma 28,200,124
Ma 28,204,136
Ma 32,192,104
TR 192,248,128
Ma 32,196,116
TR 194,248,8576
Ma 32,200,128
TR 196,248,640
Ma 32,204,140
TR 198,248,9088
LG 10
Ma 36,208,96
TR 200,248,17024
LG 9
Ma 36,212,108
TR 202,248,25472
LG 8
Ma 36,216,120
TR 204,248,17536
LG 7
Ma 36,220,132
TR 206,248,25984
Ma 40,208,100
DW 250,18,0
s_mov_b32 m0,64160
Ma 40,212,112
Ma 40,216,124
Ma 40,220,136
Ma 44,208,104
TR 208,248,160
Ma 44,212,116
TR 210,248,8608
Ma 44,216,128
TR 212,248,672
Ma 44,220,140
TR 214,248,9120
LG 10
Ma 48,192,96
TR 216,248,17056
LG 9
Ma 48,196,108
TR 218,248,25504
LG 8
Ma 48,200,120
TR 220,248,17568
LG 7
Ma 48,204,132
DW 251,18,256
s_mov_b32 m0,64960
Ma 52,192,100
TR 222,248,26016
Ma 52,196,112
Ma 52,200,124
Ma 52,204,136
Ma 56,192,104
TR 192,248,192
Ma 56,196,116
TR 194,248,8640
Ma 56,200,128
TR 196,248,704
Ma 56,204,140
TR 198,248,9152
LG 10
Ma 60,208,96
TR 200,248,17088
LG 9
Ma 60,212,108
TR 202,248,25536
LG 8
Ma 60,216,120
DW 252,18,512
s_mov_b32 m0,65760
LG 6
Ma 60,220,132
TR 204,248,17600
Ma 64,208,100
TR 206,248,26048
Ma 64,212,112
Ma 64,216,124
Ma 64,220,136
Ma 68,208,104
TR 208,248,224
Ma 68,212,116
TR 210,248,8672
Ma 68,216,128
TR 212,248,736
Ma 68,220,140
TR 214,248,9184
LG 10
Ma 72,192,96
TR 216,248,17120
LG 9
Ma 72,196,108
DW 253,18,768
s_mov_b32 m0,80256
s_add_u32 s18,s10,2621696
s_addc_u32 s19,s11,0
LG 7
Ma 72,200,120
global_load_dword a253,v255,s[38:39]
LG 5
Ma 72,204,132
TR 218,248,25568
Ma 76,192,100
TR 220,248,17632
Ma 76,196,112
TR 222,248,26080
Ma 76,200,124
Ma 76,204,136
Ma 80,192,104
Ma 80,196,116
Ma 80,200,128
Ma 80,204,140
Ma 96,192,224
Ma 96,196,228
Ma 96,200,232
Ma 96,204,236
LG 6
Ma 84,208,96
LG 4
Ma 84,212,108
LG 2
Ma 84,216,120
LG 0
Ma 84,220,132
s_waitcnt vmcnt(18) lgkmcnt(0)
s_barrier
Ma 88,208,100
TR 192,248,33792
Ma 88,212,112
TR 194,248,42240
Ma 88,216,124
TR 196,248,34304
Ma 88,220,136
TR 198,248,42752
Ma 92,208,104
TR 200,248,50688
Ma 92,212,116
TR 202,248,59136
Ma 92,216,128
TR 204,248,51200
Ma 92,220,140
TR 206,248,59648
Ma 100,208,224
DW 250,16,0
s_mov_b32 m0,81056
Ma 100,212,228
RD 224,254,12288
Ma 100,216,232
RD 228,254,13312
Ma 100,220,236
RD 232,254,14336
LG 9
Ma 0,192,144
RD 236,254,15360
LG 8
Ma 0,196,156
TR 208,248,33824
LG 7
Ma 0,200,168
TR 210,248,42272
LG 6
Ma 0,204,180
TR 212,248,34336
Ma 4,192,148
TR 214,248,42784
Ma 4,196,160
TR 216,248,50720
Ma 4,200,172
TR 218,248,59168
s_nop 0
MU 0,s26
Ma 4,204,184
TR 220,248,51232
MU 1,s26
Ma 8,192,152
TR 222,248,59680
MU 2,s26
Ma 8,196,164
DW 251,16,256
s_mov_b32 m0,81856
Ma 8,200,176
TR 192,248,33856
MU 3,s26
Ma 8,204,188
TR 194,248,42304
CV 0,0,1
LG 8
Ma 12,208,144
TR 196,248,34368
CV 1,2,3
LG 7
Ma 12,212,156
TR 198,248,42816
MU 4,s26
LG 6
Ma 12,216,168
TR 200,248,50752
MU 5,s26
LG 5
Ma 12,220,180
TR 202,248,59200
MU 6,s26
Ma 16,208,148
TR 204,248,51264
MU 7,s26
Ma 16,212,160
TR 206,248,59712
CV 4,4,5
Ma 16,216,172
DW 252,16,512
s_mov_b32 m0,82656
Ma 16,220,184
MU 12,s26
MU 13,s26
Ma 20,208,152
TR 208,248,33888
MU 14,s26
Ma 20,212,164
TR 210,248,42336
MU 15,s26
Ma 20,216,176
TR 212,248,34400
CV 2,12,13
Ma 20,220,188
TR 214,248,42848
CV 3,14,15
LG 10
Ma 24,192,144
TR 216,248,50784
v_permlane32_swap_b32 v0,v2
LG 9
Ma 24,196,156
TR 218,248,59232
v_permlane32_swap_b32 v1,v3
LG 8
Ma 24,200,168
TR 220,248,51296
v_permlane16_swap_b32 v0,v2
LG 7
Ma 24,204,180
TR 222,248,59744
v_permlane16_swap_b32 v1,v3
Ma 28,192,148
MU 16,s26
MU 17,s26
Ma 28,196,160
DW 253,16,768
s_mov_b32 m0,97152
s_add_u32 s16,s10,3145984
s_addc_u32 s17,s11,0
Ma 28,200,172
MU 18,s26
MU 19,s26
Ma 28,204,184
CV 5,6,7
CV 6,16,17
Ma 32,192,152
TR 192,248,33920
CV 7,18,19
Ma 32,196,164
TR 194,248,42368
v_permlane32_swap_b32 v4,v6
Ma 32,200,176
TR 196,248,34432
v_permlane32_swap_b32 v5,v7
Ma 32,204,188
TR 198,248,42880
v_permlane16_swap_b32 v4,v6
LG 10
Ma 36,208,144
TR 200,248,50816
v_permlane16_swap_b32 v5,v7
LG 9
Ma 36,212,156
TR 202,248,59264
MU 8,s26
LG 8
Ma 36,216,168
TR 204,248,51328
MU 9,s26
LG 7
Ma 36,220,180
TR 206,248,59776
MU 10,s26
Ma 40,208,148
DW 250,18,0
s_mov_b32 m0,97952
Ma 40,212,160
MU 11,s26
MU 20,s26
Ma 40,216,172
MU 21,s26
MU 22,s26
Ma 40,220,184
MU 23,s26
CV 8,8,9
Ma 44,208,152
TR 208,248,33952
CV 9,10,11
Ma 44,212,164
TR 210,248,42400
CV 10,20,21
Ma 44,216,176
TR 212,248,34464
CV 11,22,23
Ma 44,220,188
TR 214,248,42912
v_permlane32_swap_b32 v8,v10
LG 10
Ma 48,192,144
TR 216,248,50848
v_permlane32_swap_b32 v9,v11
LG 9
Ma 48,196,156
TR 218,248,59296
v_permlane16_swap_b32 v8,v10
LG 8
Ma 48,200,168
TR 220,248,51360
v_permlane16_swap_b32 v9,v11
LG 7
Ma 48,204,180
DW 251,18,256
s_mov_b32 m0,98752
Ma 52,192,148
TR 222,248,59808
MU 24,s26
Ma 52,196,160
MU 25,s26
MU 26,s26
Ma 52,200,172
MU 27,s26
MU 36,s26
Ma 52,204,184
MU 37,s26
MU 38,s26
Ma 56,192,152
TR 192,248,33984
MU 39,s26
Ma 56,196,164
TR 194,248,42432
CV 24,24,25
Ma 56,200,176
TR 196,248,34496
CV 25,26,27
Ma 56,204,188
TR 198,248,42944
CV 26,36,37
LG 10
Ma 60,208,144
TR 200,248,50880
CV 27,38,39
LG 9
Ma 60,212,156
TR 202,248,59328
v_permlane32_swap_b32 v24,v26
LG 8
Ma 60,216,168
DW 252,18,512
s_mov_b32 m0,99552
LG 6
Ma 60,220,180
TR 204,248,51392
v_permlane32_swap_b32 v25,v27
Ma 64,208,148
TR 206,248,59840
v_permlane16_swap_b32 v24,v26
Ma 64,212,160
v_permlane16_swap_b32 v25,v27
MU 28,s26
Ma 64,216,172
MU 29,s26
MU 30,s26
Ma 64,220,184
MU 31,s26
MU 40,s26
Ma 68,208,152
TR 208,248,34016
MU 41,s26
Ma 68,212,164
TR 210,248,42464
MU 42,s26
Ma 68,216,176
TR 212,248,34528
MU 43,s26
Ma 68,220,188
TR 214,248,42976
CV 28,28,29
LG 10
Ma 72,192,144
TR 216,248,50912
CV 29,30,31
LG 9
Ma 72,196,156
DW 253,18,768
s_add_u32 s18,s10,3670272
s_addc_u32 s19,s11,0
LG 7
Ma 72,200,168
TR 218,248,59360
CV 30,40,41
LG 6
Ma 72,204,180
TR 220,248,51424
CV 31,42,43
Ma 76,192,148
TR 222,248,59872
v_add_u32 v248,4294899712,v248
Ma 76,196,160
v_permlane32_swap_b32 v28,v30
v_permlane32_swap_b32 v29,v31
Ma 76,200,172
v_permlane16_swap_b32 v28,v30
v_permlane16_swap_b32 v29,v31
Ma 76,204,184
MU 32,s26
MU 33,s26
Ma 80,192,152
MU 34,s26
MU 35,s26
Ma 80,196,164
MU 44,s26
MU 45,s26
Ma 80,200,176
MU 46,s26
MU 47,s26
Ma 80,204,188
CV 32,32,33
CV 33,34,35
Ma 96,192,224
CV 34,44,45
CV 35,46,47
Ma 96,196,228
v_permlane32_swap_b32 v32,v34
v_permlane32_swap_b32 v33,v35
Ma 96,200,232
v_permlane16_swap_b32 v32,v34
v_permlane16_swap_b32 v33,v35
Ma 96,204,236
LG 6
Ma 84,208,144
LG 4
Ma 84,212,156
LG 2
Ma 84,216,168
LG 0
Ma 84,220,180
s_waitcnt vmcnt(18) lgkmcnt(0)
s_barrier
Ma 88,208,148
TR 192,248,0
Ma 88,212,160
TR 194,248,8448
Ma 88,216,172
TR 196,248,512
Ma 88,220,184
TR 198,248,8960
Ma 92,208,152
TR 200,248,16896
Ma 92,212,164
TR 202,248,25344
Ma 92,216,176
TR 204,248,17408
TR 206,248,25856
Ma 92,220,188
Ma 100,208,224
Ma 100,212,228
Ma 100,216,232
Ma 100,220,236
v_pk_mul_f32 v[48:49],v[48:49],s[26:27] op_sel_hi:[1,0]
v_pk_mul_f32 v[50:51],v[50:51],s[26:27] op_sel_hi:[1,0]
v_pk_mul_f32 v[60:61],v[60:61],s[26:27] op_sel_hi:[1,0]
v_pk_mul_f32 v[62:63],v[62:63],s[26:27] op_sel_hi:[1,0]
CV 48,48,49
CV 49,50,51
CV 50,60,61
CV 51,62,63
s_nop 0
v_permlane32_swap_b32 v48,v50
v_permlane32_swap_b32 v49,v51
s_nop 0
v_permlane16_swap_b32 v48,v50
v_permlane16_swap_b32 v49,v51
v_pk_mul_f32 v[52:53],v[52:53],s[26:27] op_sel_hi:[1,0]
v_pk_mul_f32 v[54:55],v[54:55],s[26:27] op_sel_hi:[1,0]
v_pk_mul_f32 v[64:65],v[64:65],s[26:27] op_sel_hi:[1,0]
v_pk_mul_f32 v[66:67],v[66:67],s[26:27] op_sel_hi:[1,0]
CV 52,52,53
CV 53,54,55
CV 54,64,65
CV 55,66,67
s_nop 0
v_permlane32_swap_b32 v52,v54
v_permlane32_swap_b32 v53,v55
s_nop 0
v_permlane16_swap_b32 v52,v54
v_permlane16_swap_b32 v53,v55
v_pk_mul_f32 v[56:57],v[56:57],s[26:27] op_sel_hi:[1,0]
v_pk_mul_f32 v[58:59],v[58:59],s[26:27] op_sel_hi:[1,0]
v_pk_mul_f32 v[68:69],v[68:69],s[26:27] op_sel_hi:[1,0]
v_pk_mul_f32 v[70:71],v[70:71],s[26:27] op_sel_hi:[1,0]
CV 56,56,57
CV 57,58,59
CV 58,68,69
CV 59,70,71
s_nop 0
v_permlane32_swap_b32 v56,v58
v_permlane32_swap_b32 v57,v59
s_nop 0
v_permlane16_swap_b32 v56,v58
v_permlane16_swap_b32 v57,v59
v_pk_mul_f32 v[72:73],v[72:73],s[26:27] op_sel_hi:[1,0]
v_pk_mul_f32 v[74:75],v[74:75],s[26:27] op_sel_hi:[1,0]
v_pk_mul_f32 v[84:85],v[84:85],s[26:27] op_sel_hi:[1,0]
v_pk_mul_f32 v[86:87],v[86:87],s[26:27] op_sel_hi:[1,0]
CV 72,72,73
CV 73,74,75
CV 74,84,85
CV 75,86,87
s_nop 0
v_permlane32_swap_b32 v72,v74
v_permlane32_swap_b32 v73,v75
s_nop 0
v_permlane16_swap_b32 v72,v74
v_permlane16_swap_b32 v73,v75
v_pk_mul_f32 v[76:77],v[76:77],s[26:27] op_sel_hi:[1,0]
v_pk_mul_f32 v[78:79],v[78:79],s[26:27] op_sel_hi:[1,0]
v_pk_mul_f32 v[88:89],v[88:89],s[26:27] op_sel_hi:[1,0]
v_pk_mul_f32 v[90:91],v[90:91],s[26:27] op_sel_hi:[1,0]
CV 76,76,77
CV 77,78,79
CV 78,88,89
CV 79,90,91
s_nop 0
v_permlane32_swap_b32 v76,v78
v_permlane32_swap_b32 v77,v79
s_nop 0
v_permlane16_swap_b32 v76,v78
v_permlane16_swap_b32 v77,v79
v_pk_mul_f32 v[80:81],v[80:81],s[26:27] op_sel_hi:[1,0]
v_pk_mul_f32 v[82:83],v[82:83],s[26:27] op_sel_hi:[1,0]
v_pk_mul_f32 v[92:93],v[92:93],s[26:27] op_sel_hi:[1,0]
v_pk_mul_f32 v[94:95],v[94:95],s[26:27] op_sel_hi:[1,0]
CV 80,80,81
CV 81,82,83
CV 82,92,93
CV 83,94,95
s_nop 0
v_permlane32_swap_b32 v80,v82
v_permlane32_swap_b32 v81,v83
s_nop 0
v_permlane16_swap_b32 v80,v82
v_permlane16_swap_b32 v81,v83
v_pk_mul_f32 v[96:97],v[96:97],s[26:27] op_sel_hi:[1,0]
v_pk_mul_f32 v[98:99],v[98:99],s[26:27] op_sel_hi:[1,0]
v_pk_mul_f32 v[100:101],v[100:101],s[26:27] op_sel_hi:[1,0]
v_pk_mul_f32 v[102:103],v[102:103],s[26:27] op_sel_hi:[1,0]
CV 96,96,97
CV 97,98,99
CV 98,100,101
CV 99,102,103
s_nop 0
v_permlane32_swap_b32 v96,v98
v_permlane32_swap_b32 v97,v99
s_nop 0
v_permlane16_swap_b32 v96,v98
v_permlane16_swap_b32 v97,v99
s_cmp_eq_u32 s20,1
s_cbranch_scc0 EA2_w3
ds_write_b128 v249,v[96:99] offset:23552
v_mov_b32 v152,v0
v_mov_b32 v153,v1
v_mov_b32 v154,v2
v_mov_b32 v155,v3
v_mov_b32 v156,v4
v_mov_b32 v157,v5
v_mov_b32 v158,v6
v_mov_b32 v159,v7
v_mov_b32 v160,v8
v_mov_b32 v161,v9
v_mov_b32 v162,v10
v_mov_b32 v163,v11
v_mov_b32 v164,v24
v_mov_b32 v165,v25
v_mov_b32 v166,v26
v_mov_b32 v167,v27
v_mov_b32 v168,v28
v_mov_b32 v169,v29
v_mov_b32 v170,v30
v_mov_b32 v171,v31
v_mov_b32 v172,v32
v_mov_b32 v173,v33
v_mov_b32 v174,v34
v_mov_b32 v175,v35
v_mov_b32 v176,v48
v_mov_b32 v177,v49
v_mov_b32 v178,v50
v_mov_b32 v179,v51
v_mov_b32 v180,v52
v_mov_b32 v181,v53
v_mov_b32 v182,v54
v_mov_b32 v183,v55
v_mov_b32 v184,v56
v_mov_b32 v185,v57
v_mov_b32 v186,v58
v_mov_b32 v187,v59
v_mov_b32 v188,v72
v_mov_b32 v189,v73
v_mov_b32 v190,v74
v_mov_b32 v191,v75
v_mov_b32 v192,v76
v_mov_b32 v193,v77
v_mov_b32 v194,v78
v_mov_b32 v195,v79
v_mov_b32 v196,v80
v_mov_b32 v197,v81
v_mov_b32 v198,v82
v_mov_b32 v199,v83
s_add_u32 s10,s10,256
s_addc_u32 s11,s11,0
s_add_u32 s20,s20,1
s_branch LA_w3
EA2_w3:
ds_write_b128 v249,v[96:99] offset:27648
v_mov_b32 v200,v0
v_mov_b32 v201,v1
v_mov_b32 v202,v2
v_mov_b32 v203,v3
v_mov_b32 v204,v4
v_mov_b32 v205,v5
v_mov_b32 v206,v6
v_mov_b32 v207,v7
v_mov_b32 v208,v8
v_mov_b32 v209,v9
v_mov_b32 v210,v10
v_mov_b32 v211,v11
v_mov_b32 v212,v24
v_mov_b32 v213,v25
v_mov_b32 v214,v26
v_mov_b32 v215,v27
v_mov_b32 v216,v28
v_mov_b32 v217,v29
v_mov_b32 v218,v30
v_mov_b32 v219,v31
v_mov_b32 v220,v32
v_mov_b32 v221,v33
v_mov_b32 v222,v34
v_mov_b32 v223,v35
v_mov_b32 v224,v48
v_mov_b32 v225,v49
v_mov_b32 v226,v50
v_mov_b32 v227,v51
v_mov_b32 v228,v52
v_mov_b32 v229,v53
v_mov_b32 v230,v54
v_mov_b32 v231,v55
v_mov_b32 v232,v56
v_mov_b32 v233,v57
v_mov_b32 v234,v58
v_mov_b32 v235,v59
v_mov_b32 v236,v72
v_mov_b32 v237,v73
v_mov_b32 v238,v74
v_mov_b32 v239,v75
v_mov_b32 v240,v76
v_mov_b32 v241,v77
v_mov_b32 v242,v78
v_mov_b32 v243,v79
v_mov_b32 v244,v80
v_mov_b32 v245,v81
v_mov_b32 v246,v82
v_mov_b32 v247,v83
s_add_u32 s10,s10,256
s_addc_u32 s11,s11,0
s_add_u32 s20,s20,1
LG 0
Za 0,192,0
RD 224,254,0
v_subrev_u32 v255,135168,v249
s_mov_b32 m0,114048
Ma 0,196,12
RD 228,254,1024
Ma 0,200,24
RD 232,254,2048
Ma 0,204,36
RD 236,254,3072
Za 4,192,4
TR 208,248,32
Ma 4,196,16
TR 210,248,8480
Ma 4,200,28
TR 212,248,544
Ma 4,204,40
TR 214,248,8992
Za 8,192,8
TR 216,248,16928
TR 218,248,25376
Ma 8,196,20
TR 220,248,17440
TR 222,248,25888
Ma 8,200,32
DW 250,16,0
s_mov_b32 m0,114848
Ma 8,204,44
TR 192,248,64
LG 7
Za 12,208,0
TR 194,248,8512
LG 6
Ma 12,212,12
TR 196,248,576
LG 5
Ma 12,216,24
TR 198,248,9024
LG 4
Ma 12,220,36
TR 200,248,16960
Za 16,208,4
TR 202,248,25408
Ma 16,212,16
TR 204,248,17472
Ma 16,216,28
TR 206,248,25920
Ma 16,220,40
DW 251,16,256
s_mov_b32 m0,115648
Za 20,208,8
TR 208,248,96
Ma 20,212,20
TR 210,248,8544
Ma 20,216,32
TR 212,248,608
Ma 20,220,44
TR 214,248,9056
LG 10
Za 24,192,0
TR 216,248,16992
LG 9
Ma 24,196,12
TR 218,248,25440
LG 8
Ma 24,200,24
TR 220,248,17504
LG 7
Ma 24,204,36
DW 252,16,512
s_mov_b32 m0,116448
Za 28,192,4
TR 222,248,25952
Ma 28,196,16
Ma 28,200,28
Ma 28,204,40
Za 32,192,8
TR 192,248,128
Ma 32,196,20
TR 194,248,8576
Ma 32,200,32
TR 196,248,640
Ma 32,204,44
TR 198,248,9088
LG 10
Za 36,208,0
TR 200,248,17024
LG 9
Ma 36,212,12
DW 253,16,768
s_mov_b32 m0,130944
s_add_u32 s16,s6,0
s_addc_u32 s17,s7,0
LG 7
Ma 36,216,24
TR 202,248,25472
LG 6
Ma 36,220,36
TR 204,248,17536
Za 40,208,4
TR 206,248,25984
Ma 40,212,16
Ma 40,216,28
Ma 40,220,40
Za 44,208,8
TR 208,248,160
Ma 44,212,20
TR 210,248,8608
Ma 44,216,32
TR 212,248,672
Ma 44,220,44
DW 250,18,0
s_mov_b32 m0,131744
LG 9
Za 48,192,0
TR 214,248,9120
v_and_b32 v250,0xf0,v255
LG 8
Ma 48,196,12
TR 216,248,17056
v_lshrrev_b32 v255,8,v255
LG 7
Ma 48,200,24
TR 218,248,25504
v_lshl_add_u32 v250,v255,12,v250
LG 6
Ma 48,204,36
TR 220,248,17568
Za 52,192,4
TR 222,248,26016
Ma 52,196,16
Ma 52,200,28
Ma 52,204,40
Za 56,192,8
TR 192,248,192
Ma 56,196,20
DW 251,18,256
s_mov_b32 m0,132544
Ma 56,200,32
TR 194,248,8640
v_mov_b32 v251,v250
Ma 56,204,44
TR 196,248,704
LG 9
Za 60,208,0
TR 198,248,9152
LG 8
Ma 60,212,12
TR 200,248,17088
LG 7
Ma 60,216,24
TR 202,248,25536
LG 6
Ma 60,220,36
TR 204,248,17600
Za 64,208,4
TR 206,248,26048
Ma 64,212,16
Ma 64,216,28
Ma 64,220,40
DW 252,18,512
s_mov_b32 m0,133344
Za 68,208,8
TR 208,248,224
v_mov_b32 v252,v250
Ma 68,212,20
TR 210,248,8672
Ma 68,216,32
TR 212,248,736
Ma 68,220,44
TR 214,248,9184
LG 10
Za 72,192,0
TR 216,248,17120
LG 9
Ma 72,196,12
TR 218,248,25568
LG 8
Ma 72,200,24
TR 220,248,17632
LG 7
Ma 72,204,36
TR 222,248,26080
Za 76,192,4
Ma 76,196,16
DW 253,18,768
s_mov_b32 m0,12672
s_add_u32 s18,s6,16384
s_addc_u32 s19,s7,0
Ma 76,200,28
v_mov_b32 v253,v250
Ma 76,204,40
Za 80,192,8
Ma 80,196,20
Ma 80,200,32
Ma 80,204,44
Za 96,192,224
Ma 96,196,228
Ma 96,200,232
Ma 96,204,236
LG 6
Za 84,208,0
AW 0,104
AW 1,105
LG 4
Ma 84,212,12
AW 2,106
AW 3,107
LG 2
Ma 84,216,24
AW 12,116
AW 13,117
LG 0
Ma 84,220,36
AW 14,118
AW 15,119
s_waitcnt vmcnt(17) lgkmcnt(0)
s_barrier
Za 88,208,4
TR 192,248,33792
AW 4,108
Ma 88,212,16
TR 194,248,42240
AW 5,109
Ma 88,216,28
TR 196,248,34304
AW 6,110
Ma 88,220,40
TR 198,248,42752
AW 7,111
Za 92,208,8
TR 200,248,50688
AW 8,112
Ma 92,212,20
TR 202,248,59136
AW 9,113
Ma 92,216,32
TR 204,248,51200
AW 10,114
Ma 92,220,44
TR 206,248,59648
AW 11,115
Za 100,208,224
DM 250,16,0
s_mov_b32 m0,13472
Ma 100,212,228
RD 224,254,4096
AW 16,120
Ma 100,216,232
RD 228,254,5120
AW 17,121
Ma 100,220,236
RD 232,254,6144
AW 18,122
LG 9
Ma 0,192,48
RD 236,254,7168
AW 19,123
LG 8
Ma 0,196,60
TR 208,248,33824
AW 20,124
LG 7
Ma 0,200,72
TR 210,248,42272
AW 21,125
LG 6
Ma 0,204,84
TR 212,248,34336
AW 22,126
Ma 4,192,52
TR 214,248,42784
AW 23,127
Ma 4,196,64
TR 216,248,50720
AW 24,128
Ma 4,200,76
TR 218,248,59168
AW 25,129
Ma 4,204,88
TR 220,248,51232
AW 26,130
Ma 8,192,56
TR 222,248,59680
AW 27,131
Ma 8,196,68
DM 251,16,256
s_mov_b32 m0,14272
Ma 8,200,80
TR 192,248,33856
AW 28,132
Ma 8,204,92
TR 194,248,42304
AW 29,133
LG 8
Ma 12,208,48
TR 196,248,34368
AW 30,134
LG 7
Ma 12,212,60
TR 198,248,42816
AW 31,135
LG 6
Ma 12,216,72
TR 200,248,50752
AW 32,136
LG 5
Ma 12,220,84
TR 202,248,59200
AW 33,137
Ma 16,208,52
TR 204,248,51264
AW 34,138
Ma 16,212,64
TR 206,248,59712
AW 35,139
Ma 16,216,76
DM 252,16,512
s_mov_b32 m0,15072
Ma 16,220,88
AW 36,140
AW 37,141
Ma 20,208,56
TR 208,248,33888
AW 38,142
Ma 20,212,68
TR 210,248,42336
AW 39,143
Ma 20,216,80
TR 212,248,34400
AW 40,144
Ma 20,220,92
TR 214,248,42848
AW 41,145
LG 10
Ma 24,192,48
TR 216,248,50784
AW 42,146
LG 9
Ma 24,196,60
TR 218,248,59232
AW 43,147
LG 8
Ma 24,200,72
TR 220,248,51296
AW 44,148
LG 7
Ma 24,204,84
TR 222,248,59744
AW 45,149
Ma 28,192,52
AW 46,150
AW 47,151
Ma 28,196,64
DM 253,16,768
s_mov_b32 m0,29568
s_add_u32 s16,s8,0
s_addc_u32 s17,s9,0
Ma 28,200,76
Ma 28,204,88
Ma 32,192,56
TR 192,248,33920
Ma 32,196,68
TR 194,248,42368
Ma 32,200,80
TR 196,248,34432
Ma 32,204,92
TR 198,248,42880
LG 10
Ma 36,208,48
TR 200,248,50816
LG 9
Ma 36,212,60
TR 202,248,59264
LG 8
Ma 36,216,72
TR 204,248,51328
LG 7
Ma 36,220,84
TR 206,248,59776
Ma 40,208,52
DM 250,18,0
s_mov_b32 m0,30368
Ma 40,212,64
Ma 40,216,76
Ma 40,220,88
Ma 44,208,56
TR 208,248,33952
Ma 44,212,68
TR 210,248,42400
Ma 44,216,80
TR 212,248,34464
Ma 44,220,92
TR 214,248,42912
LG 10
Ma 48,192,48
TR 216,248,50848
LG 9
Ma 48,196,60
TR 218,248,59296
LG 8
Ma 48,200,72
TR 220,248,51360
LG 7
Ma 48,204,84
DM 251,18,256
s_mov_b32 m0,31168
Ma 52,192,52
TR 222,248,59808
Ma 52,196,64
Ma 52,200,76
Ma 52,204,88
Ma 56,192,56
TR 192,248,33984
Ma 56,196,68
TR 194,248,42432
Ma 56,200,80
TR 196,248,34496
Ma 56,204,92
TR 198,248,42944
LG 10
Ma 60,208,48
TR 200,248,50880
LG 9
Ma 60,212,60
TR 202,248,59328
LG 8
Ma 60,216,72
DM 252,18,512
s_mov_b32 m0,31968
LG 6
Ma 60,220,84
TR 204,248,51392
Ma 64,208,52
TR 206,248,59840
Ma 64,212,64
Ma 64,216,76
Ma 64,220,88
Ma 68,208,56
TR 208,248,34016
Ma 68,212,68
TR 210,248,42464
Ma 68,216,80
TR 212,248,34528
Ma 68,220,92
TR 214,248,42976
LG 10
Ma 72,192,48
TR 216,248,50912
LG 9
Ma 72,196,60
DM 253,18,768
s_mov_b32 m0,46464
s_add_u32 s18,s6,32768
s_addc_u32 s19,s7,0
LG 7
Ma 72,200,72
TR 218,248,59360
LG 6
Ma 72,204,84
TR 220,248,51424
Ma 76,192,52
TR 222,248,59872
v_add_u32 v248,67584,v248
Ma 76,196,64
Ma 76,200,76
Ma 76,204,88
Ma 80,192,56
Ma 80,196,68
Ma 80,200,80
Ma 80,204,92
Ma 96,192,224
Ma 96,196,228
Ma 96,200,232
Ma 96,204,236
LG 6
Ma 84,208,48
AW 48,152
AW 49,153
LG 4
Ma 84,212,60
AW 50,154
AW 51,155
LG 2
Ma 84,216,72
AW 60,164
AW 61,165
LG 0
Ma 84,220,84
AW 62,166
AW 63,167
s_waitcnt vmcnt(16) lgkmcnt(0)
s_barrier
Ma 88,208,52
TR 192,248,0
AW 52,156
Ma 88,212,64
TR 194,248,8448
AW 53,157
Ma 88,216,76
TR 196,248,512
AW 54,158
Ma 88,220,88
TR 198,248,8960
AW 55,159
Ma 92,208,56
TR 200,248,16896
AW 56,160
Ma 92,212,68
TR 202,248,25344
AW 57,161
Ma 92,216,80
TR 204,248,17408
AW 58,162
Ma 92,220,92
TR 206,248,25856
AW 59,163
Ma 100,208,224
DM 250,16,0
s_mov_b32 m0,47264
Ma 100,212,228
RD 224,254,8192
AW 64,168
Ma 100,216,232
RD 228,254,9216
AW 65,169
Ma 100,220,236
RD 232,254,10240
AW 66,170
LG 9
Ma 0,192,96
RD 236,254,11264
AW 67,171
LG 8
Ma 0,196,108
TR 208,248,32
AW 68,172
LG 7
Ma 0,200,120
TR 210,248,8480
AW 69,173
LG 6
Ma 0,204,132
TR 212,248,544
AW 70,174
Ma 4,192,100
TR 214,248,8992
AW 71,175
Ma 4,196,112
TR 216,248,16928
AW 72,176
Ma 4,200,124
TR 218,248,25376
AW 73,177
Ma 4,204,136
TR 220,248,17440
AW 74,178
Ma 8,192,104
TR 222,248,25888
AW 75,179
Ma 8,196,116
DM 251,16,256
s_mov_b32 m0,48064
Ma 8,200,128
TR 192,248,64
AW 76,180
Ma 8,204,140
TR 194,248,8512
AW 77,181
LG 8
Ma 12,208,96
TR 196,248,576
AW 78,182
LG 7
Ma 12,212,108
TR 198,248,9024
AW 79,183
LG 6
Ma 12,216,120
TR 200,248,16960
AW 80,184
LG 5
Ma 12,220,132
TR 202,248,25408
AW 81,185
Ma 16,208,100
TR 204,248,17472
AW 82,186
Ma 16,212,112
TR 206,248,25920
AW 83,187
Ma 16,216,124
DM 252,16,512
s_mov_b32 m0,48864
Ma 16,220,136
AW 84,188
AW 85,189
Ma 20,208,104
TR 208,248,96
AW 86,190
Ma 20,212,116
TR 210,248,8544
AW 87,191
Ma 20,216,128
TR 212,248,608
AW 88,192
Ma 20,220,140
TR 214,248,9056
AW 89,193
LG 10
Ma 24,192,96
TR 216,248,16992
AW 90,194
LG 9
Ma 24,196,108
TR 218,248,25440
AW 91,195
LG 8
Ma 24,200,120
TR 220,248,17504
AW 92,196
LG 7
Ma 24,204,132
TR 222,248,25952
AW 93,197
Ma 28,192,100
AW 94,198
AW 95,199
Ma 28,196,112
DM 253,16,768
s_mov_b32 m0,63360
s_add_u32 s16,s8,16384
s_addc_u32 s17,s9,0
Ma 28,200,124
Ma 28,204,136
Ma 32,192,104
TR 192,248,128
Ma 32,196,116
TR 194,248,8576
Ma 32,200,128
TR 196,248,640
Ma 32,204,140
TR 198,248,9088
LG 10
Ma 36,208,96
TR 200,248,17024
LG 9
Ma 36,212,108
TR 202,248,25472
LG 8
Ma 36,216,120
TR 204,248,17536
LG 7
Ma 36,220,132
TR 206,248,25984
Ma 40,208,100
DM 250,18,0
s_mov_b32 m0,64160
Ma 40,212,112
Ma 40,216,124
Ma 40,220,136
Ma 44,208,104
TR 208,248,160
Ma 44,212,116
TR 210,248,8608
Ma 44,216,128
TR 212,248,672
Ma 44,220,140
TR 214,248,9120
LG 10
Ma 48,192,96
TR 216,248,17056
LG 9
Ma 48,196,108
TR 218,248,25504
LG 8
Ma 48,200,120
TR 220,248,17568
LG 7
Ma 48,204,132
DM 251,18,256
s_mov_b32 m0,64960
Ma 52,192,100
TR 222,248,26016
Ma 52,196,112
Ma 52,200,124
Ma 52,204,136
Ma 56,192,104
TR 192,248,192
Ma 56,196,116
TR 194,248,8640
Ma 56,200,128
TR 196,248,704
Ma 56,204,140
TR 198,248,9152
LG 10
Ma 60,208,96
TR 200,248,17088
LG 9
Ma 60,212,108
TR 202,248,25536
LG 8
Ma 60,216,120
DM 252,18,512
s_mov_b32 m0,65760
LG 6
Ma 60,220,132
TR 204,248,17600
Ma 64,208,100
TR 206,248,26048
Ma 64,212,112
Ma 64,216,124
Ma 64,220,136
Ma 68,208,104
TR 208,248,224
Ma 68,212,116
TR 210,248,8672
Ma 68,216,128
TR 212,248,736
Ma 68,220,140
TR 214,248,9184
LG 10
Ma 72,192,96
TR 216,248,17120
LG 9
Ma 72,196,108
DM 253,18,768
s_mov_b32 m0,80256
s_add_u32 s18,s6,49152
s_addc_u32 s19,s7,0
LG 7
Ma 72,200,120
TR 218,248,25568
LG 6
Ma 72,204,132
TR 220,248,17632
Ma 76,192,100
TR 222,248,26080
Ma 76,196,112
Ma 76,200,124
Ma 76,204,136
Ma 80,192,104
Ma 80,196,116
Ma 80,200,128
Ma 80,204,140
Ma 96,192,224
Ma 96,196,228
Ma 96,200,232
Ma 96,204,236
LG 6
Ma 84,208,96
AW 96,200
AW 97,201
LG 4
Ma 84,212,108
AW 98,202
AW 99,203
LG 2
Ma 84,216,120
AW 108,212
AW 109,213
LG 0
Ma 84,220,132
AW 110,214
AW 111,215
s_waitcnt vmcnt(16) lgkmcnt(0)
s_barrier
Ma 88,208,100
TR 192,248,33792
AW 100,204
Ma 88,212,112
TR 194,248,42240
AW 101,205
Ma 88,216,124
TR 196,248,34304
AW 102,206
Ma 88,220,136
TR 198,248,42752
AW 103,207
Ma 92,208,104
TR 200,248,50688
AW 104,208
Ma 92,212,116
TR 202,248,59136
AW 105,209
Ma 92,216,128
TR 204,248,51200
AW 106,210
Ma 92,220,140
TR 206,248,59648
AW 107,211
Ma 100,208,224
DM 250,16,0
s_mov_b32 m0,81056
Ma 100,212,228
RD 224,254,12288
AW 112,216
Ma 100,216,232
RD 228,254,13312
AW 113,217
Ma 100,220,236
RD 232,254,14336
AW 114,218
LG 9
Ma 0,192,144
RD 236,254,15360
AW 115,219
LG 8
Ma 0,196,156
TR 208,248,33824
AW 116,220
LG 7
Ma 0,200,168
TR 210,248,42272
AW 117,221
LG 6
Ma 0,204,180
TR 212,248,34336
AW 118,222
Ma 4,192,148
TR 214,248,42784
AW 119,223
Ma 4,196,160
TR 216,248,50720
AW 120,224
Ma 4,200,172
TR 218,248,59168
AW 121,225
Ma 4,204,184
TR 220,248,51232
AW 122,226
Ma 8,192,152
TR 222,248,59680
AW 123,227
Ma 8,196,164
DM 251,16,256
s_mov_b32 m0,81856
Ma 8,200,176
TR 192,248,33856
AW 124,228
Ma 8,204,188
TR 194,248,42304
AW 125,229
LG 8
Ma 12,208,144
TR 196,248,34368
AW 126,230
LG 7
Ma 12,212,156
TR 198,248,42816
AW 127,231
LG 6
Ma 12,216,168
TR 200,248,50752
AW 128,232
LG 5
Ma 12,220,180
TR 202,248,59200
AW 129,233
Ma 16,208,148
TR 204,248,51264
AW 130,234
Ma 16,212,160
TR 206,248,59712
AW 131,235
Ma 16,216,172
DM 252,16,512
s_mov_b32 m0,82656
Ma 16,220,184
AW 132,236
AW 133,237
Ma 20,208,152
TR 208,248,33888
AW 134,238
Ma 20,212,164
TR 210,248,42336
AW 135,239
Ma 20,216,176
TR 212,248,34400
AW 136,240
Ma 20,220,188
TR 214,248,42848
AW 137,241
LG 10
Ma 24,192,144
TR 216,248,50784
AW 138,242
LG 9
Ma 24,196,156
TR 218,248,59232
AW 139,243
LG 8
Ma 24,200,168
TR 220,248,51296
AW 140,244
LG 7
Ma 24,204,180
TR 222,248,59744
AW 141,245
Ma 28,192,148
AW 142,246
AW 143,247
Ma 28,196,160
DM 253,16,768
s_mov_b32 m0,97152
s_add_u32 s16,s8,32768
s_addc_u32 s17,s9,0
Ma 28,200,172
MU 0,s26
MU 1,s26
Ma 28,204,184
MU 2,s26
MU 3,s26
Ma 32,192,152
TR 192,248,33920
MU 12,s26
Ma 32,196,164
TR 194,248,42368
MU 13,s26
Ma 32,200,176
TR 196,248,34432
MU 14,s26
Ma 32,204,188
TR 198,248,42880
MU 15,s26
LG 10
Ma 36,208,144
TR 200,248,50816
CV 0,0,1
LG 9
Ma 36,212,156
TR 202,248,59264
CV 1,2,3
LG 8
Ma 36,216,168
TR 204,248,51328
CV 2,12,13
LG 7
Ma 36,220,180
TR 206,248,59776
CV 3,14,15
Ma 40,208,148
DM 250,18,0
s_mov_b32 m0,97952
Ma 40,212,160
v_permlane32_swap_b32 v0,v2
v_permlane32_swap_b32 v1,v3
Ma 40,216,172
v_permlane16_swap_b32 v0,v2
v_permlane16_swap_b32 v1,v3
Ma 40,220,184
MU 4,s26
MU 5,s26
Ma 44,208,152
TR 208,248,33952
MU 6,s26
Ma 44,212,164
TR 210,248,42400
MU 7,s26
Ma 44,216,176
TR 212,248,34464
MU 16,s26
Ma 44,220,188
TR 214,248,42912
MU 17,s26
LG 10
Ma 48,192,144
TR 216,248,50848
MU 18,s26
LG 9
Ma 48,196,156
TR 218,248,59296
MU 19,s26
LG 8
Ma 48,200,168
TR 220,248,51360
CV 4,4,5
LG 7
Ma 48,204,180
DM 251,18,256
s_mov_b32 m0,98752
Ma 52,192,148
TR 222,248,59808
CV 5,6,7
Ma 52,196,160
CV 6,16,17
CV 7,18,19
Ma 52,200,172
v_permlane32_swap_b32 v4,v6
v_permlane32_swap_b32 v5,v7
Ma 52,204,184
v_permlane16_swap_b32 v4,v6
v_permlane16_swap_b32 v5,v7
Ma 56,192,152
TR 192,248,33984
MU 8,s26
Ma 56,196,164
TR 194,248,42432
MU 9,s26
Ma 56,200,176
TR 196,248,34496
MU 10,s26
Ma 56,204,188
TR 198,248,42944
MU 11,s26
LG 10
Ma 60,208,144
TR 200,248,50880
MU 20,s26
LG 9
Ma 60,212,156
TR 202,248,59328
MU 21,s26
LG 8
Ma 60,216,168
DM 252,18,512
s_mov_b32 m0,99552
LG 6
Ma 60,220,180
TR 204,248,51392
MU 22,s26
Ma 64,208,148
TR 206,248,59840
MU 23,s26
Ma 64,212,160
CV 8,8,9
CV 9,10,11
Ma 64,216,172
CV 10,20,21
CV 11,22,23
Ma 64,220,184
v_permlane32_swap_b32 v8,v10
v_permlane32_swap_b32 v9,v11
Ma 68,208,152
TR 208,248,34016
v_permlane16_swap_b32 v8,v10
Ma 68,212,164
TR 210,248,42464
v_permlane16_swap_b32 v9,v11
Ma 68,216,176
TR 212,248,34528
MU 24,s26
Ma 68,220,188
TR 214,248,42976
MU 25,s26
LG 10
Ma 72,192,144
TR 216,248,50912
MU 26,s26
LG 9
Ma 72,196,156
DM 253,18,768
LG 7
Ma 72,200,168
TR 218,248,59360
MU 27,s26
LG 6
Ma 72,204,180
TR 220,248,51424
MU 36,s26
Ma 76,192,148
TR 222,248,59872
v_add_u32 v248,4294899712,v248
Ma 76,196,160
MU 37,s26
MU 38,s26
Ma 76,200,172
MU 39,s26
CV 24,24,25
Ma 76,204,184
CV 25,26,27
CV 26,36,37
Ma 80,192,152
CV 27,38,39
v_permlane32_swap_b32 v24,v26
Ma 80,196,164
v_permlane32_swap_b32 v25,v27
v_permlane16_swap_b32 v24,v26
Ma 80,200,176
v_permlane16_swap_b32 v25,v27
MU 28,s26
Ma 80,204,188
MU 29,s26
MU 30,s26
Ma 96,192,224
MU 31,s26
MU 40,s26
Ma 96,196,228
MU 41,s26
MU 42,s26
Ma 96,200,232
MU 43,s26
CV 28,28,29
Ma 96,204,236
CV 29,30,31
CV 30,40,41
LG 6
Ma 84,208,144
CV 31,42,43
v_permlane32_swap_b32 v28,v30
LG 4
Ma 84,212,156
v_permlane32_swap_b32 v29,v31
v_permlane16_swap_b32 v28,v30
LG 2
Ma 84,216,168
v_permlane16_swap_b32 v29,v31
MU 32,s26
LG 0
Ma 84,220,180
MU 33,s26
MU 34,s26
s_waitcnt vmcnt(24) lgkmcnt(0)
s_barrier
Ma 88,208,148
TR 192,248,0
MU 35,s26
Ma 88,212,160
TR 194,248,8448
MU 44,s26
Ma 88,216,172
TR 196,248,512
MU 45,s26
Ma 88,220,184
TR 198,248,8960
MU 46,s26
Ma 92,208,152
TR 200,248,16896
MU 47,s26
Ma 92,212,164
TR 202,248,25344
CV 32,32,33
Ma 92,216,176
TR 204,248,17408
TR 206,248,25856
Ma 92,220,188
CV 33,34,35
CV 34,44,45
Ma 100,208,224
CV 35,46,47
v_permlane32_swap_b32 v32,v34
Ma 100,212,228
v_permlane32_swap_b32 v33,v35
v_permlane16_swap_b32 v32,v34
Ma 100,216,232
v_permlane16_swap_b32 v33,v35
AW 144,0
Ma 100,220,236
AW 145,1
AW 146,2
v_pk_mul_f32 v[48:49],v[48:49],s[26:27] op_sel_hi:[1,0]
v_pk_mul_f32 v[50:51],v[50:51],s[26:27] op_sel_hi:[1,0]
v_pk_mul_f32 v[60:61],v[60:61],s[26:27] op_sel_hi:[1,0]
v_pk_mul_f32 v[62:63],v[62:63],s[26:27] op_sel_hi:[1,0]
CV 48,48,49
CV 49,50,51
CV 50,60,61
CV 51,62,63
s_nop 0
v_permlane32_swap_b32 v48,v50
v_permlane32_swap_b32 v49,v51
s_nop 0
v_permlane16_swap_b32 v48,v50
v_permlane16_swap_b32 v49,v51
v_pk_mul_f32 v[52:53],v[52:53],s[26:27] op_sel_hi:[1,0]
v_pk_mul_f32 v[54:55],v[54:55],s[26:27] op_sel_hi:[1,0]
v_pk_mul_f32 v[64:65],v[64:65],s[26:27] op_sel_hi:[1,0]
v_pk_mul_f32 v[66:67],v[66:67],s[26:27] op_sel_hi:[1,0]
CV 52,52,53
CV 53,54,55
CV 54,64,65
CV 55,66,67
s_nop 0
v_permlane32_swap_b32 v52,v54
v_permlane32_swap_b32 v53,v55
s_nop 0
v_permlane16_swap_b32 v52,v54
v_permlane16_swap_b32 v53,v55
v_pk_mul_f32 v[56:57],v[56:57],s[26:27] op_sel_hi:[1,0]
v_pk_mul_f32 v[58:59],v[58:59],s[26:27] op_sel_hi:[1,0]
v_pk_mul_f32 v[68:69],v[68:69],s[26:27] op_sel_hi:[1,0]
v_pk_mul_f32 v[70:71],v[70:71],s[26:27] op_sel_hi:[1,0]
CV 56,56,57
CV 57,58,59
CV 58,68,69
CV 59,70,71
s_nop 0
v_permlane32_swap_b32 v56,v58
v_permlane32_swap_b32 v57,v59
s_nop 0
v_permlane16_swap_b32 v56,v58
v_permlane16_swap_b32 v57,v59
v_pk_mul_f32 v[72:73],v[72:73],s[26:27] op_sel_hi:[1,0]
v_pk_mul_f32 v[74:75],v[74:75],s[26:27] op_sel_hi:[1,0]
v_pk_mul_f32 v[84:85],v[84:85],s[26:27] op_sel_hi:[1,0]
v_pk_mul_f32 v[86:87],v[86:87],s[26:27] op_sel_hi:[1,0]
CV 72,72,73
CV 73,74,75
CV 74,84,85
CV 75,86,87
s_nop 0
v_permlane32_swap_b32 v72,v74
v_permlane32_swap_b32 v73,v75
s_nop 0
v_permlane16_swap_b32 v72,v74
v_permlane16_swap_b32 v73,v75
v_pk_mul_f32 v[76:77],v[76:77],s[26:27] op_sel_hi:[1,0]
v_pk_mul_f32 v[78:79],v[78:79],s[26:27] op_sel_hi:[1,0]
v_pk_mul_f32 v[88:89],v[88:89],s[26:27] op_sel_hi:[1,0]
v_pk_mul_f32 v[90:91],v[90:91],s[26:27] op_sel_hi:[1,0]
CV 76,76,77
CV 77,78,79
CV 78,88,89
CV 79,90,91
s_nop 0
v_permlane32_swap_b32 v76,v78
v_permlane32_swap_b32 v77,v79
s_nop 0
v_permlane16_swap_b32 v76,v78
v_permlane16_swap_b32 v77,v79
v_pk_mul_f32 v[80:81],v[80:81],s[26:27] op_sel_hi:[1,0]
v_pk_mul_f32 v[82:83],v[82:83],s[26:27] op_sel_hi:[1,0]
v_pk_mul_f32 v[92:93],v[92:93],s[26:27] op_sel_hi:[1,0]
v_pk_mul_f32 v[94:95],v[94:95],s[26:27] op_sel_hi:[1,0]
CV 80,80,81
CV 81,82,83
CV 82,92,93
CV 83,94,95
s_nop 0
v_permlane32_swap_b32 v80,v82
v_permlane32_swap_b32 v81,v83
s_nop 0
v_permlane16_swap_b32 v80,v82
v_permlane16_swap_b32 v81,v83
v_pk_mul_f32 v[96:97],v[96:97],s[26:27] op_sel_hi:[1,0]
v_pk_mul_f32 v[98:99],v[98:99],s[26:27] op_sel_hi:[1,0]
v_pk_mul_f32 v[100:101],v[100:101],s[26:27] op_sel_hi:[1,0]
v_pk_mul_f32 v[102:103],v[102:103],s[26:27] op_sel_hi:[1,0]
CV 96,96,97
CV 97,98,99
CV 98,100,101
CV 99,102,103
s_nop 0
v_permlane32_swap_b32 v96,v98
v_permlane32_swap_b32 v97,v99
s_nop 0
v_permlane16_swap_b32 v96,v98
v_permlane16_swap_b32 v97,v99
ds_write_b128 v249,v[96:99] offset:3072
AW 147,3
AW 148,4
AW 149,5
AW 150,6
AW 151,7
AW 152,8
AW 153,9
AW 154,10
AW 155,11
AW 156,24
AW 157,25
AW 158,26
AW 159,27
AW 160,28
AW 161,29
AW 162,30
AW 163,31
AW 164,32
AW 165,33
AW 166,34
AW 167,35
AW 168,48
AW 169,49
AW 170,50
AW 171,51
AW 172,52
AW 173,53
AW 174,54
AW 175,55
AW 176,56
AW 177,57
AW 178,58
AW 179,59
AW 180,72
AW 181,73
AW 182,74
AW 183,75
AW 184,76
AW 185,77
AW 186,78
AW 187,79
AW 188,80
AW 189,81
AW 190,82
AW 191,83
v_subrev_u32 v224,135168,v249
v_lshrrev_b32 v224,4,v224
v_and_b32 v225,15,v224
v_mul_u32_u24 v220,1056,v225
v_lshrrev_b32 v226,4,v224
v_lshl_add_u32 v220,v226,4,v220
v_lshrrev_b32 v225,2,v224
v_mul_u32_u24 v221,1056,v225
v_and_b32 v226,3,v224
v_lshl_add_u32 v221,v226,3,v221
v_lshrrev_b32 v225,4,v224
v_lshlrev_b32 v225,12,v225
v_and_b32 v226,15,v224
v_lshl_add_u32 v250,v226,4,v225
v_add_u32 v251,0,v250
v_add_u32 v252,0,v250
v_add_u32 v253,0,v250
v_mov_b32 v216,v250
v_mov_b32 v217,v250
v_mov_b32 v218,v250
v_mov_b32 v219,v250
s_mov_b32 s22,0
s_mov_b32 s23,16896
s_mov_b32 s24,33792
s_mov_b32 s25,118272
s_mov_b32 s21,0
s_mov_b32 s34,0
s_add_u32 s18,s8,32768
s_addc_u32 s19,s9,0
s_mov_b32 m0,114048
s_nop 0
DW 250,18,0
s_mov_b32 m0,114848
s_nop 0
DW 251,18,256
s_mov_b32 m0,115648
s_nop 0
DW 252,18,512
s_mov_b32 m0,116448
s_nop 0
DW 253,18,768
s_add_u32 s16,s6,65536
s_addc_u32 s17,s7,0
s_add_u32 s18,s8,49152
s_addc_u32 s19,s9,0
s_waitcnt vmcnt(24) lgkmcnt(0)
s_barrier
v_mov_b32 v254,v220
RD 208,254,0
RD 212,254,64
RD 216,254,128
RD 220,254,192
RD 192,254,256
RD 196,254,320
RD 200,254,384
RD 204,254,448
RD 224,249,16384
RD 228,249,17408
RD 232,249,18432
RD 236,249,19456
LB_w3:
LG 0
Za 136,208,0
v_add_u32 v248,s24,v221
s_mov_b32 s48,s22
s_mov_b32 s49,s25
Ma 136,212,12
Ma 136,216,24
Ma 136,220,36
Za 140,208,4
Ma 140,212,16
Ma 140,216,28
s_nop 4
v_max3_f32 v200,v136,v137,v138
v_max_f32 v200,v200,v139
Ma 140,220,40
v_mov_b32 v201,v200
s_nop 1
v_permlane16_swap_b32 v200,v201
Za 144,208,8
v_max_f32 v200,v200,v201
v_mov_b32 v201,v200
Ma 144,212,20
s_nop 0
v_permlane32_swap_b32 v200,v201
v_max_f32 v200,v200,v201
Ma 144,216,32
v_mul_f32 v200,-1.0,v200
v_mov_b32 v201,v200
Ma 144,220,44
v_mov_b32 v202,v200
v_mov_b32 v203,v200
Za 148,208,224
v_max3_f32 v204,v140,v141,v142
RD 208,254,512
Ma 148,212,228
v_max_f32 v204,v204,v143
RD 212,254,576
Ma 148,216,232
v_mov_b32 v205,v204
RD 216,254,640
Ma 148,220,236
v_permlane16_swap_b32 v204,v205
RD 220,254,704
Ca 120,192,0,200
v_max_f32 v204,v204,v205
v_mov_b32 v205,v204
Ma 120,196,12
s_nop 0
v_permlane32_swap_b32 v204,v205
v_max_f32 v204,v204,v205
Ma 120,200,24
v_mul_f32 v204,-1.0,v204
v_mov_b32 v205,v204
Ma 120,204,36
v_mov_b32 v206,v204
v_mov_b32 v207,v204
s_nop 1
Ca 124,192,4,204
v_max3_f32 v208,v144,v145,v146
v_max_f32 v208,v208,v147
Ma 124,196,16
v_mov_b32 v209,v208
s_nop 1
v_permlane16_swap_b32 v208,v209
Ma 124,200,28
v_max_f32 v208,v208,v209
v_mov_b32 v209,v208
Ma 124,204,40
s_nop 0
v_permlane32_swap_b32 v208,v209
v_max_f32 v208,v208,v209
v_mul_f32 v208,-1.0,v208
v_mov_b32 v209,v208
v_mov_b32 v210,v208
v_mov_b32 v211,v208
s_nop 1
Ca 128,192,8,208
v_add_f32 v136,v136,v200
v_add_f32 v137,v137,v200
Ma 128,196,20
v_add_f32 v138,v138,v200
v_add_f32 v139,v139,v200
Ma 128,200,32
EX 136
Ma 128,204,44
EX 137
EX 138
EX 139
CV 152,136,137
CV 153,138,139
LG 3
Ca 136,208,0,200
v_add_f32 v140,v140,v204
v_add_f32 v141,v141,v204
LG 2
Ma 136,212,12
v_add_f32 v142,v142,v204
v_add_f32 v143,v143,v204
LG 1
Ma 136,216,24
EX 140
LG 0
Ma 136,220,36
EX 141
EX 142
EX 143
CV 160,140,141
CV 161,142,143
Ca 140,208,4,204
RD 192,254,768
RD 196,254,832
Ma 140,212,16
RD 200,254,896
RD 204,254,960
Ma 140,216,28
v_add_f32 v144,v144,v208
v_add_f32 v145,v145,v208
Ma 140,220,40
v_add_f32 v146,v146,v208
v_add_f32 v147,v147,v208
EX 144
EX 145
EX 146
EX 147
CV 168,144,145
CV 169,146,147
Ca 144,208,8,208
EX 120
Ma 144,212,20
EX 121
Ma 144,216,32
EX 122
Ma 144,220,44
EX 123
CV 154,120,121
CV 155,122,123
LG 3
Ca 120,192,0,200
EX 124
LG 2
Ma 120,196,12
EX 125
LG 1
Ma 120,200,24
EX 126
LG 0
Ma 120,204,36
EX 127
CV 162,124,125
CV 163,126,127
Ca 124,192,4,204
EX 128
Ma 124,196,16
EX 129
Ma 124,200,28
EX 130
Ma 124,204,40
EX 131
CV 170,128,129
CV 171,130,131
Ca 128,192,8,208
v_add_u32 v254,s23,v220
v_max3_f32 v212,v148,v149,v150
Ma 128,196,20
v_max_f32 v212,v212,v151
v_mov_b32 v213,v212
Ma 128,200,32
s_nop 0
v_permlane16_swap_b32 v212,v213
v_max_f32 v212,v212,v213
Ma 128,204,44
v_mov_b32 v213,v212
s_nop 1
v_permlane32_swap_b32 v212,v213
v_max_f32 v212,v212,v213
v_mul_f32 v212,-1.0,v212
v_mov_b32 v213,v212
v_mov_b32 v214,v212
v_mov_b32 v215,v212
s_nop 1
Ca 132,192,224,212
EX 136
Ma 132,196,228
EX 137
Ma 132,200,232
EX 138
Ma 132,204,236
EX 139
s_nop 6
EX 132
EX 133
s_nop 0
CV 132,132,133
EX 134
EX 135
s_nop 0
CV 133,134,135
ds_write_b64 v249,v[132:133] offset:5128
s_waitcnt vmcnt(16) lgkmcnt(0)
s_barrier
s_cmp_ge_u32 s21,28
s_cbranch_scc1 ProK_w3
ProK_r_w3:
CV 156,136,137
CV 157,138,139
EX 140
EX 141
EX 142
EX 143
CV 164,140,141
CV 165,142,143
EX 144
EX 145
EX 146
EX 147
CV 172,144,145
CV 173,146,147
EX 120
EX 121
EX 122
EX 123
CV 158,120,121
CV 159,122,123
EX 124
EX 125
EX 126
EX 127
CV 166,124,125
CV 167,126,127
EX 128
EX 129
EX 130
EX 131
CV 174,128,129
CV 175,130,131
s_sub_u32 s22,50688,s22
s_sub_u32 s25,185856,s25
s_add_u32 s21,s21,1
RD 192,254,768
RD 196,254,832
RD 200,254,896
RD 204,254,960
LG 0
Ca 120,192,0,200
s_add_u32 m0,s48,12672
s_mov_b32 s48,s23
Ma 120,196,12
Ma 120,200,24
RD 244,249,4096
RD 248,249,5120
Ma 120,204,36
TR 208,248,0
TR 210,248,256
Ca 124,192,4,204
TR 212,248,512
TR 214,248,768
Ma 124,196,16
Ma 124,200,28
s_nop 0
EX 120
Ma 124,204,40
DM 250,16,0
s_add_u32 m0,m0,800
Ca 128,192,8,208
TR 216,248,32
TR 218,248,288
Ma 128,196,20
TR 220,248,544
TR 222,248,800
Ma 128,200,32
EX 121
Ma 128,204,44
EX 122
Ca 132,192,224,212
EX 123
Ma 132,196,228
CV 182,120,121
CV 183,122,123
Ma 132,200,232
RD 192,254,0
Ma 132,204,236
RD 196,254,64
LG 8
Zv 0,208,152
RD 200,254,128
LG 7
Mv 0,212,156
DM 251,16,256
s_add_u32 m0,m0,800
Zv 4,208,160
RD 204,254,192
Mv 4,212,164
EX 132
Zv 8,208,168
EX 133
Mv 8,212,172
EX 134
LG 6
Zv 12,216,152
EX 135
LG 4
Mv 12,220,156
CV 132,132,133
CV 133,134,135
Zv 16,216,160
ds_write_b64 v249,v[132:133] offset:7176
Mv 16,220,164
EX 124
Zv 20,216,168
TR 208,248,64
TR 210,248,320
Mv 20,220,172
DM 252,16,512
s_add_u32 m0,m0,800
LG 6
Ca 136,192,0,200
TR 212,248,576
TR 214,248,832
LG 7
Ma 136,196,12
EX 125
LG 6
Ma 136,200,24
EX 126
LG 5
Ma 136,204,36
EX 127
Ca 140,192,4,204
TR 216,248,96
CV 190,124,125
Ma 140,196,16
TR 218,248,352
CV 191,126,127
Ma 140,200,28
TR 220,248,608
TR 222,248,864
Ma 140,204,40
EX 128
Ca 144,192,8,208
EX 129
Ma 144,196,20
DM 253,16,768
s_add_u32 m0,s49,12672
s_add_u32 s16,s16,16384
s_addc_u32 s17,s17,0
Ma 144,200,32
RD 192,254,256
CV 198,128,129
s_mov_b32 s49,s24
Ma 144,204,44
RD 196,254,320
LG 8
Zv 24,208,152
RD 200,254,384
LG 7
Mv 24,212,156
RD 204,254,448
Zv 28,208,160
EX 130
Mv 28,212,164
EX 131
Zv 32,208,168
CV 199,130,131
Mv 32,212,172
EX 136
LG 6
Zv 36,216,152
EX 137
LG 4
Mv 36,220,156
DM 216,18,0
s_add_u32 m0,m0,800
Zv 40,216,160
EX 138
Mv 40,220,164
EX 139
Zv 44,216,168
TR 208,248,128
CV 176,136,137
Mv 44,220,172
TR 210,248,384
CV 177,138,139
LG 5
Ca 120,192,0,200
TR 212,248,640
TR 214,248,896
LG 6
Ma 120,196,12
EX 140
LG 5
Ma 120,200,24
EX 141
LG 4
Ma 120,204,36
EX 142
Ca 124,192,4,204
TR 216,248,160
CV 184,140,141
Ma 124,196,16
DM 217,18,256
s_add_u32 m0,m0,800
Ma 124,200,28
TR 218,248,416
TR 220,248,672
Ma 124,204,40
TR 222,248,928
Ca 128,192,8,208
EX 143
Ma 128,196,20
CV 185,142,143
Ma 128,200,32
RD 192,254,512
Ma 128,204,44
RD 196,254,576
LG 8
Zv 48,208,152
RD 200,254,640
LG 7
Mv 48,212,156
RD 204,254,704
v_add_u32 v254,s22,v220
Zv 52,208,160
EX 144
Mv 52,212,164
DM 218,18,512
s_add_u32 m0,m0,800
Zv 56,208,168
EX 145
Mv 56,212,172
EX 146
LG 6
Zv 60,216,152
EX 147
LG 4
Mv 60,220,156
CV 192,144,145
CV 193,146,147
Zv 64,216,160
EX 120
Mv 64,220,164
EX 121
Zv 68,216,168
TR 208,248,192
CV 178,120,121
Mv 68,220,172
TR 210,248,448
TR 212,248,704
LG 6
Ca 136,192,0,200
TR 214,248,960
LG 6
Ma 136,196,12
DM 219,18,768
s_add_u32 s18,s18,16384
s_addc_u32 s19,s19,0
LG 5
Ma 136,200,24
EX 122
LG 4
Ma 136,204,36
EX 123
Ca 140,192,4,204
CV 179,122,123
Ma 140,196,16
EX 124
Ma 140,200,28
TR 216,248,224
TR 218,248,480
Ma 140,204,40
TR 220,248,736
TR 222,248,992
Ca 144,192,8,208
EX 125
Ma 144,196,20
EX 126
Ma 144,200,32
EX 127
Ma 144,204,44
CV 186,124,125
CV 187,126,127
LG 6
Zv 72,208,152
EX 128
LG 4
Mv 72,212,156
EX 129
Zv 76,208,160
EX 130
Mv 76,212,164
EX 131
Zv 80,208,168
CV 194,128,129
CV 195,130,131
Mv 80,212,172
EX 136
Za 96,208,244
EX 137
Ma 96,212,248
EX 138
LG 2
Zv 84,216,152
EX 139
LG 0
Mv 84,220,156
CV 180,136,137
CV 181,138,139
s_waitcnt vmcnt(16) lgkmcnt(0)
s_barrier
s_cmp_ge_u32 s21,28
s_cbranch_scc1 It0K_w3
It0K_r_w3:
Zv 88,216,160
RD 192,254,768
v_add_u32 v248,s25,v221
s_sub_u32 s23,101376,s23
s_sub_u32 s24,135168,s24
Mv 88,220,164
RD 196,254,832
RD 200,254,896
s_add_u32 s21,s21,1
Zv 92,216,168
RD 204,254,960
Mv 92,220,172
EX 140
Za 100,216,244
EX 141
Ma 100,220,248
EX 142
Zv 104,240,152
EX 143
Mv 104,240,156
CV 188,140,141
CV 189,142,143
Zv 108,240,160
EX 144
Mv 108,240,164
EX 145
Zv 112,240,168
EX 146
Mv 112,240,172
EX 147
Za 116,240,244
CV 196,144,145
CV 197,146,147
Ma 116,240,248
s_mov_b32 s20,3
LI_w3:
LG 0
Ca 120,192,0,200
s_add_u32 m0,s48,12672
s_mov_b32 s48,s22
Ma 120,196,12
Ma 120,200,24
RD 244,249,6144
RD 248,249,7168
Ma 120,204,36
TR 208,248,0
TR 210,248,256
Ca 124,192,4,204
TR 212,248,512
TR 214,248,768
Ma 124,196,16
Ma 124,200,28
s_nop 0
EX 120
Ma 124,204,40
DM 250,16,0
s_add_u32 m0,m0,800
Ca 128,192,8,208
TR 216,248,32
TR 218,248,288
Ma 128,196,20
TR 220,248,544
TR 222,248,800
Ma 128,200,32
EX 121
Ma 128,204,44
EX 122
Ca 132,192,224,212
EX 123
Ma 132,196,228
CV 158,120,121
CV 159,122,123
Ma 132,200,232
RD 192,254,0
Ma 132,204,236
RD 196,254,64
LG 8
Mv 0,208,176
RD 200,254,128
LG 7
Mv 0,212,180
DM 251,16,256
s_add_u32 m0,m0,800
Mv 4,208,184
RD 204,254,192
Mv 4,212,188
EX 132
Mv 8,208,192
EX 133
Mv 8,212,196
EX 134
LG 6
Mv 12,216,176
EX 135
LG 4
Mv 12,220,180
CV 132,132,133
CV 133,134,135
Mv 16,216,184
ds_write_b64 v249,v[132:133] offset:5128
Mv 16,220,188
EX 124
Mv 20,216,192
TR 208,248,64
TR 210,248,320
Mv 20,220,196
DM 252,16,512
s_add_u32 m0,m0,800
LG 6
Ca 136,192,0,200
TR 212,248,576
TR 214,248,832
LG 7
Ma 136,196,12
EX 125
LG 6
Ma 136,200,24
EX 126
LG 5
Ma 136,204,36
EX 127
Ca 140,192,4,204
TR 216,248,96
CV 166,124,125
Ma 140,196,16
TR 218,248,352
CV 167,126,127
Ma 140,200,28
TR 220,248,608
TR 222,248,864
Ma 140,204,40
EX 128
Ca 144,192,8,208
EX 129
Ma 144,196,20
DM 253,16,768
s_add_u32 m0,s49,12672
s_add_u32 s16,s16,16384
s_addc_u32 s17,s17,0
Ma 144,200,32
RD 192,254,256
CV 174,128,129
s_mov_b32 s49,s25
Ma 144,204,44
RD 196,254,320
LG 8
Mv 24,208,176
RD 200,254,384
LG 7
Mv 24,212,180
RD 204,254,448
Mv 28,208,184
EX 130
Mv 28,212,188
EX 131
Mv 32,208,192
CV 175,130,131
Mv 32,212,196
EX 136
LG 6
Mv 36,216,176
EX 137
LG 4
Mv 36,220,180
DM 216,18,0
s_add_u32 m0,m0,800
Mv 40,216,184
EX 138
Mv 40,220,188
EX 139
Mv 44,216,192
TR 208,248,128
CV 152,136,137
Mv 44,220,196
TR 210,248,384
CV 153,138,139
LG 5
Ca 120,192,0,200
TR 212,248,640
TR 214,248,896
LG 6
Ma 120,196,12
EX 140
LG 5
Ma 120,200,24
EX 141
LG 4
Ma 120,204,36
EX 142
Ca 124,192,4,204
TR 216,248,160
CV 160,140,141
Ma 124,196,16
DM 217,18,256
s_add_u32 m0,m0,800
Ma 124,200,28
TR 218,248,416
TR 220,248,672
Ma 124,204,40
TR 222,248,928
Ca 128,192,8,208
EX 143
Ma 128,196,20
CV 161,142,143
Ma 128,200,32
RD 192,254,512
Ma 128,204,44
RD 196,254,576
LG 8
Mv 48,208,176
RD 200,254,640
LG 7
Mv 48,212,180
RD 204,254,704
v_add_u32 v254,s23,v220
Mv 52,208,184
EX 144
Mv 52,212,188
DM 218,18,512
s_add_u32 m0,m0,800
Mv 56,208,192
EX 145
Mv 56,212,196
EX 146
LG 6
Mv 60,216,176
EX 147
LG 4
Mv 60,220,180
CV 168,144,145
CV 169,146,147
Mv 64,216,184
EX 120
Mv 64,220,188
EX 121
Mv 68,216,192
TR 208,248,192
CV 154,120,121
Mv 68,220,196
TR 210,248,448
TR 212,248,704
LG 6
Ca 136,192,0,200
TR 214,248,960
LG 6
Ma 136,196,12
DM 219,18,768
s_add_u32 s18,s18,16384
s_addc_u32 s19,s19,0
LG 5
Ma 136,200,24
EX 122
LG 4
Ma 136,204,36
EX 123
Ca 140,192,4,204
CV 155,122,123
Ma 140,196,16
EX 124
Ma 140,200,28
TR 216,248,224
TR 218,248,480
Ma 140,204,40
TR 220,248,736
TR 222,248,992
Ca 144,192,8,208
EX 125
Ma 144,196,20
EX 126
Ma 144,200,32
EX 127
Ma 144,204,44
CV 162,124,125
CV 163,126,127
LG 6
Mv 72,208,176
EX 128
LG 4
Mv 72,212,180
EX 129
Mv 76,208,184
EX 130
Mv 76,212,188
EX 131
Mv 80,208,192
CV 170,128,129
CV 171,130,131
Mv 80,212,196
EX 136
Ma 96,208,244
EX 137
Ma 96,212,248
EX 138
LG 2
Mv 84,216,176
EX 139
LG 0
Mv 84,220,180
CV 156,136,137
CV 157,138,139
s_waitcnt vmcnt(16) lgkmcnt(0)
s_barrier
s_cmp_ge_u32 s21,28
s_cbranch_scc1 ItOK_w3
ItOK_r_w3:
Mv 88,216,184
RD 192,254,768
v_add_u32 v248,s24,v221
s_sub_u32 s22,50688,s22
s_sub_u32 s25,185856,s25
Mv 88,220,188
RD 196,254,832
RD 200,254,896
s_add_u32 s21,s21,1
Mv 92,216,192
RD 204,254,960
Mv 92,220,196
EX 140
Ma 100,216,244
EX 141
Ma 100,220,248
EX 142
Mv 104,240,176
EX 143
Mv 104,240,180
CV 164,140,141
CV 165,142,143
Mv 108,240,184
EX 144
Mv 108,240,188
EX 145
Mv 112,240,192
EX 146
Mv 112,240,196
EX 147
Ma 116,240,244
CV 172,144,145
CV 173,146,147
Ma 116,240,248
LG 0
Ca 120,192,0,200
s_add_u32 m0,s48,12672
s_mov_b32 s48,s23
Ma 120,196,12
Ma 120,200,24
RD 244,249,4096
RD 248,249,5120
Ma 120,204,36
TR 208,248,0
TR 210,248,256
Ca 124,192,4,204
TR 212,248,512
TR 214,248,768
Ma 124,196,16
Ma 124,200,28
s_nop 0
EX 120
Ma 124,204,40
DM 250,16,0
s_add_u32 m0,m0,800
Ca 128,192,8,208
TR 216,248,32
TR 218,248,288
Ma 128,196,20
TR 220,248,544
TR 222,248,800
Ma 128,200,32
EX 121
Ma 128,204,44
EX 122
Ca 132,192,224,212
EX 123
Ma 132,196,228
CV 182,120,121
CV 183,122,123
Ma 132,200,232
RD 192,254,0
Ma 132,204,236
RD 196,254,64
LG 8
Mv 0,208,152
RD 200,254,128
LG 7
Mv 0,212,156
DM 251,16,256
s_add_u32 m0,m0,800
Mv 4,208,160
RD 204,254,192
Mv 4,212,164
EX 132
Mv 8,208,168
EX 133
Mv 8,212,172
EX 134
LG 6
Mv 12,216,152
EX 135
LG 4
Mv 12,220,156
CV 132,132,133
CV 133,134,135
Mv 16,216,160
ds_write_b64 v249,v[132:133] offset:7176
Mv 16,220,164
EX 124
Mv 20,216,168
TR 208,248,64
TR 210,248,320
Mv 20,220,172
DM 252,16,512
s_add_u32 m0,m0,800
LG 6
Ca 136,192,0,200
TR 212,248,576
TR 214,248,832
LG 7
Ma 136,196,12
EX 125
LG 6
Ma 136,200,24
EX 126
LG 5
Ma 136,204,36
EX 127
Ca 140,192,4,204
TR 216,248,96
CV 190,124,125
Ma 140,196,16
TR 218,248,352
CV 191,126,127
Ma 140,200,28
TR 220,248,608
TR 222,248,864
Ma 140,204,40
EX 128
Ca 144,192,8,208
EX 129
Ma 144,196,20
DM 253,16,768
s_add_u32 m0,s49,12672
s_add_u32 s16,s16,16384
s_addc_u32 s17,s17,0
Ma 144,200,32
RD 192,254,256
CV 198,128,129
s_mov_b32 s49,s24
Ma 144,204,44
RD 196,254,320
LG 8
Mv 24,208,152
RD 200,254,384
LG 7
Mv 24,212,156
RD 204,254,448
Mv 28,208,160
EX 130
Mv 28,212,164
EX 131
Mv 32,208,168
CV 199,130,131
Mv 32,212,172
EX 136
LG 6
Mv 36,216,152
EX 137
LG 4
Mv 36,220,156
DM 216,18,0
s_add_u32 m0,m0,800
Mv 40,216,160
EX 138
Mv 40,220,164
EX 139
Mv 44,216,168
TR 208,248,128
CV 176,136,137
Mv 44,220,172
TR 210,248,384
CV 177,138,139
LG 5
Ca 120,192,0,200
TR 212,248,640
TR 214,248,896
LG 6
Ma 120,196,12
EX 140
LG 5
Ma 120,200,24
EX 141
LG 4
Ma 120,204,36
EX 142
Ca 124,192,4,204
TR 216,248,160
CV 184,140,141
Ma 124,196,16
DM 217,18,256
s_add_u32 m0,m0,800
Ma 124,200,28
TR 218,248,416
TR 220,248,672
Ma 124,204,40
TR 222,248,928
Ca 128,192,8,208
EX 143
Ma 128,196,20
CV 185,142,143
Ma 128,200,32
RD 192,254,512
Ma 128,204,44
RD 196,254,576
LG 8
Mv 48,208,152
RD 200,254,640
LG 7
Mv 48,212,156
RD 204,254,704
v_add_u32 v254,s22,v220
Mv 52,208,160
EX 144
Mv 52,212,164
DM 218,18,512
s_add_u32 m0,m0,800
Mv 56,208,168
EX 145
Mv 56,212,172
EX 146
LG 6
Mv 60,216,152
EX 147
LG 4
Mv 60,220,156
CV 192,144,145
CV 193,146,147
Mv 64,216,160
EX 120
Mv 64,220,164
EX 121
Mv 68,216,168
TR 208,248,192
CV 178,120,121
Mv 68,220,172
TR 210,248,448
TR 212,248,704
LG 6
Ca 136,192,0,200
TR 214,248,960
LG 6
Ma 136,196,12
DM 219,18,768
s_add_u32 s18,s18,16384
s_addc_u32 s19,s19,0
LG 5
Ma 136,200,24
EX 122
LG 4
Ma 136,204,36
EX 123
Ca 140,192,4,204
CV 179,122,123
Ma 140,196,16
EX 124
Ma 140,200,28
TR 216,248,224
TR 218,248,480
Ma 140,204,40
TR 220,248,736
TR 222,248,992
Ca 144,192,8,208
EX 125
Ma 144,196,20
EX 126
Ma 144,200,32
EX 127
Ma 144,204,44
CV 186,124,125
CV 187,126,127
LG 6
Mv 72,208,152
EX 128
LG 4
Mv 72,212,156
EX 129
Mv 76,208,160
EX 130
Mv 76,212,164
EX 131
Mv 80,208,168
CV 194,128,129
CV 195,130,131
Mv 80,212,172
EX 136
Ma 96,208,244
EX 137
Ma 96,212,248
EX 138
LG 2
Mv 84,216,152
EX 139
LG 0
Mv 84,220,156
CV 180,136,137
CV 181,138,139
s_waitcnt vmcnt(16) lgkmcnt(0)
s_barrier
s_cmp_ge_u32 s21,28
s_cbranch_scc1 ItEK_w3
ItEK_r_w3:
Mv 88,216,160
RD 192,254,768
v_add_u32 v248,s25,v221
s_sub_u32 s23,101376,s23
s_sub_u32 s24,135168,s24
Mv 88,220,164
RD 196,254,832
RD 200,254,896
s_add_u32 s21,s21,1
Mv 92,216,168
RD 204,254,960
Mv 92,220,172
EX 140
Ma 100,216,244
EX 141
Ma 100,220,248
EX 142
Mv 104,240,152
EX 143
Mv 104,240,156
CV 188,140,141
CV 189,142,143
Mv 108,240,160
EX 144
Mv 108,240,164
EX 145
Mv 112,240,168
EX 146
Mv 112,240,172
EX 147
Ma 116,240,244
CV 196,144,145
CV 197,146,147
Ma 116,240,248
s_sub_u32 s20,s20,1
s_cmp_lg_u32 s20,0
s_cbranch_scc1 LI_w3
LG 0
Mv 104,240,176
RD 244,249,6144
Mv 104,240,180
RD 248,249,7168
Mv 108,240,184
TR 208,248,0
TR 210,248,256
Mv 108,240,188
TR 212,248,512
TR 214,248,768
Mv 112,240,192
TR 216,248,32
TR 218,248,288
Mv 112,240,196
TR 220,248,544
TR 222,248,800
LG 9
Ma 116,240,244
LG 8
Ma 116,240,248
s_nop 7
v_cmp_nge_f32 vcc,s27,v104
v_cmp_nle_f32_e64 s[72:73],v108,s27
s_nop 1
s_or_b64 vcc,vcc,s[72:73]
v_cmp_nle_f32_e64 s[72:73],v112,s27
s_nop 1
s_or_b64 vcc,vcc,s[72:73]
v_cmp_nle_f32_e64 s[72:73],v116,s27
s_nop 1
s_or_b64 vcc,vcc,s[72:73]
s_cbranch_vccnz SLOW_w3
LG 6
Mv 0,208,176
v_rcp_f32 v224,v104
s_add_u32 m0,s48,12672
LG 4
Mv 0,212,180
v_rcp_f32 v226,v108
Mv 4,208,184
v_rcp_f32 v228,v112
Mv 4,212,188
v_rcp_f32 v230,v116
Mv 8,208,192
TR 192,248,64
TR 194,248,320
Mv 8,212,196
TR 196,248,576
TR 198,248,832
LG 6
Mv 12,216,176
DM 250,16,0
s_add_u32 m0,m0,800
LG 4
Mv 12,220,180
TR 200,248,96
MU 0,v224
Mv 16,216,184
TR 202,248,352
MU 1,v224
Mv 16,220,188
TR 204,248,608
MU 2,v224
Mv 20,216,192
TR 206,248,864
MU 3,v224
Mv 20,220,196
DM 251,16,256
s_add_u32 m0,m0,800
LG 6
Mv 24,192,176
TR 208,248,128
MU 12,v224
LG 5
Mv 24,196,180
TR 210,248,384
MU 13,v224
Mv 28,192,184
TR 212,248,640
MU 14,v224
Mv 28,196,188
TR 214,248,896
MU 15,v224
Mv 32,192,192
DM 252,16,512
s_add_u32 m0,m0,800
Mv 32,196,196
TR 216,248,160
CV 0,0,1
LG 7
Mv 36,200,176
TR 218,248,416
CV 1,2,3
LG 6
Mv 36,204,180
DM 253,16,768
s_add_u32 m0,s49,12672
s_add_u32 s16,s16,16384
s_addc_u32 s17,s17,0
Mv 40,200,184
TR 220,248,672
CV 2,12,13
Mv 40,204,188
TR 222,248,928
CV 3,14,15
Mv 44,200,192
TR 192,248,192
MU 4,v226
Mv 44,204,196
TR 194,248,448
MU 5,v226
LG 8
Mv 48,208,176
DM 216,18,0
s_add_u32 m0,m0,800
LG 6
Mv 48,212,180
TR 196,248,704
MU 6,v226
Mv 52,208,184
TR 198,248,960
MU 7,v226
Mv 52,212,188
MU 16,v226
MU 17,v226
Mv 56,208,192
MU 18,v226
MU 19,v226
Mv 56,212,196
DM 217,18,256
s_add_u32 m0,m0,800
LG 6
Mv 60,216,176
TR 200,248,224
CV 4,4,5
LG 5
Mv 60,220,180
TR 202,248,480
CV 5,6,7
Mv 64,216,184
TR 204,248,736
CV 6,16,17
Mv 64,220,188
TR 206,248,992
CV 7,18,19
Mv 68,216,192
DM 218,18,512
s_add_u32 m0,m0,800
Mv 68,220,196
MU 8,v228
MU 9,v228
LG 6
Mv 72,192,176
MU 10,v228
MU 11,v228
LG 4
Mv 72,196,180
MU 20,v228
MU 21,v228
Mv 76,192,184
MU 22,v228
MU 23,v228
Mv 76,196,188
DM 219,18,768
s_add_u32 s18,s18,16384
s_addc_u32 s19,s19,0
Mv 80,192,192
CV 8,8,9
CV 9,10,11
Mv 80,196,196
CV 10,20,21
CV 11,22,23
Ma 96,192,244
MU 24,v224
MU 25,v224
Ma 96,196,248
MU 26,v224
MU 27,v224
LG 2
Mv 84,200,176
MU 36,v224
MU 37,v224
LG 0
Mv 84,204,180
MU 38,v224
MU 39,v224
Mv 88,200,184
CV 24,24,25
CV 25,26,27
Mv 88,204,188
CV 26,36,37
CV 27,38,39
Mv 92,200,192
MU 28,v226
MU 29,v226
Mv 92,204,196
MU 30,v226
MU 31,v226
Ma 100,200,244
MU 40,v226
MU 41,v226
Ma 100,204,248
MU 42,v226
MU 43,v226
CV 28,28,29
CV 29,30,31
CV 30,40,41
CV 31,42,43
MU 32,v228
MU 33,v228
MU 34,v228
MU 35,v228
MU 44,v228
MU 45,v228
MU 46,v228
MU 47,v228
CV 32,32,33
CV 33,34,35
CV 34,44,45
CV 35,46,47
v_pk_mul_f32 v[48:49],v[48:49],v[224:225] op_sel_hi:[1,0]
v_pk_mul_f32 v[50:51],v[50:51],v[224:225] op_sel_hi:[1,0]
v_pk_mul_f32 v[60:61],v[60:61],v[224:225] op_sel_hi:[1,0]
v_pk_mul_f32 v[62:63],v[62:63],v[224:225] op_sel_hi:[1,0]
CV 48,48,49
CV 49,50,51
CV 50,60,61
CV 51,62,63
v_pk_mul_f32 v[52:53],v[52:53],v[226:227] op_sel_hi:[1,0]
v_pk_mul_f32 v[54:55],v[54:55],v[226:227] op_sel_hi:[1,0]
v_pk_mul_f32 v[64:65],v[64:65],v[226:227] op_sel_hi:[1,0]
v_pk_mul_f32 v[66:67],v[66:67],v[226:227] op_sel_hi:[1,0]
CV 52,52,53
CV 53,54,55
CV 54,64,65
CV 55,66,67
v_pk_mul_f32 v[56:57],v[56:57],v[228:229] op_sel_hi:[1,0]
v_pk_mul_f32 v[58:59],v[58:59],v[228:229] op_sel_hi:[1,0]
v_pk_mul_f32 v[68:69],v[68:69],v[228:229] op_sel_hi:[1,0]
v_pk_mul_f32 v[70:71],v[70:71],v[228:229] op_sel_hi:[1,0]
CV 56,56,57
CV 57,58,59
CV 58,68,69
CV 59,70,71
v_pk_mul_f32 v[72:73],v[72:73],v[224:225] op_sel_hi:[1,0]
v_pk_mul_f32 v[74:75],v[74:75],v[224:225] op_sel_hi:[1,0]
v_pk_mul_f32 v[84:85],v[84:85],v[224:225] op_sel_hi:[1,0]
v_pk_mul_f32 v[86:87],v[86:87],v[224:225] op_sel_hi:[1,0]
CV 72,72,73
CV 73,74,75
CV 74,84,85
CV 75,86,87
v_pk_mul_f32 v[76:77],v[76:77],v[226:227] op_sel_hi:[1,0]
v_pk_mul_f32 v[78:79],v[78:79],v[226:227] op_sel_hi:[1,0]
v_pk_mul_f32 v[88:89],v[88:89],v[226:227] op_sel_hi:[1,0]
v_pk_mul_f32 v[90:91],v[90:91],v[226:227] op_sel_hi:[1,0]
CV 76,76,77
CV 77,78,79
CV 78,88,89
CV 79,90,91
v_pk_mul_f32 v[80:81],v[80:81],v[228:229] op_sel_hi:[1,0]
v_pk_mul_f32 v[82:83],v[82:83],v[228:229] op_sel_hi:[1,0]
v_pk_mul_f32 v[92:93],v[92:93],v[228:229] op_sel_hi:[1,0]
v_pk_mul_f32 v[94:95],v[94:95],v[228:229] op_sel_hi:[1,0]
CV 80,80,81
CV 81,82,83
CV 82,92,93
CV 83,94,95
v_pk_mul_f32 v[96:97],v[96:97],v[230:231] op_sel_hi:[1,0]
v_pk_mul_f32 v[98:99],v[98:99],v[230:231] op_sel_hi:[1,0]
v_pk_mul_f32 v[100:101],v[100:101],v[230:231] op_sel_hi:[1,0]
v_pk_mul_f32 v[102:103],v[102:103],v[230:231] op_sel_hi:[1,0]
CV 96,96,97
CV 97,98,99
CV 98,100,101
CV 99,102,103
SLOW_r_w3:
s_cmp_eq_u32 s34,0
s_cbranch_scc0 EB1_w3
v_mov_b32 v254,v220
RD 208,254,0
RD 212,254,64
RD 216,254,128
RD 220,254,192
RD 192,254,256
RD 196,254,320
RD 200,254,384
RD 204,254,448
RD 224,249,20480
RD 228,249,21504
RD 232,249,22528
RD 236,249,23552
ds_write_b128 v249,v[96:99] offset:19456
AM 0,48
AM 1,49
AM 2,50
AM 3,51
AM 4,52
AM 5,53
AM 6,54
AM 7,55
AM 8,56
AM 9,57
AM 10,58
AM 11,59
AM 12,60
AM 13,61
AM 14,62
AM 15,63
AM 16,64
AM 17,65
AM 18,66
AM 19,67
AM 20,68
AM 21,69
AM 22,70
AM 23,71
AM 24,72
AM 25,73
AM 26,74
AM 27,75
AM 28,76
AM 29,77
AM 30,78
AM 31,79
AM 32,80
AM 33,81
AM 34,82
AM 35,83
AM 36,84
AM 37,85
AM 38,86
AM 39,87
AM 40,88
AM 41,89
AM 42,90
AM 43,91
AM 44,92
AM 45,93
AM 46,94
AM 47,95
AW 48,0
AW 49,1
AW 50,2
AW 51,3
AW 52,4
AW 53,5
AW 54,6
AW 55,7
AW 56,8
AW 57,9
AW 58,10
AW 59,11
AW 60,24
AW 61,25
AW 62,26
AW 63,27
AW 64,28
AW 65,29
AW 66,30
AW 67,31
AW 68,32
AW 69,33
AW 70,34
AW 71,35
AW 72,48
AW 73,49
AW 74,50
AW 75,51
AW 76,52
AW 77,53
AW 78,54
AW 79,55
AW 80,56
AW 81,57
AW 82,58
AW 83,59
AW 84,72
AW 85,73
AW 86,74
AW 87,75
AW 88,76
AW 89,77
AW 90,78
AW 91,79
AW 92,80
AW 93,81
AW 94,82
AW 95,83
s_add_u32 s34,s34,1
s_branch LB_w3
EB1_w3:
s_cmp_eq_u32 s34,1
s_cbranch_scc0 EB2_w3
v_mov_b32 v254,v220
LG 12
RD 208,254,0
LG 12
RD 212,254,64
LG 12
RD 216,254,128
LG 12
RD 220,254,192
LG 12
RD 192,254,256
LG 12
RD 196,254,320
LG 12
RD 200,254,384
LG 12
RD 204,254,448
LG 12
RD 224,249,24576
LG 12
RD 228,249,25600
LG 12
RD 232,249,26624
LG 12
RD 236,249,27648
ds_write_b128 v249,v[96:99] offset:23552
AM 0,96
AM 1,97
AM 2,98
AM 3,99
AM 4,100
AM 5,101
AM 6,102
AM 7,103
AM 8,104
AM 9,105
AM 10,106
AM 11,107
AM 12,108
AM 13,109
AM 14,110
AM 15,111
AM 16,112
AM 17,113
AM 18,114
AM 19,115
AM 20,116
AM 21,117
AM 22,118
AM 23,119
AM 24,120
AM 25,121
AM 26,122
AM 27,123
AM 28,124
AM 29,125
AM 30,126
AM 31,127
AM 32,128
AM 33,129
AM 34,130
AM 35,131
AM 36,132
AM 37,133
AM 38,134
AM 39,135
AM 40,136
AM 41,137
AM 42,138
AM 43,139
AM 44,140
AM 45,141
AM 46,142
AM 47,143
AW 96,0
AW 97,1
AW 98,2
AW 99,3
AW 100,4
AW 101,5
AW 102,6
AW 103,7
AW 104,8
AW 105,9
AW 106,10
AW 107,11
AW 108,24
AW 109,25
AW 110,26
AW 111,27
AW 112,28
AW 113,29
AW 114,30
AW 115,31
AW 116,32
AW 117,33
AW 118,34
AW 119,35
AW 120,48
AW 121,49
AW 122,50
AW 123,51
AW 124,52
AW 125,53
AW 126,54
AW 127,55
AW 128,56
AW 129,57
AW 130,58
AW 131,59
AW 132,72
AW 133,73
AW 134,74
AW 135,75
AW 136,76
AW 137,77
AW 138,78
AW 139,79
AW 140,80
AW 141,81
AW 142,82
AW 143,83
s_add_u32 s34,s34,1
s_branch LB_w3
EB2_w3:
s_cmp_eq_u32 s34,2
s_cbranch_scc0 EB3_w3
v_mov_b32 v254,v220
LG 12
RD 208,254,0
LG 12
RD 212,254,64
LG 12
RD 216,254,128
LG 12
RD 220,254,192
LG 12
RD 192,254,256
LG 12
RD 196,254,320
LG 12
RD 200,254,384
LG 12
RD 204,254,448
LG 12
RD 224,249,0
LG 12
RD 228,249,1024
LG 12
RD 232,249,2048
LG 12
RD 236,249,3072
ds_write_b128 v249,v[96:99] offset:27648
AM 0,144
AM 1,145
AM 2,146
AM 3,147
AM 4,148
AM 5,149
AM 6,150
AM 7,151
AM 8,152
AM 9,153
AM 10,154
AM 11,155
AM 12,156
AM 13,157
AM 14,158
AM 15,159
AM 16,160
AM 17,161
AM 18,162
AM 19,163
AM 20,164
AM 21,165
AM 22,166
AM 23,167
AM 24,168
AM 25,169
AM 26,170
AM 27,171
AM 28,172
AM 29,173
AM 30,174
AM 31,175
AM 32,176
AM 33,177
AM 34,178
AM 35,179
AM 36,180
AM 37,181
AM 38,182
AM 39,183
AM 40,184
AM 41,185
AM 42,186
AM 43,187
AM 44,188
AM 45,189
AM 46,190
AM 47,191
AW 144,0
AW 145,1
AW 146,2
AW 147,3
AW 148,4
AW 149,5
AW 150,6
AW 151,7
AW 152,8
AW 153,9
AW 154,10
AW 155,11
AW 156,24
AW 157,25
AW 158,26
AW 159,27
AW 160,28
AW 161,29
AW 162,30
AW 163,31
AW 164,32
AW 165,33
AW 166,34
AW 167,35
AW 168,48
AW 169,49
AW 170,50
AW 171,51
AW 172,52
AW 173,53
AW 174,54
AW 175,55
AW 176,56
AW 177,57
AW 178,58
AW 179,59
AW 180,72
AW 181,73
AW 182,74
AW 183,75
AW 184,76
AW 185,77
AW 186,78
AW 187,79
AW 188,80
AW 189,81
AW 190,82
AW 191,83
s_add_u32 s34,s34,1
s_branch LB_w3
EB3_w3:
ds_write_b128 v249,v[96:99] offset:3072
AW 0,0
AW 1,1
AW 2,2
AW 3,3
AW 4,4
AW 5,5
AW 6,6
AW 7,7
AW 8,8
AW 9,9
AW 10,10
AW 11,11
AW 12,24
AW 13,25
AW 14,26
AW 15,27
AW 16,28
AW 17,29
AW 18,30
AW 19,31
AW 20,32
AW 21,33
AW 22,34
AW 23,35
AW 24,48
AW 25,49
AW 26,50
AW 27,51
AW 28,52
AW 29,53
AW 30,54
AW 31,55
AW 32,56
AW 33,57
AW 34,58
AW 35,59
AW 36,72
AW 37,73
AW 38,74
AW 39,75
AW 40,76
AW 41,77
AW 42,78
AW 43,79
AW 44,80
AW 45,81
AW 46,82
AW 47,83
v_mov_b32 v248,v221
s_mov_b32 s20,0
s_waitcnt vmcnt(20) lgkmcnt(0)
s_barrier
TR 192,248,0
TR 194,248,256
TR 196,248,512
TR 198,248,768
TR 200,248,16896
TR 202,248,17152
TR 204,248,17408
TR 206,248,17664
s_add_u32 s16,s12,393216
s_addc_u32 s17,s13,0
s_add_u32 s18,s12,458752
s_addc_u32 s19,s13,0
s_mov_b64 s[36:37],0
LC_w3:
LG 0
Za 0,192,48
RD 224,249,16384
s_mov_b32 m0,114048
s_add_u32 s32,s14,36864
s_addc_u32 s33,s15,0
Ma 0,196,60
RD 228,249,17408
Ma 0,200,72
RD 232,249,18432
Ma 0,204,84
RD 236,249,19456
Za 4,192,52
TR 208,248,32
Ma 4,196,64
TR 210,248,288
Ma 4,200,76
TR 212,248,544
Ma 4,204,88
TR 214,248,800
Za 8,192,56
TR 216,248,16928
TR 218,248,17184
Ma 8,196,68
TR 220,248,17440
TR 222,248,17696
Ma 8,200,80
DW 250,16,0
s_mov_b32 m0,114848
Ma 8,204,92
DW 251,16,256
s_mov_b32 m0,115648
LG 6
Za 12,208,48
TR 192,248,64
LG 5
Ma 12,212,60
TR 194,248,320
LG 4
Ma 12,216,72
TR 196,248,576
LG 3
Ma 12,220,84
TR 198,248,832
Za 16,208,52
TR 200,248,16960
Ma 16,212,64
TR 202,248,17216
Ma 16,216,76
TR 204,248,17472
Ma 16,220,88
TR 206,248,17728
Za 20,208,56
s_mov_b64 exec,s[36:37]
global_store_dwordx4 v249,v[104:107],s[32:33] offset:0 sc1
s_mov_b64 exec,-1
Ma 20,212,68
TR 208,248,96
Ma 20,216,80
TR 210,248,352
Ma 20,220,92
TR 212,248,608
LG 9
Za 24,192,48
TR 214,248,864
LG 8
Ma 24,196,60
DW 252,16,512
s_mov_b32 m0,116448
LG 6
Ma 24,200,72
TR 216,248,16992
LG 5
Ma 24,204,84
TR 218,248,17248
Za 28,192,52
TR 220,248,17504
Ma 28,196,64
TR 222,248,17760
Ma 28,200,76
Ma 28,204,88
Za 32,192,56
DW 253,16,768
s_mov_b32 m0,130944
Ma 32,196,68
TR 192,248,128
Ma 32,200,80
TR 194,248,384
Ma 32,204,92
TR 196,248,640
LG 9
Za 36,208,48
TR 198,248,896
LG 8
Ma 36,212,60
TR 200,248,17024
LG 7
Ma 36,216,72
TR 202,248,17280
LG 6
Ma 36,220,84
s_mov_b64 exec,s[36:37]
global_store_dwordx4 v249,v[108:111],s[32:33] offset:1024 sc1
s_mov_b64 exec,-1
Za 40,208,52
TR 204,248,17536
Ma 40,212,64
TR 206,248,17792
Ma 40,216,76
Ma 40,220,88
Za 44,208,56
TR 208,248,160
Ma 44,212,68
TR 210,248,416
Ma 44,216,80
DW 250,18,0
s_mov_b32 m0,131744
Ma 44,220,92
TR 212,248,672
LG 9
Za 48,192,48
TR 214,248,928
LG 8
Ma 48,196,60
TR 216,248,17056
LG 7
Ma 48,200,72
TR 218,248,17312
LG 6
Ma 48,204,84
TR 220,248,17568
Za 52,192,52
TR 222,248,17824
Ma 52,196,64
DW 251,18,256
s_mov_b32 m0,132544
Ma 52,200,76
Ma 52,204,88
Za 56,192,56
TR 192,248,192
Ma 56,196,68
TR 194,248,448
Ma 56,200,80
TR 196,248,704
Ma 56,204,92
TR 198,248,960
LG 10
Za 60,208,48
s_mov_b64 exec,s[36:37]
global_store_dwordx4 v249,v[112:115],s[32:33] offset:2048 sc1
s_mov_b64 exec,-1
LG 8
Ma 60,212,60
TR 200,248,17088
LG 7
Ma 60,216,72
TR 202,248,17344
LG 6
Ma 60,220,84
TR 204,248,17600
Za 64,208,52
TR 206,248,17856
Ma 64,212,64
Ma 64,216,76
Ma 64,220,88
DW 252,18,512
s_mov_b32 m0,133344
Za 68,208,56
TR 208,248,224
Ma 68,212,68
TR 210,248,480
Ma 68,216,80
TR 212,248,736
Ma 68,220,92
TR 214,248,992
LG 10
Za 72,192,48
TR 216,248,17120
LG 9
Ma 72,196,60
TR 218,248,17376
LG 8
Ma 72,200,72
DW 253,18,768
s_mov_b32 m0,12672
LG 6
Ma 72,204,84
TR 220,248,17632
Za 76,192,52
TR 222,248,17888
Ma 76,196,64
Ma 76,200,76
Ma 76,204,88
Za 80,192,56
Ma 80,196,68
Ma 80,200,80
Ma 80,204,92
Za 96,192,224
Ma 96,196,228
Ma 96,200,232
Ma 96,204,236
LG 6
Za 84,208,48
LG 4
Ma 84,212,60
LG 2
Ma 84,216,72
LG 0
Ma 84,220,84
s_waitcnt vmcnt(19) lgkmcnt(0)
s_barrier
s_cmp_eq_u32 s20,3
s_cbranch_scc1 Calt1_w3
s_add_u32 s16,s12,256
s_addc_u32 s17,s13,0
s_add_u32 s18,s12,65792
s_addc_u32 s19,s13,0
Calt1_r_w3:
Za 88,208,52
TR 192,248,33792
Ma 88,212,64
TR 194,248,34048
Ma 88,216,76
TR 196,248,34304
Ma 88,220,88
TR 198,248,34560
Za 92,208,56
TR 200,248,50688
Ma 92,212,68
TR 202,248,50944
Ma 92,216,80
TR 204,248,51200
Ma 92,220,92
TR 206,248,51456
Za 100,208,224
DW 250,16,0
s_mov_b32 m0,13472
Ma 100,212,228
RD 224,249,20480
Ma 100,216,232
RD 228,249,21504
Ma 100,220,236
RD 232,249,22528
LG 9
Ma 0,192,96
DW 251,16,256
s_mov_b32 m0,14272
LG 7
Ma 0,196,108
RD 236,249,23552
LG 6
Ma 0,200,120
TR 208,248,33824
LG 5
Ma 0,204,132
TR 210,248,34080
Ma 4,192,100
TR 212,248,34336
Ma 4,196,112
TR 214,248,34592
Ma 4,200,124
TR 216,248,50720
Ma 4,204,136
TR 218,248,50976
Ma 8,192,104
TR 220,248,51232
Ma 8,196,116
TR 222,248,51488
Ma 8,200,128
s_mov_b64 exec,s[36:37]
global_store_dwordx4 v249,v[116:119],s[32:33] offset:3072 sc1
s_mov_b64 exec,-1
s_add_u32 s32,s14,40960
s_addc_u32 s33,s15,0
Ma 8,204,140
TR 192,248,33856
LG 7
Ma 12,208,96
TR 194,248,34112
LG 6
Ma 12,212,108
TR 196,248,34368
LG 5
Ma 12,216,120
TR 198,248,34624
LG 4
Ma 12,220,132
DW 252,16,512
s_mov_b32 m0,15072
Ma 16,208,100
TR 200,248,50752
Ma 16,212,112
TR 202,248,51008
Ma 16,216,124
TR 204,248,51264
Ma 16,220,136
TR 206,248,51520
Ma 20,208,104
TR 208,248,33888
Ma 20,212,116
DW 253,16,768
s_mov_b32 m0,29568
Ma 20,216,128
TR 210,248,34144
Ma 20,220,140
TR 212,248,34400
LG 9
Ma 24,192,96
TR 214,248,34656
LG 8
Ma 24,196,108
TR 216,248,50784
LG 7
Ma 24,200,120
TR 218,248,51040
LG 6
Ma 24,204,132
TR 220,248,51296
Ma 28,192,100
TR 222,248,51552
Ma 28,196,112
s_mov_b64 exec,s[36:37]
global_store_dwordx4 v249,v[120:123],s[32:33] offset:0 sc1
s_mov_b64 exec,-1
Ma 28,200,124
Ma 28,204,136
Ma 32,192,104
TR 192,248,33920
Ma 32,196,116
TR 194,248,34176
Ma 32,200,128
TR 196,248,34432
Ma 32,204,140
DW 250,18,0
s_mov_b32 m0,30368
LG 9
Ma 36,208,96
TR 198,248,34688
LG 8
Ma 36,212,108
TR 200,248,50816
LG 7
Ma 36,216,120
TR 202,248,51072
LG 6
Ma 36,220,132
TR 204,248,51328
Ma 40,208,100
TR 206,248,51584
Ma 40,212,112
Ma 40,216,124
DW 251,18,256
s_mov_b32 m0,31168
Ma 40,220,136
Ma 44,208,104
TR 208,248,33952
Ma 44,212,116
TR 210,248,34208
Ma 44,216,128
TR 212,248,34464
Ma 44,220,140
TR 214,248,34720
LG 10
Ma 48,192,96
TR 216,248,50848
LG 9
Ma 48,196,108
s_mov_b64 exec,s[36:37]
global_store_dwordx4 v249,v[124:127],s[32:33] offset:1024 sc1
s_mov_b64 exec,-1
LG 7
Ma 48,200,120
TR 218,248,51104
LG 6
Ma 48,204,132
TR 220,248,51360
Ma 52,192,100
TR 222,248,51616
Ma 52,196,112
Ma 52,200,124
Ma 52,204,136
Ma 56,192,104
DW 252,18,512
s_mov_b32 m0,31968
Ma 56,196,116
TR 192,248,33984
Ma 56,200,128
TR 194,248,34240
Ma 56,204,140
TR 196,248,34496
LG 9
Ma 60,208,96
TR 198,248,34752
LG 8
Ma 60,212,108
TR 200,248,50880
LG 7
Ma 60,216,120
TR 202,248,51136
LG 6
Ma 60,220,132
DW 253,18,768
s_mov_b32 m0,46464
Ma 64,208,100
TR 204,248,51392
Ma 64,212,112
TR 206,248,51648
Ma 64,216,124
Ma 64,220,136
Ma 68,208,104
TR 208,248,34016
Ma 68,212,116
TR 210,248,34272
Ma 68,216,128
s_mov_b64 exec,s[36:37]
global_store_dwordx4 v249,v[128:131],s[32:33] offset:2048 sc1
s_mov_b64 exec,-1
Ma 68,220,140
TR 212,248,34528
LG 9
Ma 72,192,96
TR 214,248,34784
LG 8
Ma 72,196,108
TR 216,248,50912
LG 7
Ma 72,200,120
TR 218,248,51168
LG 6
Ma 72,204,132
TR 220,248,51424
Ma 76,192,100
TR 222,248,51680
v_add_u32 v248,67584,v248
Ma 76,196,112
Ma 76,200,124
Ma 76,204,136
Ma 80,192,104
Ma 80,196,116
Ma 80,200,128
Ma 80,204,140
Ma 96,192,224
Ma 96,196,228
Ma 96,200,232
Ma 96,204,236
LG 6
Ma 84,208,96
LG 4
Ma 84,212,108
LG 2
Ma 84,216,120
LG 0
Ma 84,220,132
s_waitcnt vmcnt(20) lgkmcnt(0)
s_barrier
s_cmp_eq_u32 s20,3
s_cbranch_scc1 Calt2_w3
s_add_u32 s16,s12,131328
s_addc_u32 s17,s13,0
s_add_u32 s18,s12,196864
s_addc_u32 s19,s13,0
Calt2_r_w3:
Ma 88,208,100
TR 192,248,0
Ma 88,212,112
TR 194,248,256
Ma 88,216,124
TR 196,248,512
Ma 88,220,136
TR 198,248,768
Ma 92,208,104
TR 200,248,16896
Ma 92,212,116
TR 202,248,17152
Ma 92,216,128
TR 204,248,17408
Ma 92,220,140
TR 206,248,17664
Ma 100,208,224
DW 250,16,0
s_mov_b32 m0,47264
Ma 100,212,228
RD 224,249,24576
Ma 100,216,232
RD 228,249,25600
Ma 100,220,236
RD 232,249,26624
LG 9
Ma 0,192,144
DW 251,16,256
s_mov_b32 m0,48064
LG 7
Ma 0,196,156
RD 236,249,27648
LG 6
Ma 0,200,168
TR 208,248,32
LG 5
Ma 0,204,180
TR 210,248,288
Ma 4,192,148
TR 212,248,544
Ma 4,196,160
TR 214,248,800
Ma 4,200,172
TR 216,248,16928
Ma 4,204,184
TR 218,248,17184
Ma 8,192,152
TR 220,248,17440
Ma 8,196,164
TR 222,248,17696
Ma 8,200,176
s_mov_b64 exec,s[36:37]
global_store_dwordx4 v249,v[132:135],s[32:33] offset:3072 sc1
s_mov_b64 exec,-1
s_add_u32 s32,s14,45056
s_addc_u32 s33,s15,0
Ma 8,204,188
TR 192,248,64
LG 7
Ma 12,208,144
TR 194,248,320
LG 6
Ma 12,212,156
TR 196,248,576
LG 5
Ma 12,216,168
TR 198,248,832
LG 4
Ma 12,220,180
DW 252,16,512
s_mov_b32 m0,48864
Ma 16,208,148
TR 200,248,16960
Ma 16,212,160
TR 202,248,17216
Ma 16,216,172
TR 204,248,17472
Ma 16,220,184
TR 206,248,17728
Ma 20,208,152
TR 208,248,96
Ma 20,212,164
DW 253,16,768
s_mov_b32 m0,63360
Ma 20,216,176
TR 210,248,352
Ma 20,220,188
TR 212,248,608
LG 9
Ma 24,192,144
TR 214,248,864
LG 8
Ma 24,196,156
TR 216,248,16992
LG 7
Ma 24,200,168
TR 218,248,17248
LG 6
Ma 24,204,180
TR 220,248,17504
Ma 28,192,148
TR 222,248,17760
Ma 28,196,160
s_mov_b64 exec,s[36:37]
global_store_dwordx4 v249,v[136:139],s[32:33] offset:0 sc1
s_mov_b64 exec,-1
Ma 28,200,172
Ma 28,204,184
Ma 32,192,152
TR 192,248,128
Ma 32,196,164
TR 194,248,384
Ma 32,200,176
TR 196,248,640
Ma 32,204,188
DW 250,18,0
s_mov_b32 m0,64160
LG 9
Ma 36,208,144
TR 198,248,896
LG 8
Ma 36,212,156
TR 200,248,17024
LG 7
Ma 36,216,168
TR 202,248,17280
LG 6
Ma 36,220,180
TR 204,248,17536
Ma 40,208,148
TR 206,248,17792
Ma 40,212,160
Ma 40,216,172
DW 251,18,256
s_mov_b32 m0,64960
Ma 40,220,184
Ma 44,208,152
TR 208,248,160
Ma 44,212,164
TR 210,248,416
Ma 44,216,176
TR 212,248,672
Ma 44,220,188
TR 214,248,928
LG 10
Ma 48,192,144
TR 216,248,17056
LG 9
Ma 48,196,156
s_mov_b64 exec,s[36:37]
global_store_dwordx4 v249,v[140:143],s[32:33] offset:1024 sc1
s_mov_b64 exec,-1
LG 7
Ma 48,200,168
TR 218,248,17312
LG 6
Ma 48,204,180
TR 220,248,17568
Ma 52,192,148
TR 222,248,17824
Ma 52,196,160
Ma 52,200,172
Ma 52,204,184
Ma 56,192,152
DW 252,18,512
s_mov_b32 m0,65760
Ma 56,196,164
TR 192,248,192
Ma 56,200,176
TR 194,248,448
Ma 56,204,188
TR 196,248,704
LG 9
Ma 60,208,144
TR 198,248,960
LG 8
Ma 60,212,156
TR 200,248,17088
LG 7
Ma 60,216,168
TR 202,248,17344
LG 6
Ma 60,220,180
DW 253,18,768
s_mov_b32 m0,80256
Ma 64,208,148
TR 204,248,17600
Ma 64,212,160
TR 206,248,17856
Ma 64,216,172
Ma 64,220,184
Ma 68,208,152
TR 208,248,224
Ma 68,212,164
TR 210,248,480
Ma 68,216,176
TR 212,248,736
Ma 68,220,188
TR 214,248,992
LG 10
Ma 72,192,144
TR 216,248,17120
LG 9
Ma 72,196,156
TR 218,248,17376
LG 8
Ma 72,200,168
TR 220,248,17632
LG 7
Ma 72,204,180
TR 222,248,17888
Ma 76,192,148
Ma 76,196,160
Ma 76,200,172
Ma 76,204,184
Ma 80,192,152
Ma 80,196,164
Ma 80,200,176
Ma 80,204,188
Ma 96,192,224
Ma 96,196,228
Ma 96,200,232
Ma 96,204,236
LG 6
Ma 84,208,144
LG 4
Ma 84,212,156
LG 2
Ma 84,216,168
LG 0
Ma 84,220,180
s_waitcnt vmcnt(16) lgkmcnt(0)
s_barrier
s_cmp_eq_u32 s20,3
s_cbranch_scc1 Calt3_w3
s_add_u32 s16,s12,262400
s_addc_u32 s17,s13,0
s_add_u32 s18,s12,327936
s_addc_u32 s19,s13,0
Calt3_r_w3:
Ma 88,208,148
TR 192,248,33792
Ma 88,212,160
TR 194,248,34048
Ma 88,216,172
TR 196,248,34304
Ma 88,220,184
TR 198,248,34560
Ma 92,208,152
TR 200,248,50688
Ma 92,212,164
TR 202,248,50944
Ma 92,216,176
TR 204,248,51200
Ma 92,220,188
TR 206,248,51456
Ma 100,208,224
DW 250,16,0
s_mov_b32 m0,81056
Ma 100,212,228
RD 224,249,0
Ma 100,216,232
RD 228,249,1024
Ma 100,220,236
RD 232,249,2048
LG 9
Ma 0,192,0
DW 251,16,256
s_mov_b32 m0,81856
LG 7
Ma 0,196,12
RD 236,249,3072
LG 6
Ma 0,200,24
TR 208,248,33824
LG 5
Ma 0,204,36
TR 210,248,34080
Ma 4,192,4
TR 212,248,34336
Ma 4,196,16
TR 214,248,34592
Ma 4,200,28
TR 216,248,50720
s_nop 0
CV 104,0,1
Ma 4,204,40
TR 218,248,50976
CV 105,2,3
Ma 8,192,8
TR 220,248,51232
Ma 8,196,20
TR 222,248,51488
Ma 8,200,32
s_mov_b64 exec,s[36:37]
global_store_dwordx4 v249,v[144:147],s[32:33] offset:2048 sc1
s_mov_b64 exec,-1
Ma 8,204,44
TR 192,248,33856
CV 120,4,5
LG 7
Ma 12,208,0
TR 194,248,34112
CV 121,6,7
LG 6
Ma 12,212,12
TR 196,248,34368
LG 5
Ma 12,216,24
TR 198,248,34624
CV 136,8,9
LG 4
Ma 12,220,36
DW 252,16,512
s_mov_b32 m0,82656
Ma 16,208,4
TR 200,248,50752
CV 137,10,11
Ma 16,212,16
TR 202,248,51008
Ma 16,216,28
TR 204,248,51264
CV 106,12,13
Ma 16,220,40
TR 206,248,51520
CV 107,14,15
Ma 20,208,8
TR 208,248,33888
Ma 20,212,20
DW 253,16,768
s_mov_b32 m0,97152
Ma 20,216,32
TR 210,248,34144
CV 122,16,17
Ma 20,220,44
TR 212,248,34400
CV 123,18,19
LG 9
Ma 24,192,0
TR 214,248,34656
LG 8
Ma 24,196,12
TR 216,248,50784
LG 7
Ma 24,200,24
TR 218,248,51040
CV 138,20,21
LG 6
Ma 24,204,36
TR 220,248,51296
CV 139,22,23
Ma 28,192,4
TR 222,248,51552
Ma 28,196,16
s_mov_b64 exec,s[36:37]
global_store_dwordx4 v249,v[148:151],s[32:33] offset:3072 sc1
s_mov_b64 exec,-1
s_add_u32 s32,s14,49152
s_addc_u32 s33,s15,0
Ma 28,200,28
CV 108,24,25
CV 109,26,27
Ma 28,204,40
Ma 32,192,8
TR 192,248,33920
Ma 32,196,20
TR 194,248,34176
Ma 32,200,32
TR 196,248,34432
s_nop 1
CV 124,28,29
Ma 32,204,44
DW 250,18,0
s_mov_b32 m0,97952
LG 9
Ma 36,208,0
TR 198,248,34688
CV 125,30,31
LG 8
Ma 36,212,12
TR 200,248,50816
LG 7
Ma 36,216,24
TR 202,248,51072
CV 140,32,33
LG 6
Ma 36,220,36
TR 204,248,51328
CV 141,34,35
Ma 40,208,4
TR 206,248,51584
Ma 40,212,16
Ma 40,216,28
DW 251,18,256
s_mov_b32 m0,98752
Ma 40,220,40
CV 110,36,37
CV 111,38,39
Ma 44,208,8
TR 208,248,33952
Ma 44,212,20
TR 210,248,34208
Ma 44,216,32
TR 212,248,34464
CV 126,40,41
Ma 44,220,44
TR 214,248,34720
CV 127,42,43
LG 10
Ma 48,192,0
TR 216,248,50848
LG 9
Ma 48,196,12
s_mov_b64 exec,s[36:37]
global_store_dwordx4 v249,v[152:155],s[32:33] offset:3072 sc1
s_mov_b64 exec,-1
LG 7
Ma 48,200,24
TR 218,248,51104
CV 142,44,45
LG 6
Ma 48,204,36
TR 220,248,51360
CV 143,46,47
Ma 52,192,4
TR 222,248,51616
Ma 52,196,16
Ma 52,200,28
s_nop 1
CV 112,48,49
CV 113,50,51
Ma 52,204,40
Ma 56,192,8
DW 252,18,512
s_mov_b32 m0,99552
Ma 56,196,20
TR 192,248,33984
Ma 56,200,32
TR 194,248,34240
s_nop 1
CV 128,52,53
Ma 56,204,44
TR 196,248,34496
CV 129,54,55
LG 9
Ma 60,208,0
TR 198,248,34752
LG 8
Ma 60,212,12
TR 200,248,50880
LG 7
Ma 60,216,24
TR 202,248,51136
CV 144,56,57
LG 6
Ma 60,220,36
DW 253,18,768
Ma 64,208,4
TR 204,248,51392
CV 145,58,59
Ma 64,212,16
TR 206,248,51648
Ma 64,216,28
s_nop 0
CV 114,60,61
CV 115,62,63
Ma 64,220,40
Ma 68,208,8
TR 208,248,34016
Ma 68,212,20
TR 210,248,34272
Ma 68,216,32
TR 212,248,34528
s_nop 1
CV 130,64,65
Ma 68,220,44
TR 214,248,34784
CV 131,66,67
LG 10
Ma 72,192,0
TR 216,248,50912
LG 9
Ma 72,196,12
TR 218,248,51168
LG 8
Ma 72,200,24
TR 220,248,51424
CV 146,68,69
LG 7
Ma 72,204,36
TR 222,248,51680
v_add_u32 v248,4294899712,v248
Ma 76,192,4
CV 147,70,71
Ma 76,196,16
Ma 76,200,28
s_nop 1
CV 116,72,73
CV 117,74,75
Ma 76,204,40
Ma 80,192,8
Ma 80,196,20
Ma 80,200,32
s_nop 4
CV 132,76,77
CV 133,78,79
Ma 80,204,44
Ma 96,192,224
Ma 96,196,228
Ma 96,200,232
s_nop 4
CV 148,80,81
CV 149,82,83
Ma 96,204,236
LG 6
Ma 84,208,0
LG 4
Ma 84,212,12
LG 2
Ma 84,216,24
s_nop 1
CV 152,96,97
CV 153,98,99
LG 0
Ma 84,220,36
s_waitcnt vmcnt(16) lgkmcnt(0)
s_barrier
s_cmp_eq_u32 s20,3
s_cbranch_scc1 Calt4_w3
s_add_u32 s16,s12,393472
s_addc_u32 s17,s13,0
s_add_u32 s18,s12,459008
s_addc_u32 s19,s13,0
Calt4_r_w3:
Ma 88,208,4
TR 192,248,0
Ma 88,212,16
TR 194,248,256
Ma 88,216,28
TR 196,248,512
CV 118,84,85
Ma 88,220,40
TR 198,248,768
CV 119,86,87
Ma 92,208,8
TR 200,248,16896
Ma 92,212,20
TR 202,248,17152
Ma 92,216,32
TR 204,248,17408
TR 206,248,17664
Ma 92,220,44
CV 134,88,89
CV 135,90,91
Ma 100,208,224
Ma 100,212,228
Ma 100,216,232
s_nop 2
CV 150,92,93
CV 151,94,95
Ma 100,220,236
s_nop 7
CV 154,100,101
CV 155,102,103
s_add_u32 s12,s12,256
s_addc_u32 s13,s13,0
s_cmp_eq_u32 s20,0
s_cselect_b32 s28,0,53248
s_add_u32 s14,s14,s28
s_addc_u32 s15,s15,0
s_mov_b64 s[36:37],-1
s_add_u32 s20,s20,1
s_cmp_lg_u32 s20,4
s_cbranch_scc1 LC_w3
s_add_u32 s32,s14,36864
s_addc_u32 s33,s15,0
global_store_dwordx4 v249,v[104:107],s[32:33] offset:0 sc1
global_store_dwordx4 v249,v[108:111],s[32:33] offset:1024 sc1
global_store_dwordx4 v249,v[112:115],s[32:33] offset:2048 sc1
global_store_dwordx4 v249,v[116:119],s[32:33] offset:3072 sc1
s_add_u32 s32,s14,40960
s_addc_u32 s33,s15,0
global_store_dwordx4 v249,v[120:123],s[32:33] offset:0 sc1
global_store_dwordx4 v249,v[124:127],s[32:33] offset:1024 sc1
global_store_dwordx4 v249,v[128:131],s[32:33] offset:2048 sc1
global_store_dwordx4 v249,v[132:135],s[32:33] offset:3072 sc1
s_add_u32 s32,s14,45056
s_addc_u32 s33,s15,0
global_store_dwordx4 v249,v[136:139],s[32:33] offset:0 sc1
global_store_dwordx4 v249,v[140:143],s[32:33] offset:1024 sc1
global_store_dwordx4 v249,v[144:147],s[32:33] offset:2048 sc1
global_store_dwordx4 v249,v[148:151],s[32:33] offset:3072 sc1
s_add_u32 s32,s14,49152
s_addc_u32 s33,s15,0
global_store_dwordx4 v249,v[152:155],s[32:33] offset:3072 sc1
s_waitcnt vmcnt(0) lgkmcnt(0)
s_waitcnt vmcnt(0) lgkmcnt(0)
s_endpgm
ProK_w3:
s_nop 1
v_subrev_u32 v255,135168,v249
v_and_b32 v250,0xf0,v255
v_lshrrev_b32 v255,8,v255
v_lshl_add_u32 v250,v255,14,v250
v_add_u32 v251,768,v250
v_add_u32 v252,1536,v250
v_add_u32 v253,2304,v250
s_mul_hi_u32 s28,s22,254201
s_lshl_b32 s28,s28,16
s_add_u32 s16,s12,s28
s_addc_u32 s17,s13,0
s_cmp_ge_u32 s21,29
s_cbranch_scc0 ProK_r_w3
v_subrev_u32 v255,135168,v249
v_and_b32 v216,0xf0,v255
v_lshrrev_b32 v255,8,v255
v_lshl_add_u32 v216,v255,14,v216
v_add_u32 v217,768,v216
v_add_u32 v218,1536,v216
v_add_u32 v219,2304,v216
s_mul_hi_u32 s28,s25,254201
s_lshl_b32 s28,s28,16
s_add_u32 s18,s12,s28
s_addc_u32 s19,s13,0
s_nop 1
s_branch ProK_r_w3
It0K_w3:
s_nop 1
v_subrev_u32 v255,135168,v249
v_and_b32 v250,0xf0,v255
v_lshrrev_b32 v255,8,v255
v_lshl_add_u32 v250,v255,14,v250
v_add_u32 v251,768,v250
v_add_u32 v252,1536,v250
v_add_u32 v253,2304,v250
s_mul_hi_u32 s28,s23,254201
s_lshl_b32 s28,s28,16
s_add_u32 s16,s12,s28
s_addc_u32 s17,s13,0
s_cmp_ge_u32 s21,29
s_cbranch_scc0 It0K_r_w3
v_subrev_u32 v255,135168,v249
v_and_b32 v216,0xf0,v255
v_lshrrev_b32 v255,8,v255
v_lshl_add_u32 v216,v255,14,v216
v_add_u32 v217,768,v216
v_add_u32 v218,1536,v216
v_add_u32 v219,2304,v216
s_mul_hi_u32 s28,s24,254201
s_lshl_b32 s28,s28,16
s_add_u32 s18,s12,s28
s_addc_u32 s19,s13,0
s_nop 1
s_branch It0K_r_w3
ItOK_w3:
s_nop 1
v_subrev_u32 v255,135168,v249
v_and_b32 v250,0xf0,v255
v_lshrrev_b32 v255,8,v255
v_lshl_add_u32 v250,v255,14,v250
v_add_u32 v251,768,v250
v_add_u32 v252,1536,v250
v_add_u32 v253,2304,v250
s_mul_hi_u32 s28,s22,254201
s_lshl_b32 s28,s28,16
s_add_u32 s16,s12,s28
s_addc_u32 s17,s13,0
s_cmp_ge_u32 s21,29
s_cbranch_scc0 ItOK_r_w3
v_subrev_u32 v255,135168,v249
v_and_b32 v216,0xf0,v255
v_lshrrev_b32 v255,8,v255
v_lshl_add_u32 v216,v255,14,v216
v_add_u32 v217,768,v216
v_add_u32 v218,1536,v216
v_add_u32 v219,2304,v216
s_mul_hi_u32 s28,s25,254201
s_lshl_b32 s28,s28,16
s_add_u32 s18,s12,s28
s_addc_u32 s19,s13,0
s_nop 1
s_branch ItOK_r_w3
ItEK_w3:
s_nop 1
v_subrev_u32 v255,135168,v249
v_and_b32 v250,0xf0,v255
v_lshrrev_b32 v255,8,v255
v_lshl_add_u32 v250,v255,14,v250
v_add_u32 v251,768,v250
v_add_u32 v252,1536,v250
v_add_u32 v253,2304,v250
s_mul_hi_u32 s28,s23,254201
s_lshl_b32 s28,s28,16
s_add_u32 s16,s12,s28
s_addc_u32 s17,s13,0
s_cmp_ge_u32 s21,29
s_cbranch_scc0 ItEK_r_w3
v_subrev_u32 v255,135168,v249
v_and_b32 v216,0xf0,v255
v_lshrrev_b32 v255,8,v255
v_lshl_add_u32 v216,v255,14,v216
v_add_u32 v217,768,v216
v_add_u32 v218,1536,v216
v_add_u32 v219,2304,v216
s_mul_hi_u32 s28,s24,254201
s_lshl_b32 s28,s28,16
s_add_u32 s18,s12,s28
s_addc_u32 s19,s13,0
s_nop 1
s_branch ItEK_r_w3
SLOW_w3:
s_nop 1
LG 0
s_add_u32 m0,s48,12672
s_nop 0
DM 250,16,0
s_add_u32 m0,m0,800
s_nop 0
DM 251,16,256
s_add_u32 m0,m0,800
s_nop 0
DM 252,16,512
s_add_u32 m0,m0,800
s_nop 0
DM 253,16,768
s_add_u32 s16,s16,16384
s_addc_u32 s17,s17,0
s_add_u32 m0,s49,12672
s_nop 0
DM 216,18,0
s_add_u32 m0,m0,800
s_nop 0
DM 217,18,256
s_add_u32 m0,m0,800
s_nop 0
DM 218,18,512
s_add_u32 m0,m0,800
s_nop 0
DM 219,18,768
s_add_u32 s18,s18,16384
s_addc_u32 s19,s19,0
v_subrev_u32 v230,135168,v249
v_lshrrev_b32 v230,4,v230
v_and_b32 v231,15,v230
v_lshrrev_b32 v230,4,v230
v_lshlrev_b32 v228,8,v231
v_lshl_add_u32 v228,v230,4,v228
v_lshlrev_b32 v229,10,v230
v_lshl_add_u32 v229,v231,1,v229
s_lshl_b32 s80,s34,17
s_add_u32 s72,s6,s80
s_addc_u32 s73,s7,0
s_sub_u32 s72,s72,3072
s_subb_u32 s73,s73,0
v_mov_b32 v232,0xff800000
v_mov_b32 v233,0xff800000
v_mov_b32 v234,0xff800000
v_mov_b32 v235,0xff800000
s_mov_b32 s80,0
SL1_w3:
global_load_dwordx4 v[152:155],v228,s[72:73] offset:0
global_load_dwordx4 v[156:159],v228,s[72:73] offset:64
global_load_dwordx4 v[160:163],v228,s[72:73] offset:128
global_load_dwordx4 v[164:167],v228,s[72:73] offset:192
s_waitcnt vmcnt(0)
v_mfma_f32_16x16x32_bf16 v[120:123],v[152:155],a[0:3],0
v_mfma_f32_16x16x32_bf16 v[120:123],v[156:159],a[12:15],v[120:123]
v_mfma_f32_16x16x32_bf16 v[120:123],v[160:163],a[24:27],v[120:123]
v_mfma_f32_16x16x32_bf16 v[120:123],v[164:167],a[36:39],v[120:123]
v_mfma_f32_16x16x32_bf16 v[124:127],v[152:155],a[4:7],0
v_mfma_f32_16x16x32_bf16 v[124:127],v[156:159],a[16:19],v[124:127]
v_mfma_f32_16x16x32_bf16 v[124:127],v[160:163],a[28:31],v[124:127]
v_mfma_f32_16x16x32_bf16 v[124:127],v[164:167],a[40:43],v[124:127]
v_mfma_f32_16x16x32_bf16 v[128:131],v[152:155],a[8:11],0
v_mfma_f32_16x16x32_bf16 v[128:131],v[156:159],a[20:23],v[128:131]
v_mfma_f32_16x16x32_bf16 v[128:131],v[160:163],a[32:35],v[128:131]
v_mfma_f32_16x16x32_bf16 v[128:131],v[164:167],a[44:47],v[128:131]
v_mfma_f32_16x16x32_bf16 v[132:135],v[152:155],a[224:227],0
v_mfma_f32_16x16x32_bf16 v[132:135],v[156:159],a[228:231],v[132:135]
v_mfma_f32_16x16x32_bf16 v[132:135],v[160:163],a[232:235],v[132:135]
v_mfma_f32_16x16x32_bf16 v[132:135],v[164:167],a[236:239],v[132:135]
v_max3_f32 v232,v232,v120,v121
v_max3_f32 v232,v232,v122,v123
v_max3_f32 v233,v233,v124,v125
v_max3_f32 v233,v233,v126,v127
v_max3_f32 v234,v234,v128,v129
v_max3_f32 v234,v234,v130,v131
s_nop 1
v_max3_f32 v235,v235,v132,v133
v_max3_f32 v235,v235,v134,v135
s_add_u32 s72,s72,4096
s_addc_u32 s73,s73,0
s_add_u32 s80,s80,1
s_cmp_lg_u32 s80,32
s_cbranch_scc1 SL1_w3
v_mov_b32 v200,v232
v_mov_b32 v201,v200
s_nop 1
v_permlane16_swap_b32 v200,v201
v_max_f32 v200,v200,v201
v_mov_b32 v201,v200
s_nop 1
v_permlane32_swap_b32 v200,v201
v_max_f32 v200,v200,v201
v_mul_f32 v200,-1.0,v200
v_mov_b32 v201,v200
v_mov_b32 v202,v200
v_mov_b32 v203,v200
v_mov_b32 v204,v233
v_mov_b32 v205,v204
s_nop 1
v_permlane16_swap_b32 v204,v205
v_max_f32 v204,v204,v205
v_mov_b32 v205,v204
s_nop 1
v_permlane32_swap_b32 v204,v205
v_max_f32 v204,v204,v205
v_mul_f32 v204,-1.0,v204
v_mov_b32 v205,v204
v_mov_b32 v206,v204
v_mov_b32 v207,v204
v_mov_b32 v208,v234
v_mov_b32 v209,v208
s_nop 1
v_permlane16_swap_b32 v208,v209
v_max_f32 v208,v208,v209
v_mov_b32 v209,v208
s_nop 1
v_permlane32_swap_b32 v208,v209
v_max_f32 v208,v208,v209
v_mul_f32 v208,-1.0,v208
v_mov_b32 v209,v208
v_mov_b32 v210,v208
v_mov_b32 v211,v208
v_mov_b32 v212,v235
v_mov_b32 v213,v212
s_nop 1
v_permlane16_swap_b32 v212,v213
v_max_f32 v212,v212,v213
v_mov_b32 v213,v212
s_nop 1
v_permlane32_swap_b32 v212,v213
v_max_f32 v212,v212,v213
v_mul_f32 v212,-1.0,v212
v_mov_b32 v213,v212
v_mov_b32 v214,v212
v_mov_b32 v215,v212
s_lshl_b32 s80,s34,17
s_add_u32 s72,s6,s80
s_addc_u32 s73,s7,0
s_sub_u32 s72,s72,3072
s_subb_u32 s73,s73,0
s_lshl_b32 s80,s34,17
s_add_u32 s76,s8,s80
s_addc_u32 s77,s9,0
s_sub_u32 s76,s76,3072
s_subb_u32 s77,s77,0
v_mov_b32 v0,0
v_mov_b32 v1,0
v_mov_b32 v2,0
v_mov_b32 v3,0
v_mov_b32 v4,0
v_mov_b32 v5,0
v_mov_b32 v6,0
v_mov_b32 v7,0
v_mov_b32 v8,0
v_mov_b32 v9,0
v_mov_b32 v10,0
v_mov_b32 v11,0
v_mov_b32 v12,0
v_mov_b32 v13,0
v_mov_b32 v14,0
v_mov_b32 v15,0
v_mov_b32 v16,0
v_mov_b32 v17,0
v_mov_b32 v18,0
v_mov_b32 v19,0
v_mov_b32 v20,0
v_mov_b32 v21,0
v_mov_b32 v22,0
v_mov_b32 v23,0
v_mov_b32 v24,0
v_mov_b32 v25,0
v_mov_b32 v26,0
v_mov_b32 v27,0
v_mov_b32 v28,0
v_mov_b32 v29,0
v_mov_b32 v30,0
v_mov_b32 v31,0
v_mov_b32 v32,0
v_mov_b32 v33,0
v_mov_b32 v34,0
v_mov_b32 v35,0
v_mov_b32 v36,0
v_mov_b32 v37,0
v_mov_b32 v38,0
v_mov_b32 v39,0
v_mov_b32 v40,0
v_mov_b32 v41,0
v_mov_b32 v42,0
v_mov_b32 v43,0
v_mov_b32 v44,0
v_mov_b32 v45,0
v_mov_b32 v46,0
v_mov_b32 v47,0
v_mov_b32 v48,0
v_mov_b32 v49,0
v_mov_b32 v50,0
v_mov_b32 v51,0
v_mov_b32 v52,0
v_mov_b32 v53,0
v_mov_b32 v54,0
v_mov_b32 v55,0
v_mov_b32 v56,0
v_mov_b32 v57,0
v_mov_b32 v58,0
v_mov_b32 v59,0
v_mov_b32 v60,0
v_mov_b32 v61,0
v_mov_b32 v62,0
v_mov_b32 v63,0
v_mov_b32 v64,0
v_mov_b32 v65,0
v_mov_b32 v66,0
v_mov_b32 v67,0
v_mov_b32 v68,0
v_mov_b32 v69,0
v_mov_b32 v70,0
v_mov_b32 v71,0
v_mov_b32 v72,0
v_mov_b32 v73,0
v_mov_b32 v74,0
v_mov_b32 v75,0
v_mov_b32 v76,0
v_mov_b32 v77,0
v_mov_b32 v78,0
v_mov_b32 v79,0
v_mov_b32 v80,0
v_mov_b32 v81,0
v_mov_b32 v82,0
v_mov_b32 v83,0
v_mov_b32 v84,0
v_mov_b32 v85,0
v_mov_b32 v86,0
v_mov_b32 v87,0
v_mov_b32 v88,0
v_mov_b32 v89,0
v_mov_b32 v90,0
v_mov_b32 v91,0
v_mov_b32 v92,0
v_mov_b32 v93,0
v_mov_b32 v94,0
v_mov_b32 v95,0
v_mov_b32 v96,0
v_mov_b32 v97,0
v_mov_b32 v98,0
v_mov_b32 v99,0
v_mov_b32 v100,0
v_mov_b32 v101,0
v_mov_b32 v102,0
v_mov_b32 v103,0
v_mov_b32 v104,0
v_mov_b32 v105,0
v_mov_b32 v106,0
v_mov_b32 v107,0
v_mov_b32 v108,0
v_mov_b32 v109,0
v_mov_b32 v110,0
v_mov_b32 v111,0
v_mov_b32 v112,0
v_mov_b32 v113,0
v_mov_b32 v114,0
v_mov_b32 v115,0
v_mov_b32 v116,0
v_mov_b32 v117,0
v_mov_b32 v118,0
v_mov_b32 v119,0
s_mov_b32 s80,0
SL2_w3:
s_add_u32 s74,s72,4096
s_addc_u32 s75,s73,0
s_add_u32 s78,s76,4096
s_addc_u32 s79,s77,0
global_load_dwordx4 v[152:155],v228,s[72:73] offset:0
global_load_dwordx4 v[156:159],v228,s[72:73] offset:64
global_load_dwordx4 v[160:163],v228,s[72:73] offset:128
global_load_dwordx4 v[164:167],v228,s[72:73] offset:192
global_load_dwordx4 v[168:171],v228,s[74:75] offset:0
global_load_dwordx4 v[172:175],v228,s[74:75] offset:64
global_load_dwordx4 v[176:179],v228,s[74:75] offset:128
global_load_dwordx4 v[180:183],v228,s[74:75] offset:192
s_waitcnt vmcnt(0)
v_mfma_f32_16x16x32_bf16 v[120:123],v[152:155],a[0:3],v[200:203]
v_mfma_f32_16x16x32_bf16 v[120:123],v[156:159],a[12:15],v[120:123]
v_mfma_f32_16x16x32_bf16 v[120:123],v[160:163],a[24:27],v[120:123]
v_mfma_f32_16x16x32_bf16 v[120:123],v[164:167],a[36:39],v[120:123]
v_mfma_f32_16x16x32_bf16 v[124:127],v[152:155],a[4:7],v[204:207]
v_mfma_f32_16x16x32_bf16 v[124:127],v[156:159],a[16:19],v[124:127]
v_mfma_f32_16x16x32_bf16 v[124:127],v[160:163],a[28:31],v[124:127]
v_mfma_f32_16x16x32_bf16 v[124:127],v[164:167],a[40:43],v[124:127]
v_mfma_f32_16x16x32_bf16 v[128:131],v[152:155],a[8:11],v[208:211]
v_mfma_f32_16x16x32_bf16 v[128:131],v[156:159],a[20:23],v[128:131]
v_mfma_f32_16x16x32_bf16 v[128:131],v[160:163],a[32:35],v[128:131]
v_mfma_f32_16x16x32_bf16 v[128:131],v[164:167],a[44:47],v[128:131]
v_mfma_f32_16x16x32_bf16 v[132:135],v[152:155],a[224:227],v[212:215]
v_mfma_f32_16x16x32_bf16 v[132:135],v[156:159],a[228:231],v[132:135]
v_mfma_f32_16x16x32_bf16 v[132:135],v[160:163],a[232:235],v[132:135]
v_mfma_f32_16x16x32_bf16 v[132:135],v[164:167],a[236:239],v[132:135]
v_mfma_f32_16x16x32_bf16 v[136:139],v[168:171],a[0:3],v[200:203]
v_mfma_f32_16x16x32_bf16 v[136:139],v[172:175],a[12:15],v[136:139]
v_mfma_f32_16x16x32_bf16 v[136:139],v[176:179],a[24:27],v[136:139]
v_mfma_f32_16x16x32_bf16 v[136:139],v[180:183],a[36:39],v[136:139]
v_mfma_f32_16x16x32_bf16 v[140:143],v[168:171],a[4:7],v[204:207]
v_mfma_f32_16x16x32_bf16 v[140:143],v[172:175],a[16:19],v[140:143]
v_mfma_f32_16x16x32_bf16 v[140:143],v[176:179],a[28:31],v[140:143]
v_mfma_f32_16x16x32_bf16 v[140:143],v[180:183],a[40:43],v[140:143]
v_mfma_f32_16x16x32_bf16 v[144:147],v[168:171],a[8:11],v[208:211]
v_mfma_f32_16x16x32_bf16 v[144:147],v[172:175],a[20:23],v[144:147]
v_mfma_f32_16x16x32_bf16 v[144:147],v[176:179],a[32:35],v[144:147]
v_mfma_f32_16x16x32_bf16 v[144:147],v[180:183],a[44:47],v[144:147]
v_mfma_f32_16x16x32_bf16 v[148:151],v[168:171],a[224:227],v[212:215]
v_mfma_f32_16x16x32_bf16 v[148:151],v[172:175],a[228:231],v[148:151]
v_mfma_f32_16x16x32_bf16 v[148:151],v[176:179],a[232:235],v[148:151]
v_mfma_f32_16x16x32_bf16 v[148:151],v[180:183],a[236:239],v[148:151]
EX 120
EX 121
EX 122
EX 123
EX 124
EX 125
EX 126
EX 127
EX 128
EX 129
EX 130
EX 131
EX 132
EX 133
EX 134
EX 135
EX 136
EX 137
EX 138
EX 139
EX 140
EX 141
EX 142
EX 143
EX 144
EX 145
EX 146
EX 147
EX 148
EX 149
EX 150
EX 151
CV 184,120,121
CV 185,122,123
CV 188,124,125
CV 189,126,127
CV 192,128,129
CV 193,130,131
CV 196,132,133
CV 197,134,135
CV 186,136,137
CV 187,138,139
CV 190,140,141
CV 191,142,143
CV 194,144,145
CV 195,146,147
CV 198,148,149
CV 199,150,151
global_load_ushort v236,v229,s[76:77] offset:0
global_load_ushort v237,v229,s[76:77] offset:256
global_load_ushort v238,v229,s[76:77] offset:512
global_load_ushort v239,v229,s[76:77] offset:768
global_load_ushort v240,v229,s[78:79] offset:0
global_load_ushort v241,v229,s[78:79] offset:256
global_load_ushort v242,v229,s[78:79] offset:512
global_load_ushort v243,v229,s[78:79] offset:768
s_waitcnt vmcnt(0)
v_lshl_or_b32 v224,v237,16,v236
v_lshl_or_b32 v225,v239,16,v238
v_lshl_or_b32 v226,v241,16,v240
v_lshl_or_b32 v227,v243,16,v242
s_nop 1
v_mfma_f32_16x16x32_bf16 v[0:3],v[224:227],v[184:187],v[0:3]
v_mfma_f32_16x16x32_bf16 v[4:7],v[224:227],v[188:191],v[4:7]
v_mfma_f32_16x16x32_bf16 v[8:11],v[224:227],v[192:195],v[8:11]
s_nop 1
global_load_ushort v236,v229,s[76:77] offset:32
global_load_ushort v237,v229,s[76:77] offset:288
global_load_ushort v238,v229,s[76:77] offset:544
global_load_ushort v239,v229,s[76:77] offset:800
global_load_ushort v240,v229,s[78:79] offset:32
global_load_ushort v241,v229,s[78:79] offset:288
global_load_ushort v242,v229,s[78:79] offset:544
global_load_ushort v243,v229,s[78:79] offset:800
s_waitcnt vmcnt(0)
v_lshl_or_b32 v224,v237,16,v236
v_lshl_or_b32 v225,v239,16,v238
v_lshl_or_b32 v226,v241,16,v240
v_lshl_or_b32 v227,v243,16,v242
s_nop 1
v_mfma_f32_16x16x32_bf16 v[12:15],v[224:227],v[184:187],v[12:15]
v_mfma_f32_16x16x32_bf16 v[16:19],v[224:227],v[188:191],v[16:19]
v_mfma_f32_16x16x32_bf16 v[20:23],v[224:227],v[192:195],v[20:23]
s_nop 1
global_load_ushort v236,v229,s[76:77] offset:64
global_load_ushort v237,v229,s[76:77] offset:320
global_load_ushort v238,v229,s[76:77] offset:576
global_load_ushort v239,v229,s[76:77] offset:832
global_load_ushort v240,v229,s[78:79] offset:64
global_load_ushort v241,v229,s[78:79] offset:320
global_load_ushort v242,v229,s[78:79] offset:576
global_load_ushort v243,v229,s[78:79] offset:832
s_waitcnt vmcnt(0)
v_lshl_or_b32 v224,v237,16,v236
v_lshl_or_b32 v225,v239,16,v238
v_lshl_or_b32 v226,v241,16,v240
v_lshl_or_b32 v227,v243,16,v242
s_nop 1
v_mfma_f32_16x16x32_bf16 v[24:27],v[224:227],v[184:187],v[24:27]
v_mfma_f32_16x16x32_bf16 v[28:31],v[224:227],v[188:191],v[28:31]
v_mfma_f32_16x16x32_bf16 v[32:35],v[224:227],v[192:195],v[32:35]
s_nop 1
global_load_ushort v236,v229,s[76:77] offset:96
global_load_ushort v237,v229,s[76:77] offset:352
global_load_ushort v238,v229,s[76:77] offset:608
global_load_ushort v239,v229,s[76:77] offset:864
global_load_ushort v240,v229,s[78:79] offset:96
global_load_ushort v241,v229,s[78:79] offset:352
global_load_ushort v242,v229,s[78:79] offset:608
global_load_ushort v243,v229,s[78:79] offset:864
s_waitcnt vmcnt(0)
v_lshl_or_b32 v224,v237,16,v236
v_lshl_or_b32 v225,v239,16,v238
v_lshl_or_b32 v226,v241,16,v240
v_lshl_or_b32 v227,v243,16,v242
s_nop 1
v_mfma_f32_16x16x32_bf16 v[36:39],v[224:227],v[184:187],v[36:39]
v_mfma_f32_16x16x32_bf16 v[40:43],v[224:227],v[188:191],v[40:43]
v_mfma_f32_16x16x32_bf16 v[44:47],v[224:227],v[192:195],v[44:47]
s_nop 1
global_load_ushort v236,v229,s[76:77] offset:128
global_load_ushort v237,v229,s[76:77] offset:384
global_load_ushort v238,v229,s[76:77] offset:640
global_load_ushort v239,v229,s[76:77] offset:896
global_load_ushort v240,v229,s[78:79] offset:128
global_load_ushort v241,v229,s[78:79] offset:384
global_load_ushort v242,v229,s[78:79] offset:640
global_load_ushort v243,v229,s[78:79] offset:896
s_waitcnt vmcnt(0)
v_lshl_or_b32 v224,v237,16,v236
v_lshl_or_b32 v225,v239,16,v238
v_lshl_or_b32 v226,v241,16,v240
v_lshl_or_b32 v227,v243,16,v242
s_nop 1
v_mfma_f32_16x16x32_bf16 v[48:51],v[224:227],v[184:187],v[48:51]
v_mfma_f32_16x16x32_bf16 v[52:55],v[224:227],v[188:191],v[52:55]
v_mfma_f32_16x16x32_bf16 v[56:59],v[224:227],v[192:195],v[56:59]
s_nop 1
global_load_ushort v236,v229,s[76:77] offset:160
global_load_ushort v237,v229,s[76:77] offset:416
global_load_ushort v238,v229,s[76:77] offset:672
global_load_ushort v239,v229,s[76:77] offset:928
global_load_ushort v240,v229,s[78:79] offset:160
global_load_ushort v241,v229,s[78:79] offset:416
global_load_ushort v242,v229,s[78:79] offset:672
global_load_ushort v243,v229,s[78:79] offset:928
s_waitcnt vmcnt(0)
v_lshl_or_b32 v224,v237,16,v236
v_lshl_or_b32 v225,v239,16,v238
v_lshl_or_b32 v226,v241,16,v240
v_lshl_or_b32 v227,v243,16,v242
s_nop 1
v_mfma_f32_16x16x32_bf16 v[60:63],v[224:227],v[184:187],v[60:63]
v_mfma_f32_16x16x32_bf16 v[64:67],v[224:227],v[188:191],v[64:67]
v_mfma_f32_16x16x32_bf16 v[68:71],v[224:227],v[192:195],v[68:71]
s_nop 1
global_load_ushort v236,v229,s[76:77] offset:192
global_load_ushort v237,v229,s[76:77] offset:448
global_load_ushort v238,v229,s[76:77] offset:704
global_load_ushort v239,v229,s[76:77] offset:960
global_load_ushort v240,v229,s[78:79] offset:192
global_load_ushort v241,v229,s[78:79] offset:448
global_load_ushort v242,v229,s[78:79] offset:704
global_load_ushort v243,v229,s[78:79] offset:960
s_waitcnt vmcnt(0)
v_lshl_or_b32 v224,v237,16,v236
v_lshl_or_b32 v225,v239,16,v238
v_lshl_or_b32 v226,v241,16,v240
v_lshl_or_b32 v227,v243,16,v242
s_nop 1
v_mfma_f32_16x16x32_bf16 v[72:75],v[224:227],v[184:187],v[72:75]
v_mfma_f32_16x16x32_bf16 v[76:79],v[224:227],v[188:191],v[76:79]
v_mfma_f32_16x16x32_bf16 v[80:83],v[224:227],v[192:195],v[80:83]
v_mfma_f32_16x16x32_bf16 v[96:99],v[224:227],v[196:199],v[96:99]
s_nop 1
global_load_ushort v236,v229,s[76:77] offset:224
global_load_ushort v237,v229,s[76:77] offset:480
global_load_ushort v238,v229,s[76:77] offset:736
global_load_ushort v239,v229,s[76:77] offset:992
global_load_ushort v240,v229,s[78:79] offset:224
global_load_ushort v241,v229,s[78:79] offset:480
global_load_ushort v242,v229,s[78:79] offset:736
global_load_ushort v243,v229,s[78:79] offset:992
s_waitcnt vmcnt(0)
v_lshl_or_b32 v224,v237,16,v236
v_lshl_or_b32 v225,v239,16,v238
v_lshl_or_b32 v226,v241,16,v240
v_lshl_or_b32 v227,v243,16,v242
s_nop 1
v_mfma_f32_16x16x32_bf16 v[84:87],v[224:227],v[184:187],v[84:87]
v_mfma_f32_16x16x32_bf16 v[88:91],v[224:227],v[188:191],v[88:91]
v_mfma_f32_16x16x32_bf16 v[92:95],v[224:227],v[192:195],v[92:95]
v_mfma_f32_16x16x32_bf16 v[100:103],v[224:227],v[196:199],v[100:103]
s_nop 1
v_mfma_f32_16x16x32_bf16 v[104:107],a[240:243],v[184:187],v[104:107]
v_mfma_f32_16x16x32_bf16 v[108:111],a[240:243],v[188:191],v[108:111]
v_mfma_f32_16x16x32_bf16 v[112:115],a[240:243],v[192:195],v[112:115]
v_mfma_f32_16x16x32_bf16 v[116:119],a[240:243],v[196:199],v[116:119]
s_add_u32 s72,s72,8192
s_addc_u32 s73,s73,0
s_add_u32 s76,s76,8192
s_addc_u32 s77,s77,0
s_add_u32 s80,s80,1
s_cmp_lg_u32 s80,16
s_cbranch_scc1 SL2_w3
s_nop 7
s_nop 7
v_rcp_f32 v224,v104
v_rcp_f32 v226,v108
v_rcp_f32 v228,v112
v_rcp_f32 v230,v116
v_pk_mul_f32 v[0:1],v[0:1],v[224:225] op_sel_hi:[1,0]
v_pk_mul_f32 v[2:3],v[2:3],v[224:225] op_sel_hi:[1,0]
v_pk_mul_f32 v[12:13],v[12:13],v[224:225] op_sel_hi:[1,0]
v_pk_mul_f32 v[14:15],v[14:15],v[224:225] op_sel_hi:[1,0]
CV 0,0,1
CV 1,2,3
CV 2,12,13
CV 3,14,15
v_pk_mul_f32 v[4:5],v[4:5],v[226:227] op_sel_hi:[1,0]
v_pk_mul_f32 v[6:7],v[6:7],v[226:227] op_sel_hi:[1,0]
v_pk_mul_f32 v[16:17],v[16:17],v[226:227] op_sel_hi:[1,0]
v_pk_mul_f32 v[18:19],v[18:19],v[226:227] op_sel_hi:[1,0]
CV 4,4,5
CV 5,6,7
CV 6,16,17
CV 7,18,19
v_pk_mul_f32 v[8:9],v[8:9],v[228:229] op_sel_hi:[1,0]
v_pk_mul_f32 v[10:11],v[10:11],v[228:229] op_sel_hi:[1,0]
v_pk_mul_f32 v[20:21],v[20:21],v[228:229] op_sel_hi:[1,0]
v_pk_mul_f32 v[22:23],v[22:23],v[228:229] op_sel_hi:[1,0]
CV 8,8,9
CV 9,10,11
CV 10,20,21
CV 11,22,23
v_pk_mul_f32 v[24:25],v[24:25],v[224:225] op_sel_hi:[1,0]
v_pk_mul_f32 v[26:27],v[26:27],v[224:225] op_sel_hi:[1,0]
v_pk_mul_f32 v[36:37],v[36:37],v[224:225] op_sel_hi:[1,0]
v_pk_mul_f32 v[38:39],v[38:39],v[224:225] op_sel_hi:[1,0]
CV 24,24,25
CV 25,26,27
CV 26,36,37
CV 27,38,39
v_pk_mul_f32 v[28:29],v[28:29],v[226:227] op_sel_hi:[1,0]
v_pk_mul_f32 v[30:31],v[30:31],v[226:227] op_sel_hi:[1,0]
v_pk_mul_f32 v[40:41],v[40:41],v[226:227] op_sel_hi:[1,0]
v_pk_mul_f32 v[42:43],v[42:43],v[226:227] op_sel_hi:[1,0]
CV 28,28,29
CV 29,30,31
CV 30,40,41
CV 31,42,43
v_pk_mul_f32 v[32:33],v[32:33],v[228:229] op_sel_hi:[1,0]
v_pk_mul_f32 v[34:35],v[34:35],v[228:229] op_sel_hi:[1,0]
v_pk_mul_f32 v[44:45],v[44:45],v[228:229] op_sel_hi:[1,0]
v_pk_mul_f32 v[46:47],v[46:47],v[228:229] op_sel_hi:[1,0]
CV 32,32,33
CV 33,34,35
CV 34,44,45
CV 35,46,47
v_pk_mul_f32 v[48:49],v[48:49],v[224:225] op_sel_hi:[1,0]
v_pk_mul_f32 v[50:51],v[50:51],v[224:225] op_sel_hi:[1,0]
v_pk_mul_f32 v[60:61],v[60:61],v[224:225] op_sel_hi:[1,0]
v_pk_mul_f32 v[62:63],v[62:63],v[224:225] op_sel_hi:[1,0]
CV 48,48,49
CV 49,50,51
CV 50,60,61
CV 51,62,63
v_pk_mul_f32 v[52:53],v[52:53],v[226:227] op_sel_hi:[1,0]
v_pk_mul_f32 v[54:55],v[54:55],v[226:227] op_sel_hi:[1,0]
v_pk_mul_f32 v[64:65],v[64:65],v[226:227] op_sel_hi:[1,0]
v_pk_mul_f32 v[66:67],v[66:67],v[226:227] op_sel_hi:[1,0]
CV 52,52,53
CV 53,54,55
CV 54,64,65
CV 55,66,67
v_pk_mul_f32 v[56:57],v[56:57],v[228:229] op_sel_hi:[1,0]
v_pk_mul_f32 v[58:59],v[58:59],v[228:229] op_sel_hi:[1,0]
v_pk_mul_f32 v[68:69],v[68:69],v[228:229] op_sel_hi:[1,0]
v_pk_mul_f32 v[70:71],v[70:71],v[228:229] op_sel_hi:[1,0]
CV 56,56,57
CV 57,58,59
CV 58,68,69
CV 59,70,71
v_pk_mul_f32 v[72:73],v[72:73],v[224:225] op_sel_hi:[1,0]
v_pk_mul_f32 v[74:75],v[74:75],v[224:225] op_sel_hi:[1,0]
v_pk_mul_f32 v[84:85],v[84:85],v[224:225] op_sel_hi:[1,0]
v_pk_mul_f32 v[86:87],v[86:87],v[224:225] op_sel_hi:[1,0]
CV 72,72,73
CV 73,74,75
CV 74,84,85
CV 75,86,87
v_pk_mul_f32 v[76:77],v[76:77],v[226:227] op_sel_hi:[1,0]
v_pk_mul_f32 v[78:79],v[78:79],v[226:227] op_sel_hi:[1,0]
v_pk_mul_f32 v[88:89],v[88:89],v[226:227] op_sel_hi:[1,0]
v_pk_mul_f32 v[90:91],v[90:91],v[226:227] op_sel_hi:[1,0]
CV 76,76,77
CV 77,78,79
CV 78,88,89
CV 79,90,91
v_pk_mul_f32 v[80:81],v[80:81],v[228:229] op_sel_hi:[1,0]
v_pk_mul_f32 v[82:83],v[82:83],v[228:229] op_sel_hi:[1,0]
v_pk_mul_f32 v[92:93],v[92:93],v[228:229] op_sel_hi:[1,0]
v_pk_mul_f32 v[94:95],v[94:95],v[228:229] op_sel_hi:[1,0]
CV 80,80,81
CV 81,82,83
CV 82,92,93
CV 83,94,95
v_pk_mul_f32 v[96:97],v[96:97],v[230:231] op_sel_hi:[1,0]
v_pk_mul_f32 v[98:99],v[98:99],v[230:231] op_sel_hi:[1,0]
v_pk_mul_f32 v[100:101],v[100:101],v[230:231] op_sel_hi:[1,0]
v_pk_mul_f32 v[102:103],v[102:103],v[230:231] op_sel_hi:[1,0]
CV 96,96,97
CV 97,98,99
CV 98,100,101
CV 99,102,103
s_nop 1
s_branch SLOW_r_w3
Calt1_w3:
s_nop 1
v_mov_b32 v250,0
v_mov_b32 v251,0
v_mov_b32 v252,0
v_mov_b32 v253,0
s_add_u32 s16,s12,0
s_addc_u32 s17,s13,0
s_add_u32 s18,s12,0
s_addc_u32 s19,s13,0
s_nop 1
s_branch Calt1_r_w3
Calt2_w3:
s_nop 1
s_add_u32 s16,s12,0
s_addc_u32 s17,s13,0
s_add_u32 s18,s12,0
s_addc_u32 s19,s13,0
s_nop 1
s_branch Calt2_r_w3
Calt3_w3:
s_nop 1
s_add_u32 s16,s12,0
s_addc_u32 s17,s13,0
s_add_u32 s18,s12,0
s_addc_u32 s19,s13,0
s_nop 1
s_branch Calt3_r_w3
Calt4_w3:
s_nop 1
s_add_u32 s16,s12,0
s_addc_u32 s17,s13,0
s_add_u32 s18,s12,0
s_addc_u32 s19,s13,0
s_nop 1
s_branch Calt4_r_w3
.text
.globl mha_reduce_kernel
.p2align 8
.type mha_reduce_kernel,@function
mha_reduce_kernel:
s_cmp_ge_u32 s2,832
s_cbranch_scc1 RED_END
s_load_dwordx2 s[4:5],s[0:1],56
s_load_dwordx2 s[6:7],s[0:1],40
v_lshrrev_b32 v1,6,v0
s_nop 0
v_readfirstlane_b32 s8,v1
s_lshl_b32 s9,s2,2
s_nop 2
s_add_u32 s8,s8,s9
s_mul_hi_u32 s10,s8,41297763
s_mul_i32 s11,s10,104
s_sub_u32 s11,s8,s11
s_mul_hi_u32 s12,s11,165191050
s_mul_i32 s13,s12,26
s_sub_u32 s13,s11,s13
s_mul_i32 s14,s10,1703936
s_mul_i32 s15,s12,53248
s_add_u32 s14,s14,s15
s_lshl_b32 s15,s13,11
s_add_u32 s14,s14,s15
v_and_b32 v2,63,v0
v_lshlrev_b32 v3,4,v2
s_waitcnt lgkmcnt(0)
s_add_u32 s4,s4,s14
s_addc_u32 s5,s5,0
global_load_dwordx4 v[8:11],v3,s[4:5]
global_load_dwordx4 v[12:15],v3,s[4:5] offset:1024
s_add_u32 s4,s4,212992
s_addc_u32 s5,s5,0
global_load_dwordx4 v[16:19],v3,s[4:5]
global_load_dwordx4 v[20:23],v3,s[4:5] offset:1024
s_add_u32 s4,s4,212992
s_addc_u32 s5,s5,0
global_load_dwordx4 v[24:27],v3,s[4:5]
global_load_dwordx4 v[28:31],v3,s[4:5] offset:1024
s_add_u32 s4,s4,212992
s_addc_u32 s5,s5,0
global_load_dwordx4 v[32:35],v3,s[4:5]
global_load_dwordx4 v[36:39],v3,s[4:5] offset:1024
s_add_u32 s4,s4,212992
s_addc_u32 s5,s5,0
global_load_dwordx4 v[40:43],v3,s[4:5]
global_load_dwordx4 v[44:47],v3,s[4:5] offset:1024
s_add_u32 s4,s4,212992
s_addc_u32 s5,s5,0
global_load_dwordx4 v[48:51],v3,s[4:5]
global_load_dwordx4 v[52:55],v3,s[4:5] offset:1024
s_add_u32 s4,s4,212992
s_addc_u32 s5,s5,0
global_load_dwordx4 v[56:59],v3,s[4:5]
global_load_dwordx4 v[60:63],v3,s[4:5] offset:1024
s_add_u32 s4,s4,212992
s_addc_u32 s5,s5,0
global_load_dwordx4 v[64:67],v3,s[4:5]
global_load_dwordx4 v[68:71],v3,s[4:5] offset:1024
s_lshr_b32 s16,s13,1
s_and_b32 s17,s13,1
s_mul_i32 s18,s10,208
s_lshl_b32 s16,s16,4
s_add_u32 s18,s18,s16
s_lshl_b32 s18,s18,10
s_lshl_b32 s19,s12,8
s_add_u32 s18,s18,s19
s_lshl_b32 s19,s17,7
s_add_u32 s18,s18,s19
s_add_u32 s6,s6,s18
s_addc_u32 s7,s7,0
v_and_b32 v4,15,v2
v_lshlrev_b32 v4,7,v4
v_lshrrev_b32 v5,4,v2
v_lshl_add_u32 v4,v5,4,v4
v_lshlrev_b32 v5,11,v1
v_add_u32 v4,v4,v5
v_add_u32 v100,v3,v5
v_lshrrev_b32 v101,3,v2
v_lshlrev_b32 v101,10,v101
v_and_b32 v102,7,v2
v_lshl_add_u32 v101,v102,4,v101
s_mov_b32 s20,0xffff0000
s_waitcnt vmcnt(14)
v_lshlrev_b32 v72,16,v8
v_and_b32 v73,s20,v8
v_lshlrev_b32 v74,16,v9
v_and_b32 v75,s20,v9
v_lshlrev_b32 v76,16,v10
v_and_b32 v77,s20,v10
v_lshlrev_b32 v78,16,v11
v_and_b32 v79,s20,v11
v_lshlrev_b32 v80,16,v12
v_and_b32 v81,s20,v12
v_lshlrev_b32 v82,16,v13
v_and_b32 v83,s20,v13
v_lshlrev_b32 v84,16,v14
v_and_b32 v85,s20,v14
v_lshlrev_b32 v86,16,v15
v_and_b32 v87,s20,v15
s_waitcnt vmcnt(12)
v_lshlrev_b32 v6,16,v16
v_and_b32 v7,s20,v16
v_add_f32 v72,v72,v6
v_add_f32 v73,v73,v7
v_lshlrev_b32 v6,16,v17
v_and_b32 v7,s20,v17
v_add_f32 v74,v74,v6
v_add_f32 v75,v75,v7
v_lshlrev_b32 v6,16,v18
v_and_b32 v7,s20,v18
v_add_f32 v76,v76,v6
v_add_f32 v77,v77,v7
v_lshlrev_b32 v6,16,v19
v_and_b32 v7,s20,v19
v_add_f32 v78,v78,v6
v_add_f32 v79,v79,v7
v_lshlrev_b32 v6,16,v20
v_and_b32 v7,s20,v20
v_add_f32 v80,v80,v6
v_add_f32 v81,v81,v7
v_lshlrev_b32 v6,16,v21
v_and_b32 v7,s20,v21
v_add_f32 v82,v82,v6
v_add_f32 v83,v83,v7
v_lshlrev_b32 v6,16,v22
v_and_b32 v7,s20,v22
v_add_f32 v84,v84,v6
v_add_f32 v85,v85,v7
v_lshlrev_b32 v6,16,v23
v_and_b32 v7,s20,v23
v_add_f32 v86,v86,v6
v_add_f32 v87,v87,v7
s_waitcnt vmcnt(10)
v_lshlrev_b32 v6,16,v24
v_and_b32 v7,s20,v24
v_add_f32 v72,v72,v6
v_add_f32 v73,v73,v7
v_lshlrev_b32 v6,16,v25
v_and_b32 v7,s20,v25
v_add_f32 v74,v74,v6
v_add_f32 v75,v75,v7
v_lshlrev_b32 v6,16,v26
v_and_b32 v7,s20,v26
v_add_f32 v76,v76,v6
v_add_f32 v77,v77,v7
v_lshlrev_b32 v6,16,v27
v_and_b32 v7,s20,v27
v_add_f32 v78,v78,v6
v_add_f32 v79,v79,v7
v_lshlrev_b32 v6,16,v28
v_and_b32 v7,s20,v28
v_add_f32 v80,v80,v6
v_add_f32 v81,v81,v7
v_lshlrev_b32 v6,16,v29
v_and_b32 v7,s20,v29
v_add_f32 v82,v82,v6
v_add_f32 v83,v83,v7
v_lshlrev_b32 v6,16,v30
v_and_b32 v7,s20,v30
v_add_f32 v84,v84,v6
v_add_f32 v85,v85,v7
v_lshlrev_b32 v6,16,v31
v_and_b32 v7,s20,v31
v_add_f32 v86,v86,v6
v_add_f32 v87,v87,v7
s_waitcnt vmcnt(8)
v_lshlrev_b32 v6,16,v32
v_and_b32 v7,s20,v32
v_add_f32 v72,v72,v6
v_add_f32 v73,v73,v7
v_lshlrev_b32 v6,16,v33
v_and_b32 v7,s20,v33
v_add_f32 v74,v74,v6
v_add_f32 v75,v75,v7
v_lshlrev_b32 v6,16,v34
v_and_b32 v7,s20,v34
v_add_f32 v76,v76,v6
v_add_f32 v77,v77,v7
v_lshlrev_b32 v6,16,v35
v_and_b32 v7,s20,v35
v_add_f32 v78,v78,v6
v_add_f32 v79,v79,v7
v_lshlrev_b32 v6,16,v36
v_and_b32 v7,s20,v36
v_add_f32 v80,v80,v6
v_add_f32 v81,v81,v7
v_lshlrev_b32 v6,16,v37
v_and_b32 v7,s20,v37
v_add_f32 v82,v82,v6
v_add_f32 v83,v83,v7
v_lshlrev_b32 v6,16,v38
v_and_b32 v7,s20,v38
v_add_f32 v84,v84,v6
v_add_f32 v85,v85,v7
v_lshlrev_b32 v6,16,v39
v_and_b32 v7,s20,v39
v_add_f32 v86,v86,v6
v_add_f32 v87,v87,v7
s_waitcnt vmcnt(6)
v_lshlrev_b32 v6,16,v40
v_and_b32 v7,s20,v40
v_add_f32 v72,v72,v6
v_add_f32 v73,v73,v7
v_lshlrev_b32 v6,16,v41
v_and_b32 v7,s20,v41
v_add_f32 v74,v74,v6
v_add_f32 v75,v75,v7
v_lshlrev_b32 v6,16,v42
v_and_b32 v7,s20,v42
v_add_f32 v76,v76,v6
v_add_f32 v77,v77,v7
v_lshlrev_b32 v6,16,v43
v_and_b32 v7,s20,v43
v_add_f32 v78,v78,v6
v_add_f32 v79,v79,v7
v_lshlrev_b32 v6,16,v44
v_and_b32 v7,s20,v44
v_add_f32 v80,v80,v6
v_add_f32 v81,v81,v7
v_lshlrev_b32 v6,16,v45
v_and_b32 v7,s20,v45
v_add_f32 v82,v82,v6
v_add_f32 v83,v83,v7
v_lshlrev_b32 v6,16,v46
v_and_b32 v7,s20,v46
v_add_f32 v84,v84,v6
v_add_f32 v85,v85,v7
v_lshlrev_b32 v6,16,v47
v_and_b32 v7,s20,v47
v_add_f32 v86,v86,v6
v_add_f32 v87,v87,v7
s_waitcnt vmcnt(4)
v_lshlrev_b32 v6,16,v48
v_and_b32 v7,s20,v48
v_add_f32 v72,v72,v6
v_add_f32 v73,v73,v7
v_lshlrev_b32 v6,16,v49
v_and_b32 v7,s20,v49
v_add_f32 v74,v74,v6
v_add_f32 v75,v75,v7
v_lshlrev_b32 v6,16,v50
v_and_b32 v7,s20,v50
v_add_f32 v76,v76,v6
v_add_f32 v77,v77,v7
v_lshlrev_b32 v6,16,v51
v_and_b32 v7,s20,v51
v_add_f32 v78,v78,v6
v_add_f32 v79,v79,v7
v_lshlrev_b32 v6,16,v52
v_and_b32 v7,s20,v52
v_add_f32 v80,v80,v6
v_add_f32 v81,v81,v7
v_lshlrev_b32 v6,16,v53
v_and_b32 v7,s20,v53
v_add_f32 v82,v82,v6
v_add_f32 v83,v83,v7
v_lshlrev_b32 v6,16,v54
v_and_b32 v7,s20,v54
v_add_f32 v84,v84,v6
v_add_f32 v85,v85,v7
v_lshlrev_b32 v6,16,v55
v_and_b32 v7,s20,v55
v_add_f32 v86,v86,v6
v_add_f32 v87,v87,v7
s_waitcnt vmcnt(2)
v_lshlrev_b32 v6,16,v56
v_and_b32 v7,s20,v56
v_add_f32 v72,v72,v6
v_add_f32 v73,v73,v7
v_lshlrev_b32 v6,16,v57
v_and_b32 v7,s20,v57
v_add_f32 v74,v74,v6
v_add_f32 v75,v75,v7
v_lshlrev_b32 v6,16,v58
v_and_b32 v7,s20,v58
v_add_f32 v76,v76,v6
v_add_f32 v77,v77,v7
v_lshlrev_b32 v6,16,v59
v_and_b32 v7,s20,v59
v_add_f32 v78,v78,v6
v_add_f32 v79,v79,v7
v_lshlrev_b32 v6,16,v60
v_and_b32 v7,s20,v60
v_add_f32 v80,v80,v6
v_add_f32 v81,v81,v7
v_lshlrev_b32 v6,16,v61
v_and_b32 v7,s20,v61
v_add_f32 v82,v82,v6
v_add_f32 v83,v83,v7
v_lshlrev_b32 v6,16,v62
v_and_b32 v7,s20,v62
v_add_f32 v84,v84,v6
v_add_f32 v85,v85,v7
v_lshlrev_b32 v6,16,v63
v_and_b32 v7,s20,v63
v_add_f32 v86,v86,v6
v_add_f32 v87,v87,v7
s_waitcnt vmcnt(0)
v_lshlrev_b32 v6,16,v64
v_and_b32 v7,s20,v64
v_add_f32 v72,v72,v6
v_add_f32 v73,v73,v7
v_lshlrev_b32 v6,16,v65
v_and_b32 v7,s20,v65
v_add_f32 v74,v74,v6
v_add_f32 v75,v75,v7
v_lshlrev_b32 v6,16,v66
v_and_b32 v7,s20,v66
v_add_f32 v76,v76,v6
v_add_f32 v77,v77,v7
v_lshlrev_b32 v6,16,v67
v_and_b32 v7,s20,v67
v_add_f32 v78,v78,v6
v_add_f32 v79,v79,v7
v_lshlrev_b32 v6,16,v68
v_and_b32 v7,s20,v68
v_add_f32 v80,v80,v6
v_add_f32 v81,v81,v7
v_lshlrev_b32 v6,16,v69
v_and_b32 v7,s20,v69
v_add_f32 v82,v82,v6
v_add_f32 v83,v83,v7
v_lshlrev_b32 v6,16,v70
v_and_b32 v7,s20,v70
v_add_f32 v84,v84,v6
v_add_f32 v85,v85,v7
v_lshlrev_b32 v6,16,v71
v_and_b32 v7,s20,v71
v_add_f32 v86,v86,v6
v_add_f32 v87,v87,v7
v_cvt_pk_bf16_f32 v88,v72,v73
v_cvt_pk_bf16_f32 v89,v74,v75
v_cvt_pk_bf16_f32 v90,v76,v77
v_cvt_pk_bf16_f32 v91,v78,v79
v_cvt_pk_bf16_f32 v92,v80,v81
v_cvt_pk_bf16_f32 v93,v82,v83
v_cvt_pk_bf16_f32 v94,v84,v85
v_cvt_pk_bf16_f32 v95,v86,v87
s_nop 1
v_permlane32_swap_b32 v88,v90
v_permlane32_swap_b32 v89,v91
v_permlane32_swap_b32 v92,v94
v_permlane32_swap_b32 v93,v95
s_nop 1
v_permlane16_swap_b32 v88,v90
v_permlane16_swap_b32 v89,v91
v_permlane16_swap_b32 v92,v94
v_permlane16_swap_b32 v93,v95
s_nop 1
ds_write_b128 v4,v[88:91]
ds_write_b128 v4,v[92:95] offset:64
s_waitcnt lgkmcnt(0)
ds_read_b128 v[88:91],v100
ds_read_b128 v[92:95],v100 offset:1024
s_waitcnt lgkmcnt(1)
global_store_dwordx4 v101,v[88:91],s[6:7]
s_add_u32 s6,s6,8192
s_addc_u32 s7,s7,0
s_waitcnt lgkmcnt(0)
global_store_dwordx4 v101,v[92:95],s[6:7]
RED_END:
s_endpgm

CODE_END:
.section .rodata,"a"
.p2align 6
.amdhsa_kernel mha_main_kernel
  .amdhsa_next_free_vgpr 512
  .amdhsa_next_free_sgpr 96
  .amdhsa_accum_offset 256
  .amdhsa_group_segment_fixed_size 0
  .amdhsa_kernarg_size 64
  .amdhsa_user_sgpr_count 2
  .amdhsa_user_sgpr_kernarg_segment_ptr 1
  .amdhsa_system_sgpr_workgroup_id_x 1
  .amdhsa_float_denorm_mode_32 3
.end_amdhsa_kernel

.section .rodata,"a"
.p2align 6
.amdhsa_kernel mha_reduce_kernel
  .amdhsa_next_free_vgpr 104
  .amdhsa_next_free_sgpr 32
  .amdhsa_accum_offset 104
  .amdhsa_group_segment_fixed_size 0
  .amdhsa_kernarg_size 64
  .amdhsa_user_sgpr_count 2
  .amdhsa_user_sgpr_kernarg_segment_ptr 1
  .amdhsa_system_sgpr_workgroup_id_x 1
  .amdhsa_float_denorm_mode_32 3
.end_amdhsa_kernel
```
